```python
import torch

def _softmax(x, axis=-1):
    return torch.softmax(x, dim=axis)
def _gelu(x):
    return torch.nn.functional.gelu(x, approximate="tanh")
def _silu(x):
    return torch.nn.functional.silu(x)
def _sigmoid(x):
    return torch.sigmoid(x)
def _layernorm(x, axis=-1, eps=1e-5):
    m = x.mean(dim=axis, keepdim=True)
    v = x.var(dim=axis, keepdim=True, unbiased=False)
    return (x - m) / torch.sqrt(v + eps)
def _scatter_add(tgt, idx, src, axis=0):
    return tgt.clone().index_add_(axis, idx, src)
def _segment_sum(src, seg, n):
    out = torch.zeros((n,) + src.shape[1:], dtype=src.dtype)
    return out.index_add_(0, seg, src)
def _pad(x, pw):
    flat = tuple(v for pair in reversed(pw) for v in pair)
    return torch.nn.functional.pad(x, flat)

kernel_name = 'parallel_sum__grouped_kv_mqa__glu_gated_reglu__prompt'

def setup_inputs():

    _w = (lambda a: (lambda t: t.to(torch.bfloat16) if t.is_floating_point() else t)(torch.as_tensor(a)))
    def _A_setup():
        B, S, D, H = 1, 2048, 1024, 32
        Dh = D // H
        return {
            "x": _w((lambda *s: torch.randn(*s, dtype=torch.bfloat16) * 0.05)(B, S, D)),
            "wq": _w((lambda *s: torch.randn(*s, dtype=torch.bfloat16) * 0.05)(D, H * Dh)),
            "wk": _w((lambda *s: torch.randn(*s, dtype=torch.bfloat16) * 0.05)(D, Dh)),
            "wv": _w((lambda *s: torch.randn(*s, dtype=torch.bfloat16) * 0.05)(D, Dh)),
            "wo": _w((lambda *s: torch.randn(*s, dtype=torch.bfloat16) * 0.05)(H * Dh, D)),
        }
    _A_in = _A_setup()

    def _B_setup():
        B, S, D, F = 1, 2048, 1024, 3584
        return {
            "x": _w((lambda *s: torch.randn(*s, dtype=torch.bfloat16) * 0.05)(B, S, D)),
            "W_gate": _w((lambda *s: torch.randn(*s, dtype=torch.bfloat16) * 0.8)(D, F) * (2.0 / D) ** 0.5),
            "W_up": _w((lambda *s: torch.randn(*s, dtype=torch.bfloat16) * 0.8)(D, F) * (2.0 / D) ** 0.5),
            "W_down": _w((lambda *s: torch.randn(*s, dtype=torch.bfloat16) * 0.8)(F, D) * (1.0 / F) ** 0.5),
        }
    _B_in = _B_setup()

    return {
        "A_x": _A_in["x"],
        "A_wq": _A_in["wq"],
        "A_wk": _A_in["wk"],
        "A_wv": _A_in["wv"],
        "A_wo": _A_in["wo"],
        "B_x": _B_in["x"],
        "B_W_gate": _B_in["W_gate"],
        "B_W_up": _B_in["W_up"],
        "B_W_down": _B_in["W_down"],
    }

def reference(A_x, A_wq, A_wk, A_wv, A_wo, B_x, B_W_gate, B_W_up, B_W_down):
    def _A_ref(x, wq, wk, wv, wo):
        B, S, D = x.shape
        H = 32
        Dh = D // H
        q = (lambda x, *d: x.permute(*d))((x @ wq).reshape(B, S, H, Dh), 0, 2, 1, 3)
        k = x @ wk
        v = x @ wv
        scores = torch.einsum("bhqd,bkd->bhqk", q, k) * (Dh ** -0.5)
        p = _softmax(scores, axis=-1)
        o = torch.einsum("bhqk,bkd->bhqd", p, v)
        return (lambda x, *d: x.permute(*d))(o, 0, 2, 1, 3).reshape(B, S, H * Dh) @ wo

    def _B_ref(x, W_gate, W_up, W_down):
        gate = torch.einsum("bsd,df->bsf", x, W_gate)
        up = torch.einsum("bsd,df->bsf", x, W_up)
        gate = gate * (lambda x, dt: x.to(dt))(gate > 0, gate.dtype)
        h = gate * up
        return torch.einsum("bsf,fd->bsd", h, W_down)

    x = A_x
    xn = _layernorm(x, axis=-1)
    return x + _A_ref(xn, A_wq, A_wk, A_wv, A_wo) + _B_ref(xn, B_W_gate, B_W_up, B_W_down)
```

```asm
; @launch grid=(256,1,1) block=(512,1,1) lds=163840
.amdgcn_target "amdgcn-amd-amdhsa--gfx950"
.text
.globl parallel_sum__grouped_kv_mqa__glu_gated_reglu__prompt_kernel
.p2align 8
.type parallel_sum__grouped_kv_mqa__glu_gated_reglu__prompt_kernel,@function
parallel_sum__grouped_kv_mqa__glu_gated_reglu__prompt_kernel:
    s_cmp_ge_u32 s2, 256
    s_cbranch_scc1 KM_END
    s_mov_b32 s100, s2
    s_getreg_b32 s3, hwreg(HW_REG_XCC_ID)
    s_and_b32 s3, s3, 1
    s_andn2_b32 s2, s2, 1
    s_or_b32 s2, s2, s3
KM_AGAIN:
    s_load_dwordx2 s[44:45], s[0:1], 0
    s_load_dwordx8 s[36:43], s[0:1], 48
    s_load_dwordx8 s[92:99], s[0:1], 8
    s_load_dwordx2 s[6:7], s[0:1], 88
    s_getpc_b64 s[34:35]
PF_BASE:
    s_lshr_b32 s32, s2, 3
    s_lshl_b32 s32, s32, 12
    v_lshrrev_b32 v101, 3, v0
    v_lshlrev_b32 v101, 6, v101
    v_add_u32 v101, s32, v101
    v_min_u32 v101, KM_END - PF_BASE, v101
    global_load_dword v18, v101, s[34:35]
    v_lshrrev_b32 v100, 6, v0
    v_and_b32 v1, 63, v0
    v_mov_b32 v31, v0
    v_readfirstlane_b32 s3, v100
    v_lshlrev_b32 v19, 4, v1
    v_lshrrev_b32 v16, 4, v1
    v_and_b32 v17, 15, v1
    s_lshr_b32 s51, s2, 1
    s_lshl_b32 s23, s3, 11
    s_and_b32 s54, s2, 1
    s_cbranch_scc0 P0_EVEN
    s_lshl_b32 s27, s54, 2
    s_bfe_u32 s33, s2, 0x20003
    s_add_u32 s27, s27, s33
    s_bfe_u32 s26, s2, 0x20001
    s_lshl_b32 s52, s26, 2
    s_lshl_b32 s26, s26, 3
    s_lshr_b32 s53, s2, 5
    s_add_u32 s26, s26, s53
    s_add_u32 s52, s52, s33
    s_lshr_b32 s28, s3, 2
    s_and_b32 s29, s3, 1
    s_bfe_u32 s30, s3, 0x10001
    s_and_b32 s31, s3, 3
    v_lshrrev_b32 v100, 3, v1
    s_lshl_b32 s32, s3, 4
    v_add_u32 v100, s32, v100
    v_lshlrev_b32 v100, 11, v100
    v_and_b32 v101, 7, v1
    v_xor_b32 v101, v101, v16
    v_lshl_add_u32 v2, v101, 4, v100
    v_xor_b32 v3, 64, v2
    v_add_u32 v3, 15360, v3
    s_waitcnt lgkmcnt(0)
    s_lshl_b32 s32, s27, 19
    s_add_u32 s12, s44, s32
    s_addc_u32 s13, s45, 0
    s_mov_b32 s14, 524288
    s_mov_b32 s15, 0x20000
    s_add_u32 m0, s23, 0
    s_mov_b32 s20, 0
    buffer_load_dwordx4 v2, s[12:15], s20 offen sc1 lds
    buffer_load_dwordx4 v3, s[12:15], s20 offen offset:1024 sc1 lds
    s_add_u32 m0, s23, 49152
    s_mov_b32 s20, 262144
    buffer_load_dwordx4 v2, s[12:15], s20 offen sc1 lds
    buffer_load_dwordx4 v3, s[12:15], s20 offen offset:1024 sc1 lds
    s_cmp_lt_u32 s3, 4
    s_cselect_b32 s4, s36, s38
    s_cselect_b32 s5, s37, s39
    s_lshl_b32 s24, s30, 2
    s_add_u32 s24, s24, s29
    s_lshl_b32 s24, s24, 10
    s_lshl_b32 s32, s28, 13
    s_add_u32 s24, s24, s32
    s_add_u32 s24, s24, 98304
    s_lshl_b32 s32, s29, 3
    s_lshl_b32 s33, s30, 2
    s_add_u32 s32, s32, s33
    v_add_u32 v100, s32, v16
    s_lshl_b32 s32, s29, 2
    v_add_u32 v101, s32, v16
    v_lshlrev_b32 v101, 1, v101
    v_xor_b32 v101, v101, v17
    v_lshlrev_b32 v102, 4, v101
    v_subrev_u32 v103, 192, v102
    v_add_u32 v104, 32, v102
    v_cmp_le_u32 vcc, 12, v101
    v_cmp_le_u32 s[10:11], 14, v101
    s_and_b32 s32, s26, 1
    s_cmp_eq_u32 s32, 1
    v_cndmask_b32 v103, v104, v103, vcc
    s_cselect_b64 s[34:35], -1, 0
    v_cndmask_b32 v103, v102, v103, s[34:35]
    s_mul_i32 s32, s26, 224
    v_add_u32 v103, s32, v103
    v_mov_b32 v105, 7168
    v_mad_u32_u24 v103, v100, v105, v103
    s_lshl_b32 s32, s26, 6
    s_lshl_b32 s33, s28, 5
    s_add_u32 s32, s32, s33
    v_and_b32 v102, 16, v102
    v_add_u32 v104, s32, v102
    v_lshl_add_u32 v104, v100, 11, v104
    v_mov_b32 v100, 2048
    v_cndmask_b32 v103, v103, v104, s[10:11]
    v_cndmask_b32 v105, v105, v100, s[10:11]
    v_mov_b32 v100, s92
    v_mov_b32 v101, s93
    v_mov_b32 v106, s4
    v_mov_b32 v107, s5
    v_cndmask_b32 v106, v106, v100, s[10:11]
    v_cndmask_b32 v107, v107, v101, s[10:11]
    v_lshlrev_b32 v8, 5, v105
    v_mov_b32 v9, 0
    v_add_co_u32 v4, vcc, v103, v106
    v_lshlrev_b32 v104, 4, v105
    v_mov_b32 v105, 0
    v_addc_co_u32 v5, vcc, 0, v107, vcc
    v_lshl_add_u64 v[6:7], v[104:105], 0, v[4:5]
    s_add_u32 m0, s24, 0
    s_nop 0
    global_load_lds_dwordx4 v[4:5], off sc1
    s_add_u32 m0, s24, 2048
    v_lshl_add_u64 v[4:5], v[8:9], 0, v[4:5]
    global_load_lds_dwordx4 v[6:7], off sc1
    v_lshl_add_u64 v[6:7], v[8:9], 0, v[6:7]
    s_add_u32 m0, s24, 16384
    s_nop 0
    global_load_lds_dwordx4 v[4:5], off sc1
    s_add_u32 m0, s24, 18432
    v_lshl_add_u64 v[4:5], v[8:9], 0, v[4:5]
    global_load_lds_dwordx4 v[6:7], off sc1
    v_lshl_add_u64 v[6:7], v[8:9], 0, v[6:7]
    s_add_u32 s58, s6, 8912896
    s_addc_u32 s59, s7, 0
    s_load_dwordx2 s[8:9], s[58:59], 24576
    s_mov_b32 s46, s42
    s_mov_b32 s47, s43
    s_mov_b32 s48, s98
    s_mov_b32 s49, s99
    s_mov_b32 s16, s40
    s_mov_b32 s17, s41
    s_mov_b32 s18, 7340032
    s_mov_b32 s19, 0x20000
    s_mov_b32 s36, s92
    s_mov_b32 s37, s93
    s_mov_b32 s38, 2097152
    s_mov_b32 s39, 0x20000
    s_mov_b32 s96, s6
    s_mov_b32 s97, s7
    s_mov_b32 s98, 8388608
    s_mov_b32 s99, 0x20000
    v_bfe_u32 v100, v1, 1, 2
    v_and_b32 v101, 1, v1
    v_lshrrev_b32 v103, 3, v31
    v_lshlrev_b32 v27, 11, v100
    v_lshl_add_u32 v27, v103, 5, v27
    v_lshl_add_u32 v27, v101, 4, v27
    s_lshl_b32 s34, s51, 14
    s_add_u32 s35, s34, 8192
    buffer_load_dwordx4 v[48:51], v27, s[36:39], s34 offen
    buffer_load_dwordx4 v[52:55], v27, s[36:39], s35 offen
    s_add_u32 m0, s23, 16384
    s_mov_b32 s20, 128
    buffer_load_dwordx4 v2, s[12:15], s20 offen sc1 lds
    buffer_load_dwordx4 v3, s[12:15], s20 offen offset:1024 sc1 lds
    s_add_u32 m0, s23, 65536
    s_mov_b32 s20, 262272
    buffer_load_dwordx4 v2, s[12:15], s20 offen sc1 lds
    buffer_load_dwordx4 v3, s[12:15], s20 offen offset:1024 sc1 lds
    s_add_u32 m0, s24, 32768
    s_nop 0
    global_load_lds_dwordx4 v[4:5], off sc1
    s_add_u32 m0, s24, 34816
    v_lshl_add_u64 v[4:5], v[8:9], 0, v[4:5]
    global_load_lds_dwordx4 v[6:7], off sc1
    v_lshl_add_u64 v[6:7], v[8:9], 0, v[6:7]
    v_lshrrev_b32 v104, 1, v103
    v_lshlrev_b32 v30, 16, v104
    v_and_b32 v104, 1, v103
    v_lshl_add_u32 v30, v104, 10, v30
    v_lshl_add_u32 v30, v100, 5, v30
    v_lshl_add_u32 v30, v101, 4, v30
    s_lshl_b32 s32, s26, 16
    s_lshl_b32 s33, s28, 10
    s_add_u32 s32, s32, s33
    s_lshl_b32 s33, s29, 8
    s_add_u32 s32, s32, s33
    s_lshl_b32 s33, s30, 7
    s_add_u32 s32, s32, s33
    s_add_u32 s32, s32, 4216832
    s_add_u32 s32, s32, s6
    s_addc_u32 s33, s7, 0
    v_lshl_add_u32 v104, v16, 5, v102
    v_lshl_add_u64 v[14:15], v[104:105], 0, s[32:33]
    s_mov_b32 s92, s48
    s_mov_b32 s93, s49
    s_mov_b32 s94, 2097152
    s_mov_b32 s95, 0x20000
    v_lshrrev_b32 v100, 1, v17
    v_xor_b32 v100, v100, v16
    v_lshlrev_b32 v100, 4, v100
    v_lshl_add_u32 v100, v17, 7, v100
    s_mul_i32 s32, s28, 49152
    v_add_u32 v10, s32, v100
    v_xor_b32 v11, 64, v10
    v_lshrrev_b32 v103, 2, v17
    v_lshl_add_u32 v100, v16, 2, v103
    v_and_b32 v101, 7, v100
    s_lshl_b32 s32, s31, 1
    v_xor_b32 v101, s32, v101
    v_lshlrev_b32 v101, 5, v101
    v_lshl_add_u32 v101, v100, 8, v101
    v_and_b32 v102, 3, v1
    v_lshl_add_u32 v101, v102, 3, v101
    v_add_u32 v12, 98304, v101
    v_xor_b32 v13, 32, v12
    s_lshl_b32 s55, s31, 11
    s_cmp_eq_u32 s28, 0
    s_movk_i32 s32, 4096
    s_cselect_b32 s32, s32, 0x20000
    s_add_u32 s55, s55, s32
    s_add_u32 s56, s23, 147456
    s_add_u32 s36, s6, 9437184
    s_addc_u32 s37, s7, 0
    s_mov_b32 s38, 18874368
    s_mov_b32 s39, 0x20000
    s_add_u32 s40, s6, 8380416
    s_addc_u32 s41, s7, 0
    s_mov_b32 s42, 294912
    s_mov_b32 s43, 0x20000
    s_lshr_b32 s25, s51, 2
    s_lshl_b32 s25, s25, 11
    s_and_b32 s32, s51, 3
    s_lshl_b32 s32, s32, 8
    s_add_u32 s25, s25, s32
    s_add_u32 s25, s25, 4194304
    s_waitcnt lgkmcnt(0)
    s_add_u32 s8, s8, 0x9e3779b9
    s_add_u32 s9, s9, 0x85ebca6b
    s_cmp_lg_u32 s3, 0
    s_cbranch_scc1 W0_1
    s_lshl_b32 s32, s100, 7
    s_add_u32 s32, s32, 32832
    s_xor_b32 s33, s8, s54
    v_mov_b32 v58, s32
    v_mov_b32 v60, s33
    v_mov_b32 v61, s9
    s_mov_b64 exec, 1
    global_store_dwordx2 v58, v[60:61], s[58:59] sc1
    s_mov_b64 exec, -1
W0_1:
    s_waitcnt vmcnt(10)
    s_barrier
    ds_read_b64_tr_b16 v[32:33], v12 offset:0
    ds_read_b64_tr_b16 v[34:35], v12 offset:4096
    ds_read_b64_tr_b16 v[36:37], v13 offset:0
    ds_read_b64_tr_b16 v[38:39], v13 offset:4096
    ds_read_b64_tr_b16 v[40:41], v12 offset:8192
    ds_read_b64_tr_b16 v[42:43], v12 offset:12288
    ds_read_b64_tr_b16 v[44:45], v13 offset:8192
    ds_read_b64_tr_b16 v[46:47], v13 offset:12288
    ds_read_b128 v[64:67], v10 offset:0
    ds_read_b128 v[68:71], v10 offset:2048
    ds_read_b128 v[72:75], v10 offset:4096
    ds_read_b128 v[76:79], v10 offset:6144
    ds_read_b128 v[80:83], v10 offset:8192
    ds_read_b128 v[84:87], v10 offset:10240
    ds_read_b128 v[88:91], v10 offset:12288
    ds_read_b128 v[92:95], v10 offset:14336
    s_waitcnt vmcnt(6)
    buffer_store_dwordx4 v[48:51], v30, s[96:99], s25 offen sc1
    buffer_store_dwordx4 v[52:55], v30, s[96:99], s25 offen offset:128 sc1
    s_branch P0_JOIN
P0_EVEN:
    s_lshl_b32 s32, s51, 4
    s_add_u32 s21, s32, s3
    s_lshl_b32 s32, s21, 11
    s_add_u32 s33, s32, 16384
    v_and_b32 v100, 32, v1
    v_xor_b32 v100, v100, v19
    s_lshl_b32 s57, s3, 13
    s_lshl_b32 s25, s3, 14
    s_waitcnt lgkmcnt(0)
    s_mov_b32 s12, s44
    s_mov_b32 s13, s45
    s_mov_b32 s14, 4194304
    s_mov_b32 s15, 0x20000
    buffer_load_dwordx4 v[32:35], v19, s[12:15], s32 offen
    buffer_load_dwordx4 v[36:39], v19, s[12:15], s32 offen offset:1024
    buffer_load_dwordx4 v[40:43], v19, s[12:15], s33 offen
    buffer_load_dwordx4 v[44:47], v19, s[12:15], s33 offen offset:1024
    s_add_u32 s58, s6, 8912896
    s_addc_u32 s59, s7, 0
    s_load_dwordx2 s[8:9], s[58:59], 24576
    s_mov_b32 s46, s42
    s_mov_b32 s47, s43
    s_mov_b32 s48, s98
    s_mov_b32 s49, s99
    s_mov_b32 s16, s40
    s_mov_b32 s17, s41
    s_mov_b32 s18, 7340032
    s_mov_b32 s19, 0x20000
    s_cmp_lt_u32 s3, 4
    s_cselect_b32 s4, s36, s38
    s_cselect_b32 s5, s37, s39
    s_mov_b32 s36, s94
    s_mov_b32 s37, s95
    s_mov_b32 s38, 65536
    s_mov_b32 s39, 0x20000
    s_mov_b32 s40, s96
    s_mov_b32 s41, s97
    s_mov_b32 s42, 65536
    s_mov_b32 s43, 0x20000
    s_add_u32 m0, s25, 32768
    s_add_u32 s32, s57, 0
    buffer_load_dwordx4 v100, s[36:39], s32 offen offset:0 sc1 lds
    buffer_load_dwordx4 v100, s[36:39], s32 offen offset:1024 sc1 lds
    buffer_load_dwordx4 v100, s[36:39], s32 offen offset:2048 sc1 lds
    buffer_load_dwordx4 v100, s[36:39], s32 offen offset:3072 sc1 lds
    s_add_u32 m0, s25, 36864
    s_add_u32 s32, s57, 4096
    buffer_load_dwordx4 v100, s[36:39], s32 offen offset:0 sc1 lds
    buffer_load_dwordx4 v100, s[36:39], s32 offen offset:1024 sc1 lds
    buffer_load_dwordx4 v100, s[36:39], s32 offen offset:2048 sc1 lds
    buffer_load_dwordx4 v100, s[36:39], s32 offen offset:3072 sc1 lds
    s_add_u32 m0, s25, 40960
    s_add_u32 s32, s57, 0
    buffer_load_dwordx4 v100, s[40:43], s32 offen offset:0 sc1 lds
    buffer_load_dwordx4 v100, s[40:43], s32 offen offset:1024 sc1 lds
    buffer_load_dwordx4 v100, s[40:43], s32 offen offset:2048 sc1 lds
    buffer_load_dwordx4 v100, s[40:43], s32 offen offset:3072 sc1 lds
    s_add_u32 m0, s25, 45056
    s_add_u32 s32, s57, 4096
    buffer_load_dwordx4 v100, s[40:43], s32 offen offset:0 sc1 lds
    buffer_load_dwordx4 v100, s[40:43], s32 offen offset:1024 sc1 lds
    buffer_load_dwordx4 v100, s[40:43], s32 offen offset:2048 sc1 lds
    buffer_load_dwordx4 v100, s[40:43], s32 offen offset:3072 sc1 lds
    s_mov_b32 s96, s6
    s_mov_b32 s97, s7
    s_mov_b32 s98, 8388608
    s_mov_b32 s99, 0x20000
    s_lshl_b32 s27, s54, 2
    s_bfe_u32 s33, s2, 0x20003
    s_add_u32 s27, s27, s33
    s_bfe_u32 s26, s2, 0x20001
    s_lshl_b32 s52, s26, 2
    s_lshl_b32 s26, s26, 3
    s_lshr_b32 s53, s2, 5
    s_add_u32 s26, s26, s53
    s_add_u32 s52, s52, s33
    s_lshr_b32 s28, s3, 2
    s_and_b32 s29, s3, 1
    s_bfe_u32 s30, s3, 0x10001
    s_and_b32 s31, s3, 3
    s_lshl_b32 s32, s27, 19
    s_add_u32 s12, s44, s32
    s_addc_u32 s13, s45, 0
    s_mov_b32 s14, 524288
    s_mov_b32 s15, 0x20000
    s_lshl_b32 s32, s3, 4
    v_lshlrev_b32 v20, 8, v1
    v_add_u32 v20, s32, v20
    v_lshrrev_b32 v100, 3, v1
    s_lshl_b32 s32, s3, 4
    v_add_u32 v100, s32, v100
    v_lshlrev_b32 v100, 11, v100
    v_and_b32 v101, 7, v1
    v_xor_b32 v101, v101, v16
    v_lshl_add_u32 v2, v101, 4, v100
    v_xor_b32 v3, 64, v2
    v_add_u32 v3, 15360, v3
    s_lshl_b32 s24, s30, 2
    s_add_u32 s24, s24, s29
    s_lshl_b32 s24, s24, 10
    s_lshl_b32 s32, s28, 13
    s_add_u32 s24, s24, s32
    s_add_u32 s24, s24, 98304
    s_lshl_b32 s32, s29, 3
    s_lshl_b32 s33, s30, 2
    s_add_u32 s32, s32, s33
    v_add_u32 v100, s32, v16
    s_lshl_b32 s32, s29, 2
    v_add_u32 v101, s32, v16
    v_lshlrev_b32 v101, 1, v101
    v_xor_b32 v101, v101, v17
    v_lshlrev_b32 v102, 4, v101
    v_subrev_u32 v103, 192, v102
    v_add_u32 v104, 32, v102
    v_cmp_le_u32 vcc, 12, v101
    v_cmp_le_u32 s[10:11], 14, v101
    s_and_b32 s32, s26, 1
    s_cmp_eq_u32 s32, 1
    v_cndmask_b32 v103, v104, v103, vcc
    s_cselect_b64 s[34:35], -1, 0
    v_cndmask_b32 v103, v102, v103, s[34:35]
    s_mul_i32 s32, s26, 224
    v_add_u32 v103, s32, v103
    v_mov_b32 v105, 7168
    v_mad_u32_u24 v103, v100, v105, v103
    s_lshl_b32 s32, s26, 6
    s_lshl_b32 s33, s28, 5
    s_add_u32 s32, s32, s33
    v_and_b32 v102, 16, v102
    v_add_u32 v104, s32, v102
    v_lshl_add_u32 v104, v100, 11, v104
    v_mov_b32 v100, 2048
    v_cndmask_b32 v103, v103, v104, s[10:11]
    v_cndmask_b32 v105, v105, v100, s[10:11]
    v_mov_b32 v100, s92
    v_mov_b32 v101, s93
    v_mov_b32 v106, s4
    v_mov_b32 v107, s5
    v_cndmask_b32 v106, v106, v100, s[10:11]
    v_cndmask_b32 v107, v107, v101, s[10:11]
    v_lshlrev_b32 v8, 5, v105
    v_mov_b32 v9, 0
    v_add_co_u32 v4, vcc, v103, v106
    v_lshlrev_b32 v104, 4, v105
    v_mov_b32 v105, 0
    v_addc_co_u32 v5, vcc, 0, v107, vcc
    v_lshl_add_u64 v[6:7], v[104:105], 0, v[4:5]
    v_mov_b32 v29, v102
    s_and_b32 s32, s27, 3
    v_mul_lo_u32 v104, v8, s32
    v_lshl_add_u64 v[22:23], v[104:105], 0, v[4:5]
    v_lshl_add_u64 v[24:25], v[104:105], 0, v[6:7]
    v_lshrrev_b32 v26, 4, v31
    v_lshlrev_b32 v26, 11, v26
    v_lshl_add_u32 v26, v17, 7, v26
    s_lshl_b32 s32, s53, 16
    v_add_u32 v26, s32, v26
    s_lshl_b32 s21, s21, 3
    s_waitcnt lgkmcnt(0)
    s_add_u32 s8, s8, 0x9e3779b9
    s_add_u32 s9, s9, 0x85ebca6b
    s_cmp_lg_u32 s3, 0
    s_cbranch_scc1 W0_2
    s_lshl_b32 s32, s100, 7
    s_add_u32 s32, s32, 32832
    s_xor_b32 s33, s8, s54
    v_mov_b32 v58, s32
    v_mov_b32 v60, s33
    v_mov_b32 v61, s9
    s_mov_b64 exec, 1
    global_store_dwordx2 v58, v[60:61], s[58:59] sc1
    s_mov_b64 exec, -1
W0_2:
    s_mov_b32 s35, 0xffff0000
    s_waitcnt vmcnt(16)
    v_lshlrev_b32 v64, 16, v32
    v_lshlrev_b32 v96, 16, v40
    v_and_b32 v65, s35, v32
    v_and_b32 v97, s35, v40
    v_lshlrev_b32 v66, 16, v33
    v_lshlrev_b32 v98, 16, v41
    v_and_b32 v67, s35, v33
    v_and_b32 v99, s35, v41
    v_lshlrev_b32 v68, 16, v34
    v_lshlrev_b32 v100, 16, v42
    v_and_b32 v69, s35, v34
    v_and_b32 v101, s35, v42
    v_lshlrev_b32 v70, 16, v35
    v_lshlrev_b32 v102, 16, v43
    v_and_b32 v71, s35, v35
    v_and_b32 v103, s35, v43
    v_lshlrev_b32 v72, 16, v36
    v_lshlrev_b32 v104, 16, v44
    v_and_b32 v73, s35, v36
    v_and_b32 v105, s35, v44
    v_lshlrev_b32 v74, 16, v37
    v_lshlrev_b32 v106, 16, v45
    v_and_b32 v75, s35, v37
    v_and_b32 v107, s35, v45
    v_lshlrev_b32 v76, 16, v38
    v_lshlrev_b32 v108, 16, v46
    v_and_b32 v77, s35, v38
    v_and_b32 v109, s35, v46
    v_lshlrev_b32 v78, 16, v39
    v_lshlrev_b32 v110, 16, v47
    v_and_b32 v79, s35, v39
    v_and_b32 v111, s35, v47
    v_pk_add_f32 v[52:53], v[64:65], v[66:67]
    v_pk_add_f32 v[58:59], v[96:97], v[98:99]
    v_pk_add_f32 v[54:55], v[68:69], v[70:71]
    v_pk_add_f32 v[60:61], v[100:101], v[102:103]
    v_pk_add_f32 v[52:53], v[52:53], v[72:73]
    v_pk_add_f32 v[58:59], v[58:59], v[104:105]
    v_pk_add_f32 v[54:55], v[54:55], v[74:75]
    v_pk_add_f32 v[60:61], v[60:61], v[106:107]
    v_pk_add_f32 v[52:53], v[52:53], v[76:77]
    v_pk_add_f32 v[58:59], v[58:59], v[108:109]
    v_pk_add_f32 v[54:55], v[54:55], v[78:79]
    v_pk_add_f32 v[60:61], v[60:61], v[110:111]
    v_pk_add_f32 v[52:53], v[52:53], v[54:55]
    v_pk_add_f32 v[58:59], v[58:59], v[60:61]
    v_add_f32 v52, v52, v53
    v_add_f32 v58, v58, v59
    s_nop 0
    v_add_f32_dpp v52, v52, v52 quad_perm:[1,0,3,2] row_mask:0xf bank_mask:0xf
    v_add_f32_dpp v58, v58, v58 quad_perm:[1,0,3,2] row_mask:0xf bank_mask:0xf
    s_nop 0
    v_add_f32_dpp v52, v52, v52 quad_perm:[2,3,0,1] row_mask:0xf bank_mask:0xf
    v_add_f32_dpp v58, v58, v58 quad_perm:[2,3,0,1] row_mask:0xf bank_mask:0xf
    s_nop 0
    v_add_f32_dpp v52, v52, v52 row_half_mirror row_mask:0xf bank_mask:0xf
    v_add_f32_dpp v58, v58, v58 row_half_mirror row_mask:0xf bank_mask:0xf
    s_nop 0
    v_add_f32_dpp v52, v52, v52 row_mirror row_mask:0xf bank_mask:0xf
    v_add_f32_dpp v58, v58, v58 row_mirror row_mask:0xf bank_mask:0xf
    v_mov_b32 v53, v52
    v_mov_b32 v59, v58
    s_nop 0
    v_permlane16_swap_b32 v52, v53
    v_permlane16_swap_b32 v58, v59
    v_add_f32 v52, v52, v53
    v_add_f32 v58, v58, v59
    v_mov_b32 v53, v52
    v_mov_b32 v59, v58
    s_nop 0
    v_permlane32_swap_b32 v52, v53
    v_permlane32_swap_b32 v58, v59
    v_add_f32 v52, v52, v53
    v_add_f32 v58, v58, v59
    v_mul_f32 v56, 0xba800000, v52
    v_mul_f32 v62, 0xba800000, v58
    v_pk_add_f32 v[80:81], v[64:65], v[56:57] op_sel_hi:[1,0]
    v_pk_add_f32 v[112:113], v[96:97], v[62:63] op_sel_hi:[1,0]
    v_pk_add_f32 v[82:83], v[66:67], v[56:57] op_sel_hi:[1,0]
    v_pk_add_f32 v[114:115], v[98:99], v[62:63] op_sel_hi:[1,0]
    v_pk_add_f32 v[84:85], v[68:69], v[56:57] op_sel_hi:[1,0]
    v_pk_add_f32 v[116:117], v[100:101], v[62:63] op_sel_hi:[1,0]
    v_pk_add_f32 v[86:87], v[70:71], v[56:57] op_sel_hi:[1,0]
    v_pk_add_f32 v[118:119], v[102:103], v[62:63] op_sel_hi:[1,0]
    v_pk_add_f32 v[88:89], v[72:73], v[56:57] op_sel_hi:[1,0]
    v_pk_add_f32 v[120:121], v[104:105], v[62:63] op_sel_hi:[1,0]
    v_pk_add_f32 v[90:91], v[74:75], v[56:57] op_sel_hi:[1,0]
    v_pk_add_f32 v[122:123], v[106:107], v[62:63] op_sel_hi:[1,0]
    v_pk_add_f32 v[92:93], v[76:77], v[56:57] op_sel_hi:[1,0]
    v_pk_add_f32 v[124:125], v[108:109], v[62:63] op_sel_hi:[1,0]
    v_pk_add_f32 v[94:95], v[78:79], v[56:57] op_sel_hi:[1,0]
    v_pk_add_f32 v[126:127], v[110:111], v[62:63] op_sel_hi:[1,0]
    v_pk_mul_f32 v[52:53], v[80:81], v[80:81]
    v_pk_mul_f32 v[58:59], v[112:113], v[112:113]
    v_pk_mul_f32 v[54:55], v[82:83], v[82:83]
    v_pk_mul_f32 v[60:61], v[114:115], v[114:115]
    v_pk_fma_f32 v[52:53], v[84:85], v[84:85], v[52:53]
    v_pk_fma_f32 v[58:59], v[116:117], v[116:117], v[58:59]
    v_pk_fma_f32 v[54:55], v[86:87], v[86:87], v[54:55]
    v_pk_fma_f32 v[60:61], v[118:119], v[118:119], v[60:61]
    v_pk_fma_f32 v[52:53], v[88:89], v[88:89], v[52:53]
    v_pk_fma_f32 v[58:59], v[120:121], v[120:121], v[58:59]
    v_pk_fma_f32 v[54:55], v[90:91], v[90:91], v[54:55]
    v_pk_fma_f32 v[60:61], v[122:123], v[122:123], v[60:61]
    v_pk_fma_f32 v[52:53], v[92:93], v[92:93], v[52:53]
    v_pk_fma_f32 v[58:59], v[124:125], v[124:125], v[58:59]
    v_pk_fma_f32 v[54:55], v[94:95], v[94:95], v[54:55]
    v_pk_fma_f32 v[60:61], v[126:127], v[126:127], v[60:61]
    v_pk_add_f32 v[52:53], v[52:53], v[54:55]
    v_pk_add_f32 v[58:59], v[58:59], v[60:61]
    v_add_f32 v52, v52, v53
    v_add_f32 v58, v58, v59
    v_cvt_pk_bf16_f32 v56, v56, v56
    v_cvt_pk_bf16_f32 v62, v62, v62
    v_and_b32 v56, s35, v56
    v_and_b32 v62, s35, v62
    s_nop 0
    v_add_f32_dpp v52, v52, v52 quad_perm:[1,0,3,2] row_mask:0xf bank_mask:0xf
    v_add_f32_dpp v58, v58, v58 quad_perm:[1,0,3,2] row_mask:0xf bank_mask:0xf
    s_nop 0
    v_add_f32_dpp v52, v52, v52 quad_perm:[2,3,0,1] row_mask:0xf bank_mask:0xf
    v_add_f32_dpp v58, v58, v58 quad_perm:[2,3,0,1] row_mask:0xf bank_mask:0xf
    s_nop 0
    v_add_f32_dpp v52, v52, v52 row_half_mirror row_mask:0xf bank_mask:0xf
    v_add_f32_dpp v58, v58, v58 row_half_mirror row_mask:0xf bank_mask:0xf
    s_nop 0
    v_add_f32_dpp v52, v52, v52 row_mirror row_mask:0xf bank_mask:0xf
    v_add_f32_dpp v58, v58, v58 row_mirror row_mask:0xf bank_mask:0xf
    v_mov_b32 v53, v52
    v_mov_b32 v59, v58
    s_nop 0
    v_permlane16_swap_b32 v52, v53
    v_permlane16_swap_b32 v58, v59
    v_add_f32 v52, v52, v53
    v_add_f32 v58, v58, v59
    v_mov_b32 v53, v52
    v_mov_b32 v59, v58
    s_nop 0
    v_permlane32_swap_b32 v52, v53
    v_permlane32_swap_b32 v58, v59
    v_add_f32 v52, v52, v53
    v_add_f32 v58, v58, v59
    v_pk_add_f32 v[80:81], v[64:65], v[56:57] op_sel_hi:[1,0]
    v_pk_add_f32 v[112:113], v[96:97], v[62:63] op_sel_hi:[1,0]
    v_pk_add_f32 v[82:83], v[66:67], v[56:57] op_sel_hi:[1,0]
    v_pk_add_f32 v[114:115], v[98:99], v[62:63] op_sel_hi:[1,0]
    v_pk_add_f32 v[84:85], v[68:69], v[56:57] op_sel_hi:[1,0]
    v_pk_add_f32 v[116:117], v[100:101], v[62:63] op_sel_hi:[1,0]
    v_pk_add_f32 v[86:87], v[70:71], v[56:57] op_sel_hi:[1,0]
    v_pk_add_f32 v[118:119], v[102:103], v[62:63] op_sel_hi:[1,0]
    v_pk_add_f32 v[88:89], v[72:73], v[56:57] op_sel_hi:[1,0]
    v_pk_add_f32 v[120:121], v[104:105], v[62:63] op_sel_hi:[1,0]
    v_pk_add_f32 v[90:91], v[74:75], v[56:57] op_sel_hi:[1,0]
    v_pk_add_f32 v[122:123], v[106:107], v[62:63] op_sel_hi:[1,0]
    v_pk_add_f32 v[92:93], v[76:77], v[56:57] op_sel_hi:[1,0]
    v_pk_add_f32 v[124:125], v[108:109], v[62:63] op_sel_hi:[1,0]
    v_pk_add_f32 v[94:95], v[78:79], v[56:57] op_sel_hi:[1,0]
    v_pk_add_f32 v[126:127], v[110:111], v[62:63] op_sel_hi:[1,0]
    v_mul_f32 v52, 0x3a800000, v52
    v_mul_f32 v58, 0x3a800000, v58
    v_cvt_pk_bf16_f32 v52, v52, v52
    v_cvt_pk_bf16_f32 v58, v58, v58
    v_and_b32 v52, s35, v52
    v_and_b32 v58, s35, v58
    v_add_f32 v52, 0x3727c5ac, v52
    v_add_f32 v58, 0x3727c5ac, v58
    v_cvt_pk_bf16_f32 v52, v52, v52
    v_cvt_pk_bf16_f32 v58, v58, v58
    v_and_b32 v52, s35, v52
    v_and_b32 v58, s35, v58
    v_sqrt_f32 v52, v52
    v_sqrt_f32 v58, v58
    v_cvt_pk_bf16_f32 v52, v52, v52
    v_cvt_pk_bf16_f32 v58, v58, v58
    v_and_b32 v52, s35, v52
    v_and_b32 v58, s35, v58
    v_rcp_f32 v57, v52
    v_rcp_f32 v63, v58
    v_pk_mul_f32 v[80:81], v[80:81], v[56:57] op_sel:[0,1] op_sel_hi:[1,1]
    v_pk_mul_f32 v[112:113], v[112:113], v[62:63] op_sel:[0,1] op_sel_hi:[1,1]
    v_pk_mul_f32 v[82:83], v[82:83], v[56:57] op_sel:[0,1] op_sel_hi:[1,1]
    v_pk_mul_f32 v[114:115], v[114:115], v[62:63] op_sel:[0,1] op_sel_hi:[1,1]
    v_pk_mul_f32 v[84:85], v[84:85], v[56:57] op_sel:[0,1] op_sel_hi:[1,1]
    v_pk_mul_f32 v[116:117], v[116:117], v[62:63] op_sel:[0,1] op_sel_hi:[1,1]
    v_pk_mul_f32 v[86:87], v[86:87], v[56:57] op_sel:[0,1] op_sel_hi:[1,1]
    v_pk_mul_f32 v[118:119], v[118:119], v[62:63] op_sel:[0,1] op_sel_hi:[1,1]
    v_pk_mul_f32 v[88:89], v[88:89], v[56:57] op_sel:[0,1] op_sel_hi:[1,1]
    v_pk_mul_f32 v[120:121], v[120:121], v[62:63] op_sel:[0,1] op_sel_hi:[1,1]
    v_pk_mul_f32 v[90:91], v[90:91], v[56:57] op_sel:[0,1] op_sel_hi:[1,1]
    v_pk_mul_f32 v[122:123], v[122:123], v[62:63] op_sel:[0,1] op_sel_hi:[1,1]
    v_pk_mul_f32 v[92:93], v[92:93], v[56:57] op_sel:[0,1] op_sel_hi:[1,1]
    v_pk_mul_f32 v[124:125], v[124:125], v[62:63] op_sel:[0,1] op_sel_hi:[1,1]
    v_pk_mul_f32 v[94:95], v[94:95], v[56:57] op_sel:[0,1] op_sel_hi:[1,1]
    v_pk_mul_f32 v[126:127], v[126:127], v[62:63] op_sel:[0,1] op_sel_hi:[1,1]
    v_cvt_pk_bf16_f32 v32, v80, v81
    v_cvt_pk_bf16_f32 v40, v112, v113
    v_cvt_pk_bf16_f32 v33, v82, v83
    v_cvt_pk_bf16_f32 v41, v114, v115
    v_cvt_pk_bf16_f32 v34, v84, v85
    v_cvt_pk_bf16_f32 v42, v116, v117
    v_cvt_pk_bf16_f32 v35, v86, v87
    v_cvt_pk_bf16_f32 v43, v118, v119
    v_cvt_pk_bf16_f32 v36, v88, v89
    v_cvt_pk_bf16_f32 v44, v120, v121
    v_cvt_pk_bf16_f32 v37, v90, v91
    v_cvt_pk_bf16_f32 v45, v122, v123
    v_cvt_pk_bf16_f32 v38, v92, v93
    v_cvt_pk_bf16_f32 v46, v124, v125
    v_cvt_pk_bf16_f32 v39, v94, v95
    v_cvt_pk_bf16_f32 v47, v126, v127
    ds_write_b128 v20, v[32:35] offset:0
    ds_write_b128 v20, v[36:39] offset:16384
    ds_write_b128 v20, v[40:43] offset:128
    ds_write_b128 v20, v[44:47] offset:16512
    s_mov_b64 exec, 1
    buffer_store_dwordx2 v[56:57], v19, s[96:99], s21 offen sc1
    buffer_store_dwordx2 v[62:63], v19, s[96:99], s21 offen offset:64 sc1
    s_mov_b32 exec_lo, 458759
    s_mov_b32 exec_hi, 458759
    buffer_load_dword v18, v26, s[12:15], 0 offen
    s_mov_b64 exec, -1
    global_load_dword v18, v[22:23], off
    global_load_dword v18, v[24:25], off
    v_mov_b32 v102, v29
    v_mov_b32 v105, 0
    s_lshl_b32 s32, s26, 16
    s_lshl_b32 s33, s28, 10
    s_add_u32 s32, s32, s33
    s_lshl_b32 s33, s29, 8
    s_add_u32 s32, s32, s33
    s_lshl_b32 s33, s30, 7
    s_add_u32 s32, s32, s33
    s_add_u32 s32, s32, 4216832
    s_add_u32 s32, s32, s6
    s_addc_u32 s33, s7, 0
    v_lshl_add_u32 v104, v16, 5, v102
    v_lshl_add_u64 v[14:15], v[104:105], 0, s[32:33]
    s_mov_b32 s92, s48
    s_mov_b32 s93, s49
    s_mov_b32 s94, 2097152
    s_mov_b32 s95, 0x20000
    v_lshrrev_b32 v100, 1, v17
    v_xor_b32 v100, v100, v16
    v_lshlrev_b32 v100, 4, v100
    v_lshl_add_u32 v100, v17, 7, v100
    s_mul_i32 s32, s28, 49152
    v_add_u32 v10, s32, v100
    v_xor_b32 v11, 64, v10
    v_lshrrev_b32 v103, 2, v17
    v_lshl_add_u32 v100, v16, 2, v103
    v_and_b32 v101, 7, v100
    s_lshl_b32 s32, s31, 1
    v_xor_b32 v101, s32, v101
    v_lshlrev_b32 v101, 5, v101
    v_lshl_add_u32 v101, v100, 8, v101
    v_and_b32 v102, 3, v1
    v_lshl_add_u32 v101, v102, 3, v101
    v_add_u32 v12, 98304, v101
    v_xor_b32 v13, 32, v12
    s_lshl_b32 s55, s31, 11
    s_cmp_eq_u32 s28, 0
    s_movk_i32 s32, 4096
    s_cselect_b32 s32, s32, 0x20000
    s_add_u32 s55, s55, s32
    s_add_u32 s56, s23, 147456
    s_lshl_b32 s32, s28, 14
    v_add_u32 v30, s32, v19
    s_lshl_b32 s33, s30, 13
    s_lshl_b32 s34, s29, 5
    s_add_u32 s33, s33, s34
    s_lshl_b32 s32, s28, 16
    s_add_u32 s32, s32, s33
    s_add_u32 s32, s32, 32768
    v_lshl_add_u32 v0, v16, 3, v103
    v_lshlrev_b32 v0, 6, v0
    v_lshl_add_u32 v0, v102, 3, v0
    v_add_u32 v0, s32, v0
    v_and_b32 v100, 16, v1
    v_lshlrev_b32 v101, 1, v100
    v_xor_b32 v0, v0, v101
    v_lshrrev_b32 v28, 1, v1
    v_lshlrev_b32 v28, 6, v28
    v_and_b32 v100, 1, v1
    v_lshl_add_u32 v28, v100, 4, v28
    s_add_u32 s33, s33, 147456
    v_add_u32 v28, s33, v28
    v_xor_b32 v28, v28, v101
    s_lshr_b32 s22, s51, 1
    s_lshl_b32 s22, s22, 11
    s_and_b32 s32, s51, 1
    s_lshl_b32 s33, s32, 8
    s_lshl_b32 s34, s29, 3
    s_add_u32 s33, s33, s34
    s_lshl_b32 s32, s32, 10
    s_lshl_b32 s34, s29, 8
    s_add_u32 s32, s32, s34
    s_add_u32 s32, s32, 0x20000
    s_cmp_eq_u32 s30, 0
    s_cselect_b32 s32, s33, s32
    s_cselect_b64 vcc, -1, 0
    s_add_u32 s22, s22, s32
    s_add_u32 s22, s22, 8192
    v_lshlrev_b32 v100, 9, v16
    v_and_b32 v101, 512, v100
    v_lshrrev_b32 v102, 1, v16
    v_lshl_add_u32 v101, v102, 3, v101
    v_cndmask_b32 v100, v101, v100, vcc
    v_lshl_add_u32 v29, v17, 4, v100
    s_add_u32 s36, s6, 9437184
    s_addc_u32 s37, s7, 0
    s_mov_b32 s38, 18874368
    s_mov_b32 s39, 0x20000
    s_add_u32 s40, s6, 8380416
    s_addc_u32 s41, s7, 0
    s_mov_b32 s42, 294912
    s_mov_b32 s43, 0x20000
    s_waitcnt vmcnt(5) lgkmcnt(0)
    s_barrier
    ds_read_b128 v[32:35], v30 offset:0
    ds_read_b64_tr_b16 v[64:65], v0 offset:0
    ds_read_b64_tr_b16 v[66:67], v0 offset:256
    ds_read_b128 v[36:39], v30 offset:1024
    ds_read_b64_tr_b16 v[68:69], v0 offset:2048
    ds_read_b64_tr_b16 v[70:71], v0 offset:2304
    ds_read_b128 v[40:43], v30 offset:2048
    ds_read_b64_tr_b16 v[72:73], v0 offset:4096
    ds_read_b64_tr_b16 v[74:75], v0 offset:4352
    ds_read_b128 v[44:47], v30 offset:3072
    ds_read_b64_tr_b16 v[76:77], v0 offset:6144
    ds_read_b64_tr_b16 v[78:79], v0 offset:6400
    ds_read_b128 v[48:51], v30 offset:4096
    ds_read_b64_tr_b16 v[80:81], v0 offset:16384
    ds_read_b64_tr_b16 v[82:83], v0 offset:16640
    s_cmp_lg_u32 s30, 0
    s_cbranch_scc1 P0_V
    s_waitcnt lgkmcnt(12)
    v_mfma_f32_16x16x32_bf16 v[20:23], v[64:67], v[32:35], 0
    ds_read_b128 v[52:55], v30 offset:5120
    ds_read_b64_tr_b16 v[84:85], v0 offset:18432
    ds_read_b64_tr_b16 v[86:87], v0 offset:18688
    s_waitcnt lgkmcnt(12)
    v_mfma_f32_16x16x32_bf16 v[24:27], v[68:71], v[36:39], 0
    ds_read_b128 v[56:59], v30 offset:6144
    ds_read_b64_tr_b16 v[88:89], v0 offset:20480
    ds_read_b64_tr_b16 v[90:91], v0 offset:20736
    s_waitcnt lgkmcnt(12)
    v_mfma_f32_16x16x32_bf16 v[20:23], v[72:75], v[40:43], v[20:23]
    ds_read_b128 v[60:63], v30 offset:7168
    ds_read_b64_tr_b16 v[92:93], v0 offset:22528
    ds_read_b64_tr_b16 v[94:95], v0 offset:22784
    s_waitcnt lgkmcnt(12)
    v_mfma_f32_16x16x32_bf16 v[24:27], v[76:79], v[44:47], v[24:27]
    ds_read_b128 v[32:35], v30 offset:8192
    ds_read_b64_tr_b16 v[96:97], v0 offset:32768
    ds_read_b64_tr_b16 v[98:99], v0 offset:33024
    s_waitcnt lgkmcnt(12)
    v_mfma_f32_16x16x32_bf16 v[20:23], v[80:83], v[48:51], v[20:23]
    ds_read_b128 v[36:39], v30 offset:9216
    ds_read_b64_tr_b16 v[100:101], v0 offset:34816
    ds_read_b64_tr_b16 v[102:103], v0 offset:35072
    s_waitcnt lgkmcnt(12)
    v_mfma_f32_16x16x32_bf16 v[24:27], v[84:87], v[52:55], v[24:27]
    ds_read_b128 v[40:43], v30 offset:10240
    ds_read_b64_tr_b16 v[104:105], v0 offset:36864
    ds_read_b64_tr_b16 v[106:107], v0 offset:37120
    s_waitcnt lgkmcnt(12)
    v_mfma_f32_16x16x32_bf16 v[20:23], v[88:91], v[56:59], v[20:23]
    ds_read_b128 v[44:47], v30 offset:11264
    ds_read_b64_tr_b16 v[108:109], v0 offset:38912
    ds_read_b64_tr_b16 v[110:111], v0 offset:39168
    s_waitcnt lgkmcnt(12)
    v_mfma_f32_16x16x32_bf16 v[24:27], v[92:95], v[60:63], v[24:27]
    ds_read_b128 v[48:51], v30 offset:12288
    ds_read_b64_tr_b16 v[112:113], v0 offset:49152
    ds_read_b64_tr_b16 v[114:115], v0 offset:49408
    s_waitcnt lgkmcnt(12)
    v_mfma_f32_16x16x32_bf16 v[20:23], v[96:99], v[32:35], v[20:23]
    ds_read_b128 v[52:55], v30 offset:13312
    ds_read_b64_tr_b16 v[116:117], v0 offset:51200
    ds_read_b64_tr_b16 v[118:119], v0 offset:51456
    s_waitcnt lgkmcnt(12)
    v_mfma_f32_16x16x32_bf16 v[24:27], v[100:103], v[36:39], v[24:27]
    ds_read_b128 v[56:59], v30 offset:14336
    ds_read_b64_tr_b16 v[120:121], v0 offset:53248
    ds_read_b64_tr_b16 v[122:123], v0 offset:53504
    s_waitcnt lgkmcnt(12)
    v_mfma_f32_16x16x32_bf16 v[20:23], v[104:107], v[40:43], v[20:23]
    ds_read_b128 v[60:63], v30 offset:15360
    ds_read_b64_tr_b16 v[124:125], v0 offset:55296
    ds_read_b64_tr_b16 v[126:127], v0 offset:55552
    s_waitcnt lgkmcnt(12)
    v_mfma_f32_16x16x32_bf16 v[24:27], v[108:111], v[44:47], v[24:27]
    s_waitcnt lgkmcnt(9)
    v_mfma_f32_16x16x32_bf16 v[20:23], v[112:115], v[48:51], v[20:23]
    s_waitcnt lgkmcnt(6)
    v_mfma_f32_16x16x32_bf16 v[24:27], v[116:119], v[52:55], v[24:27]
    s_waitcnt lgkmcnt(3)
    v_mfma_f32_16x16x32_bf16 v[20:23], v[120:123], v[56:59], v[20:23]
    s_waitcnt lgkmcnt(0)
    v_mfma_f32_16x16x32_bf16 v[24:27], v[124:127], v[60:63], v[24:27]
    s_branch P0_MD
P0_V:
    s_waitcnt lgkmcnt(12)
    v_mfma_f32_16x16x32_bf16 v[20:23], v[32:35], v[64:67], 0
    ds_read_b128 v[52:55], v30 offset:5120
    ds_read_b64_tr_b16 v[84:85], v0 offset:18432
    ds_read_b64_tr_b16 v[86:87], v0 offset:18688
    s_waitcnt lgkmcnt(12)
    v_mfma_f32_16x16x32_bf16 v[24:27], v[36:39], v[68:71], 0
    ds_read_b128 v[56:59], v30 offset:6144
    ds_read_b64_tr_b16 v[88:89], v0 offset:20480
    ds_read_b64_tr_b16 v[90:91], v0 offset:20736
    s_waitcnt lgkmcnt(12)
    v_mfma_f32_16x16x32_bf16 v[20:23], v[40:43], v[72:75], v[20:23]
    ds_read_b128 v[60:63], v30 offset:7168
    ds_read_b64_tr_b16 v[92:93], v0 offset:22528
    ds_read_b64_tr_b16 v[94:95], v0 offset:22784
    s_waitcnt lgkmcnt(12)
    v_mfma_f32_16x16x32_bf16 v[24:27], v[44:47], v[76:79], v[24:27]
    ds_read_b128 v[32:35], v30 offset:8192
    ds_read_b64_tr_b16 v[96:97], v0 offset:32768
    ds_read_b64_tr_b16 v[98:99], v0 offset:33024
    s_waitcnt lgkmcnt(12)
    v_mfma_f32_16x16x32_bf16 v[20:23], v[48:51], v[80:83], v[20:23]
    ds_read_b128 v[36:39], v30 offset:9216
    ds_read_b64_tr_b16 v[100:101], v0 offset:34816
    ds_read_b64_tr_b16 v[102:103], v0 offset:35072
    s_waitcnt lgkmcnt(12)
    v_mfma_f32_16x16x32_bf16 v[24:27], v[52:55], v[84:87], v[24:27]
    ds_read_b128 v[40:43], v30 offset:10240
    ds_read_b64_tr_b16 v[104:105], v0 offset:36864
    ds_read_b64_tr_b16 v[106:107], v0 offset:37120
    s_waitcnt lgkmcnt(12)
    v_mfma_f32_16x16x32_bf16 v[20:23], v[56:59], v[88:91], v[20:23]
    ds_read_b128 v[44:47], v30 offset:11264
    ds_read_b64_tr_b16 v[108:109], v0 offset:38912
    ds_read_b64_tr_b16 v[110:111], v0 offset:39168
    s_waitcnt lgkmcnt(12)
    v_mfma_f32_16x16x32_bf16 v[24:27], v[60:63], v[92:95], v[24:27]
    ds_read_b128 v[48:51], v30 offset:12288
    ds_read_b64_tr_b16 v[112:113], v0 offset:49152
    ds_read_b64_tr_b16 v[114:115], v0 offset:49408
    s_waitcnt lgkmcnt(12)
    v_mfma_f32_16x16x32_bf16 v[20:23], v[32:35], v[96:99], v[20:23]
    ds_read_b128 v[52:55], v30 offset:13312
    ds_read_b64_tr_b16 v[116:117], v0 offset:51200
    ds_read_b64_tr_b16 v[118:119], v0 offset:51456
    s_waitcnt lgkmcnt(12)
    v_mfma_f32_16x16x32_bf16 v[24:27], v[36:39], v[100:103], v[24:27]
    ds_read_b128 v[56:59], v30 offset:14336
    ds_read_b64_tr_b16 v[120:121], v0 offset:53248
    ds_read_b64_tr_b16 v[122:123], v0 offset:53504
    s_waitcnt lgkmcnt(12)
    v_mfma_f32_16x16x32_bf16 v[20:23], v[40:43], v[104:107], v[20:23]
    ds_read_b128 v[60:63], v30 offset:15360
    ds_read_b64_tr_b16 v[124:125], v0 offset:55296
    ds_read_b64_tr_b16 v[126:127], v0 offset:55552
    s_waitcnt lgkmcnt(12)
    v_mfma_f32_16x16x32_bf16 v[24:27], v[44:47], v[108:111], v[24:27]
    s_waitcnt lgkmcnt(9)
    v_mfma_f32_16x16x32_bf16 v[20:23], v[48:51], v[112:115], v[20:23]
    s_waitcnt lgkmcnt(6)
    v_mfma_f32_16x16x32_bf16 v[24:27], v[52:55], v[116:119], v[24:27]
    s_waitcnt lgkmcnt(3)
    v_mfma_f32_16x16x32_bf16 v[20:23], v[56:59], v[120:123], v[20:23]
    s_waitcnt lgkmcnt(0)
    v_mfma_f32_16x16x32_bf16 v[24:27], v[60:63], v[124:127], v[24:27]
P0_MD:
    s_nop 7
    v_pk_add_f32 v[20:21], v[20:21], v[24:25]
    v_pk_add_f32 v[22:23], v[22:23], v[26:27]
    s_cmp_eq_u32 s28, 0
    s_cbranch_scc1 P0_W0
    ds_write_b128 v28, v[20:23]
    s_waitcnt lgkmcnt(0)
P0_W0:
    s_barrier
    s_add_u32 m0, s23, 0
    s_mov_b32 s20, 0
    buffer_load_dwordx4 v2, s[12:15], s20 offen sc1 lds
    buffer_load_dwordx4 v3, s[12:15], s20 offen offset:1024 sc1 lds
    s_add_u32 m0, s23, 49152
    s_mov_b32 s20, 262144
    buffer_load_dwordx4 v2, s[12:15], s20 offen sc1 lds
    buffer_load_dwordx4 v3, s[12:15], s20 offen offset:1024 sc1 lds
    s_add_u32 m0, s24, 0
    s_nop 0
    global_load_lds_dwordx4 v[4:5], off sc1
    s_add_u32 m0, s24, 2048
    v_lshl_add_u64 v[4:5], v[8:9], 0, v[4:5]
    global_load_lds_dwordx4 v[6:7], off sc1
    v_lshl_add_u64 v[6:7], v[8:9], 0, v[6:7]
    s_add_u32 m0, s24, 16384
    s_nop 0
    global_load_lds_dwordx4 v[4:5], off sc1
    s_add_u32 m0, s24, 18432
    v_lshl_add_u64 v[4:5], v[8:9], 0, v[4:5]
    global_load_lds_dwordx4 v[6:7], off sc1
    v_lshl_add_u64 v[6:7], v[8:9], 0, v[6:7]
    s_cmp_lg_u32 s28, 0
    s_cbranch_scc1 P0_KVD
    ds_read_b128 v[24:27], v28
    s_waitcnt lgkmcnt(0)
    v_pk_add_f32 v[20:21], v[20:21], v[24:25]
    v_pk_add_f32 v[22:23], v[22:23], v[26:27]
    v_cvt_pk_bf16_f32 v20, v20, v21
    v_cvt_pk_bf16_f32 v21, v22, v23
    buffer_store_dwordx2 v[20:21], v29, s[40:43], s22 offen sc1
P0_KVD:
    s_waitcnt vmcnt(2)
    s_barrier
    ds_read_b64_tr_b16 v[32:33], v12 offset:0
    ds_read_b64_tr_b16 v[34:35], v12 offset:4096
    ds_read_b64_tr_b16 v[36:37], v13 offset:0
    ds_read_b64_tr_b16 v[38:39], v13 offset:4096
    ds_read_b64_tr_b16 v[40:41], v12 offset:8192
    ds_read_b64_tr_b16 v[42:43], v12 offset:12288
    ds_read_b64_tr_b16 v[44:45], v13 offset:8192
    ds_read_b64_tr_b16 v[46:47], v13 offset:12288
    ds_read_b128 v[64:67], v10 offset:0
    ds_read_b128 v[68:71], v10 offset:2048
    ds_read_b128 v[72:75], v10 offset:4096
    ds_read_b128 v[76:79], v10 offset:6144
    ds_read_b128 v[80:83], v10 offset:8192
    ds_read_b128 v[84:87], v10 offset:10240
    ds_read_b128 v[88:91], v10 offset:12288
    ds_read_b128 v[92:95], v10 offset:14336
    s_waitcnt vmcnt(0)
P0_JOIN:
    s_add_u32 s96, s6, 0
    s_addc_u32 s97, s7, 0
    s_mov_b32 s98, 16384
    s_mov_b32 s99, 0x20000
    s_lshl_b32 s25, s54, 7
    s_add_u32 s25, s25, s51
    s_lshl_b32 s25, s25, 3
    s_add_u32 s25, s25, 0
    s_lshl_b32 s21, s27, 1
    s_add_u32 s21, s21, s28
    s_lshl_b32 s21, s21, 10
    v_mov_b32 v20, 0x3f803f80
    v_mov_b32 v21, 0x3f803f80
    v_mov_b32 v22, 0x3f803f80
    v_mov_b32 v23, 0x3f803f80
    v_mov_b32 v24, 0
    v_mov_b32 v25, 0
    v_mov_b32 v26, 0
    v_mov_b32 v27, 0
    v_mov_b32 v28, 0
    v_mov_b32 v29, 0
    v_mov_b32 v30, 0
    v_mov_b32 v31, 0
    s_waitcnt lgkmcnt(0)
    s_barrier
    s_cmp_lg_u32 s28, 0
    s_cbranch_scc1 P1_B
    v_mfma_f32_16x16x32_bf16 v[128:131], v[32:35], v[64:67], 0
    s_cmp_lg_u32 s54, 0
    s_cbranch_scc1 P1_SA0
    s_add_u32 m0, s23, 16384
    s_mov_b32 s20, 128
    buffer_load_dwordx4 v2, s[12:15], s20 offen sc1 lds
P1_SA0:
    v_mfma_f32_16x16x32_bf16 v[160:163], v[36:39], v[64:67], 0
    s_cmp_lg_u32 s54, 0
    s_cbranch_scc1 P1_SA1
    buffer_load_dwordx4 v3, s[12:15], s20 offen offset:1024 sc1 lds
P1_SA1:
    v_mfma_f32_16x16x32_bf16 v[192:195], v[40:43], v[64:67], 0
    s_cmp_lg_u32 s54, 0
    s_cbranch_scc1 P1_SA2
    s_add_u32 m0, s23, 65536
    s_mov_b32 s20, 262272
    buffer_load_dwordx4 v2, s[12:15], s20 offen sc1 lds
P1_SA2:
    v_mfma_f32_16x16x32_bf16 v[224:227], v[44:47], v[64:67], 0
    s_cmp_lg_u32 s54, 0
    s_cbranch_scc1 P1_SA3
    buffer_load_dwordx4 v3, s[12:15], s20 offen offset:1024 sc1 lds
P1_SA3:
    v_mfma_f32_16x16x32_bf16 v[228:231], v[44:47], v[68:71], 0
    s_cmp_lg_u32 s54, 0
    s_cbranch_scc1 P1_SA4
    s_add_u32 m0, s24, 32768
    s_nop 0
    global_load_lds_dwordx4 v[4:5], off sc1
    s_add_u32 m0, s24, 34816
    v_lshl_add_u64 v[4:5], v[8:9], 0, v[4:5]
P1_SA4:
    v_mfma_f32_16x16x32_bf16 v[196:199], v[40:43], v[68:71], 0
    s_cmp_lg_u32 s54, 0
    s_cbranch_scc1 P1_SA5
    global_load_lds_dwordx4 v[6:7], off sc1
    v_lshl_add_u64 v[6:7], v[8:9], 0, v[6:7]
P1_SA5:
    v_mfma_f32_16x16x32_bf16 v[164:167], v[36:39], v[68:71], 0
    s_add_u32 m0, s24, 49152
    s_nop 0
    global_load_lds_dwordx4 v[4:5], off sc1
    s_add_u32 m0, s24, 51200
    v_lshl_add_u64 v[4:5], v[8:9], 0, v[4:5]
    v_mfma_f32_16x16x32_bf16 v[132:135], v[32:35], v[68:71], 0
    global_load_lds_dwordx4 v[6:7], off sc1
    v_lshl_add_u64 v[6:7], v[8:9], 0, v[6:7]
    v_mfma_f32_16x16x32_bf16 v[136:139], v[32:35], v[72:75], 0
    s_add_u32 m0, s23, 32768
    s_mov_b32 s20, 256
    buffer_load_dwordx4 v2, s[12:15], s20 offen sc1 lds
    v_mfma_f32_16x16x32_bf16 v[168:171], v[36:39], v[72:75], 0
    buffer_load_dwordx4 v3, s[12:15], s20 offen offset:1024 sc1 lds
    v_mfma_f32_16x16x32_bf16 v[24:27], v[32:35], v[20:23], v[24:27]
    s_add_u32 m0, s23, 81920
    s_mov_b32 s20, 262400
    buffer_load_dwordx4 v2, s[12:15], s20 offen sc1 lds
    v_mfma_f32_16x16x32_bf16 v[200:203], v[40:43], v[72:75], 0
    buffer_load_dwordx4 v3, s[12:15], s20 offen offset:1024 sc1 lds
    v_mfma_f32_16x16x32_bf16 v[232:235], v[44:47], v[72:75], 0
    s_add_u32 m0, s24, 0
    s_nop 0
    global_load_lds_dwordx4 v[4:5], off sc1
    s_add_u32 m0, s24, 2048
    v_lshl_add_u64 v[4:5], v[8:9], 0, v[4:5]
    v_mfma_f32_16x16x32_bf16 v[236:239], v[44:47], v[76:79], 0
    global_load_lds_dwordx4 v[6:7], off sc1
    v_lshl_add_u64 v[6:7], v[8:9], 0, v[6:7]
    v_mfma_f32_16x16x32_bf16 v[204:207], v[40:43], v[76:79], 0
    ds_read_b64_tr_b16 v[48:49], v12 offset:16384
    v_mfma_f32_16x16x32_bf16 v[172:175], v[36:39], v[76:79], 0
    ds_read_b64_tr_b16 v[50:51], v12 offset:20480
    v_mfma_f32_16x16x32_bf16 v[140:143], v[32:35], v[76:79], 0
    ds_read_b64_tr_b16 v[52:53], v13 offset:16384
    v_mfma_f32_16x16x32_bf16 v[144:147], v[32:35], v[80:83], 0
    ds_read_b64_tr_b16 v[54:55], v13 offset:20480
    v_mfma_f32_16x16x32_bf16 v[176:179], v[36:39], v[80:83], 0
    ds_read_b64_tr_b16 v[56:57], v12 offset:24576
    v_mfma_f32_16x16x32_bf16 v[208:211], v[40:43], v[80:83], 0
    ds_read_b64_tr_b16 v[58:59], v12 offset:28672
    v_mfma_f32_16x16x32_bf16 v[240:243], v[44:47], v[80:83], 0
    ds_read_b64_tr_b16 v[60:61], v13 offset:24576
    v_mfma_f32_16x16x32_bf16 v[28:31], v[40:43], v[20:23], v[28:31]
    ds_read_b64_tr_b16 v[62:63], v13 offset:28672
    v_mfma_f32_16x16x32_bf16 v[244:247], v[44:47], v[84:87], 0
    ds_read_b128 v[96:99], v11 offset:0
    v_mfma_f32_16x16x32_bf16 v[212:215], v[40:43], v[84:87], 0
    ds_read_b128 v[100:103], v11 offset:2048
    v_mfma_f32_16x16x32_bf16 v[180:183], v[36:39], v[84:87], 0
    ds_read_b128 v[104:107], v11 offset:4096
    v_mfma_f32_16x16x32_bf16 v[148:151], v[32:35], v[84:87], 0
    ds_read_b128 v[108:111], v11 offset:6144
    v_mfma_f32_16x16x32_bf16 v[152:155], v[32:35], v[88:91], 0
    ds_read_b128 v[112:115], v11 offset:8192
    v_mfma_f32_16x16x32_bf16 v[184:187], v[36:39], v[88:91], 0
    ds_read_b128 v[116:119], v11 offset:10240
    v_mfma_f32_16x16x32_bf16 v[216:219], v[40:43], v[88:91], 0
    ds_read_b128 v[120:123], v11 offset:12288
    v_mfma_f32_16x16x32_bf16 v[248:251], v[44:47], v[88:91], 0
    ds_read_b128 v[124:127], v11 offset:14336
    v_mfma_f32_16x16x32_bf16 v[252:255], v[44:47], v[92:95], 0
    v_mfma_f32_16x16x32_bf16 v[220:223], v[40:43], v[92:95], 0
    v_mfma_f32_16x16x32_bf16 v[188:191], v[36:39], v[92:95], 0
    v_mfma_f32_16x16x32_bf16 v[156:159], v[32:35], v[92:95], 0
    s_waitcnt vmcnt(8) lgkmcnt(0)
    s_barrier
    v_mfma_f32_16x16x32_bf16 v[128:131], v[48:51], v[96:99], v[128:131]
    s_add_u32 m0, s23, 0
    s_mov_b32 s20, 384
    buffer_load_dwordx4 v2, s[12:15], s20 offen sc1 lds
    v_mfma_f32_16x16x32_bf16 v[160:163], v[52:55], v[96:99], v[160:163]
    buffer_load_dwordx4 v3, s[12:15], s20 offen offset:1024 sc1 lds
    v_mfma_f32_16x16x32_bf16 v[192:195], v[56:59], v[96:99], v[192:195]
    s_add_u32 m0, s24, 16384
    s_nop 0
    global_load_lds_dwordx4 v[4:5], off sc1
    s_add_u32 m0, s24, 18432
    v_lshl_add_u64 v[4:5], v[8:9], 0, v[4:5]
    v_mfma_f32_16x16x32_bf16 v[224:227], v[60:63], v[96:99], v[224:227]
    global_load_lds_dwordx4 v[6:7], off sc1
    v_lshl_add_u64 v[6:7], v[8:9], 0, v[6:7]
    v_mfma_f32_16x16x32_bf16 v[228:231], v[60:63], v[100:103], v[228:231]
    ds_read_b64_tr_b16 v[32:33], v12 offset:32768
    v_mfma_f32_16x16x32_bf16 v[196:199], v[56:59], v[100:103], v[196:199]
    ds_read_b64_tr_b16 v[34:35], v12 offset:36864
    v_mfma_f32_16x16x32_bf16 v[164:167], v[52:55], v[100:103], v[164:167]
    ds_read_b64_tr_b16 v[36:37], v13 offset:32768
    v_mfma_f32_16x16x32_bf16 v[132:135], v[48:51], v[100:103], v[132:135]
    ds_read_b64_tr_b16 v[38:39], v13 offset:36864
    v_mfma_f32_16x16x32_bf16 v[136:139], v[48:51], v[104:107], v[136:139]
    ds_read_b64_tr_b16 v[40:41], v12 offset:40960
    v_mfma_f32_16x16x32_bf16 v[168:171], v[52:55], v[104:107], v[168:171]
    ds_read_b64_tr_b16 v[42:43], v12 offset:45056
    v_mfma_f32_16x16x32_bf16 v[24:27], v[48:51], v[20:23], v[24:27]
    ds_read_b64_tr_b16 v[44:45], v13 offset:40960
    v_mfma_f32_16x16x32_bf16 v[200:203], v[56:59], v[104:107], v[200:203]
    ds_read_b64_tr_b16 v[46:47], v13 offset:45056
    v_mfma_f32_16x16x32_bf16 v[232:235], v[60:63], v[104:107], v[232:235]
    ds_read_b128 v[64:67], v10 offset:16384
    v_mfma_f32_16x16x32_bf16 v[236:239], v[60:63], v[108:111], v[236:239]
    ds_read_b128 v[68:71], v10 offset:18432
    v_mfma_f32_16x16x32_bf16 v[204:207], v[56:59], v[108:111], v[204:207]
    ds_read_b128 v[72:75], v10 offset:20480
    v_mfma_f32_16x16x32_bf16 v[172:175], v[52:55], v[108:111], v[172:175]
    ds_read_b128 v[76:79], v10 offset:22528
    v_mfma_f32_16x16x32_bf16 v[140:143], v[48:51], v[108:111], v[140:143]
    ds_read_b128 v[80:83], v10 offset:24576
    v_mfma_f32_16x16x32_bf16 v[144:147], v[48:51], v[112:115], v[144:147]
    ds_read_b128 v[84:87], v10 offset:26624
    v_mfma_f32_16x16x32_bf16 v[176:179], v[52:55], v[112:115], v[176:179]
    ds_read_b128 v[88:91], v10 offset:28672
    v_mfma_f32_16x16x32_bf16 v[208:211], v[56:59], v[112:115], v[208:211]
    ds_read_b128 v[92:95], v10 offset:30720
    v_mfma_f32_16x16x32_bf16 v[240:243], v[60:63], v[112:115], v[240:243]
    v_mfma_f32_16x16x32_bf16 v[28:31], v[56:59], v[20:23], v[28:31]
    v_mfma_f32_16x16x32_bf16 v[244:247], v[60:63], v[116:119], v[244:247]
    v_mfma_f32_16x16x32_bf16 v[212:215], v[56:59], v[116:119], v[212:215]
    v_mfma_f32_16x16x32_bf16 v[180:183], v[52:55], v[116:119], v[180:183]
    v_mfma_f32_16x16x32_bf16 v[148:151], v[48:51], v[116:119], v[148:151]
    v_mfma_f32_16x16x32_bf16 v[152:155], v[48:51], v[120:123], v[152:155]
    v_mfma_f32_16x16x32_bf16 v[184:187], v[52:55], v[120:123], v[184:187]
    v_mfma_f32_16x16x32_bf16 v[216:219], v[56:59], v[120:123], v[216:219]
    v_mfma_f32_16x16x32_bf16 v[248:251], v[60:63], v[120:123], v[248:251]
    v_mfma_f32_16x16x32_bf16 v[252:255], v[60:63], v[124:127], v[252:255]
    v_mfma_f32_16x16x32_bf16 v[220:223], v[56:59], v[124:127], v[220:223]
    v_mfma_f32_16x16x32_bf16 v[188:191], v[52:55], v[124:127], v[188:191]
    v_mfma_f32_16x16x32_bf16 v[156:159], v[48:51], v[124:127], v[156:159]
    s_waitcnt vmcnt(10) lgkmcnt(0)
    s_barrier
    v_mfma_f32_16x16x32_bf16 v[128:131], v[32:35], v[64:67], v[128:131]
    s_cmp_lg_u32 s3, 0
    s_cbranch_scc1 P1_NF
    v_mov_b32 v16, s8
    v_mov_b32 v17, s9
    v_mov_b32 v18, s25
    s_mov_b64 exec, 1
    global_store_dwordx2 v18, v[16:17], s[58:59] sc1
    s_mov_b64 exec, -1
    s_xor_b32 s32, s100, 1
    s_lshl_b32 s32, s32, 7
    s_add_u32 s32, s32, 32768
    v_mov_b32 v0, s32
    global_load_dwordx2 v[16:17], v0, s[58:59] offset:64 sc1
P1_NF:
    v_mfma_f32_16x16x32_bf16 v[160:163], v[36:39], v[64:67], v[160:163]
    s_add_u32 m0, s23, 49152
    s_mov_b32 s20, 262528
    buffer_load_dwordx4 v2, s[12:15], s20 offen sc1 lds
    v_mfma_f32_16x16x32_bf16 v[192:195], v[40:43], v[64:67], v[192:195]
    buffer_load_dwordx4 v3, s[12:15], s20 offen offset:1024 sc1 lds
    v_mfma_f32_16x16x32_bf16 v[224:227], v[44:47], v[64:67], v[224:227]
    s_add_u32 m0, s24, 32768
    s_nop 0
    global_load_lds_dwordx4 v[4:5], off sc1
    s_add_u32 m0, s24, 34816
    v_lshl_add_u64 v[4:5], v[8:9], 0, v[4:5]
    v_mfma_f32_16x16x32_bf16 v[228:231], v[44:47], v[68:71], v[228:231]
    global_load_lds_dwordx4 v[6:7], off sc1
    v_lshl_add_u64 v[6:7], v[8:9], 0, v[6:7]
    v_mfma_f32_16x16x32_bf16 v[196:199], v[40:43], v[68:71], v[196:199]
    ds_read_b64_tr_b16 v[48:49], v12 offset:49152
    v_mfma_f32_16x16x32_bf16 v[164:167], v[36:39], v[68:71], v[164:167]
    ds_read_b64_tr_b16 v[50:51], v12 offset:53248
    v_mfma_f32_16x16x32_bf16 v[132:135], v[32:35], v[68:71], v[132:135]
    ds_read_b64_tr_b16 v[52:53], v13 offset:49152
    v_mfma_f32_16x16x32_bf16 v[136:139], v[32:35], v[72:75], v[136:139]
    ds_read_b64_tr_b16 v[54:55], v13 offset:53248
    v_mfma_f32_16x16x32_bf16 v[168:171], v[36:39], v[72:75], v[168:171]
    ds_read_b64_tr_b16 v[56:57], v12 offset:57344
    v_mfma_f32_16x16x32_bf16 v[24:27], v[32:35], v[20:23], v[24:27]
    ds_read_b64_tr_b16 v[58:59], v12 offset:61440
    v_mfma_f32_16x16x32_bf16 v[200:203], v[40:43], v[72:75], v[200:203]
    ds_read_b64_tr_b16 v[60:61], v13 offset:57344
    v_mfma_f32_16x16x32_bf16 v[232:235], v[44:47], v[72:75], v[232:235]
    ds_read_b64_tr_b16 v[62:63], v13 offset:61440
    v_mfma_f32_16x16x32_bf16 v[236:239], v[44:47], v[76:79], v[236:239]
    ds_read_b128 v[96:99], v11 offset:16384
    v_mfma_f32_16x16x32_bf16 v[204:207], v[40:43], v[76:79], v[204:207]
    ds_read_b128 v[100:103], v11 offset:18432
    v_mfma_f32_16x16x32_bf16 v[172:175], v[36:39], v[76:79], v[172:175]
    ds_read_b128 v[104:107], v11 offset:20480
    v_mfma_f32_16x16x32_bf16 v[140:143], v[32:35], v[76:79], v[140:143]
    ds_read_b128 v[108:111], v11 offset:22528
    v_mfma_f32_16x16x32_bf16 v[144:147], v[32:35], v[80:83], v[144:147]
    ds_read_b128 v[112:115], v11 offset:24576
    v_mfma_f32_16x16x32_bf16 v[176:179], v[36:39], v[80:83], v[176:179]
    ds_read_b128 v[116:119], v11 offset:26624
    v_mfma_f32_16x16x32_bf16 v[208:211], v[40:43], v[80:83], v[208:211]
    ds_read_b128 v[120:123], v11 offset:28672
    v_mfma_f32_16x16x32_bf16 v[240:243], v[44:47], v[80:83], v[240:243]
    ds_read_b128 v[124:127], v11 offset:30720
    v_mfma_f32_16x16x32_bf16 v[28:31], v[40:43], v[20:23], v[28:31]
    v_mfma_f32_16x16x32_bf16 v[244:247], v[44:47], v[84:87], v[244:247]
    v_mfma_f32_16x16x32_bf16 v[212:215], v[40:43], v[84:87], v[212:215]
    v_mfma_f32_16x16x32_bf16 v[180:183], v[36:39], v[84:87], v[180:183]
    v_mfma_f32_16x16x32_bf16 v[148:151], v[32:35], v[84:87], v[148:151]
    v_mfma_f32_16x16x32_bf16 v[152:155], v[32:35], v[88:91], v[152:155]
    v_mfma_f32_16x16x32_bf16 v[184:187], v[36:39], v[88:91], v[184:187]
    v_mfma_f32_16x16x32_bf16 v[216:219], v[40:43], v[88:91], v[216:219]
    v_mfma_f32_16x16x32_bf16 v[248:251], v[44:47], v[88:91], v[248:251]
    v_mfma_f32_16x16x32_bf16 v[252:255], v[44:47], v[92:95], v[252:255]
    v_mfma_f32_16x16x32_bf16 v[220:223], v[40:43], v[92:95], v[220:223]
    v_mfma_f32_16x16x32_bf16 v[188:191], v[36:39], v[92:95], v[188:191]
    v_mfma_f32_16x16x32_bf16 v[156:159], v[32:35], v[92:95], v[156:159]
    s_waitcnt vmcnt(8) lgkmcnt(0)
    s_cmp_lg_u32 s3, 0
    s_cbranch_scc1 P1_NQ
    s_waitcnt vmcnt(4)
    s_or_b32 s34, s8, 1
    s_mov_b32 s35, s9
    s_mov_b32 s33, 2097152
PL3:
    v_or_b32 v18, 1, v16
    v_mov_b32 v19, v17
    v_cmp_eq_u64 vcc, s[34:35], v[18:19]
    s_cmp_eq_u64 vcc, -1
    s_cbranch_scc1 PD3
    s_sub_u32 s33, s33, 1
    s_cbranch_scc1 PD3
    s_sleep 4
    s_xor_b32 s32, s100, 1
    s_lshl_b32 s32, s32, 7
    s_add_u32 s32, s32, 32768
    v_mov_b32 v0, s32
    global_load_dwordx2 v[16:17], v0, s[58:59] offset:64 sc1
    s_waitcnt vmcnt(0)
    s_branch PL3
PD3:
    v_readfirstlane_b32 s32, v16
    s_nop 0
    s_xor_b32 s32, s32, s8
    s_xor_b32 s32, s32, s54
    s_xor_b32 s33, s100, s2
    s_andn2_b32 s32, s33, s32
    s_and_b32 s32, s32, 1
    v_mov_b32 v19, s32
P1_NQ:
    s_barrier
    v_mfma_f32_16x16x32_bf16 v[128:131], v[48:51], v[96:99], v[128:131]
    s_cmp_lg_u32 s3, 0
    s_cbranch_scc1 P1_NW
    v_lshlrev_b32 v0, 11, v1
    v_add_u32 v0, 65536, v0
    s_mov_b64 exec, 0xff
    ds_write_b32 v0, v19
    s_mov_b64 exec, -1
P1_NW:
    v_mfma_f32_16x16x32_bf16 v[160:163], v[52:55], v[96:99], v[160:163]
    s_add_u32 m0, s23, 16384
    s_mov_b32 s20, 512
    buffer_load_dwordx4 v2, s[12:15], s20 offen sc1 lds
    v_mfma_f32_16x16x32_bf16 v[192:195], v[56:59], v[96:99], v[192:195]
    buffer_load_dwordx4 v3, s[12:15], s20 offen offset:1024 sc1 lds
    v_mfma_f32_16x16x32_bf16 v[224:227], v[60:63], v[96:99], v[224:227]
    s_add_u32 m0, s24, 49152
    s_nop 0
    global_load_lds_dwordx4 v[4:5], off sc1
    s_add_u32 m0, s24, 51200
    v_lshl_add_u64 v[4:5], v[8:9], 0, v[4:5]
    v_mfma_f32_16x16x32_bf16 v[228:231], v[60:63], v[100:103], v[228:231]
    global_load_lds_dwordx4 v[6:7], off sc1
    v_lshl_add_u64 v[6:7], v[8:9], 0, v[6:7]
    v_mfma_f32_16x16x32_bf16 v[196:199], v[56:59], v[100:103], v[196:199]
    ds_read_b64_tr_b16 v[32:33], v12 offset:0
    v_mfma_f32_16x16x32_bf16 v[164:167], v[52:55], v[100:103], v[164:167]
    ds_read_b64_tr_b16 v[34:35], v12 offset:4096
    v_mfma_f32_16x16x32_bf16 v[132:135], v[48:51], v[100:103], v[132:135]
    ds_read_b64_tr_b16 v[36:37], v13 offset:0
    v_mfma_f32_16x16x32_bf16 v[136:139], v[48:51], v[104:107], v[136:139]
    ds_read_b64_tr_b16 v[38:39], v13 offset:4096
    v_mfma_f32_16x16x32_bf16 v[168:171], v[52:55], v[104:107], v[168:171]
    ds_read_b64_tr_b16 v[40:41], v12 offset:8192
    v_mfma_f32_16x16x32_bf16 v[24:27], v[48:51], v[20:23], v[24:27]
    ds_read_b64_tr_b16 v[42:43], v12 offset:12288
    v_mfma_f32_16x16x32_bf16 v[200:203], v[56:59], v[104:107], v[200:203]
    ds_read_b64_tr_b16 v[44:45], v13 offset:8192
    v_mfma_f32_16x16x32_bf16 v[232:235], v[60:63], v[104:107], v[232:235]
    ds_read_b64_tr_b16 v[46:47], v13 offset:12288
    v_mfma_f32_16x16x32_bf16 v[236:239], v[60:63], v[108:111], v[236:239]
    ds_read_b128 v[64:67], v10 offset:32768
    v_mfma_f32_16x16x32_bf16 v[204:207], v[56:59], v[108:111], v[204:207]
    ds_read_b128 v[68:71], v10 offset:34816
    v_mfma_f32_16x16x32_bf16 v[172:175], v[52:55], v[108:111], v[172:175]
    ds_read_b128 v[72:75], v10 offset:36864
    v_mfma_f32_16x16x32_bf16 v[140:143], v[48:51], v[108:111], v[140:143]
    ds_read_b128 v[76:79], v10 offset:38912
    v_mfma_f32_16x16x32_bf16 v[144:147], v[48:51], v[112:115], v[144:147]
    ds_read_b128 v[80:83], v10 offset:40960
    v_mfma_f32_16x16x32_bf16 v[176:179], v[52:55], v[112:115], v[176:179]
    ds_read_b128 v[84:87], v10 offset:43008
    v_mfma_f32_16x16x32_bf16 v[208:211], v[56:59], v[112:115], v[208:211]
    ds_read_b128 v[88:91], v10 offset:45056
    v_mfma_f32_16x16x32_bf16 v[240:243], v[60:63], v[112:115], v[240:243]
    ds_read_b128 v[92:95], v10 offset:47104
    v_mfma_f32_16x16x32_bf16 v[28:31], v[56:59], v[20:23], v[28:31]
    v_mfma_f32_16x16x32_bf16 v[244:247], v[60:63], v[116:119], v[244:247]
    v_mfma_f32_16x16x32_bf16 v[212:215], v[56:59], v[116:119], v[212:215]
    v_mfma_f32_16x16x32_bf16 v[180:183], v[52:55], v[116:119], v[180:183]
    v_mfma_f32_16x16x32_bf16 v[148:151], v[48:51], v[116:119], v[148:151]
    v_mfma_f32_16x16x32_bf16 v[152:155], v[48:51], v[120:123], v[152:155]
    v_mfma_f32_16x16x32_bf16 v[184:187], v[52:55], v[120:123], v[184:187]
    v_mfma_f32_16x16x32_bf16 v[216:219], v[56:59], v[120:123], v[216:219]
    v_mfma_f32_16x16x32_bf16 v[248:251], v[60:63], v[120:123], v[248:251]
    v_mfma_f32_16x16x32_bf16 v[252:255], v[60:63], v[124:127], v[252:255]
    v_mfma_f32_16x16x32_bf16 v[220:223], v[56:59], v[124:127], v[220:223]
    v_mfma_f32_16x16x32_bf16 v[188:191], v[52:55], v[124:127], v[188:191]
    v_mfma_f32_16x16x32_bf16 v[156:159], v[48:51], v[124:127], v[156:159]
    s_waitcnt vmcnt(8) lgkmcnt(0)
    s_barrier
    s_add_u32 s32, s23, 65536
    v_mov_b32 v0, s32
    ds_read_b32 v0, v0
    s_waitcnt lgkmcnt(0)
    v_readfirstlane_b32 s32, v0
    s_nop 0
    s_cmp_lg_u32 s32, 0
    s_cbranch_scc1 KM_REDO
    v_mfma_f32_16x16x32_bf16 v[128:131], v[32:35], v[64:67], v[128:131]
    s_add_u32 m0, s23, 65536
    s_mov_b32 s20, 262656
    buffer_load_dwordx4 v2, s[12:15], s20 offen sc1 lds
    v_mfma_f32_16x16x32_bf16 v[160:163], v[36:39], v[64:67], v[160:163]
    buffer_load_dwordx4 v3, s[12:15], s20 offen offset:1024 sc1 lds
    v_mfma_f32_16x16x32_bf16 v[192:195], v[40:43], v[64:67], v[192:195]
    s_add_u32 m0, s24, 0
    s_nop 0
    global_load_lds_dwordx4 v[4:5], off sc1
    s_add_u32 m0, s24, 2048
    v_lshl_add_u64 v[4:5], v[8:9], 0, v[4:5]
    v_mfma_f32_16x16x32_bf16 v[224:227], v[44:47], v[64:67], v[224:227]
    global_load_lds_dwordx4 v[6:7], off sc1
    v_lshl_add_u64 v[6:7], v[8:9], 0, v[6:7]
    v_mfma_f32_16x16x32_bf16 v[228:231], v[44:47], v[68:71], v[228:231]
    ds_read_b64_tr_b16 v[48:49], v12 offset:16384
    v_mfma_f32_16x16x32_bf16 v[196:199], v[40:43], v[68:71], v[196:199]
    ds_read_b64_tr_b16 v[50:51], v12 offset:20480
    v_mfma_f32_16x16x32_bf16 v[164:167], v[36:39], v[68:71], v[164:167]
    ds_read_b64_tr_b16 v[52:53], v13 offset:16384
    v_mfma_f32_16x16x32_bf16 v[132:135], v[32:35], v[68:71], v[132:135]
    ds_read_b64_tr_b16 v[54:55], v13 offset:20480
    v_mfma_f32_16x16x32_bf16 v[136:139], v[32:35], v[72:75], v[136:139]
    ds_read_b64_tr_b16 v[56:57], v12 offset:24576
    v_mfma_f32_16x16x32_bf16 v[168:171], v[36:39], v[72:75], v[168:171]
    ds_read_b64_tr_b16 v[58:59], v12 offset:28672
    v_mfma_f32_16x16x32_bf16 v[24:27], v[32:35], v[20:23], v[24:27]
    ds_read_b64_tr_b16 v[60:61], v13 offset:24576
    v_mfma_f32_16x16x32_bf16 v[200:203], v[40:43], v[72:75], v[200:203]
    ds_read_b64_tr_b16 v[62:63], v13 offset:28672
    v_mfma_f32_16x16x32_bf16 v[232:235], v[44:47], v[72:75], v[232:235]
    ds_read_b128 v[96:99], v11 offset:32768
    v_mfma_f32_16x16x32_bf16 v[236:239], v[44:47], v[76:79], v[236:239]
    ds_read_b128 v[100:103], v11 offset:34816
    v_mfma_f32_16x16x32_bf16 v[204:207], v[40:43], v[76:79], v[204:207]
    ds_read_b128 v[104:107], v11 offset:36864
    v_mfma_f32_16x16x32_bf16 v[172:175], v[36:39], v[76:79], v[172:175]
    ds_read_b128 v[108:111], v11 offset:38912
    v_mfma_f32_16x16x32_bf16 v[140:143], v[32:35], v[76:79], v[140:143]
    ds_read_b128 v[112:115], v11 offset:40960
    v_mfma_f32_16x16x32_bf16 v[144:147], v[32:35], v[80:83], v[144:147]
    ds_read_b128 v[116:119], v11 offset:43008
    v_mfma_f32_16x16x32_bf16 v[176:179], v[36:39], v[80:83], v[176:179]
    ds_read_b128 v[120:123], v11 offset:45056
    v_mfma_f32_16x16x32_bf16 v[208:211], v[40:43], v[80:83], v[208:211]
    ds_read_b128 v[124:127], v11 offset:47104
    v_mfma_f32_16x16x32_bf16 v[240:243], v[44:47], v[80:83], v[240:243]
    v_mfma_f32_16x16x32_bf16 v[28:31], v[40:43], v[20:23], v[28:31]
    v_mfma_f32_16x16x32_bf16 v[244:247], v[44:47], v[84:87], v[244:247]
    v_mfma_f32_16x16x32_bf16 v[212:215], v[40:43], v[84:87], v[212:215]
    v_mfma_f32_16x16x32_bf16 v[180:183], v[36:39], v[84:87], v[180:183]
    v_mfma_f32_16x16x32_bf16 v[148:151], v[32:35], v[84:87], v[148:151]
    v_mfma_f32_16x16x32_bf16 v[152:155], v[32:35], v[88:91], v[152:155]
    v_mfma_f32_16x16x32_bf16 v[184:187], v[36:39], v[88:91], v[184:187]
    v_mfma_f32_16x16x32_bf16 v[216:219], v[40:43], v[88:91], v[216:219]
    v_mfma_f32_16x16x32_bf16 v[248:251], v[44:47], v[88:91], v[248:251]
    v_mfma_f32_16x16x32_bf16 v[252:255], v[44:47], v[92:95], v[252:255]
    v_mfma_f32_16x16x32_bf16 v[220:223], v[40:43], v[92:95], v[220:223]
    v_mfma_f32_16x16x32_bf16 v[188:191], v[36:39], v[92:95], v[188:191]
    v_mfma_f32_16x16x32_bf16 v[156:159], v[32:35], v[92:95], v[156:159]
    s_waitcnt vmcnt(8) lgkmcnt(0)
    s_barrier
    v_mfma_f32_16x16x32_bf16 v[128:131], v[48:51], v[96:99], v[128:131]
    s_cmp_lg_u32 s3, 0
    s_cbranch_scc1 P1_NP5
    v_mbcnt_lo_u32_b32 v16, -1, 0
    v_mbcnt_hi_u32_b32 v16, -1, v16
    v_lshlrev_b32 v16, 4, v16
    global_load_dwordx4 v[16:19], v16, s[58:59] offset:1024 sc1
P1_NP5:
    v_mfma_f32_16x16x32_bf16 v[160:163], v[52:55], v[96:99], v[160:163]
    s_add_u32 m0, s23, 32768
    s_mov_b32 s20, 640
    buffer_load_dwordx4 v2, s[12:15], s20 offen sc1 lds
    v_mfma_f32_16x16x32_bf16 v[192:195], v[56:59], v[96:99], v[192:195]
    buffer_load_dwordx4 v3, s[12:15], s20 offen offset:1024 sc1 lds
    v_mfma_f32_16x16x32_bf16 v[224:227], v[60:63], v[96:99], v[224:227]
    s_add_u32 m0, s24, 16384
    s_nop 0
    global_load_lds_dwordx4 v[4:5], off sc1
    s_add_u32 m0, s24, 18432
    v_lshl_add_u64 v[4:5], v[8:9], 0, v[4:5]
    v_mfma_f32_16x16x32_bf16 v[228:231], v[60:63], v[100:103], v[228:231]
    global_load_lds_dwordx4 v[6:7], off sc1
    v_lshl_add_u64 v[6:7], v[8:9], 0, v[6:7]
    v_mfma_f32_16x16x32_bf16 v[196:199], v[56:59], v[100:103], v[196:199]
    ds_read_b64_tr_b16 v[32:33], v12 offset:32768
    v_mfma_f32_16x16x32_bf16 v[164:167], v[52:55], v[100:103], v[164:167]
    ds_read_b64_tr_b16 v[34:35], v12 offset:36864
    v_mfma_f32_16x16x32_bf16 v[132:135], v[48:51], v[100:103], v[132:135]
    ds_read_b64_tr_b16 v[36:37], v13 offset:32768
    v_mfma_f32_16x16x32_bf16 v[136:139], v[48:51], v[104:107], v[136:139]
    ds_read_b64_tr_b16 v[38:39], v13 offset:36864
    v_mfma_f32_16x16x32_bf16 v[168:171], v[52:55], v[104:107], v[168:171]
    ds_read_b64_tr_b16 v[40:41], v12 offset:40960
    v_mfma_f32_16x16x32_bf16 v[24:27], v[48:51], v[20:23], v[24:27]
    ds_read_b64_tr_b16 v[42:43], v12 offset:45056
    v_mfma_f32_16x16x32_bf16 v[200:203], v[56:59], v[104:107], v[200:203]
    ds_read_b64_tr_b16 v[44:45], v13 offset:40960
    v_mfma_f32_16x16x32_bf16 v[232:235], v[60:63], v[104:107], v[232:235]
    ds_read_b64_tr_b16 v[46:47], v13 offset:45056
    v_mfma_f32_16x16x32_bf16 v[236:239], v[60:63], v[108:111], v[236:239]
    ds_read_b128 v[64:67], v10 offset:0
    v_mfma_f32_16x16x32_bf16 v[204:207], v[56:59], v[108:111], v[204:207]
    ds_read_b128 v[68:71], v10 offset:2048
    v_mfma_f32_16x16x32_bf16 v[172:175], v[52:55], v[108:111], v[172:175]
    ds_read_b128 v[72:75], v10 offset:4096
    v_mfma_f32_16x16x32_bf16 v[140:143], v[48:51], v[108:111], v[140:143]
    ds_read_b128 v[76:79], v10 offset:6144
    v_mfma_f32_16x16x32_bf16 v[144:147], v[48:51], v[112:115], v[144:147]
    ds_read_b128 v[80:83], v10 offset:8192
    v_mfma_f32_16x16x32_bf16 v[176:179], v[52:55], v[112:115], v[176:179]
    ds_read_b128 v[84:87], v10 offset:10240
    v_mfma_f32_16x16x32_bf16 v[208:211], v[56:59], v[112:115], v[208:211]
    ds_read_b128 v[88:91], v10 offset:12288
    v_mfma_f32_16x16x32_bf16 v[240:243], v[60:63], v[112:115], v[240:243]
    ds_read_b128 v[92:95], v10 offset:14336
    v_mfma_f32_16x16x32_bf16 v[28:31], v[56:59], v[20:23], v[28:31]
    v_mfma_f32_16x16x32_bf16 v[244:247], v[60:63], v[116:119], v[244:247]
    v_mfma_f32_16x16x32_bf16 v[212:215], v[56:59], v[116:119], v[212:215]
    v_mfma_f32_16x16x32_bf16 v[180:183], v[52:55], v[116:119], v[180:183]
    v_mfma_f32_16x16x32_bf16 v[148:151], v[48:51], v[116:119], v[148:151]
    v_mfma_f32_16x16x32_bf16 v[152:155], v[48:51], v[120:123], v[152:155]
    v_mfma_f32_16x16x32_bf16 v[184:187], v[52:55], v[120:123], v[184:187]
    v_mfma_f32_16x16x32_bf16 v[216:219], v[56:59], v[120:123], v[216:219]
    v_mfma_f32_16x16x32_bf16 v[248:251], v[60:63], v[120:123], v[248:251]
    v_mfma_f32_16x16x32_bf16 v[252:255], v[60:63], v[124:127], v[252:255]
    v_mfma_f32_16x16x32_bf16 v[220:223], v[56:59], v[124:127], v[220:223]
    v_mfma_f32_16x16x32_bf16 v[188:191], v[52:55], v[124:127], v[188:191]
    v_mfma_f32_16x16x32_bf16 v[156:159], v[48:51], v[124:127], v[156:159]
    s_waitcnt vmcnt(8) lgkmcnt(0)
    s_barrier
    v_mfma_f32_16x16x32_bf16 v[128:131], v[32:35], v[64:67], v[128:131]
    s_add_u32 m0, s23, 81920
    s_mov_b32 s20, 262784
    buffer_load_dwordx4 v2, s[12:15], s20 offen sc1 lds
    v_mfma_f32_16x16x32_bf16 v[160:163], v[36:39], v[64:67], v[160:163]
    buffer_load_dwordx4 v3, s[12:15], s20 offen offset:1024 sc1 lds
    v_mfma_f32_16x16x32_bf16 v[192:195], v[40:43], v[64:67], v[192:195]
    s_add_u32 m0, s24, 32768
    s_nop 0
    global_load_lds_dwordx4 v[4:5], off sc1
    s_add_u32 m0, s24, 34816
    v_lshl_add_u64 v[4:5], v[8:9], 0, v[4:5]
    v_mfma_f32_16x16x32_bf16 v[224:227], v[44:47], v[64:67], v[224:227]
    global_load_lds_dwordx4 v[6:7], off sc1
    v_lshl_add_u64 v[6:7], v[8:9], 0, v[6:7]
    v_mfma_f32_16x16x32_bf16 v[228:231], v[44:47], v[68:71], v[228:231]
    ds_read_b64_tr_b16 v[48:49], v12 offset:49152
    v_mfma_f32_16x16x32_bf16 v[196:199], v[40:43], v[68:71], v[196:199]
    ds_read_b64_tr_b16 v[50:51], v12 offset:53248
    v_mfma_f32_16x16x32_bf16 v[164:167], v[36:39], v[68:71], v[164:167]
    ds_read_b64_tr_b16 v[52:53], v13 offset:49152
    v_mfma_f32_16x16x32_bf16 v[132:135], v[32:35], v[68:71], v[132:135]
    ds_read_b64_tr_b16 v[54:55], v13 offset:53248
    v_mfma_f32_16x16x32_bf16 v[136:139], v[32:35], v[72:75], v[136:139]
    ds_read_b64_tr_b16 v[56:57], v12 offset:57344
    v_mfma_f32_16x16x32_bf16 v[168:171], v[36:39], v[72:75], v[168:171]
    ds_read_b64_tr_b16 v[58:59], v12 offset:61440
    v_mfma_f32_16x16x32_bf16 v[24:27], v[32:35], v[20:23], v[24:27]
    ds_read_b64_tr_b16 v[60:61], v13 offset:57344
    v_mfma_f32_16x16x32_bf16 v[200:203], v[40:43], v[72:75], v[200:203]
    ds_read_b64_tr_b16 v[62:63], v13 offset:61440
    v_mfma_f32_16x16x32_bf16 v[232:235], v[44:47], v[72:75], v[232:235]
    ds_read_b128 v[96:99], v11 offset:0
    v_mfma_f32_16x16x32_bf16 v[236:239], v[44:47], v[76:79], v[236:239]
    ds_read_b128 v[100:103], v11 offset:2048
    v_mfma_f32_16x16x32_bf16 v[204:207], v[40:43], v[76:79], v[204:207]
    ds_read_b128 v[104:107], v11 offset:4096
    v_mfma_f32_16x16x32_bf16 v[172:175], v[36:39], v[76:79], v[172:175]
    ds_read_b128 v[108:111], v11 offset:6144
    v_mfma_f32_16x16x32_bf16 v[140:143], v[32:35], v[76:79], v[140:143]
    ds_read_b128 v[112:115], v11 offset:8192
    v_mfma_f32_16x16x32_bf16 v[144:147], v[32:35], v[80:83], v[144:147]
    ds_read_b128 v[116:119], v11 offset:10240
    v_mfma_f32_16x16x32_bf16 v[176:179], v[36:39], v[80:83], v[176:179]
    ds_read_b128 v[120:123], v11 offset:12288
    v_mfma_f32_16x16x32_bf16 v[208:211], v[40:43], v[80:83], v[208:211]
    ds_read_b128 v[124:127], v11 offset:14336
    v_mfma_f32_16x16x32_bf16 v[240:243], v[44:47], v[80:83], v[240:243]
    v_mfma_f32_16x16x32_bf16 v[28:31], v[40:43], v[20:23], v[28:31]
    v_mfma_f32_16x16x32_bf16 v[244:247], v[44:47], v[84:87], v[244:247]
    v_mfma_f32_16x16x32_bf16 v[212:215], v[40:43], v[84:87], v[212:215]
    v_mfma_f32_16x16x32_bf16 v[180:183], v[36:39], v[84:87], v[180:183]
    v_mfma_f32_16x16x32_bf16 v[148:151], v[32:35], v[84:87], v[148:151]
    v_mfma_f32_16x16x32_bf16 v[152:155], v[32:35], v[88:91], v[152:155]
    v_mfma_f32_16x16x32_bf16 v[184:187], v[36:39], v[88:91], v[184:187]
    v_mfma_f32_16x16x32_bf16 v[216:219], v[40:43], v[88:91], v[216:219]
    v_mfma_f32_16x16x32_bf16 v[248:251], v[44:47], v[88:91], v[248:251]
    v_mfma_f32_16x16x32_bf16 v[252:255], v[44:47], v[92:95], v[252:255]
    v_mfma_f32_16x16x32_bf16 v[220:223], v[40:43], v[92:95], v[220:223]
    v_mfma_f32_16x16x32_bf16 v[188:191], v[36:39], v[92:95], v[188:191]
    v_mfma_f32_16x16x32_bf16 v[156:159], v[32:35], v[92:95], v[156:159]
    s_waitcnt vmcnt(8) lgkmcnt(0)
    s_cmp_lg_u32 s3, 0
    s_cbranch_scc1 P1_NC6
    s_waitcnt vmcnt(8)
    s_mov_b32 s33, 2097152
PL4:
    v_cmp_eq_u64 vcc, s[8:9], v[16:17]
    v_cmp_eq_u64 s[34:35], s[8:9], v[18:19]
    s_and_b64 vcc, vcc, s[34:35]
    s_cmp_eq_u64 vcc, -1
    s_cbranch_scc1 PD4
    s_sub_u32 s33, s33, 1
    s_cbranch_scc1 PD4
    s_sleep 8
    v_mbcnt_lo_u32_b32 v16, -1, 0
    v_mbcnt_hi_u32_b32 v16, -1, v16
    v_lshlrev_b32 v16, 4, v16
    global_load_dwordx4 v[16:19], v16, s[58:59] offset:1024 sc1
    s_waitcnt vmcnt(0)
    s_branch PL4
PD4:
P1_NC6:
    s_barrier
    v_mfma_f32_16x16x32_bf16 v[128:131], v[48:51], v[96:99], v[128:131]
    s_mov_b64 exec, s[10:11]
    v_mov_b32 v4, v14
    v_mov_b32 v5, v15
    v_mov_b32 v8, 512
    v_lshl_add_u64 v[6:7], v[8:9], 0, v[4:5]
    v_mov_b32 v8, 2048
    s_mov_b64 exec, -1
    v_mfma_f32_16x16x32_bf16 v[160:163], v[52:55], v[96:99], v[160:163]
    s_add_u32 m0, s23, 0
    s_mov_b32 s20, 768
    buffer_load_dwordx4 v2, s[12:15], s20 offen sc1 lds
    v_mfma_f32_16x16x32_bf16 v[192:195], v[56:59], v[96:99], v[192:195]
    buffer_load_dwordx4 v3, s[12:15], s20 offen offset:1024 sc1 lds
    v_mfma_f32_16x16x32_bf16 v[224:227], v[60:63], v[96:99], v[224:227]
    s_add_u32 m0, s24, 49152
    s_nop 0
    global_load_lds_dwordx4 v[4:5], off sc1
    s_add_u32 m0, s24, 51200
    v_lshl_add_u64 v[4:5], v[8:9], 0, v[4:5]
    v_mfma_f32_16x16x32_bf16 v[228:231], v[60:63], v[100:103], v[228:231]
    global_load_lds_dwordx4 v[6:7], off sc1
    v_lshl_add_u64 v[6:7], v[8:9], 0, v[6:7]
    v_mfma_f32_16x16x32_bf16 v[196:199], v[56:59], v[100:103], v[196:199]
    ds_read_b64_tr_b16 v[32:33], v12 offset:0
    v_mfma_f32_16x16x32_bf16 v[164:167], v[52:55], v[100:103], v[164:167]
    ds_read_b64_tr_b16 v[34:35], v12 offset:4096
    v_mfma_f32_16x16x32_bf16 v[132:135], v[48:51], v[100:103], v[132:135]
    ds_read_b64_tr_b16 v[36:37], v13 offset:0
    v_mfma_f32_16x16x32_bf16 v[136:139], v[48:51], v[104:107], v[136:139]
    ds_read_b64_tr_b16 v[38:39], v13 offset:4096
    v_mfma_f32_16x16x32_bf16 v[168:171], v[52:55], v[104:107], v[168:171]
    ds_read_b64_tr_b16 v[40:41], v12 offset:8192
    v_mfma_f32_16x16x32_bf16 v[24:27], v[48:51], v[20:23], v[24:27]
    ds_read_b64_tr_b16 v[42:43], v12 offset:12288
    v_mfma_f32_16x16x32_bf16 v[200:203], v[56:59], v[104:107], v[200:203]
    ds_read_b64_tr_b16 v[44:45], v13 offset:8192
    v_mfma_f32_16x16x32_bf16 v[232:235], v[60:63], v[104:107], v[232:235]
    ds_read_b64_tr_b16 v[46:47], v13 offset:12288
    v_mfma_f32_16x16x32_bf16 v[236:239], v[60:63], v[108:111], v[236:239]
    ds_read_b128 v[64:67], v10 offset:16384
    v_mfma_f32_16x16x32_bf16 v[204:207], v[56:59], v[108:111], v[204:207]
    ds_read_b128 v[68:71], v10 offset:18432
    v_mfma_f32_16x16x32_bf16 v[172:175], v[52:55], v[108:111], v[172:175]
    ds_read_b128 v[72:75], v10 offset:20480
    v_mfma_f32_16x16x32_bf16 v[140:143], v[48:51], v[108:111], v[140:143]
    ds_read_b128 v[76:79], v10 offset:22528
    v_mfma_f32_16x16x32_bf16 v[144:147], v[48:51], v[112:115], v[144:147]
    ds_read_b128 v[80:83], v10 offset:24576
    v_mfma_f32_16x16x32_bf16 v[176:179], v[52:55], v[112:115], v[176:179]
    ds_read_b128 v[84:87], v10 offset:26624
    v_mfma_f32_16x16x32_bf16 v[208:211], v[56:59], v[112:115], v[208:211]
    ds_read_b128 v[88:91], v10 offset:28672
    v_mfma_f32_16x16x32_bf16 v[240:243], v[60:63], v[112:115], v[240:243]
    ds_read_b128 v[92:95], v10 offset:30720
    v_mfma_f32_16x16x32_bf16 v[28:31], v[56:59], v[20:23], v[28:31]
    v_mfma_f32_16x16x32_bf16 v[244:247], v[60:63], v[116:119], v[244:247]
    v_mfma_f32_16x16x32_bf16 v[212:215], v[56:59], v[116:119], v[212:215]
    v_mfma_f32_16x16x32_bf16 v[180:183], v[52:55], v[116:119], v[180:183]
    v_mfma_f32_16x16x32_bf16 v[148:151], v[48:51], v[116:119], v[148:151]
    v_mfma_f32_16x16x32_bf16 v[152:155], v[48:51], v[120:123], v[152:155]
    v_mfma_f32_16x16x32_bf16 v[184:187], v[52:55], v[120:123], v[184:187]
    v_mfma_f32_16x16x32_bf16 v[216:219], v[56:59], v[120:123], v[216:219]
    v_mfma_f32_16x16x32_bf16 v[248:251], v[60:63], v[120:123], v[248:251]
    v_mfma_f32_16x16x32_bf16 v[252:255], v[60:63], v[124:127], v[252:255]
    v_mfma_f32_16x16x32_bf16 v[220:223], v[56:59], v[124:127], v[220:223]
    v_mfma_f32_16x16x32_bf16 v[188:191], v[52:55], v[124:127], v[188:191]
    v_mfma_f32_16x16x32_bf16 v[156:159], v[48:51], v[124:127], v[156:159]
    s_waitcnt vmcnt(8) lgkmcnt(0)
    s_barrier
    v_mfma_f32_16x16x32_bf16 v[128:131], v[32:35], v[64:67], v[128:131]
    s_add_u32 m0, s23, 49152
    s_mov_b32 s20, 262912
    buffer_load_dwordx4 v2, s[12:15], s20 offen sc1 lds
    v_mfma_f32_16x16x32_bf16 v[160:163], v[36:39], v[64:67], v[160:163]
    buffer_load_dwordx4 v3, s[12:15], s20 offen offset:1024 sc1 lds
    v_mfma_f32_16x16x32_bf16 v[192:195], v[40:43], v[64:67], v[192:195]
    s_add_u32 m0, s24, 0
    s_nop 0
    global_load_lds_dwordx4 v[4:5], off sc1
    s_add_u32 m0, s24, 2048
    v_lshl_add_u64 v[4:5], v[8:9], 0, v[4:5]
    v_mfma_f32_16x16x32_bf16 v[224:227], v[44:47], v[64:67], v[224:227]
    global_load_lds_dwordx4 v[6:7], off sc1
    v_lshl_add_u64 v[6:7], v[8:9], 0, v[6:7]
    v_mfma_f32_16x16x32_bf16 v[228:231], v[44:47], v[68:71], v[228:231]
    ds_read_b64_tr_b16 v[48:49], v12 offset:16384
    v_mfma_f32_16x16x32_bf16 v[196:199], v[40:43], v[68:71], v[196:199]
    ds_read_b64_tr_b16 v[50:51], v12 offset:20480
    v_mfma_f32_16x16x32_bf16 v[164:167], v[36:39], v[68:71], v[164:167]
    ds_read_b64_tr_b16 v[52:53], v13 offset:16384
    v_mfma_f32_16x16x32_bf16 v[132:135], v[32:35], v[68:71], v[132:135]
    ds_read_b64_tr_b16 v[54:55], v13 offset:20480
    v_mfma_f32_16x16x32_bf16 v[136:139], v[32:35], v[72:75], v[136:139]
    ds_read_b64_tr_b16 v[56:57], v12 offset:24576
    v_mfma_f32_16x16x32_bf16 v[168:171], v[36:39], v[72:75], v[168:171]
    ds_read_b64_tr_b16 v[58:59], v12 offset:28672
    v_mfma_f32_16x16x32_bf16 v[24:27], v[32:35], v[20:23], v[24:27]
    ds_read_b64_tr_b16 v[60:61], v13 offset:24576
    v_mfma_f32_16x16x32_bf16 v[200:203], v[40:43], v[72:75], v[200:203]
    ds_read_b64_tr_b16 v[62:63], v13 offset:28672
    v_mfma_f32_16x16x32_bf16 v[232:235], v[44:47], v[72:75], v[232:235]
    ds_read_b128 v[96:99], v11 offset:16384
    v_mfma_f32_16x16x32_bf16 v[236:239], v[44:47], v[76:79], v[236:239]
    ds_read_b128 v[100:103], v11 offset:18432
    v_mfma_f32_16x16x32_bf16 v[204:207], v[40:43], v[76:79], v[204:207]
    ds_read_b128 v[104:107], v11 offset:20480
    v_mfma_f32_16x16x32_bf16 v[172:175], v[36:39], v[76:79], v[172:175]
    ds_read_b128 v[108:111], v11 offset:22528
    v_mfma_f32_16x16x32_bf16 v[140:143], v[32:35], v[76:79], v[140:143]
    ds_read_b128 v[112:115], v11 offset:24576
    v_mfma_f32_16x16x32_bf16 v[144:147], v[32:35], v[80:83], v[144:147]
    ds_read_b128 v[116:119], v11 offset:26624
    v_mfma_f32_16x16x32_bf16 v[176:179], v[36:39], v[80:83], v[176:179]
    ds_read_b128 v[120:123], v11 offset:28672
    v_mfma_f32_16x16x32_bf16 v[208:211], v[40:43], v[80:83], v[208:211]
    ds_read_b128 v[124:127], v11 offset:30720
    v_mfma_f32_16x16x32_bf16 v[240:243], v[44:47], v[80:83], v[240:243]
    v_mfma_f32_16x16x32_bf16 v[28:31], v[40:43], v[20:23], v[28:31]
    v_mfma_f32_16x16x32_bf16 v[244:247], v[44:47], v[84:87], v[244:247]
    v_mfma_f32_16x16x32_bf16 v[212:215], v[40:43], v[84:87], v[212:215]
    v_mfma_f32_16x16x32_bf16 v[180:183], v[36:39], v[84:87], v[180:183]
    v_mfma_f32_16x16x32_bf16 v[148:151], v[32:35], v[84:87], v[148:151]
    v_mfma_f32_16x16x32_bf16 v[152:155], v[32:35], v[88:91], v[152:155]
    v_mfma_f32_16x16x32_bf16 v[184:187], v[36:39], v[88:91], v[184:187]
    v_mfma_f32_16x16x32_bf16 v[216:219], v[40:43], v[88:91], v[216:219]
    v_mfma_f32_16x16x32_bf16 v[248:251], v[44:47], v[88:91], v[248:251]
    v_mfma_f32_16x16x32_bf16 v[252:255], v[44:47], v[92:95], v[252:255]
    v_mfma_f32_16x16x32_bf16 v[220:223], v[40:43], v[92:95], v[220:223]
    v_mfma_f32_16x16x32_bf16 v[188:191], v[36:39], v[92:95], v[188:191]
    v_mfma_f32_16x16x32_bf16 v[156:159], v[32:35], v[92:95], v[156:159]
    s_waitcnt vmcnt(8) lgkmcnt(0)
    s_barrier
    v_mfma_f32_16x16x32_bf16 v[128:131], v[48:51], v[96:99], v[128:131]
    s_add_u32 m0, s23, 16384
    s_mov_b32 s20, 896
    buffer_load_dwordx4 v2, s[12:15], s20 offen sc1 lds
    v_mfma_f32_16x16x32_bf16 v[160:163], v[52:55], v[96:99], v[160:163]
    buffer_load_dwordx4 v3, s[12:15], s20 offen offset:1024 sc1 lds
    v_mfma_f32_16x16x32_bf16 v[192:195], v[56:59], v[96:99], v[192:195]
    s_add_u32 m0, s24, 16384
    s_nop 0
    global_load_lds_dwordx4 v[4:5], off sc1
    s_add_u32 m0, s24, 18432
    v_lshl_add_u64 v[4:5], v[8:9], 0, v[4:5]
    v_mfma_f32_16x16x32_bf16 v[224:227], v[60:63], v[96:99], v[224:227]
    global_load_lds_dwordx4 v[6:7], off sc1
    v_lshl_add_u64 v[6:7], v[8:9], 0, v[6:7]
    v_mfma_f32_16x16x32_bf16 v[228:231], v[60:63], v[100:103], v[228:231]
    ds_read_b64_tr_b16 v[32:33], v12 offset:32768
    v_mfma_f32_16x16x32_bf16 v[196:199], v[56:59], v[100:103], v[196:199]
    ds_read_b64_tr_b16 v[34:35], v12 offset:36864
    v_mfma_f32_16x16x32_bf16 v[164:167], v[52:55], v[100:103], v[164:167]
    ds_read_b64_tr_b16 v[36:37], v13 offset:32768
    v_mfma_f32_16x16x32_bf16 v[132:135], v[48:51], v[100:103], v[132:135]
    ds_read_b64_tr_b16 v[38:39], v13 offset:36864
    v_mfma_f32_16x16x32_bf16 v[136:139], v[48:51], v[104:107], v[136:139]
    ds_read_b64_tr_b16 v[40:41], v12 offset:40960
    v_mfma_f32_16x16x32_bf16 v[168:171], v[52:55], v[104:107], v[168:171]
    ds_read_b64_tr_b16 v[42:43], v12 offset:45056
    v_mfma_f32_16x16x32_bf16 v[24:27], v[48:51], v[20:23], v[24:27]
    ds_read_b64_tr_b16 v[44:45], v13 offset:40960
    v_mfma_f32_16x16x32_bf16 v[200:203], v[56:59], v[104:107], v[200:203]
    ds_read_b64_tr_b16 v[46:47], v13 offset:45056
    v_mfma_f32_16x16x32_bf16 v[232:235], v[60:63], v[104:107], v[232:235]
    ds_read_b128 v[64:67], v10 offset:32768
    v_mfma_f32_16x16x32_bf16 v[236:239], v[60:63], v[108:111], v[236:239]
    ds_read_b128 v[68:71], v10 offset:34816
    v_mfma_f32_16x16x32_bf16 v[204:207], v[56:59], v[108:111], v[204:207]
    ds_read_b128 v[72:75], v10 offset:36864
    v_mfma_f32_16x16x32_bf16 v[172:175], v[52:55], v[108:111], v[172:175]
    ds_read_b128 v[76:79], v10 offset:38912
    v_mfma_f32_16x16x32_bf16 v[140:143], v[48:51], v[108:111], v[140:143]
    ds_read_b128 v[80:83], v10 offset:40960
    v_mfma_f32_16x16x32_bf16 v[144:147], v[48:51], v[112:115], v[144:147]
    ds_read_b128 v[84:87], v10 offset:43008
    v_mfma_f32_16x16x32_bf16 v[176:179], v[52:55], v[112:115], v[176:179]
    ds_read_b128 v[88:91], v10 offset:45056
    v_mfma_f32_16x16x32_bf16 v[208:211], v[56:59], v[112:115], v[208:211]
    ds_read_b128 v[92:95], v10 offset:47104
    v_mfma_f32_16x16x32_bf16 v[240:243], v[60:63], v[112:115], v[240:243]
    v_mfma_f32_16x16x32_bf16 v[28:31], v[56:59], v[20:23], v[28:31]
    v_mfma_f32_16x16x32_bf16 v[244:247], v[60:63], v[116:119], v[244:247]
    v_mfma_f32_16x16x32_bf16 v[212:215], v[56:59], v[116:119], v[212:215]
    v_mfma_f32_16x16x32_bf16 v[180:183], v[52:55], v[116:119], v[180:183]
    v_mfma_f32_16x16x32_bf16 v[148:151], v[48:51], v[116:119], v[148:151]
    v_mfma_f32_16x16x32_bf16 v[152:155], v[48:51], v[120:123], v[152:155]
    v_mfma_f32_16x16x32_bf16 v[184:187], v[52:55], v[120:123], v[184:187]
    v_mfma_f32_16x16x32_bf16 v[216:219], v[56:59], v[120:123], v[216:219]
    v_mfma_f32_16x16x32_bf16 v[248:251], v[60:63], v[120:123], v[248:251]
    v_mfma_f32_16x16x32_bf16 v[252:255], v[60:63], v[124:127], v[252:255]
    v_mfma_f32_16x16x32_bf16 v[220:223], v[56:59], v[124:127], v[220:223]
    v_mfma_f32_16x16x32_bf16 v[188:191], v[52:55], v[124:127], v[188:191]
    v_mfma_f32_16x16x32_bf16 v[156:159], v[48:51], v[124:127], v[156:159]
    s_waitcnt vmcnt(8) lgkmcnt(0)
    s_barrier
    v_mfma_f32_16x16x32_bf16 v[128:131], v[32:35], v[64:67], v[128:131]
    s_add_u32 m0, s23, 65536
    s_mov_b32 s20, 263040
    buffer_load_dwordx4 v2, s[12:15], s20 offen sc1 lds
    v_mfma_f32_16x16x32_bf16 v[160:163], v[36:39], v[64:67], v[160:163]
    buffer_load_dwordx4 v3, s[12:15], s20 offen offset:1024 sc1 lds
    v_mfma_f32_16x16x32_bf16 v[192:195], v[40:43], v[64:67], v[192:195]
    s_add_u32 m0, s24, 32768
    s_nop 0
    global_load_lds_dwordx4 v[4:5], off sc1
    s_add_u32 m0, s24, 34816
    v_lshl_add_u64 v[4:5], v[8:9], 0, v[4:5]
    v_mfma_f32_16x16x32_bf16 v[224:227], v[44:47], v[64:67], v[224:227]
    global_load_lds_dwordx4 v[6:7], off sc1
    v_lshl_add_u64 v[6:7], v[8:9], 0, v[6:7]
    v_mfma_f32_16x16x32_bf16 v[228:231], v[44:47], v[68:71], v[228:231]
    ds_read_b64_tr_b16 v[48:49], v12 offset:49152
    v_mfma_f32_16x16x32_bf16 v[196:199], v[40:43], v[68:71], v[196:199]
    ds_read_b64_tr_b16 v[50:51], v12 offset:53248
    v_mfma_f32_16x16x32_bf16 v[164:167], v[36:39], v[68:71], v[164:167]
    ds_read_b64_tr_b16 v[52:53], v13 offset:49152
    v_mfma_f32_16x16x32_bf16 v[132:135], v[32:35], v[68:71], v[132:135]
    ds_read_b64_tr_b16 v[54:55], v13 offset:53248
    v_mfma_f32_16x16x32_bf16 v[136:139], v[32:35], v[72:75], v[136:139]
    ds_read_b64_tr_b16 v[56:57], v12 offset:57344
    v_mfma_f32_16x16x32_bf16 v[168:171], v[36:39], v[72:75], v[168:171]
    ds_read_b64_tr_b16 v[58:59], v12 offset:61440
    v_mfma_f32_16x16x32_bf16 v[24:27], v[32:35], v[20:23], v[24:27]
    ds_read_b64_tr_b16 v[60:61], v13 offset:57344
    v_mfma_f32_16x16x32_bf16 v[200:203], v[40:43], v[72:75], v[200:203]
    ds_read_b64_tr_b16 v[62:63], v13 offset:61440
    v_mfma_f32_16x16x32_bf16 v[232:235], v[44:47], v[72:75], v[232:235]
    ds_read_b128 v[96:99], v11 offset:32768
    v_mfma_f32_16x16x32_bf16 v[236:239], v[44:47], v[76:79], v[236:239]
    ds_read_b128 v[100:103], v11 offset:34816
    v_mfma_f32_16x16x32_bf16 v[204:207], v[40:43], v[76:79], v[204:207]
    ds_read_b128 v[104:107], v11 offset:36864
    v_mfma_f32_16x16x32_bf16 v[172:175], v[36:39], v[76:79], v[172:175]
    ds_read_b128 v[108:111], v11 offset:38912
    v_mfma_f32_16x16x32_bf16 v[140:143], v[32:35], v[76:79], v[140:143]
    ds_read_b128 v[112:115], v11 offset:40960
    v_mfma_f32_16x16x32_bf16 v[144:147], v[32:35], v[80:83], v[144:147]
    ds_read_b128 v[116:119], v11 offset:43008
    v_mfma_f32_16x16x32_bf16 v[176:179], v[36:39], v[80:83], v[176:179]
    ds_read_b128 v[120:123], v11 offset:45056
    v_mfma_f32_16x16x32_bf16 v[208:211], v[40:43], v[80:83], v[208:211]
    ds_read_b128 v[124:127], v11 offset:47104
    v_mfma_f32_16x16x32_bf16 v[240:243], v[44:47], v[80:83], v[240:243]
    v_mfma_f32_16x16x32_bf16 v[28:31], v[40:43], v[20:23], v[28:31]
    v_mfma_f32_16x16x32_bf16 v[244:247], v[44:47], v[84:87], v[244:247]
    v_mfma_f32_16x16x32_bf16 v[212:215], v[40:43], v[84:87], v[212:215]
    v_mfma_f32_16x16x32_bf16 v[180:183], v[36:39], v[84:87], v[180:183]
    v_mfma_f32_16x16x32_bf16 v[148:151], v[32:35], v[84:87], v[148:151]
    v_mfma_f32_16x16x32_bf16 v[152:155], v[32:35], v[88:91], v[152:155]
    v_mfma_f32_16x16x32_bf16 v[184:187], v[36:39], v[88:91], v[184:187]
    v_mfma_f32_16x16x32_bf16 v[216:219], v[40:43], v[88:91], v[216:219]
    v_mfma_f32_16x16x32_bf16 v[248:251], v[44:47], v[88:91], v[248:251]
    v_mfma_f32_16x16x32_bf16 v[252:255], v[44:47], v[92:95], v[252:255]
    v_mfma_f32_16x16x32_bf16 v[220:223], v[40:43], v[92:95], v[220:223]
    v_mfma_f32_16x16x32_bf16 v[188:191], v[36:39], v[92:95], v[188:191]
    v_mfma_f32_16x16x32_bf16 v[156:159], v[32:35], v[92:95], v[156:159]
    s_waitcnt vmcnt(8) lgkmcnt(0)
    s_barrier
    v_mfma_f32_16x16x32_bf16 v[128:131], v[48:51], v[96:99], v[128:131]
    s_add_u32 m0, s23, 32768
    s_mov_b32 s20, 1024
    buffer_load_dwordx4 v2, s[12:15], s20 offen sc1 lds
    v_mfma_f32_16x16x32_bf16 v[160:163], v[52:55], v[96:99], v[160:163]
    buffer_load_dwordx4 v3, s[12:15], s20 offen offset:1024 sc1 lds
    v_mfma_f32_16x16x32_bf16 v[192:195], v[56:59], v[96:99], v[192:195]
    s_add_u32 m0, s24, 49152
    s_nop 0
    global_load_lds_dwordx4 v[4:5], off sc1
    s_add_u32 m0, s24, 51200
    v_lshl_add_u64 v[4:5], v[8:9], 0, v[4:5]
    v_mfma_f32_16x16x32_bf16 v[224:227], v[60:63], v[96:99], v[224:227]
    global_load_lds_dwordx4 v[6:7], off sc1
    v_lshl_add_u64 v[6:7], v[8:9], 0, v[6:7]
    v_mfma_f32_16x16x32_bf16 v[228:231], v[60:63], v[100:103], v[228:231]
    ds_read_b64_tr_b16 v[32:33], v12 offset:0
    v_mfma_f32_16x16x32_bf16 v[196:199], v[56:59], v[100:103], v[196:199]
    ds_read_b64_tr_b16 v[34:35], v12 offset:4096
    v_mfma_f32_16x16x32_bf16 v[164:167], v[52:55], v[100:103], v[164:167]
    ds_read_b64_tr_b16 v[36:37], v13 offset:0
    v_mfma_f32_16x16x32_bf16 v[132:135], v[48:51], v[100:103], v[132:135]
    ds_read_b64_tr_b16 v[38:39], v13 offset:4096
    v_mfma_f32_16x16x32_bf16 v[136:139], v[48:51], v[104:107], v[136:139]
    ds_read_b64_tr_b16 v[40:41], v12 offset:8192
    v_mfma_f32_16x16x32_bf16 v[168:171], v[52:55], v[104:107], v[168:171]
    ds_read_b64_tr_b16 v[42:43], v12 offset:12288
    v_mfma_f32_16x16x32_bf16 v[24:27], v[48:51], v[20:23], v[24:27]
    ds_read_b64_tr_b16 v[44:45], v13 offset:8192
    v_mfma_f32_16x16x32_bf16 v[200:203], v[56:59], v[104:107], v[200:203]
    ds_read_b64_tr_b16 v[46:47], v13 offset:12288
    v_mfma_f32_16x16x32_bf16 v[232:235], v[60:63], v[104:107], v[232:235]
    ds_read_b128 v[64:67], v10 offset:0
    v_mfma_f32_16x16x32_bf16 v[236:239], v[60:63], v[108:111], v[236:239]
    ds_read_b128 v[68:71], v10 offset:2048
    v_mfma_f32_16x16x32_bf16 v[204:207], v[56:59], v[108:111], v[204:207]
    ds_read_b128 v[72:75], v10 offset:4096
    v_mfma_f32_16x16x32_bf16 v[172:175], v[52:55], v[108:111], v[172:175]
    ds_read_b128 v[76:79], v10 offset:6144
    v_mfma_f32_16x16x32_bf16 v[140:143], v[48:51], v[108:111], v[140:143]
    ds_read_b128 v[80:83], v10 offset:8192
    v_mfma_f32_16x16x32_bf16 v[144:147], v[48:51], v[112:115], v[144:147]
    ds_read_b128 v[84:87], v10 offset:10240
    v_mfma_f32_16x16x32_bf16 v[176:179], v[52:55], v[112:115], v[176:179]
    ds_read_b128 v[88:91], v10 offset:12288
    v_mfma_f32_16x16x32_bf16 v[208:211], v[56:59], v[112:115], v[208:211]
    ds_read_b128 v[92:95], v10 offset:14336
    v_mfma_f32_16x16x32_bf16 v[240:243], v[60:63], v[112:115], v[240:243]
    v_mfma_f32_16x16x32_bf16 v[28:31], v[56:59], v[20:23], v[28:31]
    v_mfma_f32_16x16x32_bf16 v[244:247], v[60:63], v[116:119], v[244:247]
    v_mfma_f32_16x16x32_bf16 v[212:215], v[56:59], v[116:119], v[212:215]
    v_mfma_f32_16x16x32_bf16 v[180:183], v[52:55], v[116:119], v[180:183]
    v_mfma_f32_16x16x32_bf16 v[148:151], v[48:51], v[116:119], v[148:151]
    v_mfma_f32_16x16x32_bf16 v[152:155], v[48:51], v[120:123], v[152:155]
    v_mfma_f32_16x16x32_bf16 v[184:187], v[52:55], v[120:123], v[184:187]
    v_mfma_f32_16x16x32_bf16 v[216:219], v[56:59], v[120:123], v[216:219]
    v_mfma_f32_16x16x32_bf16 v[248:251], v[60:63], v[120:123], v[248:251]
    v_mfma_f32_16x16x32_bf16 v[252:255], v[60:63], v[124:127], v[252:255]
    v_mfma_f32_16x16x32_bf16 v[220:223], v[56:59], v[124:127], v[220:223]
    v_mfma_f32_16x16x32_bf16 v[188:191], v[52:55], v[124:127], v[188:191]
    v_mfma_f32_16x16x32_bf16 v[156:159], v[48:51], v[124:127], v[156:159]
    s_waitcnt vmcnt(8) lgkmcnt(0)
    s_barrier
    v_mfma_f32_16x16x32_bf16 v[128:131], v[32:35], v[64:67], v[128:131]
    s_add_u32 m0, s23, 81920
    s_mov_b32 s20, 263168
    buffer_load_dwordx4 v2, s[12:15], s20 offen sc1 lds
    v_mfma_f32_16x16x32_bf16 v[160:163], v[36:39], v[64:67], v[160:163]
    buffer_load_dwordx4 v3, s[12:15], s20 offen offset:1024 sc1 lds
    v_mfma_f32_16x16x32_bf16 v[192:195], v[40:43], v[64:67], v[192:195]
    s_add_u32 m0, s24, 0
    s_nop 0
    global_load_lds_dwordx4 v[4:5], off sc1
    s_add_u32 m0, s24, 2048
    v_lshl_add_u64 v[4:5], v[8:9], 0, v[4:5]
    v_mfma_f32_16x16x32_bf16 v[224:227], v[44:47], v[64:67], v[224:227]
    global_load_lds_dwordx4 v[6:7], off sc1
    v_lshl_add_u64 v[6:7], v[8:9], 0, v[6:7]
    v_mfma_f32_16x16x32_bf16 v[228:231], v[44:47], v[68:71], v[228:231]
    ds_read_b64_tr_b16 v[48:49], v12 offset:16384
    v_mfma_f32_16x16x32_bf16 v[196:199], v[40:43], v[68:71], v[196:199]
    ds_read_b64_tr_b16 v[50:51], v12 offset:20480
    v_mfma_f32_16x16x32_bf16 v[164:167], v[36:39], v[68:71], v[164:167]
    ds_read_b64_tr_b16 v[52:53], v13 offset:16384
    v_mfma_f32_16x16x32_bf16 v[132:135], v[32:35], v[68:71], v[132:135]
    ds_read_b64_tr_b16 v[54:55], v13 offset:20480
    v_mfma_f32_16x16x32_bf16 v[136:139], v[32:35], v[72:75], v[136:139]
    ds_read_b64_tr_b16 v[56:57], v12 offset:24576
    v_mfma_f32_16x16x32_bf16 v[168:171], v[36:39], v[72:75], v[168:171]
    ds_read_b64_tr_b16 v[58:59], v12 offset:28672
    v_mfma_f32_16x16x32_bf16 v[24:27], v[32:35], v[20:23], v[24:27]
    ds_read_b64_tr_b16 v[60:61], v13 offset:24576
    v_mfma_f32_16x16x32_bf16 v[200:203], v[40:43], v[72:75], v[200:203]
    ds_read_b64_tr_b16 v[62:63], v13 offset:28672
    v_mfma_f32_16x16x32_bf16 v[232:235], v[44:47], v[72:75], v[232:235]
    ds_read_b128 v[96:99], v11 offset:0
    v_mfma_f32_16x16x32_bf16 v[236:239], v[44:47], v[76:79], v[236:239]
    ds_read_b128 v[100:103], v11 offset:2048
    v_mfma_f32_16x16x32_bf16 v[204:207], v[40:43], v[76:79], v[204:207]
    ds_read_b128 v[104:107], v11 offset:4096
    v_mfma_f32_16x16x32_bf16 v[172:175], v[36:39], v[76:79], v[172:175]
    ds_read_b128 v[108:111], v11 offset:6144
    v_mfma_f32_16x16x32_bf16 v[140:143], v[32:35], v[76:79], v[140:143]
    ds_read_b128 v[112:115], v11 offset:8192
    v_mfma_f32_16x16x32_bf16 v[144:147], v[32:35], v[80:83], v[144:147]
    ds_read_b128 v[116:119], v11 offset:10240
    v_mfma_f32_16x16x32_bf16 v[176:179], v[36:39], v[80:83], v[176:179]
    ds_read_b128 v[120:123], v11 offset:12288
    v_mfma_f32_16x16x32_bf16 v[208:211], v[40:43], v[80:83], v[208:211]
    ds_read_b128 v[124:127], v11 offset:14336
    v_mfma_f32_16x16x32_bf16 v[240:243], v[44:47], v[80:83], v[240:243]
    v_mfma_f32_16x16x32_bf16 v[28:31], v[40:43], v[20:23], v[28:31]
    v_mfma_f32_16x16x32_bf16 v[244:247], v[44:47], v[84:87], v[244:247]
    v_mfma_f32_16x16x32_bf16 v[212:215], v[40:43], v[84:87], v[212:215]
    v_mfma_f32_16x16x32_bf16 v[180:183], v[36:39], v[84:87], v[180:183]
    v_mfma_f32_16x16x32_bf16 v[148:151], v[32:35], v[84:87], v[148:151]
    v_mfma_f32_16x16x32_bf16 v[152:155], v[32:35], v[88:91], v[152:155]
    v_mfma_f32_16x16x32_bf16 v[184:187], v[36:39], v[88:91], v[184:187]
    v_mfma_f32_16x16x32_bf16 v[216:219], v[40:43], v[88:91], v[216:219]
    v_mfma_f32_16x16x32_bf16 v[248:251], v[44:47], v[88:91], v[248:251]
    v_mfma_f32_16x16x32_bf16 v[252:255], v[44:47], v[92:95], v[252:255]
    v_mfma_f32_16x16x32_bf16 v[220:223], v[40:43], v[92:95], v[220:223]
    v_mfma_f32_16x16x32_bf16 v[188:191], v[36:39], v[92:95], v[188:191]
    v_mfma_f32_16x16x32_bf16 v[156:159], v[32:35], v[92:95], v[156:159]
    s_waitcnt vmcnt(8) lgkmcnt(0)
    s_barrier
    v_mfma_f32_16x16x32_bf16 v[128:131], v[48:51], v[96:99], v[128:131]
    s_add_u32 m0, s23, 0
    s_mov_b32 s20, 1152
    buffer_load_dwordx4 v2, s[12:15], s20 offen sc1 lds
    v_mfma_f32_16x16x32_bf16 v[160:163], v[52:55], v[96:99], v[160:163]
    buffer_load_dwordx4 v3, s[12:15], s20 offen offset:1024 sc1 lds
    v_mfma_f32_16x16x32_bf16 v[192:195], v[56:59], v[96:99], v[192:195]
    s_add_u32 m0, s24, 16384
    s_nop 0
    global_load_lds_dwordx4 v[4:5], off sc1
    s_add_u32 m0, s24, 18432
    v_lshl_add_u64 v[4:5], v[8:9], 0, v[4:5]
    v_mfma_f32_16x16x32_bf16 v[224:227], v[60:63], v[96:99], v[224:227]
    global_load_lds_dwordx4 v[6:7], off sc1
    v_lshl_add_u64 v[6:7], v[8:9], 0, v[6:7]
    v_mfma_f32_16x16x32_bf16 v[228:231], v[60:63], v[100:103], v[228:231]
    ds_read_b64_tr_b16 v[32:33], v12 offset:32768
    v_mfma_f32_16x16x32_bf16 v[196:199], v[56:59], v[100:103], v[196:199]
    ds_read_b64_tr_b16 v[34:35], v12 offset:36864
    v_mfma_f32_16x16x32_bf16 v[164:167], v[52:55], v[100:103], v[164:167]
    ds_read_b64_tr_b16 v[36:37], v13 offset:32768
    v_mfma_f32_16x16x32_bf16 v[132:135], v[48:51], v[100:103], v[132:135]
    ds_read_b64_tr_b16 v[38:39], v13 offset:36864
    v_mfma_f32_16x16x32_bf16 v[136:139], v[48:51], v[104:107], v[136:139]
    ds_read_b64_tr_b16 v[40:41], v12 offset:40960
    v_mfma_f32_16x16x32_bf16 v[168:171], v[52:55], v[104:107], v[168:171]
    ds_read_b64_tr_b16 v[42:43], v12 offset:45056
    v_mfma_f32_16x16x32_bf16 v[24:27], v[48:51], v[20:23], v[24:27]
    ds_read_b64_tr_b16 v[44:45], v13 offset:40960
    v_mfma_f32_16x16x32_bf16 v[200:203], v[56:59], v[104:107], v[200:203]
    ds_read_b64_tr_b16 v[46:47], v13 offset:45056
    v_mfma_f32_16x16x32_bf16 v[232:235], v[60:63], v[104:107], v[232:235]
    ds_read_b128 v[64:67], v10 offset:16384
    v_mfma_f32_16x16x32_bf16 v[236:239], v[60:63], v[108:111], v[236:239]
    ds_read_b128 v[68:71], v10 offset:18432
    v_mfma_f32_16x16x32_bf16 v[204:207], v[56:59], v[108:111], v[204:207]
    ds_read_b128 v[72:75], v10 offset:20480
    v_mfma_f32_16x16x32_bf16 v[172:175], v[52:55], v[108:111], v[172:175]
    ds_read_b128 v[76:79], v10 offset:22528
    v_mfma_f32_16x16x32_bf16 v[140:143], v[48:51], v[108:111], v[140:143]
    ds_read_b128 v[80:83], v10 offset:24576
    v_mfma_f32_16x16x32_bf16 v[144:147], v[48:51], v[112:115], v[144:147]
    ds_read_b128 v[84:87], v10 offset:26624
    v_mfma_f32_16x16x32_bf16 v[176:179], v[52:55], v[112:115], v[176:179]
    ds_read_b128 v[88:91], v10 offset:28672
    v_mfma_f32_16x16x32_bf16 v[208:211], v[56:59], v[112:115], v[208:211]
    ds_read_b128 v[92:95], v10 offset:30720
    v_mfma_f32_16x16x32_bf16 v[240:243], v[60:63], v[112:115], v[240:243]
    v_mfma_f32_16x16x32_bf16 v[28:31], v[56:59], v[20:23], v[28:31]
    v_mfma_f32_16x16x32_bf16 v[244:247], v[60:63], v[116:119], v[244:247]
    v_mfma_f32_16x16x32_bf16 v[212:215], v[56:59], v[116:119], v[212:215]
    v_mfma_f32_16x16x32_bf16 v[180:183], v[52:55], v[116:119], v[180:183]
    v_mfma_f32_16x16x32_bf16 v[148:151], v[48:51], v[116:119], v[148:151]
    v_mfma_f32_16x16x32_bf16 v[152:155], v[48:51], v[120:123], v[152:155]
    v_mfma_f32_16x16x32_bf16 v[184:187], v[52:55], v[120:123], v[184:187]
    v_mfma_f32_16x16x32_bf16 v[216:219], v[56:59], v[120:123], v[216:219]
    v_mfma_f32_16x16x32_bf16 v[248:251], v[60:63], v[120:123], v[248:251]
    v_mfma_f32_16x16x32_bf16 v[252:255], v[60:63], v[124:127], v[252:255]
    v_mfma_f32_16x16x32_bf16 v[220:223], v[56:59], v[124:127], v[220:223]
    v_mfma_f32_16x16x32_bf16 v[188:191], v[52:55], v[124:127], v[188:191]
    v_mfma_f32_16x16x32_bf16 v[156:159], v[48:51], v[124:127], v[156:159]
    s_waitcnt vmcnt(8) lgkmcnt(0)
    s_barrier
    v_mfma_f32_16x16x32_bf16 v[128:131], v[32:35], v[64:67], v[128:131]
    s_add_u32 m0, s23, 49152
    s_mov_b32 s20, 263296
    buffer_load_dwordx4 v2, s[12:15], s20 offen sc1 lds
    v_mfma_f32_16x16x32_bf16 v[160:163], v[36:39], v[64:67], v[160:163]
    buffer_load_dwordx4 v3, s[12:15], s20 offen offset:1024 sc1 lds
    v_mfma_f32_16x16x32_bf16 v[192:195], v[40:43], v[64:67], v[192:195]
    s_add_u32 m0, s24, 32768
    s_nop 0
    global_load_lds_dwordx4 v[4:5], off sc1
    s_add_u32 m0, s24, 34816
    v_lshl_add_u64 v[4:5], v[8:9], 0, v[4:5]
    v_mfma_f32_16x16x32_bf16 v[224:227], v[44:47], v[64:67], v[224:227]
    global_load_lds_dwordx4 v[6:7], off sc1
    v_lshl_add_u64 v[6:7], v[8:9], 0, v[6:7]
    v_mfma_f32_16x16x32_bf16 v[228:231], v[44:47], v[68:71], v[228:231]
    ds_read_b64_tr_b16 v[48:49], v12 offset:49152
    v_mfma_f32_16x16x32_bf16 v[196:199], v[40:43], v[68:71], v[196:199]
    ds_read_b64_tr_b16 v[50:51], v12 offset:53248
    v_mfma_f32_16x16x32_bf16 v[164:167], v[36:39], v[68:71], v[164:167]
    ds_read_b64_tr_b16 v[52:53], v13 offset:49152
    v_mfma_f32_16x16x32_bf16 v[132:135], v[32:35], v[68:71], v[132:135]
    ds_read_b64_tr_b16 v[54:55], v13 offset:53248
    v_mfma_f32_16x16x32_bf16 v[136:139], v[32:35], v[72:75], v[136:139]
    ds_read_b64_tr_b16 v[56:57], v12 offset:57344
    v_mfma_f32_16x16x32_bf16 v[168:171], v[36:39], v[72:75], v[168:171]
    ds_read_b64_tr_b16 v[58:59], v12 offset:61440
    v_mfma_f32_16x16x32_bf16 v[24:27], v[32:35], v[20:23], v[24:27]
    ds_read_b64_tr_b16 v[60:61], v13 offset:57344
    v_mfma_f32_16x16x32_bf16 v[200:203], v[40:43], v[72:75], v[200:203]
    ds_read_b64_tr_b16 v[62:63], v13 offset:61440
    v_mfma_f32_16x16x32_bf16 v[232:235], v[44:47], v[72:75], v[232:235]
    ds_read_b128 v[96:99], v11 offset:16384
    v_mfma_f32_16x16x32_bf16 v[236:239], v[44:47], v[76:79], v[236:239]
    ds_read_b128 v[100:103], v11 offset:18432
    v_mfma_f32_16x16x32_bf16 v[204:207], v[40:43], v[76:79], v[204:207]
    ds_read_b128 v[104:107], v11 offset:20480
    v_mfma_f32_16x16x32_bf16 v[172:175], v[36:39], v[76:79], v[172:175]
    ds_read_b128 v[108:111], v11 offset:22528
    v_mfma_f32_16x16x32_bf16 v[140:143], v[32:35], v[76:79], v[140:143]
    ds_read_b128 v[112:115], v11 offset:24576
    v_mfma_f32_16x16x32_bf16 v[144:147], v[32:35], v[80:83], v[144:147]
    ds_read_b128 v[116:119], v11 offset:26624
    v_mfma_f32_16x16x32_bf16 v[176:179], v[36:39], v[80:83], v[176:179]
    ds_read_b128 v[120:123], v11 offset:28672
    v_mfma_f32_16x16x32_bf16 v[208:211], v[40:43], v[80:83], v[208:211]
    ds_read_b128 v[124:127], v11 offset:30720
    v_mfma_f32_16x16x32_bf16 v[240:243], v[44:47], v[80:83], v[240:243]
    v_mfma_f32_16x16x32_bf16 v[28:31], v[40:43], v[20:23], v[28:31]
    v_mfma_f32_16x16x32_bf16 v[244:247], v[44:47], v[84:87], v[244:247]
    v_mfma_f32_16x16x32_bf16 v[212:215], v[40:43], v[84:87], v[212:215]
    v_mfma_f32_16x16x32_bf16 v[180:183], v[36:39], v[84:87], v[180:183]
    v_mfma_f32_16x16x32_bf16 v[148:151], v[32:35], v[84:87], v[148:151]
    v_mfma_f32_16x16x32_bf16 v[152:155], v[32:35], v[88:91], v[152:155]
    v_mfma_f32_16x16x32_bf16 v[184:187], v[36:39], v[88:91], v[184:187]
    v_mfma_f32_16x16x32_bf16 v[216:219], v[40:43], v[88:91], v[216:219]
    v_mfma_f32_16x16x32_bf16 v[248:251], v[44:47], v[88:91], v[248:251]
    v_mfma_f32_16x16x32_bf16 v[252:255], v[44:47], v[92:95], v[252:255]
    v_mfma_f32_16x16x32_bf16 v[220:223], v[40:43], v[92:95], v[220:223]
    v_mfma_f32_16x16x32_bf16 v[188:191], v[36:39], v[92:95], v[188:191]
    v_mfma_f32_16x16x32_bf16 v[156:159], v[32:35], v[92:95], v[156:159]
    s_waitcnt vmcnt(8) lgkmcnt(0)
    s_barrier
    v_mfma_f32_16x16x32_bf16 v[128:131], v[48:51], v[96:99], v[128:131]
    s_add_u32 m0, s23, 16384
    s_mov_b32 s20, 1280
    buffer_load_dwordx4 v2, s[12:15], s20 offen sc1 lds
    v_mfma_f32_16x16x32_bf16 v[160:163], v[52:55], v[96:99], v[160:163]
    buffer_load_dwordx4 v3, s[12:15], s20 offen offset:1024 sc1 lds
    v_mfma_f32_16x16x32_bf16 v[192:195], v[56:59], v[96:99], v[192:195]
    s_add_u32 m0, s24, 49152
    s_nop 0
    global_load_lds_dwordx4 v[4:5], off sc1
    s_add_u32 m0, s24, 51200
    v_lshl_add_u64 v[4:5], v[8:9], 0, v[4:5]
    v_mfma_f32_16x16x32_bf16 v[224:227], v[60:63], v[96:99], v[224:227]
    global_load_lds_dwordx4 v[6:7], off sc1
    v_lshl_add_u64 v[6:7], v[8:9], 0, v[6:7]
    v_mfma_f32_16x16x32_bf16 v[228:231], v[60:63], v[100:103], v[228:231]
    ds_read_b64_tr_b16 v[32:33], v12 offset:0
    v_mfma_f32_16x16x32_bf16 v[196:199], v[56:59], v[100:103], v[196:199]
    ds_read_b64_tr_b16 v[34:35], v12 offset:4096
    v_mfma_f32_16x16x32_bf16 v[164:167], v[52:55], v[100:103], v[164:167]
    ds_read_b64_tr_b16 v[36:37], v13 offset:0
    v_mfma_f32_16x16x32_bf16 v[132:135], v[48:51], v[100:103], v[132:135]
    ds_read_b64_tr_b16 v[38:39], v13 offset:4096
    v_mfma_f32_16x16x32_bf16 v[136:139], v[48:51], v[104:107], v[136:139]
    ds_read_b64_tr_b16 v[40:41], v12 offset:8192
    v_mfma_f32_16x16x32_bf16 v[168:171], v[52:55], v[104:107], v[168:171]
    ds_read_b64_tr_b16 v[42:43], v12 offset:12288
    v_mfma_f32_16x16x32_bf16 v[24:27], v[48:51], v[20:23], v[24:27]
    ds_read_b64_tr_b16 v[44:45], v13 offset:8192
    v_mfma_f32_16x16x32_bf16 v[200:203], v[56:59], v[104:107], v[200:203]
    ds_read_b64_tr_b16 v[46:47], v13 offset:12288
    v_mfma_f32_16x16x32_bf16 v[232:235], v[60:63], v[104:107], v[232:235]
    ds_read_b128 v[64:67], v10 offset:32768
    v_mfma_f32_16x16x32_bf16 v[236:239], v[60:63], v[108:111], v[236:239]
    ds_read_b128 v[68:71], v10 offset:34816
    v_mfma_f32_16x16x32_bf16 v[204:207], v[56:59], v[108:111], v[204:207]
    ds_read_b128 v[72:75], v10 offset:36864
    v_mfma_f32_16x16x32_bf16 v[172:175], v[52:55], v[108:111], v[172:175]
    ds_read_b128 v[76:79], v10 offset:38912
    v_mfma_f32_16x16x32_bf16 v[140:143], v[48:51], v[108:111], v[140:143]
    ds_read_b128 v[80:83], v10 offset:40960
    v_mfma_f32_16x16x32_bf16 v[144:147], v[48:51], v[112:115], v[144:147]
    ds_read_b128 v[84:87], v10 offset:43008
    v_mfma_f32_16x16x32_bf16 v[176:179], v[52:55], v[112:115], v[176:179]
    ds_read_b128 v[88:91], v10 offset:45056
    v_mfma_f32_16x16x32_bf16 v[208:211], v[56:59], v[112:115], v[208:211]
    ds_read_b128 v[92:95], v10 offset:47104
    v_mfma_f32_16x16x32_bf16 v[240:243], v[60:63], v[112:115], v[240:243]
    v_mfma_f32_16x16x32_bf16 v[28:31], v[56:59], v[20:23], v[28:31]
    v_mfma_f32_16x16x32_bf16 v[244:247], v[60:63], v[116:119], v[244:247]
    v_mfma_f32_16x16x32_bf16 v[212:215], v[56:59], v[116:119], v[212:215]
    v_mfma_f32_16x16x32_bf16 v[180:183], v[52:55], v[116:119], v[180:183]
    v_mfma_f32_16x16x32_bf16 v[148:151], v[48:51], v[116:119], v[148:151]
    v_mfma_f32_16x16x32_bf16 v[152:155], v[48:51], v[120:123], v[152:155]
    v_mfma_f32_16x16x32_bf16 v[184:187], v[52:55], v[120:123], v[184:187]
    v_mfma_f32_16x16x32_bf16 v[216:219], v[56:59], v[120:123], v[216:219]
    v_mfma_f32_16x16x32_bf16 v[248:251], v[60:63], v[120:123], v[248:251]
    v_mfma_f32_16x16x32_bf16 v[252:255], v[60:63], v[124:127], v[252:255]
    v_mfma_f32_16x16x32_bf16 v[220:223], v[56:59], v[124:127], v[220:223]
    v_mfma_f32_16x16x32_bf16 v[188:191], v[52:55], v[124:127], v[188:191]
    v_mfma_f32_16x16x32_bf16 v[156:159], v[48:51], v[124:127], v[156:159]
    s_waitcnt vmcnt(8) lgkmcnt(0)
    s_barrier
    v_mfma_f32_16x16x32_bf16 v[128:131], v[32:35], v[64:67], v[128:131]
    s_add_u32 m0, s23, 65536
    s_mov_b32 s20, 263424
    buffer_load_dwordx4 v2, s[12:15], s20 offen sc1 lds
    v_mfma_f32_16x16x32_bf16 v[160:163], v[36:39], v[64:67], v[160:163]
    buffer_load_dwordx4 v3, s[12:15], s20 offen offset:1024 sc1 lds
    v_mfma_f32_16x16x32_bf16 v[192:195], v[40:43], v[64:67], v[192:195]
    s_add_u32 m0, s24, 0
    s_nop 0
    global_load_lds_dwordx4 v[4:5], off sc1
    s_add_u32 m0, s24, 2048
    v_lshl_add_u64 v[4:5], v[8:9], 0, v[4:5]
    v_mfma_f32_16x16x32_bf16 v[224:227], v[44:47], v[64:67], v[224:227]
    global_load_lds_dwordx4 v[6:7], off sc1
    v_lshl_add_u64 v[6:7], v[8:9], 0, v[6:7]
    v_mfma_f32_16x16x32_bf16 v[228:231], v[44:47], v[68:71], v[228:231]
    ds_read_b64_tr_b16 v[48:49], v12 offset:16384
    v_mfma_f32_16x16x32_bf16 v[196:199], v[40:43], v[68:71], v[196:199]
    ds_read_b64_tr_b16 v[50:51], v12 offset:20480
    v_mfma_f32_16x16x32_bf16 v[164:167], v[36:39], v[68:71], v[164:167]
    ds_read_b64_tr_b16 v[52:53], v13 offset:16384
    v_mfma_f32_16x16x32_bf16 v[132:135], v[32:35], v[68:71], v[132:135]
    ds_read_b64_tr_b16 v[54:55], v13 offset:20480
    v_mfma_f32_16x16x32_bf16 v[136:139], v[32:35], v[72:75], v[136:139]
    ds_read_b64_tr_b16 v[56:57], v12 offset:24576
    v_mfma_f32_16x16x32_bf16 v[168:171], v[36:39], v[72:75], v[168:171]
    ds_read_b64_tr_b16 v[58:59], v12 offset:28672
    v_mfma_f32_16x16x32_bf16 v[24:27], v[32:35], v[20:23], v[24:27]
    ds_read_b64_tr_b16 v[60:61], v13 offset:24576
    v_mfma_f32_16x16x32_bf16 v[200:203], v[40:43], v[72:75], v[200:203]
    ds_read_b64_tr_b16 v[62:63], v13 offset:28672
    v_mfma_f32_16x16x32_bf16 v[232:235], v[44:47], v[72:75], v[232:235]
    ds_read_b128 v[96:99], v11 offset:32768
    v_mfma_f32_16x16x32_bf16 v[236:239], v[44:47], v[76:79], v[236:239]
    ds_read_b128 v[100:103], v11 offset:34816
    v_mfma_f32_16x16x32_bf16 v[204:207], v[40:43], v[76:79], v[204:207]
    ds_read_b128 v[104:107], v11 offset:36864
    v_mfma_f32_16x16x32_bf16 v[172:175], v[36:39], v[76:79], v[172:175]
    ds_read_b128 v[108:111], v11 offset:38912
    v_mfma_f32_16x16x32_bf16 v[140:143], v[32:35], v[76:79], v[140:143]
    ds_read_b128 v[112:115], v11 offset:40960
    v_mfma_f32_16x16x32_bf16 v[144:147], v[32:35], v[80:83], v[144:147]
    ds_read_b128 v[116:119], v11 offset:43008
    v_mfma_f32_16x16x32_bf16 v[176:179], v[36:39], v[80:83], v[176:179]
    ds_read_b128 v[120:123], v11 offset:45056
    v_mfma_f32_16x16x32_bf16 v[208:211], v[40:43], v[80:83], v[208:211]
    ds_read_b128 v[124:127], v11 offset:47104
    v_mfma_f32_16x16x32_bf16 v[240:243], v[44:47], v[80:83], v[240:243]
    v_mfma_f32_16x16x32_bf16 v[28:31], v[40:43], v[20:23], v[28:31]
    v_mfma_f32_16x16x32_bf16 v[244:247], v[44:47], v[84:87], v[244:247]
    v_mfma_f32_16x16x32_bf16 v[212:215], v[40:43], v[84:87], v[212:215]
    v_mfma_f32_16x16x32_bf16 v[180:183], v[36:39], v[84:87], v[180:183]
    v_mfma_f32_16x16x32_bf16 v[148:151], v[32:35], v[84:87], v[148:151]
    v_mfma_f32_16x16x32_bf16 v[152:155], v[32:35], v[88:91], v[152:155]
    v_mfma_f32_16x16x32_bf16 v[184:187], v[36:39], v[88:91], v[184:187]
    v_mfma_f32_16x16x32_bf16 v[216:219], v[40:43], v[88:91], v[216:219]
    v_mfma_f32_16x16x32_bf16 v[248:251], v[44:47], v[88:91], v[248:251]
    v_mfma_f32_16x16x32_bf16 v[252:255], v[44:47], v[92:95], v[252:255]
    v_mfma_f32_16x16x32_bf16 v[220:223], v[40:43], v[92:95], v[220:223]
    v_mfma_f32_16x16x32_bf16 v[188:191], v[36:39], v[92:95], v[188:191]
    v_mfma_f32_16x16x32_bf16 v[156:159], v[32:35], v[92:95], v[156:159]
    s_waitcnt vmcnt(8) lgkmcnt(0)
    s_barrier
    v_mfma_f32_16x16x32_bf16 v[128:131], v[48:51], v[96:99], v[128:131]
    s_add_u32 m0, s23, 32768
    s_mov_b32 s20, 1408
    buffer_load_dwordx4 v2, s[12:15], s20 offen sc1 lds
    v_mfma_f32_16x16x32_bf16 v[160:163], v[52:55], v[96:99], v[160:163]
    buffer_load_dwordx4 v3, s[12:15], s20 offen offset:1024 sc1 lds
    v_mfma_f32_16x16x32_bf16 v[192:195], v[56:59], v[96:99], v[192:195]
    s_add_u32 m0, s24, 16384
    s_nop 0
    global_load_lds_dwordx4 v[4:5], off sc1
    s_add_u32 m0, s24, 18432
    v_lshl_add_u64 v[4:5], v[8:9], 0, v[4:5]
    v_mfma_f32_16x16x32_bf16 v[224:227], v[60:63], v[96:99], v[224:227]
    global_load_lds_dwordx4 v[6:7], off sc1
    v_lshl_add_u64 v[6:7], v[8:9], 0, v[6:7]
    v_mfma_f32_16x16x32_bf16 v[228:231], v[60:63], v[100:103], v[228:231]
    ds_read_b64_tr_b16 v[32:33], v12 offset:32768
    v_mfma_f32_16x16x32_bf16 v[196:199], v[56:59], v[100:103], v[196:199]
    ds_read_b64_tr_b16 v[34:35], v12 offset:36864
    v_mfma_f32_16x16x32_bf16 v[164:167], v[52:55], v[100:103], v[164:167]
    ds_read_b64_tr_b16 v[36:37], v13 offset:32768
    v_mfma_f32_16x16x32_bf16 v[132:135], v[48:51], v[100:103], v[132:135]
    ds_read_b64_tr_b16 v[38:39], v13 offset:36864
    v_mfma_f32_16x16x32_bf16 v[136:139], v[48:51], v[104:107], v[136:139]
    ds_read_b64_tr_b16 v[40:41], v12 offset:40960
    v_mfma_f32_16x16x32_bf16 v[168:171], v[52:55], v[104:107], v[168:171]
    ds_read_b64_tr_b16 v[42:43], v12 offset:45056
    v_mfma_f32_16x16x32_bf16 v[24:27], v[48:51], v[20:23], v[24:27]
    ds_read_b64_tr_b16 v[44:45], v13 offset:40960
    v_mfma_f32_16x16x32_bf16 v[200:203], v[56:59], v[104:107], v[200:203]
    ds_read_b64_tr_b16 v[46:47], v13 offset:45056
    v_mfma_f32_16x16x32_bf16 v[232:235], v[60:63], v[104:107], v[232:235]
    ds_read_b128 v[64:67], v10 offset:0
    v_mfma_f32_16x16x32_bf16 v[236:239], v[60:63], v[108:111], v[236:239]
    ds_read_b128 v[68:71], v10 offset:2048
    v_mfma_f32_16x16x32_bf16 v[204:207], v[56:59], v[108:111], v[204:207]
    ds_read_b128 v[72:75], v10 offset:4096
    v_mfma_f32_16x16x32_bf16 v[172:175], v[52:55], v[108:111], v[172:175]
    ds_read_b128 v[76:79], v10 offset:6144
    v_mfma_f32_16x16x32_bf16 v[140:143], v[48:51], v[108:111], v[140:143]
    ds_read_b128 v[80:83], v10 offset:8192
    v_mfma_f32_16x16x32_bf16 v[144:147], v[48:51], v[112:115], v[144:147]
    ds_read_b128 v[84:87], v10 offset:10240
    v_mfma_f32_16x16x32_bf16 v[176:179], v[52:55], v[112:115], v[176:179]
    ds_read_b128 v[88:91], v10 offset:12288
    v_mfma_f32_16x16x32_bf16 v[208:211], v[56:59], v[112:115], v[208:211]
    ds_read_b128 v[92:95], v10 offset:14336
    v_mfma_f32_16x16x32_bf16 v[240:243], v[60:63], v[112:115], v[240:243]
    v_mfma_f32_16x16x32_bf16 v[28:31], v[56:59], v[20:23], v[28:31]
    v_mfma_f32_16x16x32_bf16 v[244:247], v[60:63], v[116:119], v[244:247]
    v_mfma_f32_16x16x32_bf16 v[212:215], v[56:59], v[116:119], v[212:215]
    v_mfma_f32_16x16x32_bf16 v[180:183], v[52:55], v[116:119], v[180:183]
    v_mfma_f32_16x16x32_bf16 v[148:151], v[48:51], v[116:119], v[148:151]
    v_mfma_f32_16x16x32_bf16 v[152:155], v[48:51], v[120:123], v[152:155]
    v_mfma_f32_16x16x32_bf16 v[184:187], v[52:55], v[120:123], v[184:187]
    v_mfma_f32_16x16x32_bf16 v[216:219], v[56:59], v[120:123], v[216:219]
    v_mfma_f32_16x16x32_bf16 v[248:251], v[60:63], v[120:123], v[248:251]
    v_mfma_f32_16x16x32_bf16 v[252:255], v[60:63], v[124:127], v[252:255]
    v_mfma_f32_16x16x32_bf16 v[220:223], v[56:59], v[124:127], v[220:223]
    v_mfma_f32_16x16x32_bf16 v[188:191], v[52:55], v[124:127], v[188:191]
    v_mfma_f32_16x16x32_bf16 v[156:159], v[48:51], v[124:127], v[156:159]
    s_waitcnt vmcnt(8) lgkmcnt(0)
    s_barrier
    v_mfma_f32_16x16x32_bf16 v[128:131], v[32:35], v[64:67], v[128:131]
    s_add_u32 m0, s23, 81920
    s_mov_b32 s20, 263552
    buffer_load_dwordx4 v2, s[12:15], s20 offen sc1 lds
    v_mfma_f32_16x16x32_bf16 v[160:163], v[36:39], v[64:67], v[160:163]
    buffer_load_dwordx4 v3, s[12:15], s20 offen offset:1024 sc1 lds
    v_mfma_f32_16x16x32_bf16 v[192:195], v[40:43], v[64:67], v[192:195]
    s_add_u32 m0, s24, 32768
    s_nop 0
    global_load_lds_dwordx4 v[4:5], off sc1
    s_add_u32 m0, s24, 34816
    v_lshl_add_u64 v[4:5], v[8:9], 0, v[4:5]
    v_mfma_f32_16x16x32_bf16 v[224:227], v[44:47], v[64:67], v[224:227]
    global_load_lds_dwordx4 v[6:7], off sc1
    v_lshl_add_u64 v[6:7], v[8:9], 0, v[6:7]
    v_mfma_f32_16x16x32_bf16 v[228:231], v[44:47], v[68:71], v[228:231]
    ds_read_b64_tr_b16 v[48:49], v12 offset:49152
    v_mfma_f32_16x16x32_bf16 v[196:199], v[40:43], v[68:71], v[196:199]
    ds_read_b64_tr_b16 v[50:51], v12 offset:53248
    v_mfma_f32_16x16x32_bf16 v[164:167], v[36:39], v[68:71], v[164:167]
    ds_read_b64_tr_b16 v[52:53], v13 offset:49152
    v_mfma_f32_16x16x32_bf16 v[132:135], v[32:35], v[68:71], v[132:135]
    ds_read_b64_tr_b16 v[54:55], v13 offset:53248
    v_mfma_f32_16x16x32_bf16 v[136:139], v[32:35], v[72:75], v[136:139]
    ds_read_b64_tr_b16 v[56:57], v12 offset:57344
    v_mfma_f32_16x16x32_bf16 v[168:171], v[36:39], v[72:75], v[168:171]
    ds_read_b64_tr_b16 v[58:59], v12 offset:61440
    v_mfma_f32_16x16x32_bf16 v[24:27], v[32:35], v[20:23], v[24:27]
    ds_read_b64_tr_b16 v[60:61], v13 offset:57344
    v_mfma_f32_16x16x32_bf16 v[200:203], v[40:43], v[72:75], v[200:203]
    ds_read_b64_tr_b16 v[62:63], v13 offset:61440
    v_mfma_f32_16x16x32_bf16 v[232:235], v[44:47], v[72:75], v[232:235]
    ds_read_b128 v[96:99], v11 offset:0
    v_mfma_f32_16x16x32_bf16 v[236:239], v[44:47], v[76:79], v[236:239]
    ds_read_b128 v[100:103], v11 offset:2048
    v_mfma_f32_16x16x32_bf16 v[204:207], v[40:43], v[76:79], v[204:207]
    ds_read_b128 v[104:107], v11 offset:4096
    v_mfma_f32_16x16x32_bf16 v[172:175], v[36:39], v[76:79], v[172:175]
    ds_read_b128 v[108:111], v11 offset:6144
    v_mfma_f32_16x16x32_bf16 v[140:143], v[32:35], v[76:79], v[140:143]
    ds_read_b128 v[112:115], v11 offset:8192
    v_mfma_f32_16x16x32_bf16 v[144:147], v[32:35], v[80:83], v[144:147]
    ds_read_b128 v[116:119], v11 offset:10240
    v_mfma_f32_16x16x32_bf16 v[176:179], v[36:39], v[80:83], v[176:179]
    ds_read_b128 v[120:123], v11 offset:12288
    v_mfma_f32_16x16x32_bf16 v[208:211], v[40:43], v[80:83], v[208:211]
    ds_read_b128 v[124:127], v11 offset:14336
    v_mfma_f32_16x16x32_bf16 v[240:243], v[44:47], v[80:83], v[240:243]
    v_mfma_f32_16x16x32_bf16 v[28:31], v[40:43], v[20:23], v[28:31]
    v_mfma_f32_16x16x32_bf16 v[244:247], v[44:47], v[84:87], v[244:247]
    v_mfma_f32_16x16x32_bf16 v[212:215], v[40:43], v[84:87], v[212:215]
    v_mfma_f32_16x16x32_bf16 v[180:183], v[36:39], v[84:87], v[180:183]
    v_mfma_f32_16x16x32_bf16 v[148:151], v[32:35], v[84:87], v[148:151]
    v_mfma_f32_16x16x32_bf16 v[152:155], v[32:35], v[88:91], v[152:155]
    v_mfma_f32_16x16x32_bf16 v[184:187], v[36:39], v[88:91], v[184:187]
    v_mfma_f32_16x16x32_bf16 v[216:219], v[40:43], v[88:91], v[216:219]
    v_mfma_f32_16x16x32_bf16 v[248:251], v[44:47], v[88:91], v[248:251]
    v_mfma_f32_16x16x32_bf16 v[252:255], v[44:47], v[92:95], v[252:255]
    v_mfma_f32_16x16x32_bf16 v[220:223], v[40:43], v[92:95], v[220:223]
    v_mfma_f32_16x16x32_bf16 v[188:191], v[36:39], v[92:95], v[188:191]
    v_mfma_f32_16x16x32_bf16 v[156:159], v[32:35], v[92:95], v[156:159]
    s_waitcnt vmcnt(8) lgkmcnt(0)
    s_barrier
    v_mfma_f32_16x16x32_bf16 v[128:131], v[48:51], v[96:99], v[128:131]
    s_add_u32 m0, s23, 0
    s_mov_b32 s20, 1536
    buffer_load_dwordx4 v2, s[12:15], s20 offen sc1 lds
    v_mfma_f32_16x16x32_bf16 v[160:163], v[52:55], v[96:99], v[160:163]
    buffer_load_dwordx4 v3, s[12:15], s20 offen offset:1024 sc1 lds
    v_mfma_f32_16x16x32_bf16 v[192:195], v[56:59], v[96:99], v[192:195]
    s_add_u32 m0, s24, 49152
    s_nop 0
    global_load_lds_dwordx4 v[4:5], off sc1
    s_add_u32 m0, s24, 51200
    v_lshl_add_u64 v[4:5], v[8:9], 0, v[4:5]
    v_mfma_f32_16x16x32_bf16 v[224:227], v[60:63], v[96:99], v[224:227]
    global_load_lds_dwordx4 v[6:7], off sc1
    v_lshl_add_u64 v[6:7], v[8:9], 0, v[6:7]
    v_mfma_f32_16x16x32_bf16 v[228:231], v[60:63], v[100:103], v[228:231]
    ds_read_b64_tr_b16 v[32:33], v12 offset:0
    v_mfma_f32_16x16x32_bf16 v[196:199], v[56:59], v[100:103], v[196:199]
    ds_read_b64_tr_b16 v[34:35], v12 offset:4096
    v_mfma_f32_16x16x32_bf16 v[164:167], v[52:55], v[100:103], v[164:167]
    ds_read_b64_tr_b16 v[36:37], v13 offset:0
    v_mfma_f32_16x16x32_bf16 v[132:135], v[48:51], v[100:103], v[132:135]
    ds_read_b64_tr_b16 v[38:39], v13 offset:4096
    v_mfma_f32_16x16x32_bf16 v[136:139], v[48:51], v[104:107], v[136:139]
    ds_read_b64_tr_b16 v[40:41], v12 offset:8192
    v_mfma_f32_16x16x32_bf16 v[168:171], v[52:55], v[104:107], v[168:171]
    ds_read_b64_tr_b16 v[42:43], v12 offset:12288
    v_mfma_f32_16x16x32_bf16 v[24:27], v[48:51], v[20:23], v[24:27]
    ds_read_b64_tr_b16 v[44:45], v13 offset:8192
    v_mfma_f32_16x16x32_bf16 v[200:203], v[56:59], v[104:107], v[200:203]
    ds_read_b64_tr_b16 v[46:47], v13 offset:12288
    v_mfma_f32_16x16x32_bf16 v[232:235], v[60:63], v[104:107], v[232:235]
    ds_read_b128 v[64:67], v10 offset:16384
    v_mfma_f32_16x16x32_bf16 v[236:239], v[60:63], v[108:111], v[236:239]
    ds_read_b128 v[68:71], v10 offset:18432
    v_mfma_f32_16x16x32_bf16 v[204:207], v[56:59], v[108:111], v[204:207]
    ds_read_b128 v[72:75], v10 offset:20480
    v_mfma_f32_16x16x32_bf16 v[172:175], v[52:55], v[108:111], v[172:175]
    ds_read_b128 v[76:79], v10 offset:22528
    v_mfma_f32_16x16x32_bf16 v[140:143], v[48:51], v[108:111], v[140:143]
    ds_read_b128 v[80:83], v10 offset:24576
    v_mfma_f32_16x16x32_bf16 v[144:147], v[48:51], v[112:115], v[144:147]
    ds_read_b128 v[84:87], v10 offset:26624
    v_mfma_f32_16x16x32_bf16 v[176:179], v[52:55], v[112:115], v[176:179]
    ds_read_b128 v[88:91], v10 offset:28672
    v_mfma_f32_16x16x32_bf16 v[208:211], v[56:59], v[112:115], v[208:211]
    ds_read_b128 v[92:95], v10 offset:30720
    v_mfma_f32_16x16x32_bf16 v[240:243], v[60:63], v[112:115], v[240:243]
    v_mfma_f32_16x16x32_bf16 v[28:31], v[56:59], v[20:23], v[28:31]
    v_mfma_f32_16x16x32_bf16 v[244:247], v[60:63], v[116:119], v[244:247]
    v_mfma_f32_16x16x32_bf16 v[212:215], v[56:59], v[116:119], v[212:215]
    v_mfma_f32_16x16x32_bf16 v[180:183], v[52:55], v[116:119], v[180:183]
    v_mfma_f32_16x16x32_bf16 v[148:151], v[48:51], v[116:119], v[148:151]
    v_mfma_f32_16x16x32_bf16 v[152:155], v[48:51], v[120:123], v[152:155]
    v_mfma_f32_16x16x32_bf16 v[184:187], v[52:55], v[120:123], v[184:187]
    v_mfma_f32_16x16x32_bf16 v[216:219], v[56:59], v[120:123], v[216:219]
    v_mfma_f32_16x16x32_bf16 v[248:251], v[60:63], v[120:123], v[248:251]
    v_mfma_f32_16x16x32_bf16 v[252:255], v[60:63], v[124:127], v[252:255]
    v_mfma_f32_16x16x32_bf16 v[220:223], v[56:59], v[124:127], v[220:223]
    v_mfma_f32_16x16x32_bf16 v[188:191], v[52:55], v[124:127], v[188:191]
    v_mfma_f32_16x16x32_bf16 v[156:159], v[48:51], v[124:127], v[156:159]
    s_waitcnt vmcnt(8) lgkmcnt(0)
    s_barrier
    v_mfma_f32_16x16x32_bf16 v[128:131], v[32:35], v[64:67], v[128:131]
    s_add_u32 m0, s23, 49152
    s_mov_b32 s20, 263680
    buffer_load_dwordx4 v2, s[12:15], s20 offen sc1 lds
    v_mfma_f32_16x16x32_bf16 v[160:163], v[36:39], v[64:67], v[160:163]
    buffer_load_dwordx4 v3, s[12:15], s20 offen offset:1024 sc1 lds
    v_mfma_f32_16x16x32_bf16 v[192:195], v[40:43], v[64:67], v[192:195]
    s_add_u32 m0, s24, 0
    s_nop 0
    global_load_lds_dwordx4 v[4:5], off sc1
    s_add_u32 m0, s24, 2048
    v_lshl_add_u64 v[4:5], v[8:9], 0, v[4:5]
    v_mfma_f32_16x16x32_bf16 v[224:227], v[44:47], v[64:67], v[224:227]
    global_load_lds_dwordx4 v[6:7], off sc1
    v_lshl_add_u64 v[6:7], v[8:9], 0, v[6:7]
    v_mfma_f32_16x16x32_bf16 v[228:231], v[44:47], v[68:71], v[228:231]
    ds_read_b64_tr_b16 v[48:49], v12 offset:16384
    v_mfma_f32_16x16x32_bf16 v[196:199], v[40:43], v[68:71], v[196:199]
    ds_read_b64_tr_b16 v[50:51], v12 offset:20480
    v_mfma_f32_16x16x32_bf16 v[164:167], v[36:39], v[68:71], v[164:167]
    ds_read_b64_tr_b16 v[52:53], v13 offset:16384
    v_mfma_f32_16x16x32_bf16 v[132:135], v[32:35], v[68:71], v[132:135]
    ds_read_b64_tr_b16 v[54:55], v13 offset:20480
    v_mfma_f32_16x16x32_bf16 v[136:139], v[32:35], v[72:75], v[136:139]
    ds_read_b64_tr_b16 v[56:57], v12 offset:24576
    v_mfma_f32_16x16x32_bf16 v[168:171], v[36:39], v[72:75], v[168:171]
    ds_read_b64_tr_b16 v[58:59], v12 offset:28672
    v_mfma_f32_16x16x32_bf16 v[24:27], v[32:35], v[20:23], v[24:27]
    ds_read_b64_tr_b16 v[60:61], v13 offset:24576
    v_mfma_f32_16x16x32_bf16 v[200:203], v[40:43], v[72:75], v[200:203]
    ds_read_b64_tr_b16 v[62:63], v13 offset:28672
    v_mfma_f32_16x16x32_bf16 v[232:235], v[44:47], v[72:75], v[232:235]
    ds_read_b128 v[96:99], v11 offset:16384
    v_mfma_f32_16x16x32_bf16 v[236:239], v[44:47], v[76:79], v[236:239]
    ds_read_b128 v[100:103], v11 offset:18432
    v_mfma_f32_16x16x32_bf16 v[204:207], v[40:43], v[76:79], v[204:207]
    ds_read_b128 v[104:107], v11 offset:20480
    v_mfma_f32_16x16x32_bf16 v[172:175], v[36:39], v[76:79], v[172:175]
    ds_read_b128 v[108:111], v11 offset:22528
    v_mfma_f32_16x16x32_bf16 v[140:143], v[32:35], v[76:79], v[140:143]
    ds_read_b128 v[112:115], v11 offset:24576
    v_mfma_f32_16x16x32_bf16 v[144:147], v[32:35], v[80:83], v[144:147]
    ds_read_b128 v[116:119], v11 offset:26624
    v_mfma_f32_16x16x32_bf16 v[176:179], v[36:39], v[80:83], v[176:179]
    ds_read_b128 v[120:123], v11 offset:28672
    v_mfma_f32_16x16x32_bf16 v[208:211], v[40:43], v[80:83], v[208:211]
    ds_read_b128 v[124:127], v11 offset:30720
    v_mfma_f32_16x16x32_bf16 v[240:243], v[44:47], v[80:83], v[240:243]
    v_mfma_f32_16x16x32_bf16 v[28:31], v[40:43], v[20:23], v[28:31]
    v_mfma_f32_16x16x32_bf16 v[244:247], v[44:47], v[84:87], v[244:247]
    v_mfma_f32_16x16x32_bf16 v[212:215], v[40:43], v[84:87], v[212:215]
    v_mfma_f32_16x16x32_bf16 v[180:183], v[36:39], v[84:87], v[180:183]
    v_mfma_f32_16x16x32_bf16 v[148:151], v[32:35], v[84:87], v[148:151]
    v_mfma_f32_16x16x32_bf16 v[152:155], v[32:35], v[88:91], v[152:155]
    v_mfma_f32_16x16x32_bf16 v[184:187], v[36:39], v[88:91], v[184:187]
    v_mfma_f32_16x16x32_bf16 v[216:219], v[40:43], v[88:91], v[216:219]
    v_mfma_f32_16x16x32_bf16 v[248:251], v[44:47], v[88:91], v[248:251]
    v_mfma_f32_16x16x32_bf16 v[252:255], v[44:47], v[92:95], v[252:255]
    v_mfma_f32_16x16x32_bf16 v[220:223], v[40:43], v[92:95], v[220:223]
    v_mfma_f32_16x16x32_bf16 v[188:191], v[36:39], v[92:95], v[188:191]
    v_mfma_f32_16x16x32_bf16 v[156:159], v[32:35], v[92:95], v[156:159]
    s_waitcnt vmcnt(8) lgkmcnt(0)
    s_barrier
    v_mfma_f32_16x16x32_bf16 v[128:131], v[48:51], v[96:99], v[128:131]
    s_add_u32 m0, s23, 16384
    s_mov_b32 s20, 1664
    buffer_load_dwordx4 v2, s[12:15], s20 offen sc1 lds
    v_mfma_f32_16x16x32_bf16 v[160:163], v[52:55], v[96:99], v[160:163]
    buffer_load_dwordx4 v3, s[12:15], s20 offen offset:1024 sc1 lds
    v_mfma_f32_16x16x32_bf16 v[192:195], v[56:59], v[96:99], v[192:195]
    s_add_u32 m0, s24, 16384
    s_nop 0
    global_load_lds_dwordx4 v[4:5], off sc1
    s_add_u32 m0, s24, 18432
    v_lshl_add_u64 v[4:5], v[8:9], 0, v[4:5]
    v_mfma_f32_16x16x32_bf16 v[224:227], v[60:63], v[96:99], v[224:227]
    global_load_lds_dwordx4 v[6:7], off sc1
    v_lshl_add_u64 v[6:7], v[8:9], 0, v[6:7]
    v_mfma_f32_16x16x32_bf16 v[228:231], v[60:63], v[100:103], v[228:231]
    ds_read_b64_tr_b16 v[32:33], v12 offset:32768
    v_mfma_f32_16x16x32_bf16 v[196:199], v[56:59], v[100:103], v[196:199]
    ds_read_b64_tr_b16 v[34:35], v12 offset:36864
    v_mfma_f32_16x16x32_bf16 v[164:167], v[52:55], v[100:103], v[164:167]
    ds_read_b64_tr_b16 v[36:37], v13 offset:32768
    v_mfma_f32_16x16x32_bf16 v[132:135], v[48:51], v[100:103], v[132:135]
    ds_read_b64_tr_b16 v[38:39], v13 offset:36864
    v_mfma_f32_16x16x32_bf16 v[136:139], v[48:51], v[104:107], v[136:139]
    ds_read_b64_tr_b16 v[40:41], v12 offset:40960
    v_mfma_f32_16x16x32_bf16 v[168:171], v[52:55], v[104:107], v[168:171]
    ds_read_b64_tr_b16 v[42:43], v12 offset:45056
    v_mfma_f32_16x16x32_bf16 v[24:27], v[48:51], v[20:23], v[24:27]
    ds_read_b64_tr_b16 v[44:45], v13 offset:40960
    v_mfma_f32_16x16x32_bf16 v[200:203], v[56:59], v[104:107], v[200:203]
    ds_read_b64_tr_b16 v[46:47], v13 offset:45056
    v_mfma_f32_16x16x32_bf16 v[232:235], v[60:63], v[104:107], v[232:235]
    ds_read_b128 v[64:67], v10 offset:32768
    v_mfma_f32_16x16x32_bf16 v[236:239], v[60:63], v[108:111], v[236:239]
    ds_read_b128 v[68:71], v10 offset:34816
    v_mfma_f32_16x16x32_bf16 v[204:207], v[56:59], v[108:111], v[204:207]
    ds_read_b128 v[72:75], v10 offset:36864
    v_mfma_f32_16x16x32_bf16 v[172:175], v[52:55], v[108:111], v[172:175]
    ds_read_b128 v[76:79], v10 offset:38912
    v_mfma_f32_16x16x32_bf16 v[140:143], v[48:51], v[108:111], v[140:143]
    ds_read_b128 v[80:83], v10 offset:40960
    v_mfma_f32_16x16x32_bf16 v[144:147], v[48:51], v[112:115], v[144:147]
    ds_read_b128 v[84:87], v10 offset:43008
    v_mfma_f32_16x16x32_bf16 v[176:179], v[52:55], v[112:115], v[176:179]
    ds_read_b128 v[88:91], v10 offset:45056
    v_mfma_f32_16x16x32_bf16 v[208:211], v[56:59], v[112:115], v[208:211]
    ds_read_b128 v[92:95], v10 offset:47104
    v_mfma_f32_16x16x32_bf16 v[240:243], v[60:63], v[112:115], v[240:243]
    v_mfma_f32_16x16x32_bf16 v[28:31], v[56:59], v[20:23], v[28:31]
    v_mfma_f32_16x16x32_bf16 v[244:247], v[60:63], v[116:119], v[244:247]
    v_mfma_f32_16x16x32_bf16 v[212:215], v[56:59], v[116:119], v[212:215]
    v_mfma_f32_16x16x32_bf16 v[180:183], v[52:55], v[116:119], v[180:183]
    v_mfma_f32_16x16x32_bf16 v[148:151], v[48:51], v[116:119], v[148:151]
    v_mfma_f32_16x16x32_bf16 v[152:155], v[48:51], v[120:123], v[152:155]
    v_mfma_f32_16x16x32_bf16 v[184:187], v[52:55], v[120:123], v[184:187]
    v_mfma_f32_16x16x32_bf16 v[216:219], v[56:59], v[120:123], v[216:219]
    v_mfma_f32_16x16x32_bf16 v[248:251], v[60:63], v[120:123], v[248:251]
    v_mfma_f32_16x16x32_bf16 v[252:255], v[60:63], v[124:127], v[252:255]
    v_mfma_f32_16x16x32_bf16 v[220:223], v[56:59], v[124:127], v[220:223]
    v_mfma_f32_16x16x32_bf16 v[188:191], v[52:55], v[124:127], v[188:191]
    v_mfma_f32_16x16x32_bf16 v[156:159], v[48:51], v[124:127], v[156:159]
    s_waitcnt vmcnt(8) lgkmcnt(0)
    s_barrier
    v_mfma_f32_16x16x32_bf16 v[128:131], v[32:35], v[64:67], v[128:131]
    s_cmp_lg_u32 s3, 0
    s_cbranch_scc1 P1_NP22
    v_mbcnt_lo_u32_b32 v16, -1, 0
    v_mbcnt_hi_u32_b32 v16, -1, v16
    v_lshlrev_b32 v16, 4, v16
    global_load_dwordx4 v[16:19], v16, s[58:59] offset:0 sc1
P1_NP22:
    v_mfma_f32_16x16x32_bf16 v[160:163], v[36:39], v[64:67], v[160:163]
    s_add_u32 m0, s23, 65536
    s_mov_b32 s20, 263808
    buffer_load_dwordx4 v2, s[12:15], s20 offen sc1 lds
    v_mfma_f32_16x16x32_bf16 v[192:195], v[40:43], v[64:67], v[192:195]
    buffer_load_dwordx4 v3, s[12:15], s20 offen offset:1024 sc1 lds
    v_mfma_f32_16x16x32_bf16 v[224:227], v[44:47], v[64:67], v[224:227]
    s_add_u32 m0, s24, 32768
    s_nop 0
    global_load_lds_dwordx4 v[4:5], off sc1
    s_add_u32 m0, s24, 34816
    v_lshl_add_u64 v[4:5], v[8:9], 0, v[4:5]
    v_mfma_f32_16x16x32_bf16 v[228:231], v[44:47], v[68:71], v[228:231]
    global_load_lds_dwordx4 v[6:7], off sc1
    v_lshl_add_u64 v[6:7], v[8:9], 0, v[6:7]
    v_mfma_f32_16x16x32_bf16 v[196:199], v[40:43], v[68:71], v[196:199]
    ds_read_b64_tr_b16 v[48:49], v12 offset:49152
    v_mfma_f32_16x16x32_bf16 v[164:167], v[36:39], v[68:71], v[164:167]
    ds_read_b64_tr_b16 v[50:51], v12 offset:53248
    v_mfma_f32_16x16x32_bf16 v[132:135], v[32:35], v[68:71], v[132:135]
    ds_read_b64_tr_b16 v[52:53], v13 offset:49152
    v_mfma_f32_16x16x32_bf16 v[136:139], v[32:35], v[72:75], v[136:139]
    ds_read_b64_tr_b16 v[54:55], v13 offset:53248
    v_mfma_f32_16x16x32_bf16 v[168:171], v[36:39], v[72:75], v[168:171]
    ds_read_b64_tr_b16 v[56:57], v12 offset:57344
    v_mfma_f32_16x16x32_bf16 v[24:27], v[32:35], v[20:23], v[24:27]
    ds_read_b64_tr_b16 v[58:59], v12 offset:61440
    v_mfma_f32_16x16x32_bf16 v[200:203], v[40:43], v[72:75], v[200:203]
    ds_read_b64_tr_b16 v[60:61], v13 offset:57344
    v_mfma_f32_16x16x32_bf16 v[232:235], v[44:47], v[72:75], v[232:235]
    ds_read_b64_tr_b16 v[62:63], v13 offset:61440
    v_mfma_f32_16x16x32_bf16 v[236:239], v[44:47], v[76:79], v[236:239]
    ds_read_b128 v[96:99], v11 offset:32768
    v_mfma_f32_16x16x32_bf16 v[204:207], v[40:43], v[76:79], v[204:207]
    ds_read_b128 v[100:103], v11 offset:34816
    v_mfma_f32_16x16x32_bf16 v[172:175], v[36:39], v[76:79], v[172:175]
    ds_read_b128 v[104:107], v11 offset:36864
    v_mfma_f32_16x16x32_bf16 v[140:143], v[32:35], v[76:79], v[140:143]
    ds_read_b128 v[108:111], v11 offset:38912
    v_mfma_f32_16x16x32_bf16 v[144:147], v[32:35], v[80:83], v[144:147]
    ds_read_b128 v[112:115], v11 offset:40960
    v_mfma_f32_16x16x32_bf16 v[176:179], v[36:39], v[80:83], v[176:179]
    ds_read_b128 v[116:119], v11 offset:43008
    v_mfma_f32_16x16x32_bf16 v[208:211], v[40:43], v[80:83], v[208:211]
    ds_read_b128 v[120:123], v11 offset:45056
    v_mfma_f32_16x16x32_bf16 v[240:243], v[44:47], v[80:83], v[240:243]
    ds_read_b128 v[124:127], v11 offset:47104
    v_mfma_f32_16x16x32_bf16 v[28:31], v[40:43], v[20:23], v[28:31]
    v_mfma_f32_16x16x32_bf16 v[244:247], v[44:47], v[84:87], v[244:247]
    v_mfma_f32_16x16x32_bf16 v[212:215], v[40:43], v[84:87], v[212:215]
    v_mfma_f32_16x16x32_bf16 v[180:183], v[36:39], v[84:87], v[180:183]
    v_mfma_f32_16x16x32_bf16 v[148:151], v[32:35], v[84:87], v[148:151]
    v_mfma_f32_16x16x32_bf16 v[152:155], v[32:35], v[88:91], v[152:155]
    v_mfma_f32_16x16x32_bf16 v[184:187], v[36:39], v[88:91], v[184:187]
    v_mfma_f32_16x16x32_bf16 v[216:219], v[40:43], v[88:91], v[216:219]
    v_mfma_f32_16x16x32_bf16 v[248:251], v[44:47], v[88:91], v[248:251]
    v_mfma_f32_16x16x32_bf16 v[252:255], v[44:47], v[92:95], v[252:255]
    v_mfma_f32_16x16x32_bf16 v[220:223], v[40:43], v[92:95], v[220:223]
    v_mfma_f32_16x16x32_bf16 v[188:191], v[36:39], v[92:95], v[188:191]
    v_mfma_f32_16x16x32_bf16 v[156:159], v[32:35], v[92:95], v[156:159]
    s_waitcnt vmcnt(8) lgkmcnt(0)
    s_barrier
    v_mfma_f32_16x16x32_bf16 v[128:131], v[48:51], v[96:99], v[128:131]
    s_add_u32 m0, s23, 32768
    s_mov_b32 s20, 1792
    buffer_load_dwordx4 v2, s[12:15], s20 offen sc1 lds
    v_mfma_f32_16x16x32_bf16 v[160:163], v[52:55], v[96:99], v[160:163]
    buffer_load_dwordx4 v3, s[12:15], s20 offen offset:1024 sc1 lds
    v_mfma_f32_16x16x32_bf16 v[192:195], v[56:59], v[96:99], v[192:195]
    s_add_u32 m0, s24, 49152
    s_nop 0
    global_load_lds_dwordx4 v[4:5], off sc1
    s_add_u32 m0, s24, 51200
    v_lshl_add_u64 v[4:5], v[8:9], 0, v[4:5]
    v_mfma_f32_16x16x32_bf16 v[224:227], v[60:63], v[96:99], v[224:227]
    global_load_lds_dwordx4 v[6:7], off sc1
    v_lshl_add_u64 v[6:7], v[8:9], 0, v[6:7]
    v_mfma_f32_16x16x32_bf16 v[228:231], v[60:63], v[100:103], v[228:231]
    ds_read_b64_tr_b16 v[32:33], v12 offset:0
    v_mfma_f32_16x16x32_bf16 v[196:199], v[56:59], v[100:103], v[196:199]
    ds_read_b64_tr_b16 v[34:35], v12 offset:4096
    v_mfma_f32_16x16x32_bf16 v[164:167], v[52:55], v[100:103], v[164:167]
    ds_read_b64_tr_b16 v[36:37], v13 offset:0
    v_mfma_f32_16x16x32_bf16 v[132:135], v[48:51], v[100:103], v[132:135]
    ds_read_b64_tr_b16 v[38:39], v13 offset:4096
    v_mfma_f32_16x16x32_bf16 v[136:139], v[48:51], v[104:107], v[136:139]
    ds_read_b64_tr_b16 v[40:41], v12 offset:8192
    v_mfma_f32_16x16x32_bf16 v[168:171], v[52:55], v[104:107], v[168:171]
    ds_read_b64_tr_b16 v[42:43], v12 offset:12288
    v_mfma_f32_16x16x32_bf16 v[24:27], v[48:51], v[20:23], v[24:27]
    ds_read_b64_tr_b16 v[44:45], v13 offset:8192
    v_mfma_f32_16x16x32_bf16 v[200:203], v[56:59], v[104:107], v[200:203]
    ds_read_b64_tr_b16 v[46:47], v13 offset:12288
    v_mfma_f32_16x16x32_bf16 v[232:235], v[60:63], v[104:107], v[232:235]
    ds_read_b128 v[64:67], v10 offset:0
    v_mfma_f32_16x16x32_bf16 v[236:239], v[60:63], v[108:111], v[236:239]
    ds_read_b128 v[68:71], v10 offset:2048
    v_mfma_f32_16x16x32_bf16 v[204:207], v[56:59], v[108:111], v[204:207]
    ds_read_b128 v[72:75], v10 offset:4096
    v_mfma_f32_16x16x32_bf16 v[172:175], v[52:55], v[108:111], v[172:175]
    ds_read_b128 v[76:79], v10 offset:6144
    v_mfma_f32_16x16x32_bf16 v[140:143], v[48:51], v[108:111], v[140:143]
    ds_read_b128 v[80:83], v10 offset:8192
    v_mfma_f32_16x16x32_bf16 v[144:147], v[48:51], v[112:115], v[144:147]
    ds_read_b128 v[84:87], v10 offset:10240
    v_mfma_f32_16x16x32_bf16 v[176:179], v[52:55], v[112:115], v[176:179]
    ds_read_b128 v[88:91], v10 offset:12288
    v_mfma_f32_16x16x32_bf16 v[208:211], v[56:59], v[112:115], v[208:211]
    ds_read_b128 v[92:95], v10 offset:14336
    v_mfma_f32_16x16x32_bf16 v[240:243], v[60:63], v[112:115], v[240:243]
    v_mfma_f32_16x16x32_bf16 v[28:31], v[56:59], v[20:23], v[28:31]
    v_mfma_f32_16x16x32_bf16 v[244:247], v[60:63], v[116:119], v[244:247]
    v_mfma_f32_16x16x32_bf16 v[212:215], v[56:59], v[116:119], v[212:215]
    v_mfma_f32_16x16x32_bf16 v[180:183], v[52:55], v[116:119], v[180:183]
    v_mfma_f32_16x16x32_bf16 v[148:151], v[48:51], v[116:119], v[148:151]
    v_mfma_f32_16x16x32_bf16 v[152:155], v[48:51], v[120:123], v[152:155]
    v_mfma_f32_16x16x32_bf16 v[184:187], v[52:55], v[120:123], v[184:187]
    v_mfma_f32_16x16x32_bf16 v[216:219], v[56:59], v[120:123], v[216:219]
    v_mfma_f32_16x16x32_bf16 v[248:251], v[60:63], v[120:123], v[248:251]
    v_mfma_f32_16x16x32_bf16 v[252:255], v[60:63], v[124:127], v[252:255]
    v_mfma_f32_16x16x32_bf16 v[220:223], v[56:59], v[124:127], v[220:223]
    v_mfma_f32_16x16x32_bf16 v[188:191], v[52:55], v[124:127], v[188:191]
    v_mfma_f32_16x16x32_bf16 v[156:159], v[48:51], v[124:127], v[156:159]
    s_waitcnt vmcnt(8) lgkmcnt(0)
    s_cmp_lg_u32 s3, 0
    s_cbranch_scc1 P1_NC23
    s_waitcnt vmcnt(8)
    s_mov_b32 s33, 2097152
PL5:
    v_cmp_eq_u64 vcc, s[8:9], v[16:17]
    v_cmp_eq_u64 s[34:35], s[8:9], v[18:19]
    s_and_b64 vcc, vcc, s[34:35]
    s_cmp_eq_u64 vcc, -1
    s_cbranch_scc1 PD5
    s_sub_u32 s33, s33, 1
    s_cbranch_scc1 PD5
    s_sleep 8
    v_mbcnt_lo_u32_b32 v16, -1, 0
    v_mbcnt_hi_u32_b32 v16, -1, v16
    v_lshlrev_b32 v16, 4, v16
    global_load_dwordx4 v[16:19], v16, s[58:59] offset:0 sc1
    s_waitcnt vmcnt(0)
    s_branch PL5
PD5:
P1_NC23:
    s_barrier
    v_mfma_f32_16x16x32_bf16 v[128:131], v[32:35], v[64:67], v[128:131]
    s_add_u32 m0, s23, 81920
    s_mov_b32 s20, 263936
    buffer_load_dwordx4 v2, s[12:15], s20 offen sc1 lds
    v_mfma_f32_16x16x32_bf16 v[160:163], v[36:39], v[64:67], v[160:163]
    buffer_load_dwordx4 v3, s[12:15], s20 offen offset:1024 sc1 lds
    v_mfma_f32_16x16x32_bf16 v[192:195], v[40:43], v[64:67], v[192:195]
    s_add_u32 m0, s24, 0
    s_nop 0
    global_load_lds_dwordx4 v[4:5], off sc1
    s_add_u32 m0, s24, 2048
    v_lshl_add_u64 v[4:5], v[8:9], 0, v[4:5]
    v_mfma_f32_16x16x32_bf16 v[224:227], v[44:47], v[64:67], v[224:227]
    global_load_lds_dwordx4 v[6:7], off sc1
    v_lshl_add_u64 v[6:7], v[8:9], 0, v[6:7]
    v_mfma_f32_16x16x32_bf16 v[228:231], v[44:47], v[68:71], v[228:231]
    ds_read_b64_tr_b16 v[48:49], v12 offset:16384
    v_mfma_f32_16x16x32_bf16 v[196:199], v[40:43], v[68:71], v[196:199]
    ds_read_b64_tr_b16 v[50:51], v12 offset:20480
    v_mfma_f32_16x16x32_bf16 v[164:167], v[36:39], v[68:71], v[164:167]
    ds_read_b64_tr_b16 v[52:53], v13 offset:16384
    v_mfma_f32_16x16x32_bf16 v[132:135], v[32:35], v[68:71], v[132:135]
    ds_read_b64_tr_b16 v[54:55], v13 offset:20480
    v_mfma_f32_16x16x32_bf16 v[136:139], v[32:35], v[72:75], v[136:139]
    ds_read_b64_tr_b16 v[56:57], v12 offset:24576
    v_mfma_f32_16x16x32_bf16 v[168:171], v[36:39], v[72:75], v[168:171]
    ds_read_b64_tr_b16 v[58:59], v12 offset:28672
    v_mfma_f32_16x16x32_bf16 v[24:27], v[32:35], v[20:23], v[24:27]
    ds_read_b64_tr_b16 v[60:61], v13 offset:24576
    v_mfma_f32_16x16x32_bf16 v[200:203], v[40:43], v[72:75], v[200:203]
    ds_read_b64_tr_b16 v[62:63], v13 offset:28672
    v_mfma_f32_16x16x32_bf16 v[232:235], v[44:47], v[72:75], v[232:235]
    ds_read_b128 v[96:99], v11 offset:0
    v_mfma_f32_16x16x32_bf16 v[236:239], v[44:47], v[76:79], v[236:239]
    ds_read_b128 v[100:103], v11 offset:2048
    v_mfma_f32_16x16x32_bf16 v[204:207], v[40:43], v[76:79], v[204:207]
    ds_read_b128 v[104:107], v11 offset:4096
    v_mfma_f32_16x16x32_bf16 v[172:175], v[36:39], v[76:79], v[172:175]
    ds_read_b128 v[108:111], v11 offset:6144
    v_mfma_f32_16x16x32_bf16 v[140:143], v[32:35], v[76:79], v[140:143]
    ds_read_b128 v[112:115], v11 offset:8192
    v_mfma_f32_16x16x32_bf16 v[144:147], v[32:35], v[80:83], v[144:147]
    ds_read_b128 v[116:119], v11 offset:10240
    v_mfma_f32_16x16x32_bf16 v[176:179], v[36:39], v[80:83], v[176:179]
    ds_read_b128 v[120:123], v11 offset:12288
    v_mfma_f32_16x16x32_bf16 v[208:211], v[40:43], v[80:83], v[208:211]
    ds_read_b128 v[124:127], v11 offset:14336
    v_mfma_f32_16x16x32_bf16 v[240:243], v[44:47], v[80:83], v[240:243]
    v_mfma_f32_16x16x32_bf16 v[28:31], v[40:43], v[20:23], v[28:31]
    v_mfma_f32_16x16x32_bf16 v[244:247], v[44:47], v[84:87], v[244:247]
    v_mfma_f32_16x16x32_bf16 v[212:215], v[40:43], v[84:87], v[212:215]
    v_mfma_f32_16x16x32_bf16 v[180:183], v[36:39], v[84:87], v[180:183]
    v_mfma_f32_16x16x32_bf16 v[148:151], v[32:35], v[84:87], v[148:151]
    v_mfma_f32_16x16x32_bf16 v[152:155], v[32:35], v[88:91], v[152:155]
    v_mfma_f32_16x16x32_bf16 v[184:187], v[36:39], v[88:91], v[184:187]
    v_mfma_f32_16x16x32_bf16 v[216:219], v[40:43], v[88:91], v[216:219]
    v_mfma_f32_16x16x32_bf16 v[248:251], v[44:47], v[88:91], v[248:251]
    v_mfma_f32_16x16x32_bf16 v[252:255], v[44:47], v[92:95], v[252:255]
    v_mfma_f32_16x16x32_bf16 v[220:223], v[40:43], v[92:95], v[220:223]
    v_mfma_f32_16x16x32_bf16 v[188:191], v[36:39], v[92:95], v[188:191]
    v_mfma_f32_16x16x32_bf16 v[156:159], v[32:35], v[92:95], v[156:159]
    s_waitcnt vmcnt(8) lgkmcnt(0)
    s_barrier
    v_mfma_f32_16x16x32_bf16 v[128:131], v[48:51], v[96:99], v[128:131]
    s_add_u32 m0, s23, 0
    s_mov_b32 s20, 1920
    buffer_load_dwordx4 v2, s[12:15], s20 offen sc1 lds
    v_mfma_f32_16x16x32_bf16 v[160:163], v[52:55], v[96:99], v[160:163]
    buffer_load_dwordx4 v3, s[12:15], s20 offen offset:1024 sc1 lds
    v_mfma_f32_16x16x32_bf16 v[192:195], v[56:59], v[96:99], v[192:195]
    s_add_u32 m0, s24, 16384
    s_nop 0
    global_load_lds_dwordx4 v[4:5], off sc1
    s_add_u32 m0, s24, 18432
    v_lshl_add_u64 v[4:5], v[8:9], 0, v[4:5]
    v_mfma_f32_16x16x32_bf16 v[224:227], v[60:63], v[96:99], v[224:227]
    global_load_lds_dwordx4 v[6:7], off sc1
    v_lshl_add_u64 v[6:7], v[8:9], 0, v[6:7]
    v_mfma_f32_16x16x32_bf16 v[228:231], v[60:63], v[100:103], v[228:231]
    ds_read_b64_tr_b16 v[32:33], v12 offset:32768
    v_mfma_f32_16x16x32_bf16 v[196:199], v[56:59], v[100:103], v[196:199]
    ds_read_b64_tr_b16 v[34:35], v12 offset:36864
    v_mfma_f32_16x16x32_bf16 v[164:167], v[52:55], v[100:103], v[164:167]
    ds_read_b64_tr_b16 v[36:37], v13 offset:32768
    v_mfma_f32_16x16x32_bf16 v[132:135], v[48:51], v[100:103], v[132:135]
    ds_read_b64_tr_b16 v[38:39], v13 offset:36864
    v_mfma_f32_16x16x32_bf16 v[136:139], v[48:51], v[104:107], v[136:139]
    ds_read_b64_tr_b16 v[40:41], v12 offset:40960
    v_mfma_f32_16x16x32_bf16 v[168:171], v[52:55], v[104:107], v[168:171]
    ds_read_b64_tr_b16 v[42:43], v12 offset:45056
    v_mfma_f32_16x16x32_bf16 v[24:27], v[48:51], v[20:23], v[24:27]
    ds_read_b64_tr_b16 v[44:45], v13 offset:40960
    v_mfma_f32_16x16x32_bf16 v[200:203], v[56:59], v[104:107], v[200:203]
    ds_read_b64_tr_b16 v[46:47], v13 offset:45056
    v_mfma_f32_16x16x32_bf16 v[232:235], v[60:63], v[104:107], v[232:235]
    ds_read_b128 v[64:67], v10 offset:16384
    v_mfma_f32_16x16x32_bf16 v[236:239], v[60:63], v[108:111], v[236:239]
    ds_read_b128 v[68:71], v10 offset:18432
    v_mfma_f32_16x16x32_bf16 v[204:207], v[56:59], v[108:111], v[204:207]
    ds_read_b128 v[72:75], v10 offset:20480
    v_mfma_f32_16x16x32_bf16 v[172:175], v[52:55], v[108:111], v[172:175]
    ds_read_b128 v[76:79], v10 offset:22528
    v_mfma_f32_16x16x32_bf16 v[140:143], v[48:51], v[108:111], v[140:143]
    ds_read_b128 v[80:83], v10 offset:24576
    v_mfma_f32_16x16x32_bf16 v[144:147], v[48:51], v[112:115], v[144:147]
    ds_read_b128 v[84:87], v10 offset:26624
    v_mfma_f32_16x16x32_bf16 v[176:179], v[52:55], v[112:115], v[176:179]
    ds_read_b128 v[88:91], v10 offset:28672
    v_mfma_f32_16x16x32_bf16 v[208:211], v[56:59], v[112:115], v[208:211]
    ds_read_b128 v[92:95], v10 offset:30720
    v_mfma_f32_16x16x32_bf16 v[240:243], v[60:63], v[112:115], v[240:243]
    v_mfma_f32_16x16x32_bf16 v[28:31], v[56:59], v[20:23], v[28:31]
    v_mfma_f32_16x16x32_bf16 v[244:247], v[60:63], v[116:119], v[244:247]
    v_mfma_f32_16x16x32_bf16 v[212:215], v[56:59], v[116:119], v[212:215]
    v_mfma_f32_16x16x32_bf16 v[180:183], v[52:55], v[116:119], v[180:183]
    v_mfma_f32_16x16x32_bf16 v[148:151], v[48:51], v[116:119], v[148:151]
    v_mfma_f32_16x16x32_bf16 v[152:155], v[48:51], v[120:123], v[152:155]
    v_mfma_f32_16x16x32_bf16 v[184:187], v[52:55], v[120:123], v[184:187]
    v_mfma_f32_16x16x32_bf16 v[216:219], v[56:59], v[120:123], v[216:219]
    v_mfma_f32_16x16x32_bf16 v[248:251], v[60:63], v[120:123], v[248:251]
    v_mfma_f32_16x16x32_bf16 v[252:255], v[60:63], v[124:127], v[252:255]
    v_mfma_f32_16x16x32_bf16 v[220:223], v[56:59], v[124:127], v[220:223]
    v_mfma_f32_16x16x32_bf16 v[188:191], v[52:55], v[124:127], v[188:191]
    v_mfma_f32_16x16x32_bf16 v[156:159], v[48:51], v[124:127], v[156:159]
    s_waitcnt vmcnt(8) lgkmcnt(0)
    s_barrier
    v_mfma_f32_16x16x32_bf16 v[128:131], v[32:35], v[64:67], v[128:131]
    s_add_u32 m0, s23, 49152
    s_mov_b32 s20, 264064
    buffer_load_dwordx4 v2, s[12:15], s20 offen sc1 lds
    v_mfma_f32_16x16x32_bf16 v[160:163], v[36:39], v[64:67], v[160:163]
    buffer_load_dwordx4 v3, s[12:15], s20 offen offset:1024 sc1 lds
    v_mfma_f32_16x16x32_bf16 v[192:195], v[40:43], v[64:67], v[192:195]
    s_add_u32 m0, s24, 32768
    s_nop 0
    global_load_lds_dwordx4 v[4:5], off sc1
    s_add_u32 m0, s24, 34816
    v_lshl_add_u64 v[4:5], v[8:9], 0, v[4:5]
    v_mfma_f32_16x16x32_bf16 v[224:227], v[44:47], v[64:67], v[224:227]
    global_load_lds_dwordx4 v[6:7], off sc1
    v_lshl_add_u64 v[6:7], v[8:9], 0, v[6:7]
    v_mfma_f32_16x16x32_bf16 v[228:231], v[44:47], v[68:71], v[228:231]
    ds_read_b64_tr_b16 v[48:49], v12 offset:49152
    v_mfma_f32_16x16x32_bf16 v[196:199], v[40:43], v[68:71], v[196:199]
    ds_read_b64_tr_b16 v[50:51], v12 offset:53248
    v_mfma_f32_16x16x32_bf16 v[164:167], v[36:39], v[68:71], v[164:167]
    ds_read_b64_tr_b16 v[52:53], v13 offset:49152
    v_mfma_f32_16x16x32_bf16 v[132:135], v[32:35], v[68:71], v[132:135]
    ds_read_b64_tr_b16 v[54:55], v13 offset:53248
    v_mfma_f32_16x16x32_bf16 v[136:139], v[32:35], v[72:75], v[136:139]
    ds_read_b64_tr_b16 v[56:57], v12 offset:57344
    v_mfma_f32_16x16x32_bf16 v[168:171], v[36:39], v[72:75], v[168:171]
    ds_read_b64_tr_b16 v[58:59], v12 offset:61440
    v_mfma_f32_16x16x32_bf16 v[24:27], v[32:35], v[20:23], v[24:27]
    ds_read_b64_tr_b16 v[60:61], v13 offset:57344
    v_mfma_f32_16x16x32_bf16 v[200:203], v[40:43], v[72:75], v[200:203]
    ds_read_b64_tr_b16 v[62:63], v13 offset:61440
    v_mfma_f32_16x16x32_bf16 v[232:235], v[44:47], v[72:75], v[232:235]
    ds_read_b128 v[96:99], v11 offset:16384
    v_mfma_f32_16x16x32_bf16 v[236:239], v[44:47], v[76:79], v[236:239]
    ds_read_b128 v[100:103], v11 offset:18432
    v_mfma_f32_16x16x32_bf16 v[204:207], v[40:43], v[76:79], v[204:207]
    ds_read_b128 v[104:107], v11 offset:20480
    v_mfma_f32_16x16x32_bf16 v[172:175], v[36:39], v[76:79], v[172:175]
    ds_read_b128 v[108:111], v11 offset:22528
    v_mfma_f32_16x16x32_bf16 v[140:143], v[32:35], v[76:79], v[140:143]
    ds_read_b128 v[112:115], v11 offset:24576
    v_mfma_f32_16x16x32_bf16 v[144:147], v[32:35], v[80:83], v[144:147]
    ds_read_b128 v[116:119], v11 offset:26624
    v_mfma_f32_16x16x32_bf16 v[176:179], v[36:39], v[80:83], v[176:179]
    ds_read_b128 v[120:123], v11 offset:28672
    v_mfma_f32_16x16x32_bf16 v[208:211], v[40:43], v[80:83], v[208:211]
    ds_read_b128 v[124:127], v11 offset:30720
    v_mfma_f32_16x16x32_bf16 v[240:243], v[44:47], v[80:83], v[240:243]
    v_mfma_f32_16x16x32_bf16 v[28:31], v[40:43], v[20:23], v[28:31]
    v_mfma_f32_16x16x32_bf16 v[244:247], v[44:47], v[84:87], v[244:247]
    v_mfma_f32_16x16x32_bf16 v[212:215], v[40:43], v[84:87], v[212:215]
    v_mfma_f32_16x16x32_bf16 v[180:183], v[36:39], v[84:87], v[180:183]
    v_mfma_f32_16x16x32_bf16 v[148:151], v[32:35], v[84:87], v[148:151]
    v_mfma_f32_16x16x32_bf16 v[152:155], v[32:35], v[88:91], v[152:155]
    v_mfma_f32_16x16x32_bf16 v[184:187], v[36:39], v[88:91], v[184:187]
    v_mfma_f32_16x16x32_bf16 v[216:219], v[40:43], v[88:91], v[216:219]
    v_mfma_f32_16x16x32_bf16 v[248:251], v[44:47], v[88:91], v[248:251]
    v_mfma_f32_16x16x32_bf16 v[252:255], v[44:47], v[92:95], v[252:255]
    v_mfma_f32_16x16x32_bf16 v[220:223], v[40:43], v[92:95], v[220:223]
    v_mfma_f32_16x16x32_bf16 v[188:191], v[36:39], v[92:95], v[188:191]
    v_mfma_f32_16x16x32_bf16 v[156:159], v[32:35], v[92:95], v[156:159]
    s_waitcnt vmcnt(8) lgkmcnt(0)
    s_barrier
    v_mfma_f32_16x16x32_bf16 v[128:131], v[48:51], v[96:99], v[128:131]
    s_add_u32 m0, s24, 49152
    s_nop 0
    global_load_lds_dwordx4 v[4:5], off sc1
    s_add_u32 m0, s24, 51200
    v_lshl_add_u64 v[4:5], v[8:9], 0, v[4:5]
    v_mfma_f32_16x16x32_bf16 v[160:163], v[52:55], v[96:99], v[160:163]
    global_load_lds_dwordx4 v[6:7], off sc1
    v_lshl_add_u64 v[6:7], v[8:9], 0, v[6:7]
    v_mfma_f32_16x16x32_bf16 v[192:195], v[56:59], v[96:99], v[192:195]
    v_mbcnt_lo_u32_b32 v1, -1, 0
    v_mbcnt_hi_u32_b32 v1, -1, v1
    v_mfma_f32_16x16x32_bf16 v[224:227], v[60:63], v[96:99], v[224:227]
    v_lshlrev_b32 v19, 4, v1
    s_lshr_b32 s32, s2, 3
    s_lshl_b32 s32, s32, 13
    s_lshr_b32 s33, s23, 1
    s_add_u32 s32, s32, s33
    s_add_u32 s32, s32, 8192
    buffer_load_dword v16, v19, s[40:43], s32 offen
    v_mfma_f32_16x16x32_bf16 v[228:231], v[60:63], v[100:103], v[228:231]
    ds_read_b64_tr_b16 v[32:33], v12 offset:0
    v_mfma_f32_16x16x32_bf16 v[196:199], v[56:59], v[100:103], v[196:199]
    ds_read_b64_tr_b16 v[34:35], v12 offset:4096
    v_mfma_f32_16x16x32_bf16 v[164:167], v[52:55], v[100:103], v[164:167]
    ds_read_b64_tr_b16 v[36:37], v13 offset:0
    v_mfma_f32_16x16x32_bf16 v[132:135], v[48:51], v[100:103], v[132:135]
    ds_read_b64_tr_b16 v[38:39], v13 offset:4096
    v_mfma_f32_16x16x32_bf16 v[136:139], v[48:51], v[104:107], v[136:139]
    ds_read_b64_tr_b16 v[40:41], v12 offset:8192
    v_mfma_f32_16x16x32_bf16 v[168:171], v[52:55], v[104:107], v[168:171]
    ds_read_b64_tr_b16 v[42:43], v12 offset:12288
    v_mfma_f32_16x16x32_bf16 v[24:27], v[48:51], v[20:23], v[24:27]
    ds_read_b64_tr_b16 v[44:45], v13 offset:8192
    v_mfma_f32_16x16x32_bf16 v[200:203], v[56:59], v[104:107], v[200:203]
    ds_read_b64_tr_b16 v[46:47], v13 offset:12288
    v_mfma_f32_16x16x32_bf16 v[232:235], v[60:63], v[104:107], v[232:235]
    ds_read_b128 v[64:67], v10 offset:32768
    v_mfma_f32_16x16x32_bf16 v[236:239], v[60:63], v[108:111], v[236:239]
    ds_read_b128 v[68:71], v10 offset:34816
    v_mfma_f32_16x16x32_bf16 v[204:207], v[56:59], v[108:111], v[204:207]
    ds_read_b128 v[72:75], v10 offset:36864
    v_mfma_f32_16x16x32_bf16 v[172:175], v[52:55], v[108:111], v[172:175]
    ds_read_b128 v[76:79], v10 offset:38912
    v_mfma_f32_16x16x32_bf16 v[140:143], v[48:51], v[108:111], v[140:143]
    ds_read_b128 v[80:83], v10 offset:40960
    v_mfma_f32_16x16x32_bf16 v[144:147], v[48:51], v[112:115], v[144:147]
    ds_read_b128 v[84:87], v10 offset:43008
    v_mfma_f32_16x16x32_bf16 v[176:179], v[52:55], v[112:115], v[176:179]
    ds_read_b128 v[88:91], v10 offset:45056
    v_mfma_f32_16x16x32_bf16 v[208:211], v[56:59], v[112:115], v[208:211]
    ds_read_b128 v[92:95], v10 offset:47104
    v_mfma_f32_16x16x32_bf16 v[240:243], v[60:63], v[112:115], v[240:243]
    v_mfma_f32_16x16x32_bf16 v[28:31], v[56:59], v[20:23], v[28:31]
    v_mfma_f32_16x16x32_bf16 v[244:247], v[60:63], v[116:119], v[244:247]
    v_mfma_f32_16x16x32_bf16 v[212:215], v[56:59], v[116:119], v[212:215]
    v_mfma_f32_16x16x32_bf16 v[180:183], v[52:55], v[116:119], v[180:183]
    v_mfma_f32_16x16x32_bf16 v[148:151], v[48:51], v[116:119], v[148:151]
    v_mfma_f32_16x16x32_bf16 v[152:155], v[48:51], v[120:123], v[152:155]
    v_mfma_f32_16x16x32_bf16 v[184:187], v[52:55], v[120:123], v[184:187]
    v_mfma_f32_16x16x32_bf16 v[216:219], v[56:59], v[120:123], v[216:219]
    v_mfma_f32_16x16x32_bf16 v[248:251], v[60:63], v[120:123], v[248:251]
    v_mfma_f32_16x16x32_bf16 v[252:255], v[60:63], v[124:127], v[252:255]
    v_mfma_f32_16x16x32_bf16 v[220:223], v[56:59], v[124:127], v[220:223]
    v_mfma_f32_16x16x32_bf16 v[188:191], v[52:55], v[124:127], v[188:191]
    v_mfma_f32_16x16x32_bf16 v[156:159], v[48:51], v[124:127], v[156:159]
    s_waitcnt vmcnt(7) lgkmcnt(0)
    s_barrier
    v_mfma_f32_16x16x32_bf16 v[128:131], v[32:35], v[64:67], v[128:131]
    ds_read_b64_tr_b16 v[48:49], v12 offset:16384
    v_mfma_f32_16x16x32_bf16 v[160:163], v[36:39], v[64:67], v[160:163]
    ds_read_b64_tr_b16 v[50:51], v12 offset:20480
    v_mfma_f32_16x16x32_bf16 v[192:195], v[40:43], v[64:67], v[192:195]
    ds_read_b64_tr_b16 v[52:53], v13 offset:16384
    v_mfma_f32_16x16x32_bf16 v[224:227], v[44:47], v[64:67], v[224:227]
    ds_read_b64_tr_b16 v[54:55], v13 offset:20480
    v_mfma_f32_16x16x32_bf16 v[228:231], v[44:47], v[68:71], v[228:231]
    ds_read_b64_tr_b16 v[56:57], v12 offset:24576
    v_mfma_f32_16x16x32_bf16 v[196:199], v[40:43], v[68:71], v[196:199]
    ds_read_b64_tr_b16 v[58:59], v12 offset:28672
    v_mfma_f32_16x16x32_bf16 v[164:167], v[36:39], v[68:71], v[164:167]
    ds_read_b64_tr_b16 v[60:61], v13 offset:24576
    v_mfma_f32_16x16x32_bf16 v[132:135], v[32:35], v[68:71], v[132:135]
    ds_read_b64_tr_b16 v[62:63], v13 offset:28672
    v_mfma_f32_16x16x32_bf16 v[136:139], v[32:35], v[72:75], v[136:139]
    ds_read_b128 v[96:99], v11 offset:32768
    v_mfma_f32_16x16x32_bf16 v[168:171], v[36:39], v[72:75], v[168:171]
    ds_read_b128 v[100:103], v11 offset:34816
    v_mfma_f32_16x16x32_bf16 v[24:27], v[32:35], v[20:23], v[24:27]
    ds_read_b128 v[104:107], v11 offset:36864
    v_mfma_f32_16x16x32_bf16 v[200:203], v[40:43], v[72:75], v[200:203]
    ds_read_b128 v[108:111], v11 offset:38912
    v_mfma_f32_16x16x32_bf16 v[232:235], v[44:47], v[72:75], v[232:235]
    ds_read_b128 v[112:115], v11 offset:40960
    v_mfma_f32_16x16x32_bf16 v[236:239], v[44:47], v[76:79], v[236:239]
    ds_read_b128 v[116:119], v11 offset:43008
    v_mfma_f32_16x16x32_bf16 v[204:207], v[40:43], v[76:79], v[204:207]
    ds_read_b128 v[120:123], v11 offset:45056
    v_mfma_f32_16x16x32_bf16 v[172:175], v[36:39], v[76:79], v[172:175]
    ds_read_b128 v[124:127], v11 offset:47104
    v_mfma_f32_16x16x32_bf16 v[140:143], v[32:35], v[76:79], v[140:143]
    v_mfma_f32_16x16x32_bf16 v[144:147], v[32:35], v[80:83], v[144:147]
    v_mfma_f32_16x16x32_bf16 v[176:179], v[36:39], v[80:83], v[176:179]
    v_mfma_f32_16x16x32_bf16 v[208:211], v[40:43], v[80:83], v[208:211]
    v_mfma_f32_16x16x32_bf16 v[240:243], v[44:47], v[80:83], v[240:243]
    v_mfma_f32_16x16x32_bf16 v[28:31], v[40:43], v[20:23], v[28:31]
    v_mfma_f32_16x16x32_bf16 v[244:247], v[44:47], v[84:87], v[244:247]
    v_mfma_f32_16x16x32_bf16 v[212:215], v[40:43], v[84:87], v[212:215]
    v_mfma_f32_16x16x32_bf16 v[180:183], v[36:39], v[84:87], v[180:183]
    v_mfma_f32_16x16x32_bf16 v[148:151], v[32:35], v[84:87], v[148:151]
    v_mfma_f32_16x16x32_bf16 v[152:155], v[32:35], v[88:91], v[152:155]
    v_mfma_f32_16x16x32_bf16 v[184:187], v[36:39], v[88:91], v[184:187]
    v_mfma_f32_16x16x32_bf16 v[216:219], v[40:43], v[88:91], v[216:219]
    v_mfma_f32_16x16x32_bf16 v[248:251], v[44:47], v[88:91], v[248:251]
    v_mfma_f32_16x16x32_bf16 v[252:255], v[44:47], v[92:95], v[252:255]
    v_mfma_f32_16x16x32_bf16 v[220:223], v[40:43], v[92:95], v[220:223]
    v_mfma_f32_16x16x32_bf16 v[188:191], v[36:39], v[92:95], v[188:191]
    v_mfma_f32_16x16x32_bf16 v[156:159], v[32:35], v[92:95], v[156:159]
    s_waitcnt vmcnt(3) lgkmcnt(0)
    s_barrier
    v_mfma_f32_16x16x32_bf16 v[128:131], v[48:51], v[96:99], v[128:131]
    s_lshr_b32 s32, s23, 1
    s_add_u32 m0, s32, 32768
    s_nop 0
    buffer_load_dwordx4 v19, s[96:99], s21 offen sc1 lds
    v_mfma_f32_16x16x32_bf16 v[160:163], v[52:55], v[96:99], v[160:163]
    ds_read_b64_tr_b16 v[32:33], v12 offset:32768
    v_mfma_f32_16x16x32_bf16 v[192:195], v[56:59], v[96:99], v[192:195]
    ds_read_b64_tr_b16 v[34:35], v12 offset:36864
    v_mfma_f32_16x16x32_bf16 v[224:227], v[60:63], v[96:99], v[224:227]
    ds_read_b64_tr_b16 v[36:37], v13 offset:32768
    v_mfma_f32_16x16x32_bf16 v[228:231], v[60:63], v[100:103], v[228:231]
    ds_read_b64_tr_b16 v[38:39], v13 offset:36864
    v_mfma_f32_16x16x32_bf16 v[196:199], v[56:59], v[100:103], v[196:199]
    ds_read_b64_tr_b16 v[40:41], v12 offset:40960
    v_mfma_f32_16x16x32_bf16 v[164:167], v[52:55], v[100:103], v[164:167]
    ds_read_b64_tr_b16 v[42:43], v12 offset:45056
    v_mfma_f32_16x16x32_bf16 v[132:135], v[48:51], v[100:103], v[132:135]
    ds_read_b64_tr_b16 v[44:45], v13 offset:40960
    v_mfma_f32_16x16x32_bf16 v[136:139], v[48:51], v[104:107], v[136:139]
    ds_read_b64_tr_b16 v[46:47], v13 offset:45056
    v_mfma_f32_16x16x32_bf16 v[168:171], v[52:55], v[104:107], v[168:171]
    ds_read_b128 v[64:67], v10 offset:0
    v_mfma_f32_16x16x32_bf16 v[24:27], v[48:51], v[20:23], v[24:27]
    ds_read_b128 v[68:71], v10 offset:2048
    v_mfma_f32_16x16x32_bf16 v[200:203], v[56:59], v[104:107], v[200:203]
    ds_read_b128 v[72:75], v10 offset:4096
    v_mfma_f32_16x16x32_bf16 v[232:235], v[60:63], v[104:107], v[232:235]
    ds_read_b128 v[76:79], v10 offset:6144
    v_mfma_f32_16x16x32_bf16 v[236:239], v[60:63], v[108:111], v[236:239]
    ds_read_b128 v[80:83], v10 offset:8192
    v_mfma_f32_16x16x32_bf16 v[204:207], v[56:59], v[108:111], v[204:207]
    ds_read_b128 v[84:87], v10 offset:10240
    v_mfma_f32_16x16x32_bf16 v[172:175], v[52:55], v[108:111], v[172:175]
    ds_read_b128 v[88:91], v10 offset:12288
    v_mfma_f32_16x16x32_bf16 v[140:143], v[48:51], v[108:111], v[140:143]
    ds_read_b128 v[92:95], v10 offset:14336
    v_mfma_f32_16x16x32_bf16 v[144:147], v[48:51], v[112:115], v[144:147]
    v_mfma_f32_16x16x32_bf16 v[176:179], v[52:55], v[112:115], v[176:179]
    v_mfma_f32_16x16x32_bf16 v[208:211], v[56:59], v[112:115], v[208:211]
    v_mfma_f32_16x16x32_bf16 v[240:243], v[60:63], v[112:115], v[240:243]
    v_mfma_f32_16x16x32_bf16 v[28:31], v[56:59], v[20:23], v[28:31]
    v_mfma_f32_16x16x32_bf16 v[244:247], v[60:63], v[116:119], v[244:247]
    v_mfma_f32_16x16x32_bf16 v[212:215], v[56:59], v[116:119], v[212:215]
    v_mfma_f32_16x16x32_bf16 v[180:183], v[52:55], v[116:119], v[180:183]
    v_mfma_f32_16x16x32_bf16 v[148:151], v[48:51], v[116:119], v[148:151]
    v_mfma_f32_16x16x32_bf16 v[152:155], v[48:51], v[120:123], v[152:155]
    v_mfma_f32_16x16x32_bf16 v[184:187], v[52:55], v[120:123], v[184:187]
    v_mfma_f32_16x16x32_bf16 v[216:219], v[56:59], v[120:123], v[216:219]
    v_mfma_f32_16x16x32_bf16 v[248:251], v[60:63], v[120:123], v[248:251]
    v_mfma_f32_16x16x32_bf16 v[252:255], v[60:63], v[124:127], v[252:255]
    v_mfma_f32_16x16x32_bf16 v[220:223], v[56:59], v[124:127], v[220:223]
    v_mfma_f32_16x16x32_bf16 v[188:191], v[52:55], v[124:127], v[188:191]
    v_mfma_f32_16x16x32_bf16 v[156:159], v[48:51], v[124:127], v[156:159]
    s_waitcnt vmcnt(1) lgkmcnt(0)
    s_barrier
    v_mfma_f32_16x16x32_bf16 v[128:131], v[32:35], v[64:67], v[128:131]
    s_xor_b32 m0, s56, 0x4000
    s_add_u32 s32, s55, 8192
    buffer_load_dwordx4 v19, s[40:43], s32 offen sc1 lds
    v_mfma_f32_16x16x32_bf16 v[160:163], v[36:39], v[64:67], v[160:163]
    buffer_load_dwordx4 v19, s[40:43], s32 offen offset:1024 sc1 lds
    v_mfma_f32_16x16x32_bf16 v[192:195], v[40:43], v[64:67], v[192:195]
    v_lshlrev_b32 v19, 4, v1
    v_lshrrev_b32 v16, 4, v1
    v_and_b32 v17, 15, v1
    v_add_u32 v18, 131072, v19
    v_mfma_f32_16x16x32_bf16 v[224:227], v[44:47], v[64:67], v[224:227]
    v_lshlrev_b32 v0, 3, v17
    s_lshr_b32 s32, s23, 1
    v_add_u32 v0, s32, v0
    v_add_u32 v14, s23, v19
    s_lshl_b32 s32, s31, 11
    v_add_u32 v15, s32, v19
    v_mfma_f32_16x16x32_bf16 v[228:231], v[44:47], v[68:71], v[228:231]
    ds_read_b64_tr_b16 v[48:49], v12 offset:49152
    v_mfma_f32_16x16x32_bf16 v[196:199], v[40:43], v[68:71], v[196:199]
    ds_read_b64_tr_b16 v[50:51], v12 offset:53248
    v_mfma_f32_16x16x32_bf16 v[164:167], v[36:39], v[68:71], v[164:167]
    ds_read_b64_tr_b16 v[52:53], v13 offset:49152
    v_mfma_f32_16x16x32_bf16 v[132:135], v[32:35], v[68:71], v[132:135]
    ds_read_b64_tr_b16 v[54:55], v13 offset:53248
    v_mfma_f32_16x16x32_bf16 v[136:139], v[32:35], v[72:75], v[136:139]
    ds_read_b64_tr_b16 v[56:57], v12 offset:57344
    v_mfma_f32_16x16x32_bf16 v[168:171], v[36:39], v[72:75], v[168:171]
    ds_read_b64_tr_b16 v[58:59], v12 offset:61440
    v_mfma_f32_16x16x32_bf16 v[24:27], v[32:35], v[20:23], v[24:27]
    ds_read_b64_tr_b16 v[60:61], v13 offset:57344
    v_mfma_f32_16x16x32_bf16 v[200:203], v[40:43], v[72:75], v[200:203]
    ds_read_b64_tr_b16 v[62:63], v13 offset:61440
    v_mfma_f32_16x16x32_bf16 v[232:235], v[44:47], v[72:75], v[232:235]
    ds_read_b128 v[96:99], v11 offset:0
    v_mfma_f32_16x16x32_bf16 v[236:239], v[44:47], v[76:79], v[236:239]
    ds_read_b128 v[100:103], v11 offset:2048
    v_mfma_f32_16x16x32_bf16 v[204:207], v[40:43], v[76:79], v[204:207]
    ds_read_b128 v[104:107], v11 offset:4096
    v_mfma_f32_16x16x32_bf16 v[172:175], v[36:39], v[76:79], v[172:175]
    ds_read_b128 v[108:111], v11 offset:6144
    v_mfma_f32_16x16x32_bf16 v[140:143], v[32:35], v[76:79], v[140:143]
    ds_read_b128 v[112:115], v11 offset:8192
    v_mfma_f32_16x16x32_bf16 v[144:147], v[32:35], v[80:83], v[144:147]
    ds_read_b128 v[116:119], v11 offset:10240
    v_mfma_f32_16x16x32_bf16 v[176:179], v[36:39], v[80:83], v[176:179]
    ds_read_b128 v[120:123], v11 offset:12288
    v_mfma_f32_16x16x32_bf16 v[208:211], v[40:43], v[80:83], v[208:211]
    ds_read_b128 v[124:127], v11 offset:14336
    v_mfma_f32_16x16x32_bf16 v[240:243], v[44:47], v[80:83], v[240:243]
    v_mfma_f32_16x16x32_bf16 v[28:31], v[40:43], v[20:23], v[28:31]
    v_mfma_f32_16x16x32_bf16 v[244:247], v[44:47], v[84:87], v[244:247]
    v_mfma_f32_16x16x32_bf16 v[212:215], v[40:43], v[84:87], v[212:215]
    v_mfma_f32_16x16x32_bf16 v[180:183], v[36:39], v[84:87], v[180:183]
    v_mfma_f32_16x16x32_bf16 v[148:151], v[32:35], v[84:87], v[148:151]
    v_mfma_f32_16x16x32_bf16 v[152:155], v[32:35], v[88:91], v[152:155]
    v_mfma_f32_16x16x32_bf16 v[184:187], v[36:39], v[88:91], v[184:187]
    v_mfma_f32_16x16x32_bf16 v[216:219], v[40:43], v[88:91], v[216:219]
    v_mfma_f32_16x16x32_bf16 v[248:251], v[44:47], v[88:91], v[248:251]
    v_mfma_f32_16x16x32_bf16 v[252:255], v[44:47], v[92:95], v[252:255]
    v_mfma_f32_16x16x32_bf16 v[220:223], v[40:43], v[92:95], v[220:223]
    v_mfma_f32_16x16x32_bf16 v[188:191], v[36:39], v[92:95], v[188:191]
    v_mfma_f32_16x16x32_bf16 v[156:159], v[32:35], v[92:95], v[156:159]
    s_waitcnt vmcnt(2) lgkmcnt(0)
    s_barrier
    v_mfma_f32_16x16x32_bf16 v[24:27], v[48:51], v[20:23], v[24:27]
    s_mov_b32 m0, s56
    s_nop 0
    buffer_load_dwordx4 v19, s[40:43], s55 offen sc1 lds
    v_mfma_f32_16x16x32_bf16 v[28:31], v[56:59], v[20:23], v[28:31]
    buffer_load_dwordx4 v19, s[40:43], s55 offen offset:1024 sc1 lds
    s_add_u32 s55, s55, 16384
    v_mfma_f32_16x16x32_bf16 v[128:131], v[48:51], v[96:99], v[128:131]
    ds_read_b64 v[64:65], v0 offset:32768
    v_mfma_f32_16x16x32_bf16 v[160:163], v[52:55], v[96:99], v[160:163]
    ds_read_b64 v[66:67], v0 offset:32896
    v_mfma_f32_16x16x32_bf16 v[192:195], v[56:59], v[96:99], v[192:195]
    ds_read_b64 v[68:69], v0 offset:33024
    v_mfma_f32_16x16x32_bf16 v[224:227], v[60:63], v[96:99], v[224:227]
    ds_read_b64 v[70:71], v0 offset:33152
    v_mfma_f32_16x16x32_bf16 v[228:231], v[60:63], v[100:103], v[228:231]
    ds_read_b64 v[72:73], v0 offset:33280
    v_mfma_f32_16x16x32_bf16 v[196:199], v[56:59], v[100:103], v[196:199]
    ds_read_b64 v[74:75], v0 offset:33408
    v_mfma_f32_16x16x32_bf16 v[164:167], v[52:55], v[100:103], v[164:167]
    ds_read_b64 v[76:77], v0 offset:33536
    v_mfma_f32_16x16x32_bf16 v[132:135], v[48:51], v[100:103], v[132:135]
    ds_read_b64 v[78:79], v0 offset:33664
    v_mfma_f32_16x16x32_bf16 v[136:139], v[48:51], v[104:107], v[136:139]
    v_mfma_f32_16x16x32_bf16 v[168:171], v[52:55], v[104:107], v[168:171]
    v_mfma_f32_16x16x32_bf16 v[200:203], v[56:59], v[104:107], v[200:203]
    ds_write_b128 v14, v[24:27] offset:16384
    v_mfma_f32_16x16x32_bf16 v[232:235], v[60:63], v[104:107], v[232:235]
    ds_write_b128 v14, v[28:31] offset:17408
    v_mfma_f32_16x16x32_bf16 v[236:239], v[60:63], v[108:111], v[236:239]
    v_mfma_f32_16x16x32_bf16 v[204:207], v[56:59], v[108:111], v[204:207]
    v_mfma_f32_16x16x32_bf16 v[172:175], v[52:55], v[108:111], v[172:175]
    v_mfma_f32_16x16x32_bf16 v[140:143], v[48:51], v[108:111], v[140:143]
    v_mfma_f32_16x16x32_bf16 v[144:147], v[48:51], v[112:115], v[144:147]
    v_mfma_f32_16x16x32_bf16 v[176:179], v[52:55], v[112:115], v[176:179]
    v_mfma_f32_16x16x32_bf16 v[208:211], v[56:59], v[112:115], v[208:211]
    v_mfma_f32_16x16x32_bf16 v[240:243], v[60:63], v[112:115], v[240:243]
    v_mfma_f32_16x16x32_bf16 v[244:247], v[60:63], v[116:119], v[244:247]
    v_mfma_f32_16x16x32_bf16 v[212:215], v[56:59], v[116:119], v[212:215]
    v_mfma_f32_16x16x32_bf16 v[180:183], v[52:55], v[116:119], v[180:183]
    v_mfma_f32_16x16x32_bf16 v[148:151], v[48:51], v[116:119], v[148:151]
    v_mfma_f32_16x16x32_bf16 v[152:155], v[48:51], v[120:123], v[152:155]
    v_mfma_f32_16x16x32_bf16 v[184:187], v[52:55], v[120:123], v[184:187]
    v_mfma_f32_16x16x32_bf16 v[216:219], v[56:59], v[120:123], v[216:219]
    v_mfma_f32_16x16x32_bf16 v[248:251], v[60:63], v[120:123], v[248:251]
    v_mfma_f32_16x16x32_bf16 v[252:255], v[60:63], v[124:127], v[252:255]
    v_mfma_f32_16x16x32_bf16 v[220:223], v[56:59], v[124:127], v[220:223]
    v_mfma_f32_16x16x32_bf16 v[188:191], v[52:55], v[124:127], v[188:191]
    v_mfma_f32_16x16x32_bf16 v[156:159], v[48:51], v[124:127], v[156:159]
    s_waitcnt lgkmcnt(0)
    s_barrier
    s_branch P1_END
P1_B:
    v_mfma_f32_16x16x32_bf16 v[128:131], v[32:35], v[64:67], 0
    s_cmp_lg_u32 s54, 0
    s_cbranch_scc1 P1_SB0
    s_add_u32 m0, s23, 16384
    s_mov_b32 s20, 128
    buffer_load_dwordx4 v2, s[12:15], s20 offen sc1 lds
P1_SB0:
    v_mfma_f32_16x16x32_bf16 v[160:163], v[36:39], v[64:67], 0
    s_cmp_lg_u32 s54, 0
    s_cbranch_scc1 P1_SB1
    buffer_load_dwordx4 v3, s[12:15], s20 offen offset:1024 sc1 lds
P1_SB1:
    v_mfma_f32_16x16x32_bf16 v[192:195], v[40:43], v[64:67], 0
    s_cmp_lg_u32 s54, 0
    s_cbranch_scc1 P1_SB2
    s_add_u32 m0, s23, 65536
    s_mov_b32 s20, 262272
    buffer_load_dwordx4 v2, s[12:15], s20 offen sc1 lds
P1_SB2:
    v_mfma_f32_16x16x32_bf16 v[224:227], v[44:47], v[64:67], 0
    s_cmp_lg_u32 s54, 0
    s_cbranch_scc1 P1_SB3
    buffer_load_dwordx4 v3, s[12:15], s20 offen offset:1024 sc1 lds
P1_SB3:
    v_mfma_f32_16x16x32_bf16 v[228:231], v[44:47], v[68:71], 0
    s_cmp_lg_u32 s54, 0
    s_cbranch_scc1 P1_SB4
    s_add_u32 m0, s24, 32768
    s_nop 0
    global_load_lds_dwordx4 v[4:5], off sc1
    s_add_u32 m0, s24, 34816
    v_lshl_add_u64 v[4:5], v[8:9], 0, v[4:5]
P1_SB4:
    v_mfma_f32_16x16x32_bf16 v[196:199], v[40:43], v[68:71], 0
    s_cmp_lg_u32 s54, 0
    s_cbranch_scc1 P1_SB5
    global_load_lds_dwordx4 v[6:7], off sc1
    v_lshl_add_u64 v[6:7], v[8:9], 0, v[6:7]
P1_SB5:
    v_mfma_f32_16x16x32_bf16 v[164:167], v[36:39], v[68:71], 0
    s_add_u32 m0, s24, 49152
    s_nop 0
    global_load_lds_dwordx4 v[4:5], off sc1
    s_add_u32 m0, s24, 51200
    v_lshl_add_u64 v[4:5], v[8:9], 0, v[4:5]
    v_mfma_f32_16x16x32_bf16 v[132:135], v[32:35], v[68:71], 0
    global_load_lds_dwordx4 v[6:7], off sc1
    v_lshl_add_u64 v[6:7], v[8:9], 0, v[6:7]
    v_mfma_f32_16x16x32_bf16 v[136:139], v[32:35], v[72:75], 0
    s_add_u32 m0, s23, 32768
    s_mov_b32 s20, 256
    buffer_load_dwordx4 v2, s[12:15], s20 offen sc1 lds
    v_mfma_f32_16x16x32_bf16 v[168:171], v[36:39], v[72:75], 0
    buffer_load_dwordx4 v3, s[12:15], s20 offen offset:1024 sc1 lds
    v_mfma_f32_16x16x32_bf16 v[24:27], v[36:39], v[20:23], v[24:27]
    s_add_u32 m0, s23, 81920
    s_mov_b32 s20, 262400
    buffer_load_dwordx4 v2, s[12:15], s20 offen sc1 lds
    v_mfma_f32_16x16x32_bf16 v[200:203], v[40:43], v[72:75], 0
    buffer_load_dwordx4 v3, s[12:15], s20 offen offset:1024 sc1 lds
    v_mfma_f32_16x16x32_bf16 v[232:235], v[44:47], v[72:75], 0
    s_add_u32 m0, s24, 0
    s_nop 0
    global_load_lds_dwordx4 v[4:5], off sc1
    s_add_u32 m0, s24, 2048
    v_lshl_add_u64 v[4:5], v[8:9], 0, v[4:5]
    v_mfma_f32_16x16x32_bf16 v[236:239], v[44:47], v[76:79], 0
    global_load_lds_dwordx4 v[6:7], off sc1
    v_lshl_add_u64 v[6:7], v[8:9], 0, v[6:7]
    v_mfma_f32_16x16x32_bf16 v[204:207], v[40:43], v[76:79], 0
    ds_read_b64_tr_b16 v[48:49], v12 offset:16384
    v_mfma_f32_16x16x32_bf16 v[172:175], v[36:39], v[76:79], 0
    ds_read_b64_tr_b16 v[50:51], v12 offset:20480
    v_mfma_f32_16x16x32_bf16 v[140:143], v[32:35], v[76:79], 0
    ds_read_b64_tr_b16 v[52:53], v13 offset:16384
    v_mfma_f32_16x16x32_bf16 v[144:147], v[32:35], v[80:83], 0
    ds_read_b64_tr_b16 v[54:55], v13 offset:20480
    v_mfma_f32_16x16x32_bf16 v[176:179], v[36:39], v[80:83], 0
    ds_read_b64_tr_b16 v[56:57], v12 offset:24576
    v_mfma_f32_16x16x32_bf16 v[208:211], v[40:43], v[80:83], 0
    ds_read_b64_tr_b16 v[58:59], v12 offset:28672
    v_mfma_f32_16x16x32_bf16 v[240:243], v[44:47], v[80:83], 0
    ds_read_b64_tr_b16 v[60:61], v13 offset:24576
    v_mfma_f32_16x16x32_bf16 v[28:31], v[44:47], v[20:23], v[28:31]
    ds_read_b64_tr_b16 v[62:63], v13 offset:28672
    v_mfma_f32_16x16x32_bf16 v[244:247], v[44:47], v[84:87], 0
    ds_read_b128 v[96:99], v11 offset:0
    v_mfma_f32_16x16x32_bf16 v[212:215], v[40:43], v[84:87], 0
    ds_read_b128 v[100:103], v11 offset:2048
    v_mfma_f32_16x16x32_bf16 v[180:183], v[36:39], v[84:87], 0
    ds_read_b128 v[104:107], v11 offset:4096
    v_mfma_f32_16x16x32_bf16 v[148:151], v[32:35], v[84:87], 0
    ds_read_b128 v[108:111], v11 offset:6144
    v_mfma_f32_16x16x32_bf16 v[152:155], v[32:35], v[88:91], 0
    ds_read_b128 v[112:115], v11 offset:8192
    v_mfma_f32_16x16x32_bf16 v[184:187], v[36:39], v[88:91], 0
    ds_read_b128 v[116:119], v11 offset:10240
    v_mfma_f32_16x16x32_bf16 v[216:219], v[40:43], v[88:91], 0
    ds_read_b128 v[120:123], v11 offset:12288
    v_mfma_f32_16x16x32_bf16 v[248:251], v[44:47], v[88:91], 0
    ds_read_b128 v[124:127], v11 offset:14336
    v_mfma_f32_16x16x32_bf16 v[252:255], v[44:47], v[92:95], 0
    v_mfma_f32_16x16x32_bf16 v[220:223], v[40:43], v[92:95], 0
    v_mfma_f32_16x16x32_bf16 v[188:191], v[36:39], v[92:95], 0
    v_mfma_f32_16x16x32_bf16 v[156:159], v[32:35], v[92:95], 0
    s_waitcnt vmcnt(8) lgkmcnt(0)
    s_barrier
    v_mfma_f32_16x16x32_bf16 v[128:131], v[48:51], v[96:99], v[128:131]
    v_mfma_f32_16x16x32_bf16 v[160:163], v[52:55], v[96:99], v[160:163]
    v_mfma_f32_16x16x32_bf16 v[192:195], v[56:59], v[96:99], v[192:195]
    v_mfma_f32_16x16x32_bf16 v[224:227], v[60:63], v[96:99], v[224:227]
    v_mfma_f32_16x16x32_bf16 v[228:231], v[60:63], v[100:103], v[228:231]
    v_mfma_f32_16x16x32_bf16 v[196:199], v[56:59], v[100:103], v[196:199]
    v_mfma_f32_16x16x32_bf16 v[164:167], v[52:55], v[100:103], v[164:167]
    s_add_u32 m0, s23, 0
    s_mov_b32 s20, 384
    buffer_load_dwordx4 v2, s[12:15], s20 offen sc1 lds
    v_mfma_f32_16x16x32_bf16 v[132:135], v[48:51], v[100:103], v[132:135]
    buffer_load_dwordx4 v3, s[12:15], s20 offen offset:1024 sc1 lds
    v_mfma_f32_16x16x32_bf16 v[136:139], v[48:51], v[104:107], v[136:139]
    s_add_u32 m0, s24, 16384
    s_nop 0
    global_load_lds_dwordx4 v[4:5], off sc1
    s_add_u32 m0, s24, 18432
    v_lshl_add_u64 v[4:5], v[8:9], 0, v[4:5]
    v_mfma_f32_16x16x32_bf16 v[168:171], v[52:55], v[104:107], v[168:171]
    global_load_lds_dwordx4 v[6:7], off sc1
    v_lshl_add_u64 v[6:7], v[8:9], 0, v[6:7]
    v_mfma_f32_16x16x32_bf16 v[24:27], v[52:55], v[20:23], v[24:27]
    ds_read_b64_tr_b16 v[32:33], v12 offset:32768
    v_mfma_f32_16x16x32_bf16 v[200:203], v[56:59], v[104:107], v[200:203]
    ds_read_b64_tr_b16 v[34:35], v12 offset:36864
    v_mfma_f32_16x16x32_bf16 v[232:235], v[60:63], v[104:107], v[232:235]
    ds_read_b64_tr_b16 v[36:37], v13 offset:32768
    v_mfma_f32_16x16x32_bf16 v[236:239], v[60:63], v[108:111], v[236:239]
    ds_read_b64_tr_b16 v[38:39], v13 offset:36864
    v_mfma_f32_16x16x32_bf16 v[204:207], v[56:59], v[108:111], v[204:207]
    ds_read_b64_tr_b16 v[40:41], v12 offset:40960
    v_mfma_f32_16x16x32_bf16 v[172:175], v[52:55], v[108:111], v[172:175]
    ds_read_b64_tr_b16 v[42:43], v12 offset:45056
    v_mfma_f32_16x16x32_bf16 v[140:143], v[48:51], v[108:111], v[140:143]
    ds_read_b64_tr_b16 v[44:45], v13 offset:40960
    v_mfma_f32_16x16x32_bf16 v[144:147], v[48:51], v[112:115], v[144:147]
    ds_read_b64_tr_b16 v[46:47], v13 offset:45056
    v_mfma_f32_16x16x32_bf16 v[176:179], v[52:55], v[112:115], v[176:179]
    ds_read_b128 v[64:67], v10 offset:16384
    v_mfma_f32_16x16x32_bf16 v[208:211], v[56:59], v[112:115], v[208:211]
    ds_read_b128 v[68:71], v10 offset:18432
    v_mfma_f32_16x16x32_bf16 v[240:243], v[60:63], v[112:115], v[240:243]
    ds_read_b128 v[72:75], v10 offset:20480
    v_mfma_f32_16x16x32_bf16 v[28:31], v[60:63], v[20:23], v[28:31]
    ds_read_b128 v[76:79], v10 offset:22528
    v_mfma_f32_16x16x32_bf16 v[244:247], v[60:63], v[116:119], v[244:247]
    ds_read_b128 v[80:83], v10 offset:24576
    v_mfma_f32_16x16x32_bf16 v[212:215], v[56:59], v[116:119], v[212:215]
    ds_read_b128 v[84:87], v10 offset:26624
    v_mfma_f32_16x16x32_bf16 v[180:183], v[52:55], v[116:119], v[180:183]
    ds_read_b128 v[88:91], v10 offset:28672
    v_mfma_f32_16x16x32_bf16 v[148:151], v[48:51], v[116:119], v[148:151]
    ds_read_b128 v[92:95], v10 offset:30720
    v_mfma_f32_16x16x32_bf16 v[152:155], v[48:51], v[120:123], v[152:155]
    v_mfma_f32_16x16x32_bf16 v[184:187], v[52:55], v[120:123], v[184:187]
    v_mfma_f32_16x16x32_bf16 v[216:219], v[56:59], v[120:123], v[216:219]
    v_mfma_f32_16x16x32_bf16 v[248:251], v[60:63], v[120:123], v[248:251]
    v_mfma_f32_16x16x32_bf16 v[252:255], v[60:63], v[124:127], v[252:255]
    v_mfma_f32_16x16x32_bf16 v[220:223], v[56:59], v[124:127], v[220:223]
    v_mfma_f32_16x16x32_bf16 v[188:191], v[52:55], v[124:127], v[188:191]
    v_mfma_f32_16x16x32_bf16 v[156:159], v[48:51], v[124:127], v[156:159]
    s_waitcnt vmcnt(10) lgkmcnt(0)
    s_barrier
    v_mfma_f32_16x16x32_bf16 v[128:131], v[32:35], v[64:67], v[128:131]
    v_mfma_f32_16x16x32_bf16 v[160:163], v[36:39], v[64:67], v[160:163]
    v_mfma_f32_16x16x32_bf16 v[192:195], v[40:43], v[64:67], v[192:195]
    v_mfma_f32_16x16x32_bf16 v[224:227], v[44:47], v[64:67], v[224:227]
    v_mfma_f32_16x16x32_bf16 v[228:231], v[44:47], v[68:71], v[228:231]
    v_mfma_f32_16x16x32_bf16 v[196:199], v[40:43], v[68:71], v[196:199]
    v_mfma_f32_16x16x32_bf16 v[164:167], v[36:39], v[68:71], v[164:167]
    s_add_u32 m0, s23, 49152
    s_mov_b32 s20, 262528
    buffer_load_dwordx4 v2, s[12:15], s20 offen sc1 lds
    v_mfma_f32_16x16x32_bf16 v[132:135], v[32:35], v[68:71], v[132:135]
    buffer_load_dwordx4 v3, s[12:15], s20 offen offset:1024 sc1 lds
    v_mfma_f32_16x16x32_bf16 v[136:139], v[32:35], v[72:75], v[136:139]
    s_add_u32 m0, s24, 32768
    s_nop 0
    global_load_lds_dwordx4 v[4:5], off sc1
    s_add_u32 m0, s24, 34816
    v_lshl_add_u64 v[4:5], v[8:9], 0, v[4:5]
    v_mfma_f32_16x16x32_bf16 v[168:171], v[36:39], v[72:75], v[168:171]
    global_load_lds_dwordx4 v[6:7], off sc1
    v_lshl_add_u64 v[6:7], v[8:9], 0, v[6:7]
    v_mfma_f32_16x16x32_bf16 v[24:27], v[36:39], v[20:23], v[24:27]
    ds_read_b64_tr_b16 v[48:49], v12 offset:49152
    v_mfma_f32_16x16x32_bf16 v[200:203], v[40:43], v[72:75], v[200:203]
    ds_read_b64_tr_b16 v[50:51], v12 offset:53248
    v_mfma_f32_16x16x32_bf16 v[232:235], v[44:47], v[72:75], v[232:235]
    ds_read_b64_tr_b16 v[52:53], v13 offset:49152
    v_mfma_f32_16x16x32_bf16 v[236:239], v[44:47], v[76:79], v[236:239]
    ds_read_b64_tr_b16 v[54:55], v13 offset:53248
    v_mfma_f32_16x16x32_bf16 v[204:207], v[40:43], v[76:79], v[204:207]
    ds_read_b64_tr_b16 v[56:57], v12 offset:57344
    v_mfma_f32_16x16x32_bf16 v[172:175], v[36:39], v[76:79], v[172:175]
    ds_read_b64_tr_b16 v[58:59], v12 offset:61440
    v_mfma_f32_16x16x32_bf16 v[140:143], v[32:35], v[76:79], v[140:143]
    ds_read_b64_tr_b16 v[60:61], v13 offset:57344
    v_mfma_f32_16x16x32_bf16 v[144:147], v[32:35], v[80:83], v[144:147]
    ds_read_b64_tr_b16 v[62:63], v13 offset:61440
    v_mfma_f32_16x16x32_bf16 v[176:179], v[36:39], v[80:83], v[176:179]
    ds_read_b128 v[96:99], v11 offset:16384
    v_mfma_f32_16x16x32_bf16 v[208:211], v[40:43], v[80:83], v[208:211]
    ds_read_b128 v[100:103], v11 offset:18432
    v_mfma_f32_16x16x32_bf16 v[240:243], v[44:47], v[80:83], v[240:243]
    ds_read_b128 v[104:107], v11 offset:20480
    v_mfma_f32_16x16x32_bf16 v[28:31], v[44:47], v[20:23], v[28:31]
    ds_read_b128 v[108:111], v11 offset:22528
    v_mfma_f32_16x16x32_bf16 v[244:247], v[44:47], v[84:87], v[244:247]
    ds_read_b128 v[112:115], v11 offset:24576
    v_mfma_f32_16x16x32_bf16 v[212:215], v[40:43], v[84:87], v[212:215]
    ds_read_b128 v[116:119], v11 offset:26624
    v_mfma_f32_16x16x32_bf16 v[180:183], v[36:39], v[84:87], v[180:183]
    ds_read_b128 v[120:123], v11 offset:28672
    v_mfma_f32_16x16x32_bf16 v[148:151], v[32:35], v[84:87], v[148:151]
    ds_read_b128 v[124:127], v11 offset:30720
    v_mfma_f32_16x16x32_bf16 v[152:155], v[32:35], v[88:91], v[152:155]
    v_mfma_f32_16x16x32_bf16 v[184:187], v[36:39], v[88:91], v[184:187]
    v_mfma_f32_16x16x32_bf16 v[216:219], v[40:43], v[88:91], v[216:219]
    v_mfma_f32_16x16x32_bf16 v[248:251], v[44:47], v[88:91], v[248:251]
    v_mfma_f32_16x16x32_bf16 v[252:255], v[44:47], v[92:95], v[252:255]
    v_mfma_f32_16x16x32_bf16 v[220:223], v[40:43], v[92:95], v[220:223]
    v_mfma_f32_16x16x32_bf16 v[188:191], v[36:39], v[92:95], v[188:191]
    v_mfma_f32_16x16x32_bf16 v[156:159], v[32:35], v[92:95], v[156:159]
    s_waitcnt vmcnt(8) lgkmcnt(0)
    s_barrier
    v_mfma_f32_16x16x32_bf16 v[128:131], v[48:51], v[96:99], v[128:131]
    v_mfma_f32_16x16x32_bf16 v[160:163], v[52:55], v[96:99], v[160:163]
    v_mfma_f32_16x16x32_bf16 v[192:195], v[56:59], v[96:99], v[192:195]
    v_mfma_f32_16x16x32_bf16 v[224:227], v[60:63], v[96:99], v[224:227]
    v_mfma_f32_16x16x32_bf16 v[228:231], v[60:63], v[100:103], v[228:231]
    v_mfma_f32_16x16x32_bf16 v[196:199], v[56:59], v[100:103], v[196:199]
    v_mfma_f32_16x16x32_bf16 v[164:167], v[52:55], v[100:103], v[164:167]
    s_add_u32 m0, s23, 16384
    s_mov_b32 s20, 512
    buffer_load_dwordx4 v2, s[12:15], s20 offen sc1 lds
    v_mfma_f32_16x16x32_bf16 v[132:135], v[48:51], v[100:103], v[132:135]
    buffer_load_dwordx4 v3, s[12:15], s20 offen offset:1024 sc1 lds
    v_mfma_f32_16x16x32_bf16 v[136:139], v[48:51], v[104:107], v[136:139]
    s_add_u32 m0, s24, 49152
    s_nop 0
    global_load_lds_dwordx4 v[4:5], off sc1
    s_add_u32 m0, s24, 51200
    v_lshl_add_u64 v[4:5], v[8:9], 0, v[4:5]
    v_mfma_f32_16x16x32_bf16 v[168:171], v[52:55], v[104:107], v[168:171]
    global_load_lds_dwordx4 v[6:7], off sc1
    v_lshl_add_u64 v[6:7], v[8:9], 0, v[6:7]
    v_mfma_f32_16x16x32_bf16 v[24:27], v[52:55], v[20:23], v[24:27]
    ds_read_b64_tr_b16 v[32:33], v12 offset:0
    v_mfma_f32_16x16x32_bf16 v[200:203], v[56:59], v[104:107], v[200:203]
    ds_read_b64_tr_b16 v[34:35], v12 offset:4096
    v_mfma_f32_16x16x32_bf16 v[232:235], v[60:63], v[104:107], v[232:235]
    ds_read_b64_tr_b16 v[36:37], v13 offset:0
    v_mfma_f32_16x16x32_bf16 v[236:239], v[60:63], v[108:111], v[236:239]
    ds_read_b64_tr_b16 v[38:39], v13 offset:4096
    v_mfma_f32_16x16x32_bf16 v[204:207], v[56:59], v[108:111], v[204:207]
    ds_read_b64_tr_b16 v[40:41], v12 offset:8192
    v_mfma_f32_16x16x32_bf16 v[172:175], v[52:55], v[108:111], v[172:175]
    ds_read_b64_tr_b16 v[42:43], v12 offset:12288
    v_mfma_f32_16x16x32_bf16 v[140:143], v[48:51], v[108:111], v[140:143]
    ds_read_b64_tr_b16 v[44:45], v13 offset:8192
    v_mfma_f32_16x16x32_bf16 v[144:147], v[48:51], v[112:115], v[144:147]
    ds_read_b64_tr_b16 v[46:47], v13 offset:12288
    v_mfma_f32_16x16x32_bf16 v[176:179], v[52:55], v[112:115], v[176:179]
    ds_read_b128 v[64:67], v10 offset:32768
    v_mfma_f32_16x16x32_bf16 v[208:211], v[56:59], v[112:115], v[208:211]
    ds_read_b128 v[68:71], v10 offset:34816
    v_mfma_f32_16x16x32_bf16 v[240:243], v[60:63], v[112:115], v[240:243]
    ds_read_b128 v[72:75], v10 offset:36864
    v_mfma_f32_16x16x32_bf16 v[28:31], v[60:63], v[20:23], v[28:31]
    ds_read_b128 v[76:79], v10 offset:38912
    v_mfma_f32_16x16x32_bf16 v[244:247], v[60:63], v[116:119], v[244:247]
    ds_read_b128 v[80:83], v10 offset:40960
    v_mfma_f32_16x16x32_bf16 v[212:215], v[56:59], v[116:119], v[212:215]
    ds_read_b128 v[84:87], v10 offset:43008
    v_mfma_f32_16x16x32_bf16 v[180:183], v[52:55], v[116:119], v[180:183]
    ds_read_b128 v[88:91], v10 offset:45056
    v_mfma_f32_16x16x32_bf16 v[148:151], v[48:51], v[116:119], v[148:151]
    ds_read_b128 v[92:95], v10 offset:47104
    v_mfma_f32_16x16x32_bf16 v[152:155], v[48:51], v[120:123], v[152:155]
    v_mfma_f32_16x16x32_bf16 v[184:187], v[52:55], v[120:123], v[184:187]
    v_mfma_f32_16x16x32_bf16 v[216:219], v[56:59], v[120:123], v[216:219]
    v_mfma_f32_16x16x32_bf16 v[248:251], v[60:63], v[120:123], v[248:251]
    v_mfma_f32_16x16x32_bf16 v[252:255], v[60:63], v[124:127], v[252:255]
    v_mfma_f32_16x16x32_bf16 v[220:223], v[56:59], v[124:127], v[220:223]
    v_mfma_f32_16x16x32_bf16 v[188:191], v[52:55], v[124:127], v[188:191]
    v_mfma_f32_16x16x32_bf16 v[156:159], v[48:51], v[124:127], v[156:159]
    s_waitcnt vmcnt(8) lgkmcnt(0)
    s_barrier
    s_add_u32 s32, s23, 65536
    v_mov_b32 v0, s32
    ds_read_b32 v0, v0
    s_waitcnt lgkmcnt(0)
    v_readfirstlane_b32 s32, v0
    s_nop 0
    s_cmp_lg_u32 s32, 0
    s_cbranch_scc1 KM_REDO
    v_mfma_f32_16x16x32_bf16 v[128:131], v[32:35], v[64:67], v[128:131]
    v_mfma_f32_16x16x32_bf16 v[160:163], v[36:39], v[64:67], v[160:163]
    v_mfma_f32_16x16x32_bf16 v[192:195], v[40:43], v[64:67], v[192:195]
    v_mfma_f32_16x16x32_bf16 v[224:227], v[44:47], v[64:67], v[224:227]
    v_mfma_f32_16x16x32_bf16 v[228:231], v[44:47], v[68:71], v[228:231]
    v_mfma_f32_16x16x32_bf16 v[196:199], v[40:43], v[68:71], v[196:199]
    v_mfma_f32_16x16x32_bf16 v[164:167], v[36:39], v[68:71], v[164:167]
    s_add_u32 m0, s23, 65536
    s_mov_b32 s20, 262656
    buffer_load_dwordx4 v2, s[12:15], s20 offen sc1 lds
    v_mfma_f32_16x16x32_bf16 v[132:135], v[32:35], v[68:71], v[132:135]
    buffer_load_dwordx4 v3, s[12:15], s20 offen offset:1024 sc1 lds
    v_mfma_f32_16x16x32_bf16 v[136:139], v[32:35], v[72:75], v[136:139]
    s_add_u32 m0, s24, 0
    s_nop 0
    global_load_lds_dwordx4 v[4:5], off sc1
    s_add_u32 m0, s24, 2048
    v_lshl_add_u64 v[4:5], v[8:9], 0, v[4:5]
    v_mfma_f32_16x16x32_bf16 v[168:171], v[36:39], v[72:75], v[168:171]
    global_load_lds_dwordx4 v[6:7], off sc1
    v_lshl_add_u64 v[6:7], v[8:9], 0, v[6:7]
    v_mfma_f32_16x16x32_bf16 v[24:27], v[36:39], v[20:23], v[24:27]
    ds_read_b64_tr_b16 v[48:49], v12 offset:16384
    v_mfma_f32_16x16x32_bf16 v[200:203], v[40:43], v[72:75], v[200:203]
    ds_read_b64_tr_b16 v[50:51], v12 offset:20480
    v_mfma_f32_16x16x32_bf16 v[232:235], v[44:47], v[72:75], v[232:235]
    ds_read_b64_tr_b16 v[52:53], v13 offset:16384
    v_mfma_f32_16x16x32_bf16 v[236:239], v[44:47], v[76:79], v[236:239]
    ds_read_b64_tr_b16 v[54:55], v13 offset:20480
    v_mfma_f32_16x16x32_bf16 v[204:207], v[40:43], v[76:79], v[204:207]
    ds_read_b64_tr_b16 v[56:57], v12 offset:24576
    v_mfma_f32_16x16x32_bf16 v[172:175], v[36:39], v[76:79], v[172:175]
    ds_read_b64_tr_b16 v[58:59], v12 offset:28672
    v_mfma_f32_16x16x32_bf16 v[140:143], v[32:35], v[76:79], v[140:143]
    ds_read_b64_tr_b16 v[60:61], v13 offset:24576
    v_mfma_f32_16x16x32_bf16 v[144:147], v[32:35], v[80:83], v[144:147]
    ds_read_b64_tr_b16 v[62:63], v13 offset:28672
    v_mfma_f32_16x16x32_bf16 v[176:179], v[36:39], v[80:83], v[176:179]
    ds_read_b128 v[96:99], v11 offset:32768
    v_mfma_f32_16x16x32_bf16 v[208:211], v[40:43], v[80:83], v[208:211]
    ds_read_b128 v[100:103], v11 offset:34816
    v_mfma_f32_16x16x32_bf16 v[240:243], v[44:47], v[80:83], v[240:243]
    ds_read_b128 v[104:107], v11 offset:36864
    v_mfma_f32_16x16x32_bf16 v[28:31], v[44:47], v[20:23], v[28:31]
    ds_read_b128 v[108:111], v11 offset:38912
    v_mfma_f32_16x16x32_bf16 v[244:247], v[44:47], v[84:87], v[244:247]
    ds_read_b128 v[112:115], v11 offset:40960
    v_mfma_f32_16x16x32_bf16 v[212:215], v[40:43], v[84:87], v[212:215]
    ds_read_b128 v[116:119], v11 offset:43008
    v_mfma_f32_16x16x32_bf16 v[180:183], v[36:39], v[84:87], v[180:183]
    ds_read_b128 v[120:123], v11 offset:45056
    v_mfma_f32_16x16x32_bf16 v[148:151], v[32:35], v[84:87], v[148:151]
    ds_read_b128 v[124:127], v11 offset:47104
    v_mfma_f32_16x16x32_bf16 v[152:155], v[32:35], v[88:91], v[152:155]
    v_mfma_f32_16x16x32_bf16 v[184:187], v[36:39], v[88:91], v[184:187]
    v_mfma_f32_16x16x32_bf16 v[216:219], v[40:43], v[88:91], v[216:219]
    v_mfma_f32_16x16x32_bf16 v[248:251], v[44:47], v[88:91], v[248:251]
    v_mfma_f32_16x16x32_bf16 v[252:255], v[44:47], v[92:95], v[252:255]
    v_mfma_f32_16x16x32_bf16 v[220:223], v[40:43], v[92:95], v[220:223]
    v_mfma_f32_16x16x32_bf16 v[188:191], v[36:39], v[92:95], v[188:191]
    v_mfma_f32_16x16x32_bf16 v[156:159], v[32:35], v[92:95], v[156:159]
    s_waitcnt vmcnt(8) lgkmcnt(0)
    s_barrier
    v_mfma_f32_16x16x32_bf16 v[128:131], v[48:51], v[96:99], v[128:131]
    v_mfma_f32_16x16x32_bf16 v[160:163], v[52:55], v[96:99], v[160:163]
    v_mfma_f32_16x16x32_bf16 v[192:195], v[56:59], v[96:99], v[192:195]
    v_mfma_f32_16x16x32_bf16 v[224:227], v[60:63], v[96:99], v[224:227]
    v_mfma_f32_16x16x32_bf16 v[228:231], v[60:63], v[100:103], v[228:231]
    v_mfma_f32_16x16x32_bf16 v[196:199], v[56:59], v[100:103], v[196:199]
    v_mfma_f32_16x16x32_bf16 v[164:167], v[52:55], v[100:103], v[164:167]
    s_add_u32 m0, s23, 32768
    s_mov_b32 s20, 640
    buffer_load_dwordx4 v2, s[12:15], s20 offen sc1 lds
    v_mfma_f32_16x16x32_bf16 v[132:135], v[48:51], v[100:103], v[132:135]
    buffer_load_dwordx4 v3, s[12:15], s20 offen offset:1024 sc1 lds
    v_mfma_f32_16x16x32_bf16 v[136:139], v[48:51], v[104:107], v[136:139]
    s_add_u32 m0, s24, 16384
    s_nop 0
    global_load_lds_dwordx4 v[4:5], off sc1
    s_add_u32 m0, s24, 18432
    v_lshl_add_u64 v[4:5], v[8:9], 0, v[4:5]
    v_mfma_f32_16x16x32_bf16 v[168:171], v[52:55], v[104:107], v[168:171]
    global_load_lds_dwordx4 v[6:7], off sc1
    v_lshl_add_u64 v[6:7], v[8:9], 0, v[6:7]
    v_mfma_f32_16x16x32_bf16 v[24:27], v[52:55], v[20:23], v[24:27]
    ds_read_b64_tr_b16 v[32:33], v12 offset:32768
    v_mfma_f32_16x16x32_bf16 v[200:203], v[56:59], v[104:107], v[200:203]
    ds_read_b64_tr_b16 v[34:35], v12 offset:36864
    v_mfma_f32_16x16x32_bf16 v[232:235], v[60:63], v[104:107], v[232:235]
    ds_read_b64_tr_b16 v[36:37], v13 offset:32768
    v_mfma_f32_16x16x32_bf16 v[236:239], v[60:63], v[108:111], v[236:239]
    ds_read_b64_tr_b16 v[38:39], v13 offset:36864
    v_mfma_f32_16x16x32_bf16 v[204:207], v[56:59], v[108:111], v[204:207]
    ds_read_b64_tr_b16 v[40:41], v12 offset:40960
    v_mfma_f32_16x16x32_bf16 v[172:175], v[52:55], v[108:111], v[172:175]
    ds_read_b64_tr_b16 v[42:43], v12 offset:45056
    v_mfma_f32_16x16x32_bf16 v[140:143], v[48:51], v[108:111], v[140:143]
    ds_read_b64_tr_b16 v[44:45], v13 offset:40960
    v_mfma_f32_16x16x32_bf16 v[144:147], v[48:51], v[112:115], v[144:147]
    ds_read_b64_tr_b16 v[46:47], v13 offset:45056
    v_mfma_f32_16x16x32_bf16 v[176:179], v[52:55], v[112:115], v[176:179]
    ds_read_b128 v[64:67], v10 offset:0
    v_mfma_f32_16x16x32_bf16 v[208:211], v[56:59], v[112:115], v[208:211]
    ds_read_b128 v[68:71], v10 offset:2048
    v_mfma_f32_16x16x32_bf16 v[240:243], v[60:63], v[112:115], v[240:243]
    ds_read_b128 v[72:75], v10 offset:4096
    v_mfma_f32_16x16x32_bf16 v[28:31], v[60:63], v[20:23], v[28:31]
    ds_read_b128 v[76:79], v10 offset:6144
    v_mfma_f32_16x16x32_bf16 v[244:247], v[60:63], v[116:119], v[244:247]
    ds_read_b128 v[80:83], v10 offset:8192
    v_mfma_f32_16x16x32_bf16 v[212:215], v[56:59], v[116:119], v[212:215]
    ds_read_b128 v[84:87], v10 offset:10240
    v_mfma_f32_16x16x32_bf16 v[180:183], v[52:55], v[116:119], v[180:183]
    ds_read_b128 v[88:91], v10 offset:12288
    v_mfma_f32_16x16x32_bf16 v[148:151], v[48:51], v[116:119], v[148:151]
    ds_read_b128 v[92:95], v10 offset:14336
    v_mfma_f32_16x16x32_bf16 v[152:155], v[48:51], v[120:123], v[152:155]
    v_mfma_f32_16x16x32_bf16 v[184:187], v[52:55], v[120:123], v[184:187]
    v_mfma_f32_16x16x32_bf16 v[216:219], v[56:59], v[120:123], v[216:219]
    v_mfma_f32_16x16x32_bf16 v[248:251], v[60:63], v[120:123], v[248:251]
    v_mfma_f32_16x16x32_bf16 v[252:255], v[60:63], v[124:127], v[252:255]
    v_mfma_f32_16x16x32_bf16 v[220:223], v[56:59], v[124:127], v[220:223]
    v_mfma_f32_16x16x32_bf16 v[188:191], v[52:55], v[124:127], v[188:191]
    v_mfma_f32_16x16x32_bf16 v[156:159], v[48:51], v[124:127], v[156:159]
    s_waitcnt vmcnt(8) lgkmcnt(0)
    s_barrier
    v_mfma_f32_16x16x32_bf16 v[128:131], v[32:35], v[64:67], v[128:131]
    v_mfma_f32_16x16x32_bf16 v[160:163], v[36:39], v[64:67], v[160:163]
    v_mfma_f32_16x16x32_bf16 v[192:195], v[40:43], v[64:67], v[192:195]
    v_mfma_f32_16x16x32_bf16 v[224:227], v[44:47], v[64:67], v[224:227]
    v_mfma_f32_16x16x32_bf16 v[228:231], v[44:47], v[68:71], v[228:231]
    v_mfma_f32_16x16x32_bf16 v[196:199], v[40:43], v[68:71], v[196:199]
    v_mfma_f32_16x16x32_bf16 v[164:167], v[36:39], v[68:71], v[164:167]
    s_add_u32 m0, s23, 81920
    s_mov_b32 s20, 262784
    buffer_load_dwordx4 v2, s[12:15], s20 offen sc1 lds
    v_mfma_f32_16x16x32_bf16 v[132:135], v[32:35], v[68:71], v[132:135]
    buffer_load_dwordx4 v3, s[12:15], s20 offen offset:1024 sc1 lds
    v_mfma_f32_16x16x32_bf16 v[136:139], v[32:35], v[72:75], v[136:139]
    s_add_u32 m0, s24, 32768
    s_nop 0
    global_load_lds_dwordx4 v[4:5], off sc1
    s_add_u32 m0, s24, 34816
    v_lshl_add_u64 v[4:5], v[8:9], 0, v[4:5]
    v_mfma_f32_16x16x32_bf16 v[168:171], v[36:39], v[72:75], v[168:171]
    global_load_lds_dwordx4 v[6:7], off sc1
    v_lshl_add_u64 v[6:7], v[8:9], 0, v[6:7]
    v_mfma_f32_16x16x32_bf16 v[24:27], v[36:39], v[20:23], v[24:27]
    ds_read_b64_tr_b16 v[48:49], v12 offset:49152
    v_mfma_f32_16x16x32_bf16 v[200:203], v[40:43], v[72:75], v[200:203]
    ds_read_b64_tr_b16 v[50:51], v12 offset:53248
    v_mfma_f32_16x16x32_bf16 v[232:235], v[44:47], v[72:75], v[232:235]
    ds_read_b64_tr_b16 v[52:53], v13 offset:49152
    v_mfma_f32_16x16x32_bf16 v[236:239], v[44:47], v[76:79], v[236:239]
    ds_read_b64_tr_b16 v[54:55], v13 offset:53248
    v_mfma_f32_16x16x32_bf16 v[204:207], v[40:43], v[76:79], v[204:207]
    ds_read_b64_tr_b16 v[56:57], v12 offset:57344
    v_mfma_f32_16x16x32_bf16 v[172:175], v[36:39], v[76:79], v[172:175]
    ds_read_b64_tr_b16 v[58:59], v12 offset:61440
    v_mfma_f32_16x16x32_bf16 v[140:143], v[32:35], v[76:79], v[140:143]
    ds_read_b64_tr_b16 v[60:61], v13 offset:57344
    v_mfma_f32_16x16x32_bf16 v[144:147], v[32:35], v[80:83], v[144:147]
    ds_read_b64_tr_b16 v[62:63], v13 offset:61440
    v_mfma_f32_16x16x32_bf16 v[176:179], v[36:39], v[80:83], v[176:179]
    ds_read_b128 v[96:99], v11 offset:0
    v_mfma_f32_16x16x32_bf16 v[208:211], v[40:43], v[80:83], v[208:211]
    ds_read_b128 v[100:103], v11 offset:2048
    v_mfma_f32_16x16x32_bf16 v[240:243], v[44:47], v[80:83], v[240:243]
    ds_read_b128 v[104:107], v11 offset:4096
    v_mfma_f32_16x16x32_bf16 v[28:31], v[44:47], v[20:23], v[28:31]
    ds_read_b128 v[108:111], v11 offset:6144
    v_mfma_f32_16x16x32_bf16 v[244:247], v[44:47], v[84:87], v[244:247]
    ds_read_b128 v[112:115], v11 offset:8192
    v_mfma_f32_16x16x32_bf16 v[212:215], v[40:43], v[84:87], v[212:215]
    ds_read_b128 v[116:119], v11 offset:10240
    v_mfma_f32_16x16x32_bf16 v[180:183], v[36:39], v[84:87], v[180:183]
    ds_read_b128 v[120:123], v11 offset:12288
    v_mfma_f32_16x16x32_bf16 v[148:151], v[32:35], v[84:87], v[148:151]
    ds_read_b128 v[124:127], v11 offset:14336
    v_mfma_f32_16x16x32_bf16 v[152:155], v[32:35], v[88:91], v[152:155]
    v_mfma_f32_16x16x32_bf16 v[184:187], v[36:39], v[88:91], v[184:187]
    v_mfma_f32_16x16x32_bf16 v[216:219], v[40:43], v[88:91], v[216:219]
    v_mfma_f32_16x16x32_bf16 v[248:251], v[44:47], v[88:91], v[248:251]
    v_mfma_f32_16x16x32_bf16 v[252:255], v[44:47], v[92:95], v[252:255]
    v_mfma_f32_16x16x32_bf16 v[220:223], v[40:43], v[92:95], v[220:223]
    v_mfma_f32_16x16x32_bf16 v[188:191], v[36:39], v[92:95], v[188:191]
    v_mfma_f32_16x16x32_bf16 v[156:159], v[32:35], v[92:95], v[156:159]
    s_waitcnt vmcnt(8) lgkmcnt(0)
    s_barrier
    v_mfma_f32_16x16x32_bf16 v[128:131], v[48:51], v[96:99], v[128:131]
    v_mfma_f32_16x16x32_bf16 v[160:163], v[52:55], v[96:99], v[160:163]
    v_mfma_f32_16x16x32_bf16 v[192:195], v[56:59], v[96:99], v[192:195]
    v_mfma_f32_16x16x32_bf16 v[224:227], v[60:63], v[96:99], v[224:227]
    v_mfma_f32_16x16x32_bf16 v[228:231], v[60:63], v[100:103], v[228:231]
    v_mfma_f32_16x16x32_bf16 v[196:199], v[56:59], v[100:103], v[196:199]
    v_mfma_f32_16x16x32_bf16 v[164:167], v[52:55], v[100:103], v[164:167]
    s_mov_b64 exec, s[10:11]
    v_mov_b32 v4, v14
    v_mov_b32 v5, v15
    v_mov_b32 v8, 512
    v_lshl_add_u64 v[6:7], v[8:9], 0, v[4:5]
    v_mov_b32 v8, 2048
    s_mov_b64 exec, -1
    v_mfma_f32_16x16x32_bf16 v[132:135], v[48:51], v[100:103], v[132:135]
    s_add_u32 m0, s23, 0
    s_mov_b32 s20, 768
    buffer_load_dwordx4 v2, s[12:15], s20 offen sc1 lds
    v_mfma_f32_16x16x32_bf16 v[136:139], v[48:51], v[104:107], v[136:139]
    buffer_load_dwordx4 v3, s[12:15], s20 offen offset:1024 sc1 lds
    v_mfma_f32_16x16x32_bf16 v[168:171], v[52:55], v[104:107], v[168:171]
    s_add_u32 m0, s24, 49152
    s_nop 0
    global_load_lds_dwordx4 v[4:5], off sc1
    s_add_u32 m0, s24, 51200
    v_lshl_add_u64 v[4:5], v[8:9], 0, v[4:5]
    v_mfma_f32_16x16x32_bf16 v[24:27], v[52:55], v[20:23], v[24:27]
    global_load_lds_dwordx4 v[6:7], off sc1
    v_lshl_add_u64 v[6:7], v[8:9], 0, v[6:7]
    v_mfma_f32_16x16x32_bf16 v[200:203], v[56:59], v[104:107], v[200:203]
    ds_read_b64_tr_b16 v[32:33], v12 offset:0
    v_mfma_f32_16x16x32_bf16 v[232:235], v[60:63], v[104:107], v[232:235]
    ds_read_b64_tr_b16 v[34:35], v12 offset:4096
    v_mfma_f32_16x16x32_bf16 v[236:239], v[60:63], v[108:111], v[236:239]
    ds_read_b64_tr_b16 v[36:37], v13 offset:0
    v_mfma_f32_16x16x32_bf16 v[204:207], v[56:59], v[108:111], v[204:207]
    ds_read_b64_tr_b16 v[38:39], v13 offset:4096
    v_mfma_f32_16x16x32_bf16 v[172:175], v[52:55], v[108:111], v[172:175]
    ds_read_b64_tr_b16 v[40:41], v12 offset:8192
    v_mfma_f32_16x16x32_bf16 v[140:143], v[48:51], v[108:111], v[140:143]
    ds_read_b64_tr_b16 v[42:43], v12 offset:12288
    v_mfma_f32_16x16x32_bf16 v[144:147], v[48:51], v[112:115], v[144:147]
    ds_read_b64_tr_b16 v[44:45], v13 offset:8192
    v_mfma_f32_16x16x32_bf16 v[176:179], v[52:55], v[112:115], v[176:179]
    ds_read_b64_tr_b16 v[46:47], v13 offset:12288
    v_mfma_f32_16x16x32_bf16 v[208:211], v[56:59], v[112:115], v[208:211]
    ds_read_b128 v[64:67], v10 offset:16384
    v_mfma_f32_16x16x32_bf16 v[240:243], v[60:63], v[112:115], v[240:243]
    ds_read_b128 v[68:71], v10 offset:18432
    v_mfma_f32_16x16x32_bf16 v[28:31], v[60:63], v[20:23], v[28:31]
    ds_read_b128 v[72:75], v10 offset:20480
    v_mfma_f32_16x16x32_bf16 v[244:247], v[60:63], v[116:119], v[244:247]
    ds_read_b128 v[76:79], v10 offset:22528
    v_mfma_f32_16x16x32_bf16 v[212:215], v[56:59], v[116:119], v[212:215]
    ds_read_b128 v[80:83], v10 offset:24576
    v_mfma_f32_16x16x32_bf16 v[180:183], v[52:55], v[116:119], v[180:183]
    ds_read_b128 v[84:87], v10 offset:26624
    v_mfma_f32_16x16x32_bf16 v[148:151], v[48:51], v[116:119], v[148:151]
    ds_read_b128 v[88:91], v10 offset:28672
    v_mfma_f32_16x16x32_bf16 v[152:155], v[48:51], v[120:123], v[152:155]
    ds_read_b128 v[92:95], v10 offset:30720
    v_mfma_f32_16x16x32_bf16 v[184:187], v[52:55], v[120:123], v[184:187]
    v_mfma_f32_16x16x32_bf16 v[216:219], v[56:59], v[120:123], v[216:219]
    v_mfma_f32_16x16x32_bf16 v[248:251], v[60:63], v[120:123], v[248:251]
    v_mfma_f32_16x16x32_bf16 v[252:255], v[60:63], v[124:127], v[252:255]
    v_mfma_f32_16x16x32_bf16 v[220:223], v[56:59], v[124:127], v[220:223]
    v_mfma_f32_16x16x32_bf16 v[188:191], v[52:55], v[124:127], v[188:191]
    v_mfma_f32_16x16x32_bf16 v[156:159], v[48:51], v[124:127], v[156:159]
    s_waitcnt vmcnt(8) lgkmcnt(0)
    s_barrier
    v_mfma_f32_16x16x32_bf16 v[128:131], v[32:35], v[64:67], v[128:131]
    v_mfma_f32_16x16x32_bf16 v[160:163], v[36:39], v[64:67], v[160:163]
    v_mfma_f32_16x16x32_bf16 v[192:195], v[40:43], v[64:67], v[192:195]
    v_mfma_f32_16x16x32_bf16 v[224:227], v[44:47], v[64:67], v[224:227]
    v_mfma_f32_16x16x32_bf16 v[228:231], v[44:47], v[68:71], v[228:231]
    v_mfma_f32_16x16x32_bf16 v[196:199], v[40:43], v[68:71], v[196:199]
    v_mfma_f32_16x16x32_bf16 v[164:167], v[36:39], v[68:71], v[164:167]
    s_add_u32 m0, s23, 49152
    s_mov_b32 s20, 262912
    buffer_load_dwordx4 v2, s[12:15], s20 offen sc1 lds
    v_mfma_f32_16x16x32_bf16 v[132:135], v[32:35], v[68:71], v[132:135]
    buffer_load_dwordx4 v3, s[12:15], s20 offen offset:1024 sc1 lds
    v_mfma_f32_16x16x32_bf16 v[136:139], v[32:35], v[72:75], v[136:139]
    s_add_u32 m0, s24, 0
    s_nop 0
    global_load_lds_dwordx4 v[4:5], off sc1
    s_add_u32 m0, s24, 2048
    v_lshl_add_u64 v[4:5], v[8:9], 0, v[4:5]
    v_mfma_f32_16x16x32_bf16 v[168:171], v[36:39], v[72:75], v[168:171]
    global_load_lds_dwordx4 v[6:7], off sc1
    v_lshl_add_u64 v[6:7], v[8:9], 0, v[6:7]
    v_mfma_f32_16x16x32_bf16 v[24:27], v[36:39], v[20:23], v[24:27]
    ds_read_b64_tr_b16 v[48:49], v12 offset:16384
    v_mfma_f32_16x16x32_bf16 v[200:203], v[40:43], v[72:75], v[200:203]
    ds_read_b64_tr_b16 v[50:51], v12 offset:20480
    v_mfma_f32_16x16x32_bf16 v[232:235], v[44:47], v[72:75], v[232:235]
    ds_read_b64_tr_b16 v[52:53], v13 offset:16384
    v_mfma_f32_16x16x32_bf16 v[236:239], v[44:47], v[76:79], v[236:239]
    ds_read_b64_tr_b16 v[54:55], v13 offset:20480
    v_mfma_f32_16x16x32_bf16 v[204:207], v[40:43], v[76:79], v[204:207]
    ds_read_b64_tr_b16 v[56:57], v12 offset:24576
    v_mfma_f32_16x16x32_bf16 v[172:175], v[36:39], v[76:79], v[172:175]
    ds_read_b64_tr_b16 v[58:59], v12 offset:28672
    v_mfma_f32_16x16x32_bf16 v[140:143], v[32:35], v[76:79], v[140:143]
    ds_read_b64_tr_b16 v[60:61], v13 offset:24576
    v_mfma_f32_16x16x32_bf16 v[144:147], v[32:35], v[80:83], v[144:147]
    ds_read_b64_tr_b16 v[62:63], v13 offset:28672
    v_mfma_f32_16x16x32_bf16 v[176:179], v[36:39], v[80:83], v[176:179]
    ds_read_b128 v[96:99], v11 offset:16384
    v_mfma_f32_16x16x32_bf16 v[208:211], v[40:43], v[80:83], v[208:211]
    ds_read_b128 v[100:103], v11 offset:18432
    v_mfma_f32_16x16x32_bf16 v[240:243], v[44:47], v[80:83], v[240:243]
    ds_read_b128 v[104:107], v11 offset:20480
    v_mfma_f32_16x16x32_bf16 v[28:31], v[44:47], v[20:23], v[28:31]
    ds_read_b128 v[108:111], v11 offset:22528
    v_mfma_f32_16x16x32_bf16 v[244:247], v[44:47], v[84:87], v[244:247]
    ds_read_b128 v[112:115], v11 offset:24576
    v_mfma_f32_16x16x32_bf16 v[212:215], v[40:43], v[84:87], v[212:215]
    ds_read_b128 v[116:119], v11 offset:26624
    v_mfma_f32_16x16x32_bf16 v[180:183], v[36:39], v[84:87], v[180:183]
    ds_read_b128 v[120:123], v11 offset:28672
    v_mfma_f32_16x16x32_bf16 v[148:151], v[32:35], v[84:87], v[148:151]
    ds_read_b128 v[124:127], v11 offset:30720
    v_mfma_f32_16x16x32_bf16 v[152:155], v[32:35], v[88:91], v[152:155]
    v_mfma_f32_16x16x32_bf16 v[184:187], v[36:39], v[88:91], v[184:187]
    v_mfma_f32_16x16x32_bf16 v[216:219], v[40:43], v[88:91], v[216:219]
    v_mfma_f32_16x16x32_bf16 v[248:251], v[44:47], v[88:91], v[248:251]
    v_mfma_f32_16x16x32_bf16 v[252:255], v[44:47], v[92:95], v[252:255]
    v_mfma_f32_16x16x32_bf16 v[220:223], v[40:43], v[92:95], v[220:223]
    v_mfma_f32_16x16x32_bf16 v[188:191], v[36:39], v[92:95], v[188:191]
    v_mfma_f32_16x16x32_bf16 v[156:159], v[32:35], v[92:95], v[156:159]
    s_waitcnt vmcnt(8) lgkmcnt(0)
    s_barrier
    v_mfma_f32_16x16x32_bf16 v[128:131], v[48:51], v[96:99], v[128:131]
    v_mfma_f32_16x16x32_bf16 v[160:163], v[52:55], v[96:99], v[160:163]
    v_mfma_f32_16x16x32_bf16 v[192:195], v[56:59], v[96:99], v[192:195]
    v_mfma_f32_16x16x32_bf16 v[224:227], v[60:63], v[96:99], v[224:227]
    v_mfma_f32_16x16x32_bf16 v[228:231], v[60:63], v[100:103], v[228:231]
    v_mfma_f32_16x16x32_bf16 v[196:199], v[56:59], v[100:103], v[196:199]
    v_mfma_f32_16x16x32_bf16 v[164:167], v[52:55], v[100:103], v[164:167]
    s_add_u32 m0, s23, 16384
    s_mov_b32 s20, 896
    buffer_load_dwordx4 v2, s[12:15], s20 offen sc1 lds
    v_mfma_f32_16x16x32_bf16 v[132:135], v[48:51], v[100:103], v[132:135]
    buffer_load_dwordx4 v3, s[12:15], s20 offen offset:1024 sc1 lds
    v_mfma_f32_16x16x32_bf16 v[136:139], v[48:51], v[104:107], v[136:139]
    s_add_u32 m0, s24, 16384
    s_nop 0
    global_load_lds_dwordx4 v[4:5], off sc1
    s_add_u32 m0, s24, 18432
    v_lshl_add_u64 v[4:5], v[8:9], 0, v[4:5]
    v_mfma_f32_16x16x32_bf16 v[168:171], v[52:55], v[104:107], v[168:171]
    global_load_lds_dwordx4 v[6:7], off sc1
    v_lshl_add_u64 v[6:7], v[8:9], 0, v[6:7]
    v_mfma_f32_16x16x32_bf16 v[24:27], v[52:55], v[20:23], v[24:27]
    ds_read_b64_tr_b16 v[32:33], v12 offset:32768
    v_mfma_f32_16x16x32_bf16 v[200:203], v[56:59], v[104:107], v[200:203]
    ds_read_b64_tr_b16 v[34:35], v12 offset:36864
    v_mfma_f32_16x16x32_bf16 v[232:235], v[60:63], v[104:107], v[232:235]
    ds_read_b64_tr_b16 v[36:37], v13 offset:32768
    v_mfma_f32_16x16x32_bf16 v[236:239], v[60:63], v[108:111], v[236:239]
    ds_read_b64_tr_b16 v[38:39], v13 offset:36864
    v_mfma_f32_16x16x32_bf16 v[204:207], v[56:59], v[108:111], v[204:207]
    ds_read_b64_tr_b16 v[40:41], v12 offset:40960
    v_mfma_f32_16x16x32_bf16 v[172:175], v[52:55], v[108:111], v[172:175]
    ds_read_b64_tr_b16 v[42:43], v12 offset:45056
    v_mfma_f32_16x16x32_bf16 v[140:143], v[48:51], v[108:111], v[140:143]
    ds_read_b64_tr_b16 v[44:45], v13 offset:40960
    v_mfma_f32_16x16x32_bf16 v[144:147], v[48:51], v[112:115], v[144:147]
    ds_read_b64_tr_b16 v[46:47], v13 offset:45056
    v_mfma_f32_16x16x32_bf16 v[176:179], v[52:55], v[112:115], v[176:179]
    ds_read_b128 v[64:67], v10 offset:32768
    v_mfma_f32_16x16x32_bf16 v[208:211], v[56:59], v[112:115], v[208:211]
    ds_read_b128 v[68:71], v10 offset:34816
    v_mfma_f32_16x16x32_bf16 v[240:243], v[60:63], v[112:115], v[240:243]
    ds_read_b128 v[72:75], v10 offset:36864
    v_mfma_f32_16x16x32_bf16 v[28:31], v[60:63], v[20:23], v[28:31]
    ds_read_b128 v[76:79], v10 offset:38912
    v_mfma_f32_16x16x32_bf16 v[244:247], v[60:63], v[116:119], v[244:247]
    ds_read_b128 v[80:83], v10 offset:40960
    v_mfma_f32_16x16x32_bf16 v[212:215], v[56:59], v[116:119], v[212:215]
    ds_read_b128 v[84:87], v10 offset:43008
    v_mfma_f32_16x16x32_bf16 v[180:183], v[52:55], v[116:119], v[180:183]
    ds_read_b128 v[88:91], v10 offset:45056
    v_mfma_f32_16x16x32_bf16 v[148:151], v[48:51], v[116:119], v[148:151]
    ds_read_b128 v[92:95], v10 offset:47104
    v_mfma_f32_16x16x32_bf16 v[152:155], v[48:51], v[120:123], v[152:155]
    v_mfma_f32_16x16x32_bf16 v[184:187], v[52:55], v[120:123], v[184:187]
    v_mfma_f32_16x16x32_bf16 v[216:219], v[56:59], v[120:123], v[216:219]
    v_mfma_f32_16x16x32_bf16 v[248:251], v[60:63], v[120:123], v[248:251]
    v_mfma_f32_16x16x32_bf16 v[252:255], v[60:63], v[124:127], v[252:255]
    v_mfma_f32_16x16x32_bf16 v[220:223], v[56:59], v[124:127], v[220:223]
    v_mfma_f32_16x16x32_bf16 v[188:191], v[52:55], v[124:127], v[188:191]
    v_mfma_f32_16x16x32_bf16 v[156:159], v[48:51], v[124:127], v[156:159]
    s_waitcnt vmcnt(8) lgkmcnt(0)
    s_barrier
    v_mfma_f32_16x16x32_bf16 v[128:131], v[32:35], v[64:67], v[128:131]
    v_mfma_f32_16x16x32_bf16 v[160:163], v[36:39], v[64:67], v[160:163]
    v_mfma_f32_16x16x32_bf16 v[192:195], v[40:43], v[64:67], v[192:195]
    v_mfma_f32_16x16x32_bf16 v[224:227], v[44:47], v[64:67], v[224:227]
    v_mfma_f32_16x16x32_bf16 v[228:231], v[44:47], v[68:71], v[228:231]
    v_mfma_f32_16x16x32_bf16 v[196:199], v[40:43], v[68:71], v[196:199]
    v_mfma_f32_16x16x32_bf16 v[164:167], v[36:39], v[68:71], v[164:167]
    s_add_u32 m0, s23, 65536
    s_mov_b32 s20, 263040
    buffer_load_dwordx4 v2, s[12:15], s20 offen sc1 lds
    v_mfma_f32_16x16x32_bf16 v[132:135], v[32:35], v[68:71], v[132:135]
    buffer_load_dwordx4 v3, s[12:15], s20 offen offset:1024 sc1 lds
    v_mfma_f32_16x16x32_bf16 v[136:139], v[32:35], v[72:75], v[136:139]
    s_add_u32 m0, s24, 32768
    s_nop 0
    global_load_lds_dwordx4 v[4:5], off sc1
    s_add_u32 m0, s24, 34816
    v_lshl_add_u64 v[4:5], v[8:9], 0, v[4:5]
    v_mfma_f32_16x16x32_bf16 v[168:171], v[36:39], v[72:75], v[168:171]
    global_load_lds_dwordx4 v[6:7], off sc1
    v_lshl_add_u64 v[6:7], v[8:9], 0, v[6:7]
    v_mfma_f32_16x16x32_bf16 v[24:27], v[36:39], v[20:23], v[24:27]
    ds_read_b64_tr_b16 v[48:49], v12 offset:49152
    v_mfma_f32_16x16x32_bf16 v[200:203], v[40:43], v[72:75], v[200:203]
    ds_read_b64_tr_b16 v[50:51], v12 offset:53248
    v_mfma_f32_16x16x32_bf16 v[232:235], v[44:47], v[72:75], v[232:235]
    ds_read_b64_tr_b16 v[52:53], v13 offset:49152
    v_mfma_f32_16x16x32_bf16 v[236:239], v[44:47], v[76:79], v[236:239]
    ds_read_b64_tr_b16 v[54:55], v13 offset:53248
    v_mfma_f32_16x16x32_bf16 v[204:207], v[40:43], v[76:79], v[204:207]
    ds_read_b64_tr_b16 v[56:57], v12 offset:57344
    v_mfma_f32_16x16x32_bf16 v[172:175], v[36:39], v[76:79], v[172:175]
    ds_read_b64_tr_b16 v[58:59], v12 offset:61440
    v_mfma_f32_16x16x32_bf16 v[140:143], v[32:35], v[76:79], v[140:143]
    ds_read_b64_tr_b16 v[60:61], v13 offset:57344
    v_mfma_f32_16x16x32_bf16 v[144:147], v[32:35], v[80:83], v[144:147]
    ds_read_b64_tr_b16 v[62:63], v13 offset:61440
    v_mfma_f32_16x16x32_bf16 v[176:179], v[36:39], v[80:83], v[176:179]
    ds_read_b128 v[96:99], v11 offset:32768
    v_mfma_f32_16x16x32_bf16 v[208:211], v[40:43], v[80:83], v[208:211]
    ds_read_b128 v[100:103], v11 offset:34816
    v_mfma_f32_16x16x32_bf16 v[240:243], v[44:47], v[80:83], v[240:243]
    ds_read_b128 v[104:107], v11 offset:36864
    v_mfma_f32_16x16x32_bf16 v[28:31], v[44:47], v[20:23], v[28:31]
    ds_read_b128 v[108:111], v11 offset:38912
    v_mfma_f32_16x16x32_bf16 v[244:247], v[44:47], v[84:87], v[244:247]
    ds_read_b128 v[112:115], v11 offset:40960
    v_mfma_f32_16x16x32_bf16 v[212:215], v[40:43], v[84:87], v[212:215]
    ds_read_b128 v[116:119], v11 offset:43008
    v_mfma_f32_16x16x32_bf16 v[180:183], v[36:39], v[84:87], v[180:183]
    ds_read_b128 v[120:123], v11 offset:45056
    v_mfma_f32_16x16x32_bf16 v[148:151], v[32:35], v[84:87], v[148:151]
    ds_read_b128 v[124:127], v11 offset:47104
    v_mfma_f32_16x16x32_bf16 v[152:155], v[32:35], v[88:91], v[152:155]
    v_mfma_f32_16x16x32_bf16 v[184:187], v[36:39], v[88:91], v[184:187]
    v_mfma_f32_16x16x32_bf16 v[216:219], v[40:43], v[88:91], v[216:219]
    v_mfma_f32_16x16x32_bf16 v[248:251], v[44:47], v[88:91], v[248:251]
    v_mfma_f32_16x16x32_bf16 v[252:255], v[44:47], v[92:95], v[252:255]
    v_mfma_f32_16x16x32_bf16 v[220:223], v[40:43], v[92:95], v[220:223]
    v_mfma_f32_16x16x32_bf16 v[188:191], v[36:39], v[92:95], v[188:191]
    v_mfma_f32_16x16x32_bf16 v[156:159], v[32:35], v[92:95], v[156:159]
    s_waitcnt vmcnt(8) lgkmcnt(0)
    s_barrier
    v_mfma_f32_16x16x32_bf16 v[128:131], v[48:51], v[96:99], v[128:131]
    v_mfma_f32_16x16x32_bf16 v[160:163], v[52:55], v[96:99], v[160:163]
    v_mfma_f32_16x16x32_bf16 v[192:195], v[56:59], v[96:99], v[192:195]
    v_mfma_f32_16x16x32_bf16 v[224:227], v[60:63], v[96:99], v[224:227]
    v_mfma_f32_16x16x32_bf16 v[228:231], v[60:63], v[100:103], v[228:231]
    v_mfma_f32_16x16x32_bf16 v[196:199], v[56:59], v[100:103], v[196:199]
    v_mfma_f32_16x16x32_bf16 v[164:167], v[52:55], v[100:103], v[164:167]
    s_add_u32 m0, s23, 32768
    s_mov_b32 s20, 1024
    buffer_load_dwordx4 v2, s[12:15], s20 offen sc1 lds
    v_mfma_f32_16x16x32_bf16 v[132:135], v[48:51], v[100:103], v[132:135]
    buffer_load_dwordx4 v3, s[12:15], s20 offen offset:1024 sc1 lds
    v_mfma_f32_16x16x32_bf16 v[136:139], v[48:51], v[104:107], v[136:139]
    s_add_u32 m0, s24, 49152
    s_nop 0
    global_load_lds_dwordx4 v[4:5], off sc1
    s_add_u32 m0, s24, 51200
    v_lshl_add_u64 v[4:5], v[8:9], 0, v[4:5]
    v_mfma_f32_16x16x32_bf16 v[168:171], v[52:55], v[104:107], v[168:171]
    global_load_lds_dwordx4 v[6:7], off sc1
    v_lshl_add_u64 v[6:7], v[8:9], 0, v[6:7]
    v_mfma_f32_16x16x32_bf16 v[24:27], v[52:55], v[20:23], v[24:27]
    ds_read_b64_tr_b16 v[32:33], v12 offset:0
    v_mfma_f32_16x16x32_bf16 v[200:203], v[56:59], v[104:107], v[200:203]
    ds_read_b64_tr_b16 v[34:35], v12 offset:4096
    v_mfma_f32_16x16x32_bf16 v[232:235], v[60:63], v[104:107], v[232:235]
    ds_read_b64_tr_b16 v[36:37], v13 offset:0
    v_mfma_f32_16x16x32_bf16 v[236:239], v[60:63], v[108:111], v[236:239]
    ds_read_b64_tr_b16 v[38:39], v13 offset:4096
    v_mfma_f32_16x16x32_bf16 v[204:207], v[56:59], v[108:111], v[204:207]
    ds_read_b64_tr_b16 v[40:41], v12 offset:8192
    v_mfma_f32_16x16x32_bf16 v[172:175], v[52:55], v[108:111], v[172:175]
    ds_read_b64_tr_b16 v[42:43], v12 offset:12288
    v_mfma_f32_16x16x32_bf16 v[140:143], v[48:51], v[108:111], v[140:143]
    ds_read_b64_tr_b16 v[44:45], v13 offset:8192
    v_mfma_f32_16x16x32_bf16 v[144:147], v[48:51], v[112:115], v[144:147]
    ds_read_b64_tr_b16 v[46:47], v13 offset:12288
    v_mfma_f32_16x16x32_bf16 v[176:179], v[52:55], v[112:115], v[176:179]
    ds_read_b128 v[64:67], v10 offset:0
    v_mfma_f32_16x16x32_bf16 v[208:211], v[56:59], v[112:115], v[208:211]
    ds_read_b128 v[68:71], v10 offset:2048
    v_mfma_f32_16x16x32_bf16 v[240:243], v[60:63], v[112:115], v[240:243]
    ds_read_b128 v[72:75], v10 offset:4096
    v_mfma_f32_16x16x32_bf16 v[28:31], v[60:63], v[20:23], v[28:31]
    ds_read_b128 v[76:79], v10 offset:6144
    v_mfma_f32_16x16x32_bf16 v[244:247], v[60:63], v[116:119], v[244:247]
    ds_read_b128 v[80:83], v10 offset:8192
    v_mfma_f32_16x16x32_bf16 v[212:215], v[56:59], v[116:119], v[212:215]
    ds_read_b128 v[84:87], v10 offset:10240
    v_mfma_f32_16x16x32_bf16 v[180:183], v[52:55], v[116:119], v[180:183]
    ds_read_b128 v[88:91], v10 offset:12288
    v_mfma_f32_16x16x32_bf16 v[148:151], v[48:51], v[116:119], v[148:151]
    ds_read_b128 v[92:95], v10 offset:14336
    v_mfma_f32_16x16x32_bf16 v[152:155], v[48:51], v[120:123], v[152:155]
    v_mfma_f32_16x16x32_bf16 v[184:187], v[52:55], v[120:123], v[184:187]
    v_mfma_f32_16x16x32_bf16 v[216:219], v[56:59], v[120:123], v[216:219]
    v_mfma_f32_16x16x32_bf16 v[248:251], v[60:63], v[120:123], v[248:251]
    v_mfma_f32_16x16x32_bf16 v[252:255], v[60:63], v[124:127], v[252:255]
    v_mfma_f32_16x16x32_bf16 v[220:223], v[56:59], v[124:127], v[220:223]
    v_mfma_f32_16x16x32_bf16 v[188:191], v[52:55], v[124:127], v[188:191]
    v_mfma_f32_16x16x32_bf16 v[156:159], v[48:51], v[124:127], v[156:159]
    s_waitcnt vmcnt(8) lgkmcnt(0)
    s_barrier
    v_mfma_f32_16x16x32_bf16 v[128:131], v[32:35], v[64:67], v[128:131]
    v_mfma_f32_16x16x32_bf16 v[160:163], v[36:39], v[64:67], v[160:163]
    v_mfma_f32_16x16x32_bf16 v[192:195], v[40:43], v[64:67], v[192:195]
    v_mfma_f32_16x16x32_bf16 v[224:227], v[44:47], v[64:67], v[224:227]
    v_mfma_f32_16x16x32_bf16 v[228:231], v[44:47], v[68:71], v[228:231]
    v_mfma_f32_16x16x32_bf16 v[196:199], v[40:43], v[68:71], v[196:199]
    v_mfma_f32_16x16x32_bf16 v[164:167], v[36:39], v[68:71], v[164:167]
    s_add_u32 m0, s23, 81920
    s_mov_b32 s20, 263168
    buffer_load_dwordx4 v2, s[12:15], s20 offen sc1 lds
    v_mfma_f32_16x16x32_bf16 v[132:135], v[32:35], v[68:71], v[132:135]
    buffer_load_dwordx4 v3, s[12:15], s20 offen offset:1024 sc1 lds
    v_mfma_f32_16x16x32_bf16 v[136:139], v[32:35], v[72:75], v[136:139]
    s_add_u32 m0, s24, 0
    s_nop 0
    global_load_lds_dwordx4 v[4:5], off sc1
    s_add_u32 m0, s24, 2048
    v_lshl_add_u64 v[4:5], v[8:9], 0, v[4:5]
    v_mfma_f32_16x16x32_bf16 v[168:171], v[36:39], v[72:75], v[168:171]
    global_load_lds_dwordx4 v[6:7], off sc1
    v_lshl_add_u64 v[6:7], v[8:9], 0, v[6:7]
    v_mfma_f32_16x16x32_bf16 v[24:27], v[36:39], v[20:23], v[24:27]
    ds_read_b64_tr_b16 v[48:49], v12 offset:16384
    v_mfma_f32_16x16x32_bf16 v[200:203], v[40:43], v[72:75], v[200:203]
    ds_read_b64_tr_b16 v[50:51], v12 offset:20480
    v_mfma_f32_16x16x32_bf16 v[232:235], v[44:47], v[72:75], v[232:235]
    ds_read_b64_tr_b16 v[52:53], v13 offset:16384
    v_mfma_f32_16x16x32_bf16 v[236:239], v[44:47], v[76:79], v[236:239]
    ds_read_b64_tr_b16 v[54:55], v13 offset:20480
    v_mfma_f32_16x16x32_bf16 v[204:207], v[40:43], v[76:79], v[204:207]
    ds_read_b64_tr_b16 v[56:57], v12 offset:24576
    v_mfma_f32_16x16x32_bf16 v[172:175], v[36:39], v[76:79], v[172:175]
    ds_read_b64_tr_b16 v[58:59], v12 offset:28672
    v_mfma_f32_16x16x32_bf16 v[140:143], v[32:35], v[76:79], v[140:143]
    ds_read_b64_tr_b16 v[60:61], v13 offset:24576
    v_mfma_f32_16x16x32_bf16 v[144:147], v[32:35], v[80:83], v[144:147]
    ds_read_b64_tr_b16 v[62:63], v13 offset:28672
    v_mfma_f32_16x16x32_bf16 v[176:179], v[36:39], v[80:83], v[176:179]
    ds_read_b128 v[96:99], v11 offset:0
    v_mfma_f32_16x16x32_bf16 v[208:211], v[40:43], v[80:83], v[208:211]
    ds_read_b128 v[100:103], v11 offset:2048
    v_mfma_f32_16x16x32_bf16 v[240:243], v[44:47], v[80:83], v[240:243]
    ds_read_b128 v[104:107], v11 offset:4096
    v_mfma_f32_16x16x32_bf16 v[28:31], v[44:47], v[20:23], v[28:31]
    ds_read_b128 v[108:111], v11 offset:6144
    v_mfma_f32_16x16x32_bf16 v[244:247], v[44:47], v[84:87], v[244:247]
    ds_read_b128 v[112:115], v11 offset:8192
    v_mfma_f32_16x16x32_bf16 v[212:215], v[40:43], v[84:87], v[212:215]
    ds_read_b128 v[116:119], v11 offset:10240
    v_mfma_f32_16x16x32_bf16 v[180:183], v[36:39], v[84:87], v[180:183]
    ds_read_b128 v[120:123], v11 offset:12288
    v_mfma_f32_16x16x32_bf16 v[148:151], v[32:35], v[84:87], v[148:151]
    ds_read_b128 v[124:127], v11 offset:14336
    v_mfma_f32_16x16x32_bf16 v[152:155], v[32:35], v[88:91], v[152:155]
    v_mfma_f32_16x16x32_bf16 v[184:187], v[36:39], v[88:91], v[184:187]
    v_mfma_f32_16x16x32_bf16 v[216:219], v[40:43], v[88:91], v[216:219]
    v_mfma_f32_16x16x32_bf16 v[248:251], v[44:47], v[88:91], v[248:251]
    v_mfma_f32_16x16x32_bf16 v[252:255], v[44:47], v[92:95], v[252:255]
    v_mfma_f32_16x16x32_bf16 v[220:223], v[40:43], v[92:95], v[220:223]
    v_mfma_f32_16x16x32_bf16 v[188:191], v[36:39], v[92:95], v[188:191]
    v_mfma_f32_16x16x32_bf16 v[156:159], v[32:35], v[92:95], v[156:159]
    s_waitcnt vmcnt(8) lgkmcnt(0)
    s_barrier
    v_mfma_f32_16x16x32_bf16 v[128:131], v[48:51], v[96:99], v[128:131]
    v_mfma_f32_16x16x32_bf16 v[160:163], v[52:55], v[96:99], v[160:163]
    v_mfma_f32_16x16x32_bf16 v[192:195], v[56:59], v[96:99], v[192:195]
    v_mfma_f32_16x16x32_bf16 v[224:227], v[60:63], v[96:99], v[224:227]
    v_mfma_f32_16x16x32_bf16 v[228:231], v[60:63], v[100:103], v[228:231]
    v_mfma_f32_16x16x32_bf16 v[196:199], v[56:59], v[100:103], v[196:199]
    v_mfma_f32_16x16x32_bf16 v[164:167], v[52:55], v[100:103], v[164:167]
    s_add_u32 m0, s23, 0
    s_mov_b32 s20, 1152
    buffer_load_dwordx4 v2, s[12:15], s20 offen sc1 lds
    v_mfma_f32_16x16x32_bf16 v[132:135], v[48:51], v[100:103], v[132:135]
    buffer_load_dwordx4 v3, s[12:15], s20 offen offset:1024 sc1 lds
    v_mfma_f32_16x16x32_bf16 v[136:139], v[48:51], v[104:107], v[136:139]
    s_add_u32 m0, s24, 16384
    s_nop 0
    global_load_lds_dwordx4 v[4:5], off sc1
    s_add_u32 m0, s24, 18432
    v_lshl_add_u64 v[4:5], v[8:9], 0, v[4:5]
    v_mfma_f32_16x16x32_bf16 v[168:171], v[52:55], v[104:107], v[168:171]
    global_load_lds_dwordx4 v[6:7], off sc1
    v_lshl_add_u64 v[6:7], v[8:9], 0, v[6:7]
    v_mfma_f32_16x16x32_bf16 v[24:27], v[52:55], v[20:23], v[24:27]
    ds_read_b64_tr_b16 v[32:33], v12 offset:32768
    v_mfma_f32_16x16x32_bf16 v[200:203], v[56:59], v[104:107], v[200:203]
    ds_read_b64_tr_b16 v[34:35], v12 offset:36864
    v_mfma_f32_16x16x32_bf16 v[232:235], v[60:63], v[104:107], v[232:235]
    ds_read_b64_tr_b16 v[36:37], v13 offset:32768
    v_mfma_f32_16x16x32_bf16 v[236:239], v[60:63], v[108:111], v[236:239]
    ds_read_b64_tr_b16 v[38:39], v13 offset:36864
    v_mfma_f32_16x16x32_bf16 v[204:207], v[56:59], v[108:111], v[204:207]
    ds_read_b64_tr_b16 v[40:41], v12 offset:40960
    v_mfma_f32_16x16x32_bf16 v[172:175], v[52:55], v[108:111], v[172:175]
    ds_read_b64_tr_b16 v[42:43], v12 offset:45056
    v_mfma_f32_16x16x32_bf16 v[140:143], v[48:51], v[108:111], v[140:143]
    ds_read_b64_tr_b16 v[44:45], v13 offset:40960
    v_mfma_f32_16x16x32_bf16 v[144:147], v[48:51], v[112:115], v[144:147]
    ds_read_b64_tr_b16 v[46:47], v13 offset:45056
    v_mfma_f32_16x16x32_bf16 v[176:179], v[52:55], v[112:115], v[176:179]
    ds_read_b128 v[64:67], v10 offset:16384
    v_mfma_f32_16x16x32_bf16 v[208:211], v[56:59], v[112:115], v[208:211]
    ds_read_b128 v[68:71], v10 offset:18432
    v_mfma_f32_16x16x32_bf16 v[240:243], v[60:63], v[112:115], v[240:243]
    ds_read_b128 v[72:75], v10 offset:20480
    v_mfma_f32_16x16x32_bf16 v[28:31], v[60:63], v[20:23], v[28:31]
    ds_read_b128 v[76:79], v10 offset:22528
    v_mfma_f32_16x16x32_bf16 v[244:247], v[60:63], v[116:119], v[244:247]
    ds_read_b128 v[80:83], v10 offset:24576
    v_mfma_f32_16x16x32_bf16 v[212:215], v[56:59], v[116:119], v[212:215]
    ds_read_b128 v[84:87], v10 offset:26624
    v_mfma_f32_16x16x32_bf16 v[180:183], v[52:55], v[116:119], v[180:183]
    ds_read_b128 v[88:91], v10 offset:28672
    v_mfma_f32_16x16x32_bf16 v[148:151], v[48:51], v[116:119], v[148:151]
    ds_read_b128 v[92:95], v10 offset:30720
    v_mfma_f32_16x16x32_bf16 v[152:155], v[48:51], v[120:123], v[152:155]
    v_mfma_f32_16x16x32_bf16 v[184:187], v[52:55], v[120:123], v[184:187]
    v_mfma_f32_16x16x32_bf16 v[216:219], v[56:59], v[120:123], v[216:219]
    v_mfma_f32_16x16x32_bf16 v[248:251], v[60:63], v[120:123], v[248:251]
    v_mfma_f32_16x16x32_bf16 v[252:255], v[60:63], v[124:127], v[252:255]
    v_mfma_f32_16x16x32_bf16 v[220:223], v[56:59], v[124:127], v[220:223]
    v_mfma_f32_16x16x32_bf16 v[188:191], v[52:55], v[124:127], v[188:191]
    v_mfma_f32_16x16x32_bf16 v[156:159], v[48:51], v[124:127], v[156:159]
    s_waitcnt vmcnt(8) lgkmcnt(0)
    s_barrier
    v_mfma_f32_16x16x32_bf16 v[128:131], v[32:35], v[64:67], v[128:131]
    v_mfma_f32_16x16x32_bf16 v[160:163], v[36:39], v[64:67], v[160:163]
    v_mfma_f32_16x16x32_bf16 v[192:195], v[40:43], v[64:67], v[192:195]
    v_mfma_f32_16x16x32_bf16 v[224:227], v[44:47], v[64:67], v[224:227]
    v_mfma_f32_16x16x32_bf16 v[228:231], v[44:47], v[68:71], v[228:231]
    v_mfma_f32_16x16x32_bf16 v[196:199], v[40:43], v[68:71], v[196:199]
    v_mfma_f32_16x16x32_bf16 v[164:167], v[36:39], v[68:71], v[164:167]
    s_add_u32 m0, s23, 49152
    s_mov_b32 s20, 263296
    buffer_load_dwordx4 v2, s[12:15], s20 offen sc1 lds
    v_mfma_f32_16x16x32_bf16 v[132:135], v[32:35], v[68:71], v[132:135]
    buffer_load_dwordx4 v3, s[12:15], s20 offen offset:1024 sc1 lds
    v_mfma_f32_16x16x32_bf16 v[136:139], v[32:35], v[72:75], v[136:139]
    s_add_u32 m0, s24, 32768
    s_nop 0
    global_load_lds_dwordx4 v[4:5], off sc1
    s_add_u32 m0, s24, 34816
    v_lshl_add_u64 v[4:5], v[8:9], 0, v[4:5]
    v_mfma_f32_16x16x32_bf16 v[168:171], v[36:39], v[72:75], v[168:171]
    global_load_lds_dwordx4 v[6:7], off sc1
    v_lshl_add_u64 v[6:7], v[8:9], 0, v[6:7]
    v_mfma_f32_16x16x32_bf16 v[24:27], v[36:39], v[20:23], v[24:27]
    ds_read_b64_tr_b16 v[48:49], v12 offset:49152
    v_mfma_f32_16x16x32_bf16 v[200:203], v[40:43], v[72:75], v[200:203]
    ds_read_b64_tr_b16 v[50:51], v12 offset:53248
    v_mfma_f32_16x16x32_bf16 v[232:235], v[44:47], v[72:75], v[232:235]
    ds_read_b64_tr_b16 v[52:53], v13 offset:49152
    v_mfma_f32_16x16x32_bf16 v[236:239], v[44:47], v[76:79], v[236:239]
    ds_read_b64_tr_b16 v[54:55], v13 offset:53248
    v_mfma_f32_16x16x32_bf16 v[204:207], v[40:43], v[76:79], v[204:207]
    ds_read_b64_tr_b16 v[56:57], v12 offset:57344
    v_mfma_f32_16x16x32_bf16 v[172:175], v[36:39], v[76:79], v[172:175]
    ds_read_b64_tr_b16 v[58:59], v12 offset:61440
    v_mfma_f32_16x16x32_bf16 v[140:143], v[32:35], v[76:79], v[140:143]
    ds_read_b64_tr_b16 v[60:61], v13 offset:57344
    v_mfma_f32_16x16x32_bf16 v[144:147], v[32:35], v[80:83], v[144:147]
    ds_read_b64_tr_b16 v[62:63], v13 offset:61440
    v_mfma_f32_16x16x32_bf16 v[176:179], v[36:39], v[80:83], v[176:179]
    ds_read_b128 v[96:99], v11 offset:16384
    v_mfma_f32_16x16x32_bf16 v[208:211], v[40:43], v[80:83], v[208:211]
    ds_read_b128 v[100:103], v11 offset:18432
    v_mfma_f32_16x16x32_bf16 v[240:243], v[44:47], v[80:83], v[240:243]
    ds_read_b128 v[104:107], v11 offset:20480
    v_mfma_f32_16x16x32_bf16 v[28:31], v[44:47], v[20:23], v[28:31]
    ds_read_b128 v[108:111], v11 offset:22528
    v_mfma_f32_16x16x32_bf16 v[244:247], v[44:47], v[84:87], v[244:247]
    ds_read_b128 v[112:115], v11 offset:24576
    v_mfma_f32_16x16x32_bf16 v[212:215], v[40:43], v[84:87], v[212:215]
    ds_read_b128 v[116:119], v11 offset:26624
    v_mfma_f32_16x16x32_bf16 v[180:183], v[36:39], v[84:87], v[180:183]
    ds_read_b128 v[120:123], v11 offset:28672
    v_mfma_f32_16x16x32_bf16 v[148:151], v[32:35], v[84:87], v[148:151]
    ds_read_b128 v[124:127], v11 offset:30720
    v_mfma_f32_16x16x32_bf16 v[152:155], v[32:35], v[88:91], v[152:155]
    v_mfma_f32_16x16x32_bf16 v[184:187], v[36:39], v[88:91], v[184:187]
    v_mfma_f32_16x16x32_bf16 v[216:219], v[40:43], v[88:91], v[216:219]
    v_mfma_f32_16x16x32_bf16 v[248:251], v[44:47], v[88:91], v[248:251]
    v_mfma_f32_16x16x32_bf16 v[252:255], v[44:47], v[92:95], v[252:255]
    v_mfma_f32_16x16x32_bf16 v[220:223], v[40:43], v[92:95], v[220:223]
    v_mfma_f32_16x16x32_bf16 v[188:191], v[36:39], v[92:95], v[188:191]
    v_mfma_f32_16x16x32_bf16 v[156:159], v[32:35], v[92:95], v[156:159]
    s_waitcnt vmcnt(8) lgkmcnt(0)
    s_barrier
    v_mfma_f32_16x16x32_bf16 v[128:131], v[48:51], v[96:99], v[128:131]
    v_mfma_f32_16x16x32_bf16 v[160:163], v[52:55], v[96:99], v[160:163]
    v_mfma_f32_16x16x32_bf16 v[192:195], v[56:59], v[96:99], v[192:195]
    v_mfma_f32_16x16x32_bf16 v[224:227], v[60:63], v[96:99], v[224:227]
    v_mfma_f32_16x16x32_bf16 v[228:231], v[60:63], v[100:103], v[228:231]
    v_mfma_f32_16x16x32_bf16 v[196:199], v[56:59], v[100:103], v[196:199]
    v_mfma_f32_16x16x32_bf16 v[164:167], v[52:55], v[100:103], v[164:167]
    s_add_u32 m0, s23, 16384
    s_mov_b32 s20, 1280
    buffer_load_dwordx4 v2, s[12:15], s20 offen sc1 lds
    v_mfma_f32_16x16x32_bf16 v[132:135], v[48:51], v[100:103], v[132:135]
    buffer_load_dwordx4 v3, s[12:15], s20 offen offset:1024 sc1 lds
    v_mfma_f32_16x16x32_bf16 v[136:139], v[48:51], v[104:107], v[136:139]
    s_add_u32 m0, s24, 49152
    s_nop 0
    global_load_lds_dwordx4 v[4:5], off sc1
    s_add_u32 m0, s24, 51200
    v_lshl_add_u64 v[4:5], v[8:9], 0, v[4:5]
    v_mfma_f32_16x16x32_bf16 v[168:171], v[52:55], v[104:107], v[168:171]
    global_load_lds_dwordx4 v[6:7], off sc1
    v_lshl_add_u64 v[6:7], v[8:9], 0, v[6:7]
    v_mfma_f32_16x16x32_bf16 v[24:27], v[52:55], v[20:23], v[24:27]
    ds_read_b64_tr_b16 v[32:33], v12 offset:0
    v_mfma_f32_16x16x32_bf16 v[200:203], v[56:59], v[104:107], v[200:203]
    ds_read_b64_tr_b16 v[34:35], v12 offset:4096
    v_mfma_f32_16x16x32_bf16 v[232:235], v[60:63], v[104:107], v[232:235]
    ds_read_b64_tr_b16 v[36:37], v13 offset:0
    v_mfma_f32_16x16x32_bf16 v[236:239], v[60:63], v[108:111], v[236:239]
    ds_read_b64_tr_b16 v[38:39], v13 offset:4096
    v_mfma_f32_16x16x32_bf16 v[204:207], v[56:59], v[108:111], v[204:207]
    ds_read_b64_tr_b16 v[40:41], v12 offset:8192
    v_mfma_f32_16x16x32_bf16 v[172:175], v[52:55], v[108:111], v[172:175]
    ds_read_b64_tr_b16 v[42:43], v12 offset:12288
    v_mfma_f32_16x16x32_bf16 v[140:143], v[48:51], v[108:111], v[140:143]
    ds_read_b64_tr_b16 v[44:45], v13 offset:8192
    v_mfma_f32_16x16x32_bf16 v[144:147], v[48:51], v[112:115], v[144:147]
    ds_read_b64_tr_b16 v[46:47], v13 offset:12288
    v_mfma_f32_16x16x32_bf16 v[176:179], v[52:55], v[112:115], v[176:179]
    ds_read_b128 v[64:67], v10 offset:32768
    v_mfma_f32_16x16x32_bf16 v[208:211], v[56:59], v[112:115], v[208:211]
    ds_read_b128 v[68:71], v10 offset:34816
    v_mfma_f32_16x16x32_bf16 v[240:243], v[60:63], v[112:115], v[240:243]
    ds_read_b128 v[72:75], v10 offset:36864
    v_mfma_f32_16x16x32_bf16 v[28:31], v[60:63], v[20:23], v[28:31]
    ds_read_b128 v[76:79], v10 offset:38912
    v_mfma_f32_16x16x32_bf16 v[244:247], v[60:63], v[116:119], v[244:247]
    ds_read_b128 v[80:83], v10 offset:40960
    v_mfma_f32_16x16x32_bf16 v[212:215], v[56:59], v[116:119], v[212:215]
    ds_read_b128 v[84:87], v10 offset:43008
    v_mfma_f32_16x16x32_bf16 v[180:183], v[52:55], v[116:119], v[180:183]
    ds_read_b128 v[88:91], v10 offset:45056
    v_mfma_f32_16x16x32_bf16 v[148:151], v[48:51], v[116:119], v[148:151]
    ds_read_b128 v[92:95], v10 offset:47104
    v_mfma_f32_16x16x32_bf16 v[152:155], v[48:51], v[120:123], v[152:155]
    v_mfma_f32_16x16x32_bf16 v[184:187], v[52:55], v[120:123], v[184:187]
    v_mfma_f32_16x16x32_bf16 v[216:219], v[56:59], v[120:123], v[216:219]
    v_mfma_f32_16x16x32_bf16 v[248:251], v[60:63], v[120:123], v[248:251]
    v_mfma_f32_16x16x32_bf16 v[252:255], v[60:63], v[124:127], v[252:255]
    v_mfma_f32_16x16x32_bf16 v[220:223], v[56:59], v[124:127], v[220:223]
    v_mfma_f32_16x16x32_bf16 v[188:191], v[52:55], v[124:127], v[188:191]
    v_mfma_f32_16x16x32_bf16 v[156:159], v[48:51], v[124:127], v[156:159]
    s_waitcnt vmcnt(8) lgkmcnt(0)
    s_barrier
    v_mfma_f32_16x16x32_bf16 v[128:131], v[32:35], v[64:67], v[128:131]
    v_mfma_f32_16x16x32_bf16 v[160:163], v[36:39], v[64:67], v[160:163]
    v_mfma_f32_16x16x32_bf16 v[192:195], v[40:43], v[64:67], v[192:195]
    v_mfma_f32_16x16x32_bf16 v[224:227], v[44:47], v[64:67], v[224:227]
    v_mfma_f32_16x16x32_bf16 v[228:231], v[44:47], v[68:71], v[228:231]
    v_mfma_f32_16x16x32_bf16 v[196:199], v[40:43], v[68:71], v[196:199]
    v_mfma_f32_16x16x32_bf16 v[164:167], v[36:39], v[68:71], v[164:167]
    s_add_u32 m0, s23, 65536
    s_mov_b32 s20, 263424
    buffer_load_dwordx4 v2, s[12:15], s20 offen sc1 lds
    v_mfma_f32_16x16x32_bf16 v[132:135], v[32:35], v[68:71], v[132:135]
    buffer_load_dwordx4 v3, s[12:15], s20 offen offset:1024 sc1 lds
    v_mfma_f32_16x16x32_bf16 v[136:139], v[32:35], v[72:75], v[136:139]
    s_add_u32 m0, s24, 0
    s_nop 0
    global_load_lds_dwordx4 v[4:5], off sc1
    s_add_u32 m0, s24, 2048
    v_lshl_add_u64 v[4:5], v[8:9], 0, v[4:5]
    v_mfma_f32_16x16x32_bf16 v[168:171], v[36:39], v[72:75], v[168:171]
    global_load_lds_dwordx4 v[6:7], off sc1
    v_lshl_add_u64 v[6:7], v[8:9], 0, v[6:7]
    v_mfma_f32_16x16x32_bf16 v[24:27], v[36:39], v[20:23], v[24:27]
    ds_read_b64_tr_b16 v[48:49], v12 offset:16384
    v_mfma_f32_16x16x32_bf16 v[200:203], v[40:43], v[72:75], v[200:203]
    ds_read_b64_tr_b16 v[50:51], v12 offset:20480
    v_mfma_f32_16x16x32_bf16 v[232:235], v[44:47], v[72:75], v[232:235]
    ds_read_b64_tr_b16 v[52:53], v13 offset:16384
    v_mfma_f32_16x16x32_bf16 v[236:239], v[44:47], v[76:79], v[236:239]
    ds_read_b64_tr_b16 v[54:55], v13 offset:20480
    v_mfma_f32_16x16x32_bf16 v[204:207], v[40:43], v[76:79], v[204:207]
    ds_read_b64_tr_b16 v[56:57], v12 offset:24576
    v_mfma_f32_16x16x32_bf16 v[172:175], v[36:39], v[76:79], v[172:175]
    ds_read_b64_tr_b16 v[58:59], v12 offset:28672
    v_mfma_f32_16x16x32_bf16 v[140:143], v[32:35], v[76:79], v[140:143]
    ds_read_b64_tr_b16 v[60:61], v13 offset:24576
    v_mfma_f32_16x16x32_bf16 v[144:147], v[32:35], v[80:83], v[144:147]
    ds_read_b64_tr_b16 v[62:63], v13 offset:28672
    v_mfma_f32_16x16x32_bf16 v[176:179], v[36:39], v[80:83], v[176:179]
    ds_read_b128 v[96:99], v11 offset:32768
    v_mfma_f32_16x16x32_bf16 v[208:211], v[40:43], v[80:83], v[208:211]
    ds_read_b128 v[100:103], v11 offset:34816
    v_mfma_f32_16x16x32_bf16 v[240:243], v[44:47], v[80:83], v[240:243]
    ds_read_b128 v[104:107], v11 offset:36864
    v_mfma_f32_16x16x32_bf16 v[28:31], v[44:47], v[20:23], v[28:31]
    ds_read_b128 v[108:111], v11 offset:38912
    v_mfma_f32_16x16x32_bf16 v[244:247], v[44:47], v[84:87], v[244:247]
    ds_read_b128 v[112:115], v11 offset:40960
    v_mfma_f32_16x16x32_bf16 v[212:215], v[40:43], v[84:87], v[212:215]
    ds_read_b128 v[116:119], v11 offset:43008
    v_mfma_f32_16x16x32_bf16 v[180:183], v[36:39], v[84:87], v[180:183]
    ds_read_b128 v[120:123], v11 offset:45056
    v_mfma_f32_16x16x32_bf16 v[148:151], v[32:35], v[84:87], v[148:151]
    ds_read_b128 v[124:127], v11 offset:47104
    v_mfma_f32_16x16x32_bf16 v[152:155], v[32:35], v[88:91], v[152:155]
    v_mfma_f32_16x16x32_bf16 v[184:187], v[36:39], v[88:91], v[184:187]
    v_mfma_f32_16x16x32_bf16 v[216:219], v[40:43], v[88:91], v[216:219]
    v_mfma_f32_16x16x32_bf16 v[248:251], v[44:47], v[88:91], v[248:251]
    v_mfma_f32_16x16x32_bf16 v[252:255], v[44:47], v[92:95], v[252:255]
    v_mfma_f32_16x16x32_bf16 v[220:223], v[40:43], v[92:95], v[220:223]
    v_mfma_f32_16x16x32_bf16 v[188:191], v[36:39], v[92:95], v[188:191]
    v_mfma_f32_16x16x32_bf16 v[156:159], v[32:35], v[92:95], v[156:159]
    s_waitcnt vmcnt(8) lgkmcnt(0)
    s_barrier
    v_mfma_f32_16x16x32_bf16 v[128:131], v[48:51], v[96:99], v[128:131]
    v_mfma_f32_16x16x32_bf16 v[160:163], v[52:55], v[96:99], v[160:163]
    v_mfma_f32_16x16x32_bf16 v[192:195], v[56:59], v[96:99], v[192:195]
    v_mfma_f32_16x16x32_bf16 v[224:227], v[60:63], v[96:99], v[224:227]
    v_mfma_f32_16x16x32_bf16 v[228:231], v[60:63], v[100:103], v[228:231]
    v_mfma_f32_16x16x32_bf16 v[196:199], v[56:59], v[100:103], v[196:199]
    v_mfma_f32_16x16x32_bf16 v[164:167], v[52:55], v[100:103], v[164:167]
    s_add_u32 m0, s23, 32768
    s_mov_b32 s20, 1408
    buffer_load_dwordx4 v2, s[12:15], s20 offen sc1 lds
    v_mfma_f32_16x16x32_bf16 v[132:135], v[48:51], v[100:103], v[132:135]
    buffer_load_dwordx4 v3, s[12:15], s20 offen offset:1024 sc1 lds
    v_mfma_f32_16x16x32_bf16 v[136:139], v[48:51], v[104:107], v[136:139]
    s_add_u32 m0, s24, 16384
    s_nop 0
    global_load_lds_dwordx4 v[4:5], off sc1
    s_add_u32 m0, s24, 18432
    v_lshl_add_u64 v[4:5], v[8:9], 0, v[4:5]
    v_mfma_f32_16x16x32_bf16 v[168:171], v[52:55], v[104:107], v[168:171]
    global_load_lds_dwordx4 v[6:7], off sc1
    v_lshl_add_u64 v[6:7], v[8:9], 0, v[6:7]
    v_mfma_f32_16x16x32_bf16 v[24:27], v[52:55], v[20:23], v[24:27]
    ds_read_b64_tr_b16 v[32:33], v12 offset:32768
    v_mfma_f32_16x16x32_bf16 v[200:203], v[56:59], v[104:107], v[200:203]
    ds_read_b64_tr_b16 v[34:35], v12 offset:36864
    v_mfma_f32_16x16x32_bf16 v[232:235], v[60:63], v[104:107], v[232:235]
    ds_read_b64_tr_b16 v[36:37], v13 offset:32768
    v_mfma_f32_16x16x32_bf16 v[236:239], v[60:63], v[108:111], v[236:239]
    ds_read_b64_tr_b16 v[38:39], v13 offset:36864
    v_mfma_f32_16x16x32_bf16 v[204:207], v[56:59], v[108:111], v[204:207]
    ds_read_b64_tr_b16 v[40:41], v12 offset:40960
    v_mfma_f32_16x16x32_bf16 v[172:175], v[52:55], v[108:111], v[172:175]
    ds_read_b64_tr_b16 v[42:43], v12 offset:45056
    v_mfma_f32_16x16x32_bf16 v[140:143], v[48:51], v[108:111], v[140:143]
    ds_read_b64_tr_b16 v[44:45], v13 offset:40960
    v_mfma_f32_16x16x32_bf16 v[144:147], v[48:51], v[112:115], v[144:147]
    ds_read_b64_tr_b16 v[46:47], v13 offset:45056
    v_mfma_f32_16x16x32_bf16 v[176:179], v[52:55], v[112:115], v[176:179]
    ds_read_b128 v[64:67], v10 offset:0
    v_mfma_f32_16x16x32_bf16 v[208:211], v[56:59], v[112:115], v[208:211]
    ds_read_b128 v[68:71], v10 offset:2048
    v_mfma_f32_16x16x32_bf16 v[240:243], v[60:63], v[112:115], v[240:243]
    ds_read_b128 v[72:75], v10 offset:4096
    v_mfma_f32_16x16x32_bf16 v[28:31], v[60:63], v[20:23], v[28:31]
    ds_read_b128 v[76:79], v10 offset:6144
    v_mfma_f32_16x16x32_bf16 v[244:247], v[60:63], v[116:119], v[244:247]
    ds_read_b128 v[80:83], v10 offset:8192
    v_mfma_f32_16x16x32_bf16 v[212:215], v[56:59], v[116:119], v[212:215]
    ds_read_b128 v[84:87], v10 offset:10240
    v_mfma_f32_16x16x32_bf16 v[180:183], v[52:55], v[116:119], v[180:183]
    ds_read_b128 v[88:91], v10 offset:12288
    v_mfma_f32_16x16x32_bf16 v[148:151], v[48:51], v[116:119], v[148:151]
    ds_read_b128 v[92:95], v10 offset:14336
    v_mfma_f32_16x16x32_bf16 v[152:155], v[48:51], v[120:123], v[152:155]
    v_mfma_f32_16x16x32_bf16 v[184:187], v[52:55], v[120:123], v[184:187]
    v_mfma_f32_16x16x32_bf16 v[216:219], v[56:59], v[120:123], v[216:219]
    v_mfma_f32_16x16x32_bf16 v[248:251], v[60:63], v[120:123], v[248:251]
    v_mfma_f32_16x16x32_bf16 v[252:255], v[60:63], v[124:127], v[252:255]
    v_mfma_f32_16x16x32_bf16 v[220:223], v[56:59], v[124:127], v[220:223]
    v_mfma_f32_16x16x32_bf16 v[188:191], v[52:55], v[124:127], v[188:191]
    v_mfma_f32_16x16x32_bf16 v[156:159], v[48:51], v[124:127], v[156:159]
    s_waitcnt vmcnt(8) lgkmcnt(0)
    s_barrier
    v_mfma_f32_16x16x32_bf16 v[128:131], v[32:35], v[64:67], v[128:131]
    v_mfma_f32_16x16x32_bf16 v[160:163], v[36:39], v[64:67], v[160:163]
    v_mfma_f32_16x16x32_bf16 v[192:195], v[40:43], v[64:67], v[192:195]
    v_mfma_f32_16x16x32_bf16 v[224:227], v[44:47], v[64:67], v[224:227]
    v_mfma_f32_16x16x32_bf16 v[228:231], v[44:47], v[68:71], v[228:231]
    v_mfma_f32_16x16x32_bf16 v[196:199], v[40:43], v[68:71], v[196:199]
    v_mfma_f32_16x16x32_bf16 v[164:167], v[36:39], v[68:71], v[164:167]
    s_add_u32 m0, s23, 81920
    s_mov_b32 s20, 263552
    buffer_load_dwordx4 v2, s[12:15], s20 offen sc1 lds
    v_mfma_f32_16x16x32_bf16 v[132:135], v[32:35], v[68:71], v[132:135]
    buffer_load_dwordx4 v3, s[12:15], s20 offen offset:1024 sc1 lds
    v_mfma_f32_16x16x32_bf16 v[136:139], v[32:35], v[72:75], v[136:139]
    s_add_u32 m0, s24, 32768
    s_nop 0
    global_load_lds_dwordx4 v[4:5], off sc1
    s_add_u32 m0, s24, 34816
    v_lshl_add_u64 v[4:5], v[8:9], 0, v[4:5]
    v_mfma_f32_16x16x32_bf16 v[168:171], v[36:39], v[72:75], v[168:171]
    global_load_lds_dwordx4 v[6:7], off sc1
    v_lshl_add_u64 v[6:7], v[8:9], 0, v[6:7]
    v_mfma_f32_16x16x32_bf16 v[24:27], v[36:39], v[20:23], v[24:27]
    ds_read_b64_tr_b16 v[48:49], v12 offset:49152
    v_mfma_f32_16x16x32_bf16 v[200:203], v[40:43], v[72:75], v[200:203]
    ds_read_b64_tr_b16 v[50:51], v12 offset:53248
    v_mfma_f32_16x16x32_bf16 v[232:235], v[44:47], v[72:75], v[232:235]
    ds_read_b64_tr_b16 v[52:53], v13 offset:49152
    v_mfma_f32_16x16x32_bf16 v[236:239], v[44:47], v[76:79], v[236:239]
    ds_read_b64_tr_b16 v[54:55], v13 offset:53248
    v_mfma_f32_16x16x32_bf16 v[204:207], v[40:43], v[76:79], v[204:207]
    ds_read_b64_tr_b16 v[56:57], v12 offset:57344
    v_mfma_f32_16x16x32_bf16 v[172:175], v[36:39], v[76:79], v[172:175]
    ds_read_b64_tr_b16 v[58:59], v12 offset:61440
    v_mfma_f32_16x16x32_bf16 v[140:143], v[32:35], v[76:79], v[140:143]
    ds_read_b64_tr_b16 v[60:61], v13 offset:57344
    v_mfma_f32_16x16x32_bf16 v[144:147], v[32:35], v[80:83], v[144:147]
    ds_read_b64_tr_b16 v[62:63], v13 offset:61440
    v_mfma_f32_16x16x32_bf16 v[176:179], v[36:39], v[80:83], v[176:179]
    ds_read_b128 v[96:99], v11 offset:0
    v_mfma_f32_16x16x32_bf16 v[208:211], v[40:43], v[80:83], v[208:211]
    ds_read_b128 v[100:103], v11 offset:2048
    v_mfma_f32_16x16x32_bf16 v[240:243], v[44:47], v[80:83], v[240:243]
    ds_read_b128 v[104:107], v11 offset:4096
    v_mfma_f32_16x16x32_bf16 v[28:31], v[44:47], v[20:23], v[28:31]
    ds_read_b128 v[108:111], v11 offset:6144
    v_mfma_f32_16x16x32_bf16 v[244:247], v[44:47], v[84:87], v[244:247]
    ds_read_b128 v[112:115], v11 offset:8192
    v_mfma_f32_16x16x32_bf16 v[212:215], v[40:43], v[84:87], v[212:215]
    ds_read_b128 v[116:119], v11 offset:10240
    v_mfma_f32_16x16x32_bf16 v[180:183], v[36:39], v[84:87], v[180:183]
    ds_read_b128 v[120:123], v11 offset:12288
    v_mfma_f32_16x16x32_bf16 v[148:151], v[32:35], v[84:87], v[148:151]
    ds_read_b128 v[124:127], v11 offset:14336
    v_mfma_f32_16x16x32_bf16 v[152:155], v[32:35], v[88:91], v[152:155]
    v_mfma_f32_16x16x32_bf16 v[184:187], v[36:39], v[88:91], v[184:187]
    v_mfma_f32_16x16x32_bf16 v[216:219], v[40:43], v[88:91], v[216:219]
    v_mfma_f32_16x16x32_bf16 v[248:251], v[44:47], v[88:91], v[248:251]
    v_mfma_f32_16x16x32_bf16 v[252:255], v[44:47], v[92:95], v[252:255]
    v_mfma_f32_16x16x32_bf16 v[220:223], v[40:43], v[92:95], v[220:223]
    v_mfma_f32_16x16x32_bf16 v[188:191], v[36:39], v[92:95], v[188:191]
    v_mfma_f32_16x16x32_bf16 v[156:159], v[32:35], v[92:95], v[156:159]
    s_waitcnt vmcnt(8) lgkmcnt(0)
    s_barrier
    v_mfma_f32_16x16x32_bf16 v[128:131], v[48:51], v[96:99], v[128:131]
    v_mfma_f32_16x16x32_bf16 v[160:163], v[52:55], v[96:99], v[160:163]
    v_mfma_f32_16x16x32_bf16 v[192:195], v[56:59], v[96:99], v[192:195]
    v_mfma_f32_16x16x32_bf16 v[224:227], v[60:63], v[96:99], v[224:227]
    v_mfma_f32_16x16x32_bf16 v[228:231], v[60:63], v[100:103], v[228:231]
    v_mfma_f32_16x16x32_bf16 v[196:199], v[56:59], v[100:103], v[196:199]
    v_mfma_f32_16x16x32_bf16 v[164:167], v[52:55], v[100:103], v[164:167]
    s_add_u32 m0, s23, 0
    s_mov_b32 s20, 1536
    buffer_load_dwordx4 v2, s[12:15], s20 offen sc1 lds
    v_mfma_f32_16x16x32_bf16 v[132:135], v[48:51], v[100:103], v[132:135]
    buffer_load_dwordx4 v3, s[12:15], s20 offen offset:1024 sc1 lds
    v_mfma_f32_16x16x32_bf16 v[136:139], v[48:51], v[104:107], v[136:139]
    s_add_u32 m0, s24, 49152
    s_nop 0
    global_load_lds_dwordx4 v[4:5], off sc1
    s_add_u32 m0, s24, 51200
    v_lshl_add_u64 v[4:5], v[8:9], 0, v[4:5]
    v_mfma_f32_16x16x32_bf16 v[168:171], v[52:55], v[104:107], v[168:171]
    global_load_lds_dwordx4 v[6:7], off sc1
    v_lshl_add_u64 v[6:7], v[8:9], 0, v[6:7]
    v_mfma_f32_16x16x32_bf16 v[24:27], v[52:55], v[20:23], v[24:27]
    ds_read_b64_tr_b16 v[32:33], v12 offset:0
    v_mfma_f32_16x16x32_bf16 v[200:203], v[56:59], v[104:107], v[200:203]
    ds_read_b64_tr_b16 v[34:35], v12 offset:4096
    v_mfma_f32_16x16x32_bf16 v[232:235], v[60:63], v[104:107], v[232:235]
    ds_read_b64_tr_b16 v[36:37], v13 offset:0
    v_mfma_f32_16x16x32_bf16 v[236:239], v[60:63], v[108:111], v[236:239]
    ds_read_b64_tr_b16 v[38:39], v13 offset:4096
    v_mfma_f32_16x16x32_bf16 v[204:207], v[56:59], v[108:111], v[204:207]
    ds_read_b64_tr_b16 v[40:41], v12 offset:8192
    v_mfma_f32_16x16x32_bf16 v[172:175], v[52:55], v[108:111], v[172:175]
    ds_read_b64_tr_b16 v[42:43], v12 offset:12288
    v_mfma_f32_16x16x32_bf16 v[140:143], v[48:51], v[108:111], v[140:143]
    ds_read_b64_tr_b16 v[44:45], v13 offset:8192
    v_mfma_f32_16x16x32_bf16 v[144:147], v[48:51], v[112:115], v[144:147]
    ds_read_b64_tr_b16 v[46:47], v13 offset:12288
    v_mfma_f32_16x16x32_bf16 v[176:179], v[52:55], v[112:115], v[176:179]
    ds_read_b128 v[64:67], v10 offset:16384
    v_mfma_f32_16x16x32_bf16 v[208:211], v[56:59], v[112:115], v[208:211]
    ds_read_b128 v[68:71], v10 offset:18432
    v_mfma_f32_16x16x32_bf16 v[240:243], v[60:63], v[112:115], v[240:243]
    ds_read_b128 v[72:75], v10 offset:20480
    v_mfma_f32_16x16x32_bf16 v[28:31], v[60:63], v[20:23], v[28:31]
    ds_read_b128 v[76:79], v10 offset:22528
    v_mfma_f32_16x16x32_bf16 v[244:247], v[60:63], v[116:119], v[244:247]
    ds_read_b128 v[80:83], v10 offset:24576
    v_mfma_f32_16x16x32_bf16 v[212:215], v[56:59], v[116:119], v[212:215]
    ds_read_b128 v[84:87], v10 offset:26624
    v_mfma_f32_16x16x32_bf16 v[180:183], v[52:55], v[116:119], v[180:183]
    ds_read_b128 v[88:91], v10 offset:28672
    v_mfma_f32_16x16x32_bf16 v[148:151], v[48:51], v[116:119], v[148:151]
    ds_read_b128 v[92:95], v10 offset:30720
    v_mfma_f32_16x16x32_bf16 v[152:155], v[48:51], v[120:123], v[152:155]
    v_mfma_f32_16x16x32_bf16 v[184:187], v[52:55], v[120:123], v[184:187]
    v_mfma_f32_16x16x32_bf16 v[216:219], v[56:59], v[120:123], v[216:219]
    v_mfma_f32_16x16x32_bf16 v[248:251], v[60:63], v[120:123], v[248:251]
    v_mfma_f32_16x16x32_bf16 v[252:255], v[60:63], v[124:127], v[252:255]
    v_mfma_f32_16x16x32_bf16 v[220:223], v[56:59], v[124:127], v[220:223]
    v_mfma_f32_16x16x32_bf16 v[188:191], v[52:55], v[124:127], v[188:191]
    v_mfma_f32_16x16x32_bf16 v[156:159], v[48:51], v[124:127], v[156:159]
    s_waitcnt vmcnt(8) lgkmcnt(0)
    s_barrier
    v_mfma_f32_16x16x32_bf16 v[128:131], v[32:35], v[64:67], v[128:131]
    v_mfma_f32_16x16x32_bf16 v[160:163], v[36:39], v[64:67], v[160:163]
    v_mfma_f32_16x16x32_bf16 v[192:195], v[40:43], v[64:67], v[192:195]
    v_mfma_f32_16x16x32_bf16 v[224:227], v[44:47], v[64:67], v[224:227]
    v_mfma_f32_16x16x32_bf16 v[228:231], v[44:47], v[68:71], v[228:231]
    v_mfma_f32_16x16x32_bf16 v[196:199], v[40:43], v[68:71], v[196:199]
    v_mfma_f32_16x16x32_bf16 v[164:167], v[36:39], v[68:71], v[164:167]
    s_add_u32 m0, s23, 49152
    s_mov_b32 s20, 263680
    buffer_load_dwordx4 v2, s[12:15], s20 offen sc1 lds
    v_mfma_f32_16x16x32_bf16 v[132:135], v[32:35], v[68:71], v[132:135]
    buffer_load_dwordx4 v3, s[12:15], s20 offen offset:1024 sc1 lds
    v_mfma_f32_16x16x32_bf16 v[136:139], v[32:35], v[72:75], v[136:139]
    s_add_u32 m0, s24, 0
    s_nop 0
    global_load_lds_dwordx4 v[4:5], off sc1
    s_add_u32 m0, s24, 2048
    v_lshl_add_u64 v[4:5], v[8:9], 0, v[4:5]
    v_mfma_f32_16x16x32_bf16 v[168:171], v[36:39], v[72:75], v[168:171]
    global_load_lds_dwordx4 v[6:7], off sc1
    v_lshl_add_u64 v[6:7], v[8:9], 0, v[6:7]
    v_mfma_f32_16x16x32_bf16 v[24:27], v[36:39], v[20:23], v[24:27]
    ds_read_b64_tr_b16 v[48:49], v12 offset:16384
    v_mfma_f32_16x16x32_bf16 v[200:203], v[40:43], v[72:75], v[200:203]
    ds_read_b64_tr_b16 v[50:51], v12 offset:20480
    v_mfma_f32_16x16x32_bf16 v[232:235], v[44:47], v[72:75], v[232:235]
    ds_read_b64_tr_b16 v[52:53], v13 offset:16384
    v_mfma_f32_16x16x32_bf16 v[236:239], v[44:47], v[76:79], v[236:239]
    ds_read_b64_tr_b16 v[54:55], v13 offset:20480
    v_mfma_f32_16x16x32_bf16 v[204:207], v[40:43], v[76:79], v[204:207]
    ds_read_b64_tr_b16 v[56:57], v12 offset:24576
    v_mfma_f32_16x16x32_bf16 v[172:175], v[36:39], v[76:79], v[172:175]
    ds_read_b64_tr_b16 v[58:59], v12 offset:28672
    v_mfma_f32_16x16x32_bf16 v[140:143], v[32:35], v[76:79], v[140:143]
    ds_read_b64_tr_b16 v[60:61], v13 offset:24576
    v_mfma_f32_16x16x32_bf16 v[144:147], v[32:35], v[80:83], v[144:147]
    ds_read_b64_tr_b16 v[62:63], v13 offset:28672
    v_mfma_f32_16x16x32_bf16 v[176:179], v[36:39], v[80:83], v[176:179]
    ds_read_b128 v[96:99], v11 offset:16384
    v_mfma_f32_16x16x32_bf16 v[208:211], v[40:43], v[80:83], v[208:211]
    ds_read_b128 v[100:103], v11 offset:18432
    v_mfma_f32_16x16x32_bf16 v[240:243], v[44:47], v[80:83], v[240:243]
    ds_read_b128 v[104:107], v11 offset:20480
    v_mfma_f32_16x16x32_bf16 v[28:31], v[44:47], v[20:23], v[28:31]
    ds_read_b128 v[108:111], v11 offset:22528
    v_mfma_f32_16x16x32_bf16 v[244:247], v[44:47], v[84:87], v[244:247]
    ds_read_b128 v[112:115], v11 offset:24576
    v_mfma_f32_16x16x32_bf16 v[212:215], v[40:43], v[84:87], v[212:215]
    ds_read_b128 v[116:119], v11 offset:26624
    v_mfma_f32_16x16x32_bf16 v[180:183], v[36:39], v[84:87], v[180:183]
    ds_read_b128 v[120:123], v11 offset:28672
    v_mfma_f32_16x16x32_bf16 v[148:151], v[32:35], v[84:87], v[148:151]
    ds_read_b128 v[124:127], v11 offset:30720
    v_mfma_f32_16x16x32_bf16 v[152:155], v[32:35], v[88:91], v[152:155]
    v_mfma_f32_16x16x32_bf16 v[184:187], v[36:39], v[88:91], v[184:187]
    v_mfma_f32_16x16x32_bf16 v[216:219], v[40:43], v[88:91], v[216:219]
    v_mfma_f32_16x16x32_bf16 v[248:251], v[44:47], v[88:91], v[248:251]
    v_mfma_f32_16x16x32_bf16 v[252:255], v[44:47], v[92:95], v[252:255]
    v_mfma_f32_16x16x32_bf16 v[220:223], v[40:43], v[92:95], v[220:223]
    v_mfma_f32_16x16x32_bf16 v[188:191], v[36:39], v[92:95], v[188:191]
    v_mfma_f32_16x16x32_bf16 v[156:159], v[32:35], v[92:95], v[156:159]
    s_waitcnt vmcnt(8) lgkmcnt(0)
    s_barrier
    v_mfma_f32_16x16x32_bf16 v[128:131], v[48:51], v[96:99], v[128:131]
    v_mfma_f32_16x16x32_bf16 v[160:163], v[52:55], v[96:99], v[160:163]
    v_mfma_f32_16x16x32_bf16 v[192:195], v[56:59], v[96:99], v[192:195]
    v_mfma_f32_16x16x32_bf16 v[224:227], v[60:63], v[96:99], v[224:227]
    v_mfma_f32_16x16x32_bf16 v[228:231], v[60:63], v[100:103], v[228:231]
    v_mfma_f32_16x16x32_bf16 v[196:199], v[56:59], v[100:103], v[196:199]
    v_mfma_f32_16x16x32_bf16 v[164:167], v[52:55], v[100:103], v[164:167]
    s_add_u32 m0, s23, 16384
    s_mov_b32 s20, 1664
    buffer_load_dwordx4 v2, s[12:15], s20 offen sc1 lds
    v_mfma_f32_16x16x32_bf16 v[132:135], v[48:51], v[100:103], v[132:135]
    buffer_load_dwordx4 v3, s[12:15], s20 offen offset:1024 sc1 lds
    v_mfma_f32_16x16x32_bf16 v[136:139], v[48:51], v[104:107], v[136:139]
    s_add_u32 m0, s24, 16384
    s_nop 0
    global_load_lds_dwordx4 v[4:5], off sc1
    s_add_u32 m0, s24, 18432
    v_lshl_add_u64 v[4:5], v[8:9], 0, v[4:5]
    v_mfma_f32_16x16x32_bf16 v[168:171], v[52:55], v[104:107], v[168:171]
    global_load_lds_dwordx4 v[6:7], off sc1
    v_lshl_add_u64 v[6:7], v[8:9], 0, v[6:7]
    v_mfma_f32_16x16x32_bf16 v[24:27], v[52:55], v[20:23], v[24:27]
    ds_read_b64_tr_b16 v[32:33], v12 offset:32768
    v_mfma_f32_16x16x32_bf16 v[200:203], v[56:59], v[104:107], v[200:203]
    ds_read_b64_tr_b16 v[34:35], v12 offset:36864
    v_mfma_f32_16x16x32_bf16 v[232:235], v[60:63], v[104:107], v[232:235]
    ds_read_b64_tr_b16 v[36:37], v13 offset:32768
    v_mfma_f32_16x16x32_bf16 v[236:239], v[60:63], v[108:111], v[236:239]
    ds_read_b64_tr_b16 v[38:39], v13 offset:36864
    v_mfma_f32_16x16x32_bf16 v[204:207], v[56:59], v[108:111], v[204:207]
    ds_read_b64_tr_b16 v[40:41], v12 offset:40960
    v_mfma_f32_16x16x32_bf16 v[172:175], v[52:55], v[108:111], v[172:175]
    ds_read_b64_tr_b16 v[42:43], v12 offset:45056
    v_mfma_f32_16x16x32_bf16 v[140:143], v[48:51], v[108:111], v[140:143]
    ds_read_b64_tr_b16 v[44:45], v13 offset:40960
    v_mfma_f32_16x16x32_bf16 v[144:147], v[48:51], v[112:115], v[144:147]
    ds_read_b64_tr_b16 v[46:47], v13 offset:45056
    v_mfma_f32_16x16x32_bf16 v[176:179], v[52:55], v[112:115], v[176:179]
    ds_read_b128 v[64:67], v10 offset:32768
    v_mfma_f32_16x16x32_bf16 v[208:211], v[56:59], v[112:115], v[208:211]
    ds_read_b128 v[68:71], v10 offset:34816
    v_mfma_f32_16x16x32_bf16 v[240:243], v[60:63], v[112:115], v[240:243]
    ds_read_b128 v[72:75], v10 offset:36864
    v_mfma_f32_16x16x32_bf16 v[28:31], v[60:63], v[20:23], v[28:31]
    ds_read_b128 v[76:79], v10 offset:38912
    v_mfma_f32_16x16x32_bf16 v[244:247], v[60:63], v[116:119], v[244:247]
    ds_read_b128 v[80:83], v10 offset:40960
    v_mfma_f32_16x16x32_bf16 v[212:215], v[56:59], v[116:119], v[212:215]
    ds_read_b128 v[84:87], v10 offset:43008
    v_mfma_f32_16x16x32_bf16 v[180:183], v[52:55], v[116:119], v[180:183]
    ds_read_b128 v[88:91], v10 offset:45056
    v_mfma_f32_16x16x32_bf16 v[148:151], v[48:51], v[116:119], v[148:151]
    ds_read_b128 v[92:95], v10 offset:47104
    v_mfma_f32_16x16x32_bf16 v[152:155], v[48:51], v[120:123], v[152:155]
    v_mfma_f32_16x16x32_bf16 v[184:187], v[52:55], v[120:123], v[184:187]
    v_mfma_f32_16x16x32_bf16 v[216:219], v[56:59], v[120:123], v[216:219]
    v_mfma_f32_16x16x32_bf16 v[248:251], v[60:63], v[120:123], v[248:251]
    v_mfma_f32_16x16x32_bf16 v[252:255], v[60:63], v[124:127], v[252:255]
    v_mfma_f32_16x16x32_bf16 v[220:223], v[56:59], v[124:127], v[220:223]
    v_mfma_f32_16x16x32_bf16 v[188:191], v[52:55], v[124:127], v[188:191]
    v_mfma_f32_16x16x32_bf16 v[156:159], v[48:51], v[124:127], v[156:159]
    s_waitcnt vmcnt(8) lgkmcnt(0)
    s_barrier
    v_mfma_f32_16x16x32_bf16 v[128:131], v[32:35], v[64:67], v[128:131]
    v_mfma_f32_16x16x32_bf16 v[160:163], v[36:39], v[64:67], v[160:163]
    v_mfma_f32_16x16x32_bf16 v[192:195], v[40:43], v[64:67], v[192:195]
    v_mfma_f32_16x16x32_bf16 v[224:227], v[44:47], v[64:67], v[224:227]
    v_mfma_f32_16x16x32_bf16 v[228:231], v[44:47], v[68:71], v[228:231]
    v_mfma_f32_16x16x32_bf16 v[196:199], v[40:43], v[68:71], v[196:199]
    v_mfma_f32_16x16x32_bf16 v[164:167], v[36:39], v[68:71], v[164:167]
    s_add_u32 m0, s23, 65536
    s_mov_b32 s20, 263808
    buffer_load_dwordx4 v2, s[12:15], s20 offen sc1 lds
    v_mfma_f32_16x16x32_bf16 v[132:135], v[32:35], v[68:71], v[132:135]
    buffer_load_dwordx4 v3, s[12:15], s20 offen offset:1024 sc1 lds
    v_mfma_f32_16x16x32_bf16 v[136:139], v[32:35], v[72:75], v[136:139]
    s_add_u32 m0, s24, 32768
    s_nop 0
    global_load_lds_dwordx4 v[4:5], off sc1
    s_add_u32 m0, s24, 34816
    v_lshl_add_u64 v[4:5], v[8:9], 0, v[4:5]
    v_mfma_f32_16x16x32_bf16 v[168:171], v[36:39], v[72:75], v[168:171]
    global_load_lds_dwordx4 v[6:7], off sc1
    v_lshl_add_u64 v[6:7], v[8:9], 0, v[6:7]
    v_mfma_f32_16x16x32_bf16 v[24:27], v[36:39], v[20:23], v[24:27]
    ds_read_b64_tr_b16 v[48:49], v12 offset:49152
    v_mfma_f32_16x16x32_bf16 v[200:203], v[40:43], v[72:75], v[200:203]
    ds_read_b64_tr_b16 v[50:51], v12 offset:53248
    v_mfma_f32_16x16x32_bf16 v[232:235], v[44:47], v[72:75], v[232:235]
    ds_read_b64_tr_b16 v[52:53], v13 offset:49152
    v_mfma_f32_16x16x32_bf16 v[236:239], v[44:47], v[76:79], v[236:239]
    ds_read_b64_tr_b16 v[54:55], v13 offset:53248
    v_mfma_f32_16x16x32_bf16 v[204:207], v[40:43], v[76:79], v[204:207]
    ds_read_b64_tr_b16 v[56:57], v12 offset:57344
    v_mfma_f32_16x16x32_bf16 v[172:175], v[36:39], v[76:79], v[172:175]
    ds_read_b64_tr_b16 v[58:59], v12 offset:61440
    v_mfma_f32_16x16x32_bf16 v[140:143], v[32:35], v[76:79], v[140:143]
    ds_read_b64_tr_b16 v[60:61], v13 offset:57344
    v_mfma_f32_16x16x32_bf16 v[144:147], v[32:35], v[80:83], v[144:147]
    ds_read_b64_tr_b16 v[62:63], v13 offset:61440
    v_mfma_f32_16x16x32_bf16 v[176:179], v[36:39], v[80:83], v[176:179]
    ds_read_b128 v[96:99], v11 offset:32768
    v_mfma_f32_16x16x32_bf16 v[208:211], v[40:43], v[80:83], v[208:211]
    ds_read_b128 v[100:103], v11 offset:34816
    v_mfma_f32_16x16x32_bf16 v[240:243], v[44:47], v[80:83], v[240:243]
    ds_read_b128 v[104:107], v11 offset:36864
    v_mfma_f32_16x16x32_bf16 v[28:31], v[44:47], v[20:23], v[28:31]
    ds_read_b128 v[108:111], v11 offset:38912
    v_mfma_f32_16x16x32_bf16 v[244:247], v[44:47], v[84:87], v[244:247]
    ds_read_b128 v[112:115], v11 offset:40960
    v_mfma_f32_16x16x32_bf16 v[212:215], v[40:43], v[84:87], v[212:215]
    ds_read_b128 v[116:119], v11 offset:43008
    v_mfma_f32_16x16x32_bf16 v[180:183], v[36:39], v[84:87], v[180:183]
    ds_read_b128 v[120:123], v11 offset:45056
    v_mfma_f32_16x16x32_bf16 v[148:151], v[32:35], v[84:87], v[148:151]
    ds_read_b128 v[124:127], v11 offset:47104
    v_mfma_f32_16x16x32_bf16 v[152:155], v[32:35], v[88:91], v[152:155]
    v_mfma_f32_16x16x32_bf16 v[184:187], v[36:39], v[88:91], v[184:187]
    v_mfma_f32_16x16x32_bf16 v[216:219], v[40:43], v[88:91], v[216:219]
    v_mfma_f32_16x16x32_bf16 v[248:251], v[44:47], v[88:91], v[248:251]
    v_mfma_f32_16x16x32_bf16 v[252:255], v[44:47], v[92:95], v[252:255]
    v_mfma_f32_16x16x32_bf16 v[220:223], v[40:43], v[92:95], v[220:223]
    v_mfma_f32_16x16x32_bf16 v[188:191], v[36:39], v[92:95], v[188:191]
    v_mfma_f32_16x16x32_bf16 v[156:159], v[32:35], v[92:95], v[156:159]
    s_waitcnt vmcnt(8) lgkmcnt(0)
    s_barrier
    v_mfma_f32_16x16x32_bf16 v[128:131], v[48:51], v[96:99], v[128:131]
    v_mfma_f32_16x16x32_bf16 v[160:163], v[52:55], v[96:99], v[160:163]
    v_mfma_f32_16x16x32_bf16 v[192:195], v[56:59], v[96:99], v[192:195]
    v_mfma_f32_16x16x32_bf16 v[224:227], v[60:63], v[96:99], v[224:227]
    v_mfma_f32_16x16x32_bf16 v[228:231], v[60:63], v[100:103], v[228:231]
    v_mfma_f32_16x16x32_bf16 v[196:199], v[56:59], v[100:103], v[196:199]
    v_mfma_f32_16x16x32_bf16 v[164:167], v[52:55], v[100:103], v[164:167]
    s_add_u32 m0, s23, 32768
    s_mov_b32 s20, 1792
    buffer_load_dwordx4 v2, s[12:15], s20 offen sc1 lds
    v_mfma_f32_16x16x32_bf16 v[132:135], v[48:51], v[100:103], v[132:135]
    buffer_load_dwordx4 v3, s[12:15], s20 offen offset:1024 sc1 lds
    v_mfma_f32_16x16x32_bf16 v[136:139], v[48:51], v[104:107], v[136:139]
    s_add_u32 m0, s24, 49152
    s_nop 0
    global_load_lds_dwordx4 v[4:5], off sc1
    s_add_u32 m0, s24, 51200
    v_lshl_add_u64 v[4:5], v[8:9], 0, v[4:5]
    v_mfma_f32_16x16x32_bf16 v[168:171], v[52:55], v[104:107], v[168:171]
    global_load_lds_dwordx4 v[6:7], off sc1
    v_lshl_add_u64 v[6:7], v[8:9], 0, v[6:7]
    v_mfma_f32_16x16x32_bf16 v[24:27], v[52:55], v[20:23], v[24:27]
    ds_read_b64_tr_b16 v[32:33], v12 offset:0
    v_mfma_f32_16x16x32_bf16 v[200:203], v[56:59], v[104:107], v[200:203]
    ds_read_b64_tr_b16 v[34:35], v12 offset:4096
    v_mfma_f32_16x16x32_bf16 v[232:235], v[60:63], v[104:107], v[232:235]
    ds_read_b64_tr_b16 v[36:37], v13 offset:0
    v_mfma_f32_16x16x32_bf16 v[236:239], v[60:63], v[108:111], v[236:239]
    ds_read_b64_tr_b16 v[38:39], v13 offset:4096
    v_mfma_f32_16x16x32_bf16 v[204:207], v[56:59], v[108:111], v[204:207]
    ds_read_b64_tr_b16 v[40:41], v12 offset:8192
    v_mfma_f32_16x16x32_bf16 v[172:175], v[52:55], v[108:111], v[172:175]
    ds_read_b64_tr_b16 v[42:43], v12 offset:12288
    v_mfma_f32_16x16x32_bf16 v[140:143], v[48:51], v[108:111], v[140:143]
    ds_read_b64_tr_b16 v[44:45], v13 offset:8192
    v_mfma_f32_16x16x32_bf16 v[144:147], v[48:51], v[112:115], v[144:147]
    ds_read_b64_tr_b16 v[46:47], v13 offset:12288
    v_mfma_f32_16x16x32_bf16 v[176:179], v[52:55], v[112:115], v[176:179]
    ds_read_b128 v[64:67], v10 offset:0
    v_mfma_f32_16x16x32_bf16 v[208:211], v[56:59], v[112:115], v[208:211]
    ds_read_b128 v[68:71], v10 offset:2048
    v_mfma_f32_16x16x32_bf16 v[240:243], v[60:63], v[112:115], v[240:243]
    ds_read_b128 v[72:75], v10 offset:4096
    v_mfma_f32_16x16x32_bf16 v[28:31], v[60:63], v[20:23], v[28:31]
    ds_read_b128 v[76:79], v10 offset:6144
    v_mfma_f32_16x16x32_bf16 v[244:247], v[60:63], v[116:119], v[244:247]
    ds_read_b128 v[80:83], v10 offset:8192
    v_mfma_f32_16x16x32_bf16 v[212:215], v[56:59], v[116:119], v[212:215]
    ds_read_b128 v[84:87], v10 offset:10240
    v_mfma_f32_16x16x32_bf16 v[180:183], v[52:55], v[116:119], v[180:183]
    ds_read_b128 v[88:91], v10 offset:12288
    v_mfma_f32_16x16x32_bf16 v[148:151], v[48:51], v[116:119], v[148:151]
    ds_read_b128 v[92:95], v10 offset:14336
    v_mfma_f32_16x16x32_bf16 v[152:155], v[48:51], v[120:123], v[152:155]
    v_mfma_f32_16x16x32_bf16 v[184:187], v[52:55], v[120:123], v[184:187]
    v_mfma_f32_16x16x32_bf16 v[216:219], v[56:59], v[120:123], v[216:219]
    v_mfma_f32_16x16x32_bf16 v[248:251], v[60:63], v[120:123], v[248:251]
    v_mfma_f32_16x16x32_bf16 v[252:255], v[60:63], v[124:127], v[252:255]
    v_mfma_f32_16x16x32_bf16 v[220:223], v[56:59], v[124:127], v[220:223]
    v_mfma_f32_16x16x32_bf16 v[188:191], v[52:55], v[124:127], v[188:191]
    v_mfma_f32_16x16x32_bf16 v[156:159], v[48:51], v[124:127], v[156:159]
    s_waitcnt vmcnt(8) lgkmcnt(0)
    s_barrier
    v_mfma_f32_16x16x32_bf16 v[128:131], v[32:35], v[64:67], v[128:131]
    v_mfma_f32_16x16x32_bf16 v[160:163], v[36:39], v[64:67], v[160:163]
    v_mfma_f32_16x16x32_bf16 v[192:195], v[40:43], v[64:67], v[192:195]
    v_mfma_f32_16x16x32_bf16 v[224:227], v[44:47], v[64:67], v[224:227]
    v_mfma_f32_16x16x32_bf16 v[228:231], v[44:47], v[68:71], v[228:231]
    v_mfma_f32_16x16x32_bf16 v[196:199], v[40:43], v[68:71], v[196:199]
    v_mfma_f32_16x16x32_bf16 v[164:167], v[36:39], v[68:71], v[164:167]
    s_add_u32 m0, s23, 81920
    s_mov_b32 s20, 263936
    buffer_load_dwordx4 v2, s[12:15], s20 offen sc1 lds
    v_mfma_f32_16x16x32_bf16 v[132:135], v[32:35], v[68:71], v[132:135]
    buffer_load_dwordx4 v3, s[12:15], s20 offen offset:1024 sc1 lds
    v_mfma_f32_16x16x32_bf16 v[136:139], v[32:35], v[72:75], v[136:139]
    s_add_u32 m0, s24, 0
    s_nop 0
    global_load_lds_dwordx4 v[4:5], off sc1
    s_add_u32 m0, s24, 2048
    v_lshl_add_u64 v[4:5], v[8:9], 0, v[4:5]
    v_mfma_f32_16x16x32_bf16 v[168:171], v[36:39], v[72:75], v[168:171]
    global_load_lds_dwordx4 v[6:7], off sc1
    v_lshl_add_u64 v[6:7], v[8:9], 0, v[6:7]
    v_mfma_f32_16x16x32_bf16 v[24:27], v[36:39], v[20:23], v[24:27]
    ds_read_b64_tr_b16 v[48:49], v12 offset:16384
    v_mfma_f32_16x16x32_bf16 v[200:203], v[40:43], v[72:75], v[200:203]
    ds_read_b64_tr_b16 v[50:51], v12 offset:20480
    v_mfma_f32_16x16x32_bf16 v[232:235], v[44:47], v[72:75], v[232:235]
    ds_read_b64_tr_b16 v[52:53], v13 offset:16384
    v_mfma_f32_16x16x32_bf16 v[236:239], v[44:47], v[76:79], v[236:239]
    ds_read_b64_tr_b16 v[54:55], v13 offset:20480
    v_mfma_f32_16x16x32_bf16 v[204:207], v[40:43], v[76:79], v[204:207]
    ds_read_b64_tr_b16 v[56:57], v12 offset:24576
    v_mfma_f32_16x16x32_bf16 v[172:175], v[36:39], v[76:79], v[172:175]
    ds_read_b64_tr_b16 v[58:59], v12 offset:28672
    v_mfma_f32_16x16x32_bf16 v[140:143], v[32:35], v[76:79], v[140:143]
    ds_read_b64_tr_b16 v[60:61], v13 offset:24576
    v_mfma_f32_16x16x32_bf16 v[144:147], v[32:35], v[80:83], v[144:147]
    ds_read_b64_tr_b16 v[62:63], v13 offset:28672
    v_mfma_f32_16x16x32_bf16 v[176:179], v[36:39], v[80:83], v[176:179]
    ds_read_b128 v[96:99], v11 offset:0
    v_mfma_f32_16x16x32_bf16 v[208:211], v[40:43], v[80:83], v[208:211]
    ds_read_b128 v[100:103], v11 offset:2048
    v_mfma_f32_16x16x32_bf16 v[240:243], v[44:47], v[80:83], v[240:243]
    ds_read_b128 v[104:107], v11 offset:4096
    v_mfma_f32_16x16x32_bf16 v[28:31], v[44:47], v[20:23], v[28:31]
    ds_read_b128 v[108:111], v11 offset:6144
    v_mfma_f32_16x16x32_bf16 v[244:247], v[44:47], v[84:87], v[244:247]
    ds_read_b128 v[112:115], v11 offset:8192
    v_mfma_f32_16x16x32_bf16 v[212:215], v[40:43], v[84:87], v[212:215]
    ds_read_b128 v[116:119], v11 offset:10240
    v_mfma_f32_16x16x32_bf16 v[180:183], v[36:39], v[84:87], v[180:183]
    ds_read_b128 v[120:123], v11 offset:12288
    v_mfma_f32_16x16x32_bf16 v[148:151], v[32:35], v[84:87], v[148:151]
    ds_read_b128 v[124:127], v11 offset:14336
    v_mfma_f32_16x16x32_bf16 v[152:155], v[32:35], v[88:91], v[152:155]
    v_mfma_f32_16x16x32_bf16 v[184:187], v[36:39], v[88:91], v[184:187]
    v_mfma_f32_16x16x32_bf16 v[216:219], v[40:43], v[88:91], v[216:219]
    v_mfma_f32_16x16x32_bf16 v[248:251], v[44:47], v[88:91], v[248:251]
    v_mfma_f32_16x16x32_bf16 v[252:255], v[44:47], v[92:95], v[252:255]
    v_mfma_f32_16x16x32_bf16 v[220:223], v[40:43], v[92:95], v[220:223]
    v_mfma_f32_16x16x32_bf16 v[188:191], v[36:39], v[92:95], v[188:191]
    v_mfma_f32_16x16x32_bf16 v[156:159], v[32:35], v[92:95], v[156:159]
    s_waitcnt vmcnt(8) lgkmcnt(0)
    s_barrier
    v_mfma_f32_16x16x32_bf16 v[128:131], v[48:51], v[96:99], v[128:131]
    v_mfma_f32_16x16x32_bf16 v[160:163], v[52:55], v[96:99], v[160:163]
    v_mfma_f32_16x16x32_bf16 v[192:195], v[56:59], v[96:99], v[192:195]
    v_mfma_f32_16x16x32_bf16 v[224:227], v[60:63], v[96:99], v[224:227]
    v_mfma_f32_16x16x32_bf16 v[228:231], v[60:63], v[100:103], v[228:231]
    v_mfma_f32_16x16x32_bf16 v[196:199], v[56:59], v[100:103], v[196:199]
    v_mfma_f32_16x16x32_bf16 v[164:167], v[52:55], v[100:103], v[164:167]
    s_add_u32 m0, s23, 0
    s_mov_b32 s20, 1920
    buffer_load_dwordx4 v2, s[12:15], s20 offen sc1 lds
    v_mfma_f32_16x16x32_bf16 v[132:135], v[48:51], v[100:103], v[132:135]
    buffer_load_dwordx4 v3, s[12:15], s20 offen offset:1024 sc1 lds
    v_mfma_f32_16x16x32_bf16 v[136:139], v[48:51], v[104:107], v[136:139]
    s_add_u32 m0, s24, 16384
    s_nop 0
    global_load_lds_dwordx4 v[4:5], off sc1
    s_add_u32 m0, s24, 18432
    v_lshl_add_u64 v[4:5], v[8:9], 0, v[4:5]
    v_mfma_f32_16x16x32_bf16 v[168:171], v[52:55], v[104:107], v[168:171]
    global_load_lds_dwordx4 v[6:7], off sc1
    v_lshl_add_u64 v[6:7], v[8:9], 0, v[6:7]
    v_mfma_f32_16x16x32_bf16 v[24:27], v[52:55], v[20:23], v[24:27]
    ds_read_b64_tr_b16 v[32:33], v12 offset:32768
    v_mfma_f32_16x16x32_bf16 v[200:203], v[56:59], v[104:107], v[200:203]
    ds_read_b64_tr_b16 v[34:35], v12 offset:36864
    v_mfma_f32_16x16x32_bf16 v[232:235], v[60:63], v[104:107], v[232:235]
    ds_read_b64_tr_b16 v[36:37], v13 offset:32768
    v_mfma_f32_16x16x32_bf16 v[236:239], v[60:63], v[108:111], v[236:239]
    ds_read_b64_tr_b16 v[38:39], v13 offset:36864
    v_mfma_f32_16x16x32_bf16 v[204:207], v[56:59], v[108:111], v[204:207]
    ds_read_b64_tr_b16 v[40:41], v12 offset:40960
    v_mfma_f32_16x16x32_bf16 v[172:175], v[52:55], v[108:111], v[172:175]
    ds_read_b64_tr_b16 v[42:43], v12 offset:45056
    v_mfma_f32_16x16x32_bf16 v[140:143], v[48:51], v[108:111], v[140:143]
    ds_read_b64_tr_b16 v[44:45], v13 offset:40960
    v_mfma_f32_16x16x32_bf16 v[144:147], v[48:51], v[112:115], v[144:147]
    ds_read_b64_tr_b16 v[46:47], v13 offset:45056
    v_mfma_f32_16x16x32_bf16 v[176:179], v[52:55], v[112:115], v[176:179]
    ds_read_b128 v[64:67], v10 offset:16384
    v_mfma_f32_16x16x32_bf16 v[208:211], v[56:59], v[112:115], v[208:211]
    ds_read_b128 v[68:71], v10 offset:18432
    v_mfma_f32_16x16x32_bf16 v[240:243], v[60:63], v[112:115], v[240:243]
    ds_read_b128 v[72:75], v10 offset:20480
    v_mfma_f32_16x16x32_bf16 v[28:31], v[60:63], v[20:23], v[28:31]
    ds_read_b128 v[76:79], v10 offset:22528
    v_mfma_f32_16x16x32_bf16 v[244:247], v[60:63], v[116:119], v[244:247]
    ds_read_b128 v[80:83], v10 offset:24576
    v_mfma_f32_16x16x32_bf16 v[212:215], v[56:59], v[116:119], v[212:215]
    ds_read_b128 v[84:87], v10 offset:26624
    v_mfma_f32_16x16x32_bf16 v[180:183], v[52:55], v[116:119], v[180:183]
    ds_read_b128 v[88:91], v10 offset:28672
    v_mfma_f32_16x16x32_bf16 v[148:151], v[48:51], v[116:119], v[148:151]
    ds_read_b128 v[92:95], v10 offset:30720
    v_mfma_f32_16x16x32_bf16 v[152:155], v[48:51], v[120:123], v[152:155]
    v_mfma_f32_16x16x32_bf16 v[184:187], v[52:55], v[120:123], v[184:187]
    v_mfma_f32_16x16x32_bf16 v[216:219], v[56:59], v[120:123], v[216:219]
    v_mfma_f32_16x16x32_bf16 v[248:251], v[60:63], v[120:123], v[248:251]
    v_mfma_f32_16x16x32_bf16 v[252:255], v[60:63], v[124:127], v[252:255]
    v_mfma_f32_16x16x32_bf16 v[220:223], v[56:59], v[124:127], v[220:223]
    v_mfma_f32_16x16x32_bf16 v[188:191], v[52:55], v[124:127], v[188:191]
    v_mfma_f32_16x16x32_bf16 v[156:159], v[48:51], v[124:127], v[156:159]
    s_waitcnt vmcnt(8) lgkmcnt(0)
    s_barrier
    v_mfma_f32_16x16x32_bf16 v[128:131], v[32:35], v[64:67], v[128:131]
    v_mfma_f32_16x16x32_bf16 v[160:163], v[36:39], v[64:67], v[160:163]
    v_mfma_f32_16x16x32_bf16 v[192:195], v[40:43], v[64:67], v[192:195]
    v_mfma_f32_16x16x32_bf16 v[224:227], v[44:47], v[64:67], v[224:227]
    v_mfma_f32_16x16x32_bf16 v[228:231], v[44:47], v[68:71], v[228:231]
    v_mfma_f32_16x16x32_bf16 v[196:199], v[40:43], v[68:71], v[196:199]
    v_mfma_f32_16x16x32_bf16 v[164:167], v[36:39], v[68:71], v[164:167]
    s_add_u32 m0, s23, 49152
    s_mov_b32 s20, 264064
    buffer_load_dwordx4 v2, s[12:15], s20 offen sc1 lds
    v_mfma_f32_16x16x32_bf16 v[132:135], v[32:35], v[68:71], v[132:135]
    buffer_load_dwordx4 v3, s[12:15], s20 offen offset:1024 sc1 lds
    v_mfma_f32_16x16x32_bf16 v[136:139], v[32:35], v[72:75], v[136:139]
    s_add_u32 m0, s24, 32768
    s_nop 0
    global_load_lds_dwordx4 v[4:5], off sc1
    s_add_u32 m0, s24, 34816
    v_lshl_add_u64 v[4:5], v[8:9], 0, v[4:5]
    v_mfma_f32_16x16x32_bf16 v[168:171], v[36:39], v[72:75], v[168:171]
    global_load_lds_dwordx4 v[6:7], off sc1
    v_lshl_add_u64 v[6:7], v[8:9], 0, v[6:7]
    v_mfma_f32_16x16x32_bf16 v[24:27], v[36:39], v[20:23], v[24:27]
    ds_read_b64_tr_b16 v[48:49], v12 offset:49152
    v_mfma_f32_16x16x32_bf16 v[200:203], v[40:43], v[72:75], v[200:203]
    ds_read_b64_tr_b16 v[50:51], v12 offset:53248
    v_mfma_f32_16x16x32_bf16 v[232:235], v[44:47], v[72:75], v[232:235]
    ds_read_b64_tr_b16 v[52:53], v13 offset:49152
    v_mfma_f32_16x16x32_bf16 v[236:239], v[44:47], v[76:79], v[236:239]
    ds_read_b64_tr_b16 v[54:55], v13 offset:53248
    v_mfma_f32_16x16x32_bf16 v[204:207], v[40:43], v[76:79], v[204:207]
    ds_read_b64_tr_b16 v[56:57], v12 offset:57344
    v_mfma_f32_16x16x32_bf16 v[172:175], v[36:39], v[76:79], v[172:175]
    ds_read_b64_tr_b16 v[58:59], v12 offset:61440
    v_mfma_f32_16x16x32_bf16 v[140:143], v[32:35], v[76:79], v[140:143]
    ds_read_b64_tr_b16 v[60:61], v13 offset:57344
    v_mfma_f32_16x16x32_bf16 v[144:147], v[32:35], v[80:83], v[144:147]
    ds_read_b64_tr_b16 v[62:63], v13 offset:61440
    v_mfma_f32_16x16x32_bf16 v[176:179], v[36:39], v[80:83], v[176:179]
    ds_read_b128 v[96:99], v11 offset:16384
    v_mfma_f32_16x16x32_bf16 v[208:211], v[40:43], v[80:83], v[208:211]
    ds_read_b128 v[100:103], v11 offset:18432
    v_mfma_f32_16x16x32_bf16 v[240:243], v[44:47], v[80:83], v[240:243]
    ds_read_b128 v[104:107], v11 offset:20480
    v_mfma_f32_16x16x32_bf16 v[28:31], v[44:47], v[20:23], v[28:31]
    ds_read_b128 v[108:111], v11 offset:22528
    v_mfma_f32_16x16x32_bf16 v[244:247], v[44:47], v[84:87], v[244:247]
    ds_read_b128 v[112:115], v11 offset:24576
    v_mfma_f32_16x16x32_bf16 v[212:215], v[40:43], v[84:87], v[212:215]
    ds_read_b128 v[116:119], v11 offset:26624
    v_mfma_f32_16x16x32_bf16 v[180:183], v[36:39], v[84:87], v[180:183]
    ds_read_b128 v[120:123], v11 offset:28672
    v_mfma_f32_16x16x32_bf16 v[148:151], v[32:35], v[84:87], v[148:151]
    ds_read_b128 v[124:127], v11 offset:30720
    v_mfma_f32_16x16x32_bf16 v[152:155], v[32:35], v[88:91], v[152:155]
    v_mfma_f32_16x16x32_bf16 v[184:187], v[36:39], v[88:91], v[184:187]
    v_mfma_f32_16x16x32_bf16 v[216:219], v[40:43], v[88:91], v[216:219]
    v_mfma_f32_16x16x32_bf16 v[248:251], v[44:47], v[88:91], v[248:251]
    v_mfma_f32_16x16x32_bf16 v[252:255], v[44:47], v[92:95], v[252:255]
    v_mfma_f32_16x16x32_bf16 v[220:223], v[40:43], v[92:95], v[220:223]
    v_mfma_f32_16x16x32_bf16 v[188:191], v[36:39], v[92:95], v[188:191]
    v_mfma_f32_16x16x32_bf16 v[156:159], v[32:35], v[92:95], v[156:159]
    s_waitcnt vmcnt(8) lgkmcnt(0)
    s_barrier
    v_mfma_f32_16x16x32_bf16 v[128:131], v[48:51], v[96:99], v[128:131]
    v_mfma_f32_16x16x32_bf16 v[160:163], v[52:55], v[96:99], v[160:163]
    v_mfma_f32_16x16x32_bf16 v[192:195], v[56:59], v[96:99], v[192:195]
    v_mfma_f32_16x16x32_bf16 v[224:227], v[60:63], v[96:99], v[224:227]
    v_mfma_f32_16x16x32_bf16 v[228:231], v[60:63], v[100:103], v[228:231]
    v_mfma_f32_16x16x32_bf16 v[196:199], v[56:59], v[100:103], v[196:199]
    v_mfma_f32_16x16x32_bf16 v[164:167], v[52:55], v[100:103], v[164:167]
    s_add_u32 m0, s24, 49152
    s_nop 0
    global_load_lds_dwordx4 v[4:5], off sc1
    s_add_u32 m0, s24, 51200
    v_lshl_add_u64 v[4:5], v[8:9], 0, v[4:5]
    v_mfma_f32_16x16x32_bf16 v[132:135], v[48:51], v[100:103], v[132:135]
    global_load_lds_dwordx4 v[6:7], off sc1
    v_lshl_add_u64 v[6:7], v[8:9], 0, v[6:7]
    v_mfma_f32_16x16x32_bf16 v[136:139], v[48:51], v[104:107], v[136:139]
    v_mbcnt_lo_u32_b32 v1, -1, 0
    v_mbcnt_hi_u32_b32 v1, -1, v1
    v_mfma_f32_16x16x32_bf16 v[168:171], v[52:55], v[104:107], v[168:171]
    v_lshlrev_b32 v19, 4, v1
    s_lshr_b32 s32, s2, 3
    s_lshl_b32 s32, s32, 13
    s_lshr_b32 s33, s23, 1
    s_add_u32 s32, s32, s33
    s_add_u32 s32, s32, 8192
    buffer_load_dword v16, v19, s[40:43], s32 offen
    v_mfma_f32_16x16x32_bf16 v[24:27], v[52:55], v[20:23], v[24:27]
    ds_read_b64_tr_b16 v[32:33], v12 offset:0
    v_mfma_f32_16x16x32_bf16 v[200:203], v[56:59], v[104:107], v[200:203]
    ds_read_b64_tr_b16 v[34:35], v12 offset:4096
    v_mfma_f32_16x16x32_bf16 v[232:235], v[60:63], v[104:107], v[232:235]
    ds_read_b64_tr_b16 v[36:37], v13 offset:0
    v_mfma_f32_16x16x32_bf16 v[236:239], v[60:63], v[108:111], v[236:239]
    ds_read_b64_tr_b16 v[38:39], v13 offset:4096
    v_mfma_f32_16x16x32_bf16 v[204:207], v[56:59], v[108:111], v[204:207]
    ds_read_b64_tr_b16 v[40:41], v12 offset:8192
    v_mfma_f32_16x16x32_bf16 v[172:175], v[52:55], v[108:111], v[172:175]
    ds_read_b64_tr_b16 v[42:43], v12 offset:12288
    v_mfma_f32_16x16x32_bf16 v[140:143], v[48:51], v[108:111], v[140:143]
    ds_read_b64_tr_b16 v[44:45], v13 offset:8192
    v_mfma_f32_16x16x32_bf16 v[144:147], v[48:51], v[112:115], v[144:147]
    ds_read_b64_tr_b16 v[46:47], v13 offset:12288
    v_mfma_f32_16x16x32_bf16 v[176:179], v[52:55], v[112:115], v[176:179]
    ds_read_b128 v[64:67], v10 offset:32768
    v_mfma_f32_16x16x32_bf16 v[208:211], v[56:59], v[112:115], v[208:211]
    ds_read_b128 v[68:71], v10 offset:34816
    v_mfma_f32_16x16x32_bf16 v[240:243], v[60:63], v[112:115], v[240:243]
    ds_read_b128 v[72:75], v10 offset:36864
    v_mfma_f32_16x16x32_bf16 v[28:31], v[60:63], v[20:23], v[28:31]
    ds_read_b128 v[76:79], v10 offset:38912
    v_mfma_f32_16x16x32_bf16 v[244:247], v[60:63], v[116:119], v[244:247]
    ds_read_b128 v[80:83], v10 offset:40960
    v_mfma_f32_16x16x32_bf16 v[212:215], v[56:59], v[116:119], v[212:215]
    ds_read_b128 v[84:87], v10 offset:43008
    v_mfma_f32_16x16x32_bf16 v[180:183], v[52:55], v[116:119], v[180:183]
    ds_read_b128 v[88:91], v10 offset:45056
    v_mfma_f32_16x16x32_bf16 v[148:151], v[48:51], v[116:119], v[148:151]
    ds_read_b128 v[92:95], v10 offset:47104
    v_mfma_f32_16x16x32_bf16 v[152:155], v[48:51], v[120:123], v[152:155]
    v_mfma_f32_16x16x32_bf16 v[184:187], v[52:55], v[120:123], v[184:187]
    v_mfma_f32_16x16x32_bf16 v[216:219], v[56:59], v[120:123], v[216:219]
    v_mfma_f32_16x16x32_bf16 v[248:251], v[60:63], v[120:123], v[248:251]
    v_mfma_f32_16x16x32_bf16 v[252:255], v[60:63], v[124:127], v[252:255]
    v_mfma_f32_16x16x32_bf16 v[220:223], v[56:59], v[124:127], v[220:223]
    v_mfma_f32_16x16x32_bf16 v[188:191], v[52:55], v[124:127], v[188:191]
    v_mfma_f32_16x16x32_bf16 v[156:159], v[48:51], v[124:127], v[156:159]
    s_waitcnt vmcnt(7) lgkmcnt(0)
    s_barrier
    v_mfma_f32_16x16x32_bf16 v[128:131], v[32:35], v[64:67], v[128:131]
    v_mfma_f32_16x16x32_bf16 v[160:163], v[36:39], v[64:67], v[160:163]
    v_mfma_f32_16x16x32_bf16 v[192:195], v[40:43], v[64:67], v[192:195]
    v_mfma_f32_16x16x32_bf16 v[224:227], v[44:47], v[64:67], v[224:227]
    v_mfma_f32_16x16x32_bf16 v[228:231], v[44:47], v[68:71], v[228:231]
    v_mfma_f32_16x16x32_bf16 v[196:199], v[40:43], v[68:71], v[196:199]
    v_mfma_f32_16x16x32_bf16 v[164:167], v[36:39], v[68:71], v[164:167]
    ds_read_b64_tr_b16 v[48:49], v12 offset:16384
    v_mfma_f32_16x16x32_bf16 v[132:135], v[32:35], v[68:71], v[132:135]
    ds_read_b64_tr_b16 v[50:51], v12 offset:20480
    v_mfma_f32_16x16x32_bf16 v[136:139], v[32:35], v[72:75], v[136:139]
    ds_read_b64_tr_b16 v[52:53], v13 offset:16384
    v_mfma_f32_16x16x32_bf16 v[168:171], v[36:39], v[72:75], v[168:171]
    ds_read_b64_tr_b16 v[54:55], v13 offset:20480
    v_mfma_f32_16x16x32_bf16 v[24:27], v[36:39], v[20:23], v[24:27]
    ds_read_b64_tr_b16 v[56:57], v12 offset:24576
    v_mfma_f32_16x16x32_bf16 v[200:203], v[40:43], v[72:75], v[200:203]
    ds_read_b64_tr_b16 v[58:59], v12 offset:28672
    v_mfma_f32_16x16x32_bf16 v[232:235], v[44:47], v[72:75], v[232:235]
    ds_read_b64_tr_b16 v[60:61], v13 offset:24576
    v_mfma_f32_16x16x32_bf16 v[236:239], v[44:47], v[76:79], v[236:239]
    ds_read_b64_tr_b16 v[62:63], v13 offset:28672
    v_mfma_f32_16x16x32_bf16 v[204:207], v[40:43], v[76:79], v[204:207]
    ds_read_b128 v[96:99], v11 offset:32768
    v_mfma_f32_16x16x32_bf16 v[172:175], v[36:39], v[76:79], v[172:175]
    ds_read_b128 v[100:103], v11 offset:34816
    v_mfma_f32_16x16x32_bf16 v[140:143], v[32:35], v[76:79], v[140:143]
    ds_read_b128 v[104:107], v11 offset:36864
    v_mfma_f32_16x16x32_bf16 v[144:147], v[32:35], v[80:83], v[144:147]
    ds_read_b128 v[108:111], v11 offset:38912
    v_mfma_f32_16x16x32_bf16 v[176:179], v[36:39], v[80:83], v[176:179]
    ds_read_b128 v[112:115], v11 offset:40960
    v_mfma_f32_16x16x32_bf16 v[208:211], v[40:43], v[80:83], v[208:211]
    ds_read_b128 v[116:119], v11 offset:43008
    v_mfma_f32_16x16x32_bf16 v[240:243], v[44:47], v[80:83], v[240:243]
    ds_read_b128 v[120:123], v11 offset:45056
    v_mfma_f32_16x16x32_bf16 v[28:31], v[44:47], v[20:23], v[28:31]
    ds_read_b128 v[124:127], v11 offset:47104
    v_mfma_f32_16x16x32_bf16 v[244:247], v[44:47], v[84:87], v[244:247]
    v_mfma_f32_16x16x32_bf16 v[212:215], v[40:43], v[84:87], v[212:215]
    v_mfma_f32_16x16x32_bf16 v[180:183], v[36:39], v[84:87], v[180:183]
    v_mfma_f32_16x16x32_bf16 v[148:151], v[32:35], v[84:87], v[148:151]
    v_mfma_f32_16x16x32_bf16 v[152:155], v[32:35], v[88:91], v[152:155]
    v_mfma_f32_16x16x32_bf16 v[184:187], v[36:39], v[88:91], v[184:187]
    v_mfma_f32_16x16x32_bf16 v[216:219], v[40:43], v[88:91], v[216:219]
    v_mfma_f32_16x16x32_bf16 v[248:251], v[44:47], v[88:91], v[248:251]
    v_mfma_f32_16x16x32_bf16 v[252:255], v[44:47], v[92:95], v[252:255]
    v_mfma_f32_16x16x32_bf16 v[220:223], v[40:43], v[92:95], v[220:223]
    v_mfma_f32_16x16x32_bf16 v[188:191], v[36:39], v[92:95], v[188:191]
    v_mfma_f32_16x16x32_bf16 v[156:159], v[32:35], v[92:95], v[156:159]
    s_waitcnt vmcnt(3) lgkmcnt(0)
    s_barrier
    v_mfma_f32_16x16x32_bf16 v[128:131], v[48:51], v[96:99], v[128:131]
    v_mfma_f32_16x16x32_bf16 v[160:163], v[52:55], v[96:99], v[160:163]
    v_mfma_f32_16x16x32_bf16 v[192:195], v[56:59], v[96:99], v[192:195]
    v_mfma_f32_16x16x32_bf16 v[224:227], v[60:63], v[96:99], v[224:227]
    v_mfma_f32_16x16x32_bf16 v[228:231], v[60:63], v[100:103], v[228:231]
    v_mfma_f32_16x16x32_bf16 v[196:199], v[56:59], v[100:103], v[196:199]
    v_mfma_f32_16x16x32_bf16 v[164:167], v[52:55], v[100:103], v[164:167]
    s_lshr_b32 s32, s23, 1
    s_add_u32 m0, s32, 32768
    s_nop 0
    buffer_load_dwordx4 v19, s[96:99], s21 offen sc1 lds
    v_mfma_f32_16x16x32_bf16 v[132:135], v[48:51], v[100:103], v[132:135]
    ds_read_b64_tr_b16 v[32:33], v12 offset:32768
    v_mfma_f32_16x16x32_bf16 v[136:139], v[48:51], v[104:107], v[136:139]
    ds_read_b64_tr_b16 v[34:35], v12 offset:36864
    v_mfma_f32_16x16x32_bf16 v[168:171], v[52:55], v[104:107], v[168:171]
    ds_read_b64_tr_b16 v[36:37], v13 offset:32768
    v_mfma_f32_16x16x32_bf16 v[24:27], v[52:55], v[20:23], v[24:27]
    ds_read_b64_tr_b16 v[38:39], v13 offset:36864
    v_mfma_f32_16x16x32_bf16 v[200:203], v[56:59], v[104:107], v[200:203]
    ds_read_b64_tr_b16 v[40:41], v12 offset:40960
    v_mfma_f32_16x16x32_bf16 v[232:235], v[60:63], v[104:107], v[232:235]
    ds_read_b64_tr_b16 v[42:43], v12 offset:45056
    v_mfma_f32_16x16x32_bf16 v[236:239], v[60:63], v[108:111], v[236:239]
    ds_read_b64_tr_b16 v[44:45], v13 offset:40960
    v_mfma_f32_16x16x32_bf16 v[204:207], v[56:59], v[108:111], v[204:207]
    ds_read_b64_tr_b16 v[46:47], v13 offset:45056
    v_mfma_f32_16x16x32_bf16 v[172:175], v[52:55], v[108:111], v[172:175]
    ds_read_b128 v[64:67], v10 offset:0
    v_mfma_f32_16x16x32_bf16 v[140:143], v[48:51], v[108:111], v[140:143]
    ds_read_b128 v[68:71], v10 offset:2048
    v_mfma_f32_16x16x32_bf16 v[144:147], v[48:51], v[112:115], v[144:147]
    ds_read_b128 v[72:75], v10 offset:4096
    v_mfma_f32_16x16x32_bf16 v[176:179], v[52:55], v[112:115], v[176:179]
    ds_read_b128 v[76:79], v10 offset:6144
    v_mfma_f32_16x16x32_bf16 v[208:211], v[56:59], v[112:115], v[208:211]
    ds_read_b128 v[80:83], v10 offset:8192
    v_mfma_f32_16x16x32_bf16 v[240:243], v[60:63], v[112:115], v[240:243]
    ds_read_b128 v[84:87], v10 offset:10240
    v_mfma_f32_16x16x32_bf16 v[28:31], v[60:63], v[20:23], v[28:31]
    ds_read_b128 v[88:91], v10 offset:12288
    v_mfma_f32_16x16x32_bf16 v[244:247], v[60:63], v[116:119], v[244:247]
    ds_read_b128 v[92:95], v10 offset:14336
    v_mfma_f32_16x16x32_bf16 v[212:215], v[56:59], v[116:119], v[212:215]
    v_mfma_f32_16x16x32_bf16 v[180:183], v[52:55], v[116:119], v[180:183]
    v_mfma_f32_16x16x32_bf16 v[148:151], v[48:51], v[116:119], v[148:151]
    v_mfma_f32_16x16x32_bf16 v[152:155], v[48:51], v[120:123], v[152:155]
    v_mfma_f32_16x16x32_bf16 v[184:187], v[52:55], v[120:123], v[184:187]
    v_mfma_f32_16x16x32_bf16 v[216:219], v[56:59], v[120:123], v[216:219]
    v_mfma_f32_16x16x32_bf16 v[248:251], v[60:63], v[120:123], v[248:251]
    v_mfma_f32_16x16x32_bf16 v[252:255], v[60:63], v[124:127], v[252:255]
    v_mfma_f32_16x16x32_bf16 v[220:223], v[56:59], v[124:127], v[220:223]
    v_mfma_f32_16x16x32_bf16 v[188:191], v[52:55], v[124:127], v[188:191]
    v_mfma_f32_16x16x32_bf16 v[156:159], v[48:51], v[124:127], v[156:159]
    s_waitcnt vmcnt(1) lgkmcnt(0)
    s_barrier
    v_mfma_f32_16x16x32_bf16 v[128:131], v[32:35], v[64:67], v[128:131]
    v_mfma_f32_16x16x32_bf16 v[160:163], v[36:39], v[64:67], v[160:163]
    v_mfma_f32_16x16x32_bf16 v[192:195], v[40:43], v[64:67], v[192:195]
    v_mfma_f32_16x16x32_bf16 v[224:227], v[44:47], v[64:67], v[224:227]
    v_mfma_f32_16x16x32_bf16 v[228:231], v[44:47], v[68:71], v[228:231]
    v_mfma_f32_16x16x32_bf16 v[196:199], v[40:43], v[68:71], v[196:199]
    v_mfma_f32_16x16x32_bf16 v[164:167], v[36:39], v[68:71], v[164:167]
    s_xor_b32 m0, s56, 0x4000
    s_add_u32 s32, s55, 8192
    buffer_load_dwordx4 v19, s[40:43], s32 offen sc1 lds
    v_mfma_f32_16x16x32_bf16 v[132:135], v[32:35], v[68:71], v[132:135]
    buffer_load_dwordx4 v19, s[40:43], s32 offen offset:1024 sc1 lds
    v_mfma_f32_16x16x32_bf16 v[136:139], v[32:35], v[72:75], v[136:139]
    v_lshlrev_b32 v19, 4, v1
    v_lshrrev_b32 v16, 4, v1
    v_and_b32 v17, 15, v1
    v_add_u32 v18, 131072, v19
    v_mfma_f32_16x16x32_bf16 v[168:171], v[36:39], v[72:75], v[168:171]
    v_lshlrev_b32 v0, 3, v17
    s_lshr_b32 s32, s23, 1
    v_add_u32 v0, s32, v0
    v_add_u32 v14, s23, v19
    s_lshl_b32 s32, s31, 11
    v_add_u32 v15, s32, v19
    v_mfma_f32_16x16x32_bf16 v[24:27], v[36:39], v[20:23], v[24:27]
    ds_read_b64_tr_b16 v[48:49], v12 offset:49152
    v_mfma_f32_16x16x32_bf16 v[200:203], v[40:43], v[72:75], v[200:203]
    ds_read_b64_tr_b16 v[50:51], v12 offset:53248
    v_mfma_f32_16x16x32_bf16 v[232:235], v[44:47], v[72:75], v[232:235]
    ds_read_b64_tr_b16 v[52:53], v13 offset:49152
    v_mfma_f32_16x16x32_bf16 v[236:239], v[44:47], v[76:79], v[236:239]
    ds_read_b64_tr_b16 v[54:55], v13 offset:53248
    v_mfma_f32_16x16x32_bf16 v[204:207], v[40:43], v[76:79], v[204:207]
    ds_read_b64_tr_b16 v[56:57], v12 offset:57344
    v_mfma_f32_16x16x32_bf16 v[172:175], v[36:39], v[76:79], v[172:175]
    ds_read_b64_tr_b16 v[58:59], v12 offset:61440
    v_mfma_f32_16x16x32_bf16 v[140:143], v[32:35], v[76:79], v[140:143]
    ds_read_b64_tr_b16 v[60:61], v13 offset:57344
    v_mfma_f32_16x16x32_bf16 v[144:147], v[32:35], v[80:83], v[144:147]
    ds_read_b64_tr_b16 v[62:63], v13 offset:61440
    v_mfma_f32_16x16x32_bf16 v[176:179], v[36:39], v[80:83], v[176:179]
    ds_read_b128 v[96:99], v11 offset:0
    v_mfma_f32_16x16x32_bf16 v[208:211], v[40:43], v[80:83], v[208:211]
    ds_read_b128 v[100:103], v11 offset:2048
    v_mfma_f32_16x16x32_bf16 v[240:243], v[44:47], v[80:83], v[240:243]
    ds_read_b128 v[104:107], v11 offset:4096
    v_mfma_f32_16x16x32_bf16 v[28:31], v[44:47], v[20:23], v[28:31]
    ds_read_b128 v[108:111], v11 offset:6144
    v_mfma_f32_16x16x32_bf16 v[244:247], v[44:47], v[84:87], v[244:247]
    ds_read_b128 v[112:115], v11 offset:8192
    v_mfma_f32_16x16x32_bf16 v[212:215], v[40:43], v[84:87], v[212:215]
    ds_read_b128 v[116:119], v11 offset:10240
    v_mfma_f32_16x16x32_bf16 v[180:183], v[36:39], v[84:87], v[180:183]
    ds_read_b128 v[120:123], v11 offset:12288
    v_mfma_f32_16x16x32_bf16 v[148:151], v[32:35], v[84:87], v[148:151]
    ds_read_b128 v[124:127], v11 offset:14336
    v_mfma_f32_16x16x32_bf16 v[152:155], v[32:35], v[88:91], v[152:155]
    v_mfma_f32_16x16x32_bf16 v[184:187], v[36:39], v[88:91], v[184:187]
    v_mfma_f32_16x16x32_bf16 v[216:219], v[40:43], v[88:91], v[216:219]
    v_mfma_f32_16x16x32_bf16 v[248:251], v[44:47], v[88:91], v[248:251]
    v_mfma_f32_16x16x32_bf16 v[252:255], v[44:47], v[92:95], v[252:255]
    v_mfma_f32_16x16x32_bf16 v[220:223], v[40:43], v[92:95], v[220:223]
    v_mfma_f32_16x16x32_bf16 v[188:191], v[36:39], v[92:95], v[188:191]
    v_mfma_f32_16x16x32_bf16 v[156:159], v[32:35], v[92:95], v[156:159]
    s_waitcnt vmcnt(2) lgkmcnt(0)
    s_barrier
    v_mfma_f32_16x16x32_bf16 v[24:27], v[52:55], v[20:23], v[24:27]
    s_mov_b32 m0, s56
    s_nop 0
    buffer_load_dwordx4 v19, s[40:43], s55 offen sc1 lds
    v_mfma_f32_16x16x32_bf16 v[28:31], v[60:63], v[20:23], v[28:31]
    buffer_load_dwordx4 v19, s[40:43], s55 offen offset:1024 sc1 lds
    s_add_u32 s55, s55, 16384
    v_mfma_f32_16x16x32_bf16 v[128:131], v[48:51], v[96:99], v[128:131]
    ds_read_b64 v[64:65], v0 offset:32768
    v_mfma_f32_16x16x32_bf16 v[160:163], v[52:55], v[96:99], v[160:163]
    ds_read_b64 v[66:67], v0 offset:32896
    v_mfma_f32_16x16x32_bf16 v[192:195], v[56:59], v[96:99], v[192:195]
    ds_read_b64 v[68:69], v0 offset:33024
    v_mfma_f32_16x16x32_bf16 v[224:227], v[60:63], v[96:99], v[224:227]
    ds_read_b64 v[70:71], v0 offset:33152
    v_mfma_f32_16x16x32_bf16 v[228:231], v[60:63], v[100:103], v[228:231]
    ds_read_b64 v[72:73], v0 offset:33280
    v_mfma_f32_16x16x32_bf16 v[196:199], v[56:59], v[100:103], v[196:199]
    ds_read_b64 v[74:75], v0 offset:33408
    v_mfma_f32_16x16x32_bf16 v[164:167], v[52:55], v[100:103], v[164:167]
    ds_read_b64 v[76:77], v0 offset:33536
    v_mfma_f32_16x16x32_bf16 v[132:135], v[48:51], v[100:103], v[132:135]
    ds_read_b64 v[78:79], v0 offset:33664
    v_mfma_f32_16x16x32_bf16 v[136:139], v[48:51], v[104:107], v[136:139]
    v_mfma_f32_16x16x32_bf16 v[168:171], v[52:55], v[104:107], v[168:171]
    v_mfma_f32_16x16x32_bf16 v[200:203], v[56:59], v[104:107], v[200:203]
    ds_write_b128 v14, v[24:27] offset:16384
    v_mfma_f32_16x16x32_bf16 v[232:235], v[60:63], v[104:107], v[232:235]
    ds_write_b128 v14, v[28:31] offset:17408
    v_mfma_f32_16x16x32_bf16 v[236:239], v[60:63], v[108:111], v[236:239]
    v_mfma_f32_16x16x32_bf16 v[204:207], v[56:59], v[108:111], v[204:207]
    v_mfma_f32_16x16x32_bf16 v[172:175], v[52:55], v[108:111], v[172:175]
    v_mfma_f32_16x16x32_bf16 v[140:143], v[48:51], v[108:111], v[140:143]
    v_mfma_f32_16x16x32_bf16 v[144:147], v[48:51], v[112:115], v[144:147]
    v_mfma_f32_16x16x32_bf16 v[176:179], v[52:55], v[112:115], v[176:179]
    v_mfma_f32_16x16x32_bf16 v[208:211], v[56:59], v[112:115], v[208:211]
    v_mfma_f32_16x16x32_bf16 v[240:243], v[60:63], v[112:115], v[240:243]
    v_mfma_f32_16x16x32_bf16 v[244:247], v[60:63], v[116:119], v[244:247]
    v_mfma_f32_16x16x32_bf16 v[212:215], v[56:59], v[116:119], v[212:215]
    v_mfma_f32_16x16x32_bf16 v[180:183], v[52:55], v[116:119], v[180:183]
    v_mfma_f32_16x16x32_bf16 v[148:151], v[48:51], v[116:119], v[148:151]
    v_mfma_f32_16x16x32_bf16 v[152:155], v[48:51], v[120:123], v[152:155]
    v_mfma_f32_16x16x32_bf16 v[184:187], v[52:55], v[120:123], v[184:187]
    v_mfma_f32_16x16x32_bf16 v[216:219], v[56:59], v[120:123], v[216:219]
    v_mfma_f32_16x16x32_bf16 v[248:251], v[60:63], v[120:123], v[248:251]
    v_mfma_f32_16x16x32_bf16 v[252:255], v[60:63], v[124:127], v[252:255]
    v_mfma_f32_16x16x32_bf16 v[220:223], v[56:59], v[124:127], v[220:223]
    v_mfma_f32_16x16x32_bf16 v[188:191], v[52:55], v[124:127], v[188:191]
    v_mfma_f32_16x16x32_bf16 v[156:159], v[48:51], v[124:127], v[156:159]
    s_waitcnt lgkmcnt(0)
    s_barrier
P1_END:
    ds_read_b128 v[80:83], v15 offset:16384
    ds_read_b128 v[88:91], v15 offset:17408
    ds_read_b128 v[84:87], v15 offset:24576
    ds_read_b128 v[92:95], v15 offset:25600
    v_lshlrev_b32 v4, 9, v16
    v_lshl_add_u32 v4, v17, 4, v4
    v_add_u32 v5, 0x1000, v4
    s_lshr_b32 s32, s26, 1
    s_mul_i32 s32, s32, 7
    s_and_b32 s33, s26, 1
    s_lshl_b32 s34, s33, 2
    s_add_u32 s34, s34, s31
    s_cmp_eq_u32 s31, 3
    s_cselect_b32 s34, 3, s34
    s_add_u32 s32, s32, s34
    s_lshl_b32 s34, s27, 1
    s_add_u32 s34, s34, s28
    s_mul_i32 s35, s34, 144
    s_add_u32 s32, s32, s35
    s_lshl_b32 s24, s32, 13
    s_lshl_b32 s20, s27, 8
    s_lshl_b32 s35, s26, 3
    s_add_u32 s20, s20, s35
    s_add_u32 s20, s20, 12288
    s_waitcnt lgkmcnt(0)
    v_mul_f32 v96, v65, v65
    v_mul_f32 v97, v67, v67
    v_mul_f32 v98, v69, v69
    v_mul_f32 v99, v71, v71
    v_mul_f32 v100, v73, v73
    v_mul_f32 v101, v75, v75
    v_mul_f32 v102, v77, v77
    v_mul_f32 v103, v79, v79
    s_cmp_eq_u32 s31, 3
    s_cbranch_scc1 P1_EP3
    v_pk_fma_f32 v[160:161], v[84:85], v[64:65], v[160:161] op_sel_hi:[1,0,1]
    v_pk_fma_f32 v[162:163], v[86:87], v[64:65], v[162:163] op_sel_hi:[1,0,1]
    v_pk_fma_f32 v[224:225], v[92:93], v[64:65], v[224:225] op_sel_hi:[1,0,1]
    v_pk_fma_f32 v[226:227], v[94:95], v[64:65], v[226:227] op_sel_hi:[1,0,1]
    v_max_f32 v160, 0, v160
    v_max_f32 v161, 0, v161
    v_max_f32 v162, 0, v162
    v_max_f32 v163, 0, v163
    v_pk_mul_f32 v[224:225], v[224:225], v[96:97] op_sel_hi:[1,0]
    v_pk_mul_f32 v[226:227], v[226:227], v[96:97] op_sel_hi:[1,0]
    v_pk_mul_f32 v[160:161], v[160:161], v[224:225]
    v_pk_mul_f32 v[162:163], v[162:163], v[226:227]
    v_cvt_pk_bf16_f32 v163, v162, v163
    v_cvt_pk_bf16_f32 v162, v160, v161
    v_pk_fma_f32 v[128:129], v[80:81], v[64:65], v[128:129] op_sel_hi:[1,0,1]
    v_pk_fma_f32 v[130:131], v[82:83], v[64:65], v[130:131] op_sel_hi:[1,0,1]
    v_pk_fma_f32 v[192:193], v[88:89], v[64:65], v[192:193] op_sel_hi:[1,0,1]
    v_pk_fma_f32 v[194:195], v[90:91], v[64:65], v[194:195] op_sel_hi:[1,0,1]
    v_max_f32 v128, 0, v128
    v_max_f32 v129, 0, v129
    v_max_f32 v130, 0, v130
    v_max_f32 v131, 0, v131
    v_pk_mul_f32 v[192:193], v[192:193], v[96:97] op_sel_hi:[1,0]
    v_pk_mul_f32 v[194:195], v[194:195], v[96:97] op_sel_hi:[1,0]
    v_pk_mul_f32 v[128:129], v[128:129], v[192:193]
    v_pk_mul_f32 v[130:131], v[130:131], v[194:195]
    v_cvt_pk_bf16_f32 v161, v130, v131
    v_cvt_pk_bf16_f32 v160, v128, v129
    buffer_store_dwordx4 v[160:163], v4, s[36:39], s24 offen offset:0 sc1
    v_pk_fma_f32 v[164:165], v[84:85], v[66:67], v[164:165] op_sel_hi:[1,0,1]
    v_pk_fma_f32 v[166:167], v[86:87], v[66:67], v[166:167] op_sel_hi:[1,0,1]
    v_pk_fma_f32 v[228:229], v[92:93], v[66:67], v[228:229] op_sel_hi:[1,0,1]
    v_pk_fma_f32 v[230:231], v[94:95], v[66:67], v[230:231] op_sel_hi:[1,0,1]
    v_max_f32 v164, 0, v164
    v_max_f32 v165, 0, v165
    v_max_f32 v166, 0, v166
    v_max_f32 v167, 0, v167
    v_pk_mul_f32 v[228:229], v[228:229], v[96:97] op_sel:[0,1] op_sel_hi:[1,1]
    v_pk_mul_f32 v[230:231], v[230:231], v[96:97] op_sel:[0,1] op_sel_hi:[1,1]
    v_pk_mul_f32 v[164:165], v[164:165], v[228:229]
    v_pk_mul_f32 v[166:167], v[166:167], v[230:231]
    v_cvt_pk_bf16_f32 v167, v166, v167
    v_cvt_pk_bf16_f32 v166, v164, v165
    v_pk_fma_f32 v[132:133], v[80:81], v[66:67], v[132:133] op_sel_hi:[1,0,1]
    v_pk_fma_f32 v[134:135], v[82:83], v[66:67], v[134:135] op_sel_hi:[1,0,1]
    v_pk_fma_f32 v[196:197], v[88:89], v[66:67], v[196:197] op_sel_hi:[1,0,1]
    v_pk_fma_f32 v[198:199], v[90:91], v[66:67], v[198:199] op_sel_hi:[1,0,1]
    v_max_f32 v132, 0, v132
    v_max_f32 v133, 0, v133
    v_max_f32 v134, 0, v134
    v_max_f32 v135, 0, v135
    v_pk_mul_f32 v[196:197], v[196:197], v[96:97] op_sel:[0,1] op_sel_hi:[1,1]
    v_pk_mul_f32 v[198:199], v[198:199], v[96:97] op_sel:[0,1] op_sel_hi:[1,1]
    v_pk_mul_f32 v[132:133], v[132:133], v[196:197]
    v_pk_mul_f32 v[134:135], v[134:135], v[198:199]
    v_cvt_pk_bf16_f32 v165, v134, v135
    v_cvt_pk_bf16_f32 v164, v132, v133
    v_pk_fma_f32 v[168:169], v[84:85], v[68:69], v[168:169] op_sel_hi:[1,0,1]
    v_pk_fma_f32 v[170:171], v[86:87], v[68:69], v[170:171] op_sel_hi:[1,0,1]
    v_pk_fma_f32 v[232:233], v[92:93], v[68:69], v[232:233] op_sel_hi:[1,0,1]
    v_pk_fma_f32 v[234:235], v[94:95], v[68:69], v[234:235] op_sel_hi:[1,0,1]
    v_max_f32 v168, 0, v168
    v_max_f32 v169, 0, v169
    v_max_f32 v170, 0, v170
    v_max_f32 v171, 0, v171
    v_pk_mul_f32 v[232:233], v[232:233], v[98:99] op_sel_hi:[1,0]
    v_pk_mul_f32 v[234:235], v[234:235], v[98:99] op_sel_hi:[1,0]
    v_pk_mul_f32 v[168:169], v[168:169], v[232:233]
    v_pk_mul_f32 v[170:171], v[170:171], v[234:235]
    v_cvt_pk_bf16_f32 v171, v170, v171
    v_cvt_pk_bf16_f32 v170, v168, v169
    v_pk_fma_f32 v[136:137], v[80:81], v[68:69], v[136:137] op_sel_hi:[1,0,1]
    v_pk_fma_f32 v[138:139], v[82:83], v[68:69], v[138:139] op_sel_hi:[1,0,1]
    v_pk_fma_f32 v[200:201], v[88:89], v[68:69], v[200:201] op_sel_hi:[1,0,1]
    v_pk_fma_f32 v[202:203], v[90:91], v[68:69], v[202:203] op_sel_hi:[1,0,1]
    v_max_f32 v136, 0, v136
    v_max_f32 v137, 0, v137
    v_max_f32 v138, 0, v138
    v_max_f32 v139, 0, v139
    v_pk_mul_f32 v[200:201], v[200:201], v[98:99] op_sel_hi:[1,0]
    v_pk_mul_f32 v[202:203], v[202:203], v[98:99] op_sel_hi:[1,0]
    v_pk_mul_f32 v[136:137], v[136:137], v[200:201]
    v_pk_mul_f32 v[138:139], v[138:139], v[202:203]
    v_cvt_pk_bf16_f32 v169, v138, v139
    v_cvt_pk_bf16_f32 v168, v136, v137
    buffer_store_dwordx4 v[164:167], v4, s[36:39], s24 offen offset:256 sc1
    v_pk_fma_f32 v[172:173], v[84:85], v[70:71], v[172:173] op_sel_hi:[1,0,1]
    v_pk_fma_f32 v[174:175], v[86:87], v[70:71], v[174:175] op_sel_hi:[1,0,1]
    v_pk_fma_f32 v[236:237], v[92:93], v[70:71], v[236:237] op_sel_hi:[1,0,1]
    v_pk_fma_f32 v[238:239], v[94:95], v[70:71], v[238:239] op_sel_hi:[1,0,1]
    v_max_f32 v172, 0, v172
    v_max_f32 v173, 0, v173
    v_max_f32 v174, 0, v174
    v_max_f32 v175, 0, v175
    v_pk_mul_f32 v[236:237], v[236:237], v[98:99] op_sel:[0,1] op_sel_hi:[1,1]
    v_pk_mul_f32 v[238:239], v[238:239], v[98:99] op_sel:[0,1] op_sel_hi:[1,1]
    v_pk_mul_f32 v[172:173], v[172:173], v[236:237]
    v_pk_mul_f32 v[174:175], v[174:175], v[238:239]
    v_cvt_pk_bf16_f32 v175, v174, v175
    v_cvt_pk_bf16_f32 v174, v172, v173
    v_pk_fma_f32 v[140:141], v[80:81], v[70:71], v[140:141] op_sel_hi:[1,0,1]
    v_pk_fma_f32 v[142:143], v[82:83], v[70:71], v[142:143] op_sel_hi:[1,0,1]
    v_pk_fma_f32 v[204:205], v[88:89], v[70:71], v[204:205] op_sel_hi:[1,0,1]
    v_pk_fma_f32 v[206:207], v[90:91], v[70:71], v[206:207] op_sel_hi:[1,0,1]
    v_max_f32 v140, 0, v140
    v_max_f32 v141, 0, v141
    v_max_f32 v142, 0, v142
    v_max_f32 v143, 0, v143
    v_pk_mul_f32 v[204:205], v[204:205], v[98:99] op_sel:[0,1] op_sel_hi:[1,1]
    v_pk_mul_f32 v[206:207], v[206:207], v[98:99] op_sel:[0,1] op_sel_hi:[1,1]
    v_pk_mul_f32 v[140:141], v[140:141], v[204:205]
    v_pk_mul_f32 v[142:143], v[142:143], v[206:207]
    v_cvt_pk_bf16_f32 v173, v142, v143
    v_cvt_pk_bf16_f32 v172, v140, v141
    v_pk_fma_f32 v[176:177], v[84:85], v[72:73], v[176:177] op_sel_hi:[1,0,1]
    v_pk_fma_f32 v[178:179], v[86:87], v[72:73], v[178:179] op_sel_hi:[1,0,1]
    v_pk_fma_f32 v[240:241], v[92:93], v[72:73], v[240:241] op_sel_hi:[1,0,1]
    v_pk_fma_f32 v[242:243], v[94:95], v[72:73], v[242:243] op_sel_hi:[1,0,1]
    v_max_f32 v176, 0, v176
    v_max_f32 v177, 0, v177
    v_max_f32 v178, 0, v178
    v_max_f32 v179, 0, v179
    v_pk_mul_f32 v[240:241], v[240:241], v[100:101] op_sel_hi:[1,0]
    v_pk_mul_f32 v[242:243], v[242:243], v[100:101] op_sel_hi:[1,0]
    v_pk_mul_f32 v[176:177], v[176:177], v[240:241]
    v_pk_mul_f32 v[178:179], v[178:179], v[242:243]
    v_cvt_pk_bf16_f32 v179, v178, v179
    v_cvt_pk_bf16_f32 v178, v176, v177
    v_pk_fma_f32 v[144:145], v[80:81], v[72:73], v[144:145] op_sel_hi:[1,0,1]
    v_pk_fma_f32 v[146:147], v[82:83], v[72:73], v[146:147] op_sel_hi:[1,0,1]
    v_pk_fma_f32 v[208:209], v[88:89], v[72:73], v[208:209] op_sel_hi:[1,0,1]
    v_pk_fma_f32 v[210:211], v[90:91], v[72:73], v[210:211] op_sel_hi:[1,0,1]
    v_max_f32 v144, 0, v144
    v_max_f32 v145, 0, v145
    v_max_f32 v146, 0, v146
    v_max_f32 v147, 0, v147
    v_pk_mul_f32 v[208:209], v[208:209], v[100:101] op_sel_hi:[1,0]
    v_pk_mul_f32 v[210:211], v[210:211], v[100:101] op_sel_hi:[1,0]
    v_pk_mul_f32 v[144:145], v[144:145], v[208:209]
    v_pk_mul_f32 v[146:147], v[146:147], v[210:211]
    v_cvt_pk_bf16_f32 v177, v146, v147
    v_cvt_pk_bf16_f32 v176, v144, v145
    buffer_store_dwordx4 v[168:171], v4, s[36:39], s24 offen offset:2048 sc1
    v_pk_fma_f32 v[180:181], v[84:85], v[74:75], v[180:181] op_sel_hi:[1,0,1]
    v_pk_fma_f32 v[182:183], v[86:87], v[74:75], v[182:183] op_sel_hi:[1,0,1]
    v_pk_fma_f32 v[244:245], v[92:93], v[74:75], v[244:245] op_sel_hi:[1,0,1]
    v_pk_fma_f32 v[246:247], v[94:95], v[74:75], v[246:247] op_sel_hi:[1,0,1]
    v_max_f32 v180, 0, v180
    v_max_f32 v181, 0, v181
    v_max_f32 v182, 0, v182
    v_max_f32 v183, 0, v183
    v_pk_mul_f32 v[244:245], v[244:245], v[100:101] op_sel:[0,1] op_sel_hi:[1,1]
    v_pk_mul_f32 v[246:247], v[246:247], v[100:101] op_sel:[0,1] op_sel_hi:[1,1]
    v_pk_mul_f32 v[180:181], v[180:181], v[244:245]
    v_pk_mul_f32 v[182:183], v[182:183], v[246:247]
    v_cvt_pk_bf16_f32 v183, v182, v183
    v_cvt_pk_bf16_f32 v182, v180, v181
    v_pk_fma_f32 v[148:149], v[80:81], v[74:75], v[148:149] op_sel_hi:[1,0,1]
    v_pk_fma_f32 v[150:151], v[82:83], v[74:75], v[150:151] op_sel_hi:[1,0,1]
    v_pk_fma_f32 v[212:213], v[88:89], v[74:75], v[212:213] op_sel_hi:[1,0,1]
    v_pk_fma_f32 v[214:215], v[90:91], v[74:75], v[214:215] op_sel_hi:[1,0,1]
    v_max_f32 v148, 0, v148
    v_max_f32 v149, 0, v149
    v_max_f32 v150, 0, v150
    v_max_f32 v151, 0, v151
    v_pk_mul_f32 v[212:213], v[212:213], v[100:101] op_sel:[0,1] op_sel_hi:[1,1]
    v_pk_mul_f32 v[214:215], v[214:215], v[100:101] op_sel:[0,1] op_sel_hi:[1,1]
    v_pk_mul_f32 v[148:149], v[148:149], v[212:213]
    v_pk_mul_f32 v[150:151], v[150:151], v[214:215]
    v_cvt_pk_bf16_f32 v181, v150, v151
    v_cvt_pk_bf16_f32 v180, v148, v149
    v_pk_fma_f32 v[184:185], v[84:85], v[76:77], v[184:185] op_sel_hi:[1,0,1]
    v_pk_fma_f32 v[186:187], v[86:87], v[76:77], v[186:187] op_sel_hi:[1,0,1]
    v_pk_fma_f32 v[248:249], v[92:93], v[76:77], v[248:249] op_sel_hi:[1,0,1]
    v_pk_fma_f32 v[250:251], v[94:95], v[76:77], v[250:251] op_sel_hi:[1,0,1]
    v_max_f32 v184, 0, v184
    v_max_f32 v185, 0, v185
    v_max_f32 v186, 0, v186
    v_max_f32 v187, 0, v187
    v_pk_mul_f32 v[248:249], v[248:249], v[102:103] op_sel_hi:[1,0]
    v_pk_mul_f32 v[250:251], v[250:251], v[102:103] op_sel_hi:[1,0]
    v_pk_mul_f32 v[184:185], v[184:185], v[248:249]
    v_pk_mul_f32 v[186:187], v[186:187], v[250:251]
    v_cvt_pk_bf16_f32 v187, v186, v187
    v_cvt_pk_bf16_f32 v186, v184, v185
    v_pk_fma_f32 v[152:153], v[80:81], v[76:77], v[152:153] op_sel_hi:[1,0,1]
    v_pk_fma_f32 v[154:155], v[82:83], v[76:77], v[154:155] op_sel_hi:[1,0,1]
    v_pk_fma_f32 v[216:217], v[88:89], v[76:77], v[216:217] op_sel_hi:[1,0,1]
    v_pk_fma_f32 v[218:219], v[90:91], v[76:77], v[218:219] op_sel_hi:[1,0,1]
    v_max_f32 v152, 0, v152
    v_max_f32 v153, 0, v153
    v_max_f32 v154, 0, v154
    v_max_f32 v155, 0, v155
    v_pk_mul_f32 v[216:217], v[216:217], v[102:103] op_sel_hi:[1,0]
    v_pk_mul_f32 v[218:219], v[218:219], v[102:103] op_sel_hi:[1,0]
    v_pk_mul_f32 v[152:153], v[152:153], v[216:217]
    v_pk_mul_f32 v[154:155], v[154:155], v[218:219]
    v_cvt_pk_bf16_f32 v185, v154, v155
    v_cvt_pk_bf16_f32 v184, v152, v153
    buffer_store_dwordx4 v[172:175], v4, s[36:39], s24 offen offset:2304 sc1
    v_pk_fma_f32 v[188:189], v[84:85], v[78:79], v[188:189] op_sel_hi:[1,0,1]
    v_pk_fma_f32 v[190:191], v[86:87], v[78:79], v[190:191] op_sel_hi:[1,0,1]
    v_pk_fma_f32 v[252:253], v[92:93], v[78:79], v[252:253] op_sel_hi:[1,0,1]
    v_pk_fma_f32 v[254:255], v[94:95], v[78:79], v[254:255] op_sel_hi:[1,0,1]
    v_max_f32 v188, 0, v188
    v_max_f32 v189, 0, v189
    v_max_f32 v190, 0, v190
    v_max_f32 v191, 0, v191
    v_pk_mul_f32 v[252:253], v[252:253], v[102:103] op_sel:[0,1] op_sel_hi:[1,1]
    v_pk_mul_f32 v[254:255], v[254:255], v[102:103] op_sel:[0,1] op_sel_hi:[1,1]
    v_pk_mul_f32 v[188:189], v[188:189], v[252:253]
    v_pk_mul_f32 v[190:191], v[190:191], v[254:255]
    v_cvt_pk_bf16_f32 v191, v190, v191
    v_cvt_pk_bf16_f32 v190, v188, v189
    v_pk_fma_f32 v[156:157], v[80:81], v[78:79], v[156:157] op_sel_hi:[1,0,1]
    v_pk_fma_f32 v[158:159], v[82:83], v[78:79], v[158:159] op_sel_hi:[1,0,1]
    v_pk_fma_f32 v[220:221], v[88:89], v[78:79], v[220:221] op_sel_hi:[1,0,1]
    v_pk_fma_f32 v[222:223], v[90:91], v[78:79], v[222:223] op_sel_hi:[1,0,1]
    v_max_f32 v156, 0, v156
    v_max_f32 v157, 0, v157
    v_max_f32 v158, 0, v158
    v_max_f32 v159, 0, v159
    v_pk_mul_f32 v[220:221], v[220:221], v[102:103] op_sel:[0,1] op_sel_hi:[1,1]
    v_pk_mul_f32 v[222:223], v[222:223], v[102:103] op_sel:[0,1] op_sel_hi:[1,1]
    v_pk_mul_f32 v[156:157], v[156:157], v[220:221]
    v_pk_mul_f32 v[158:159], v[158:159], v[222:223]
    v_cvt_pk_bf16_f32 v189, v158, v159
    v_cvt_pk_bf16_f32 v188, v156, v157
    s_branch P1_EPD
P1_EP3:
    s_lshl_b32 s25, s28, 13
    v_add_u32 v24, s25, v4
    v_mul_f32 v65, 1048744942, v65
    v_mul_f32 v67, 1048744942, v67
    v_mul_f32 v69, 1048744942, v69
    v_mul_f32 v71, 1048744942, v71
    v_mul_f32 v73, 1048744942, v73
    v_mul_f32 v75, 1048744942, v75
    v_mul_f32 v77, 1048744942, v77
    v_mul_f32 v79, 1048744942, v79
    v_pk_fma_f32 v[160:161], v[84:85], v[64:65], v[160:161] op_sel_hi:[1,0,1]
    v_pk_fma_f32 v[162:163], v[86:87], v[64:65], v[162:163] op_sel_hi:[1,0,1]
    v_pk_mul_f32 v[160:161], v[160:161], v[64:65] op_sel:[0,1] op_sel_hi:[1,1]
    v_pk_mul_f32 v[162:163], v[162:163], v[64:65] op_sel:[0,1] op_sel_hi:[1,1]
    v_cvt_pk_bf16_f32 v104, v160, v161
    v_cvt_pk_bf16_f32 v105, v162, v163
    v_pk_fma_f32 v[224:225], v[92:93], v[64:65], v[224:225] op_sel_hi:[1,0,1]
    v_pk_fma_f32 v[226:227], v[94:95], v[64:65], v[226:227] op_sel_hi:[1,0,1]
    v_pk_mul_f32 v[224:225], v[224:225], v[64:65] op_sel:[0,1] op_sel_hi:[1,1]
    v_pk_mul_f32 v[226:227], v[226:227], v[64:65] op_sel:[0,1] op_sel_hi:[1,1]
    v_cvt_pk_bf16_f32 v106, v224, v225
    v_cvt_pk_bf16_f32 v107, v226, v227
    ds_write_b128 v24, v[104:107] offset:0
    v_pk_fma_f32 v[164:165], v[84:85], v[66:67], v[164:165] op_sel_hi:[1,0,1]
    v_pk_fma_f32 v[166:167], v[86:87], v[66:67], v[166:167] op_sel_hi:[1,0,1]
    v_pk_mul_f32 v[164:165], v[164:165], v[66:67] op_sel:[0,1] op_sel_hi:[1,1]
    v_pk_mul_f32 v[166:167], v[166:167], v[66:67] op_sel:[0,1] op_sel_hi:[1,1]
    v_cvt_pk_bf16_f32 v108, v164, v165
    v_cvt_pk_bf16_f32 v109, v166, v167
    v_pk_fma_f32 v[228:229], v[92:93], v[66:67], v[228:229] op_sel_hi:[1,0,1]
    v_pk_fma_f32 v[230:231], v[94:95], v[66:67], v[230:231] op_sel_hi:[1,0,1]
    v_pk_mul_f32 v[228:229], v[228:229], v[66:67] op_sel:[0,1] op_sel_hi:[1,1]
    v_pk_mul_f32 v[230:231], v[230:231], v[66:67] op_sel:[0,1] op_sel_hi:[1,1]
    v_cvt_pk_bf16_f32 v110, v228, v229
    v_cvt_pk_bf16_f32 v111, v230, v231
    ds_write_b128 v24, v[108:111] offset:256
    v_pk_fma_f32 v[168:169], v[84:85], v[68:69], v[168:169] op_sel_hi:[1,0,1]
    v_pk_fma_f32 v[170:171], v[86:87], v[68:69], v[170:171] op_sel_hi:[1,0,1]
    v_pk_mul_f32 v[168:169], v[168:169], v[68:69] op_sel:[0,1] op_sel_hi:[1,1]
    v_pk_mul_f32 v[170:171], v[170:171], v[68:69] op_sel:[0,1] op_sel_hi:[1,1]
    v_cvt_pk_bf16_f32 v112, v168, v169
    v_cvt_pk_bf16_f32 v113, v170, v171
    v_pk_fma_f32 v[232:233], v[92:93], v[68:69], v[232:233] op_sel_hi:[1,0,1]
    v_pk_fma_f32 v[234:235], v[94:95], v[68:69], v[234:235] op_sel_hi:[1,0,1]
    v_pk_mul_f32 v[232:233], v[232:233], v[68:69] op_sel:[0,1] op_sel_hi:[1,1]
    v_pk_mul_f32 v[234:235], v[234:235], v[68:69] op_sel:[0,1] op_sel_hi:[1,1]
    v_cvt_pk_bf16_f32 v114, v232, v233
    v_cvt_pk_bf16_f32 v115, v234, v235
    ds_write_b128 v24, v[112:115] offset:2048
    v_pk_fma_f32 v[172:173], v[84:85], v[70:71], v[172:173] op_sel_hi:[1,0,1]
    v_pk_fma_f32 v[174:175], v[86:87], v[70:71], v[174:175] op_sel_hi:[1,0,1]
    v_pk_mul_f32 v[172:173], v[172:173], v[70:71] op_sel:[0,1] op_sel_hi:[1,1]
    v_pk_mul_f32 v[174:175], v[174:175], v[70:71] op_sel:[0,1] op_sel_hi:[1,1]
    v_cvt_pk_bf16_f32 v116, v172, v173
    v_cvt_pk_bf16_f32 v117, v174, v175
    v_pk_fma_f32 v[236:237], v[92:93], v[70:71], v[236:237] op_sel_hi:[1,0,1]
    v_pk_fma_f32 v[238:239], v[94:95], v[70:71], v[238:239] op_sel_hi:[1,0,1]
    v_pk_mul_f32 v[236:237], v[236:237], v[70:71] op_sel:[0,1] op_sel_hi:[1,1]
    v_pk_mul_f32 v[238:239], v[238:239], v[70:71] op_sel:[0,1] op_sel_hi:[1,1]
    v_cvt_pk_bf16_f32 v118, v236, v237
    v_cvt_pk_bf16_f32 v119, v238, v239
    ds_write_b128 v24, v[116:119] offset:2304
    v_pk_fma_f32 v[176:177], v[84:85], v[72:73], v[176:177] op_sel_hi:[1,0,1]
    v_pk_fma_f32 v[178:179], v[86:87], v[72:73], v[178:179] op_sel_hi:[1,0,1]
    v_pk_mul_f32 v[176:177], v[176:177], v[72:73] op_sel:[0,1] op_sel_hi:[1,1]
    v_pk_mul_f32 v[178:179], v[178:179], v[72:73] op_sel:[0,1] op_sel_hi:[1,1]
    v_cvt_pk_bf16_f32 v104, v176, v177
    v_cvt_pk_bf16_f32 v105, v178, v179
    v_pk_fma_f32 v[240:241], v[92:93], v[72:73], v[240:241] op_sel_hi:[1,0,1]
    v_pk_fma_f32 v[242:243], v[94:95], v[72:73], v[242:243] op_sel_hi:[1,0,1]
    v_pk_mul_f32 v[240:241], v[240:241], v[72:73] op_sel:[0,1] op_sel_hi:[1,1]
    v_pk_mul_f32 v[242:243], v[242:243], v[72:73] op_sel:[0,1] op_sel_hi:[1,1]
    v_cvt_pk_bf16_f32 v106, v240, v241
    v_cvt_pk_bf16_f32 v107, v242, v243
    ds_write_b128 v24, v[104:107] offset:4096
    v_pk_fma_f32 v[180:181], v[84:85], v[74:75], v[180:181] op_sel_hi:[1,0,1]
    v_pk_fma_f32 v[182:183], v[86:87], v[74:75], v[182:183] op_sel_hi:[1,0,1]
    v_pk_mul_f32 v[180:181], v[180:181], v[74:75] op_sel:[0,1] op_sel_hi:[1,1]
    v_pk_mul_f32 v[182:183], v[182:183], v[74:75] op_sel:[0,1] op_sel_hi:[1,1]
    v_cvt_pk_bf16_f32 v108, v180, v181
    v_cvt_pk_bf16_f32 v109, v182, v183
    v_pk_fma_f32 v[244:245], v[92:93], v[74:75], v[244:245] op_sel_hi:[1,0,1]
    v_pk_fma_f32 v[246:247], v[94:95], v[74:75], v[246:247] op_sel_hi:[1,0,1]
    v_pk_mul_f32 v[244:245], v[244:245], v[74:75] op_sel:[0,1] op_sel_hi:[1,1]
    v_pk_mul_f32 v[246:247], v[246:247], v[74:75] op_sel:[0,1] op_sel_hi:[1,1]
    v_cvt_pk_bf16_f32 v110, v244, v245
    v_cvt_pk_bf16_f32 v111, v246, v247
    ds_write_b128 v24, v[108:111] offset:4352
    v_pk_fma_f32 v[184:185], v[84:85], v[76:77], v[184:185] op_sel_hi:[1,0,1]
    v_pk_fma_f32 v[186:187], v[86:87], v[76:77], v[186:187] op_sel_hi:[1,0,1]
    v_pk_mul_f32 v[184:185], v[184:185], v[76:77] op_sel:[0,1] op_sel_hi:[1,1]
    v_pk_mul_f32 v[186:187], v[186:187], v[76:77] op_sel:[0,1] op_sel_hi:[1,1]
    v_cvt_pk_bf16_f32 v112, v184, v185
    v_cvt_pk_bf16_f32 v113, v186, v187
    v_pk_fma_f32 v[248:249], v[92:93], v[76:77], v[248:249] op_sel_hi:[1,0,1]
    v_pk_fma_f32 v[250:251], v[94:95], v[76:77], v[250:251] op_sel_hi:[1,0,1]
    v_pk_mul_f32 v[248:249], v[248:249], v[76:77] op_sel:[0,1] op_sel_hi:[1,1]
    v_pk_mul_f32 v[250:251], v[250:251], v[76:77] op_sel:[0,1] op_sel_hi:[1,1]
    v_cvt_pk_bf16_f32 v114, v248, v249
    v_cvt_pk_bf16_f32 v115, v250, v251
    ds_write_b128 v24, v[112:115] offset:6144
    v_pk_fma_f32 v[188:189], v[84:85], v[78:79], v[188:189] op_sel_hi:[1,0,1]
    v_pk_fma_f32 v[190:191], v[86:87], v[78:79], v[190:191] op_sel_hi:[1,0,1]
    v_pk_mul_f32 v[188:189], v[188:189], v[78:79] op_sel:[0,1] op_sel_hi:[1,1]
    v_pk_mul_f32 v[190:191], v[190:191], v[78:79] op_sel:[0,1] op_sel_hi:[1,1]
    v_cvt_pk_bf16_f32 v116, v188, v189
    v_cvt_pk_bf16_f32 v117, v190, v191
    v_pk_fma_f32 v[252:253], v[92:93], v[78:79], v[252:253] op_sel_hi:[1,0,1]
    v_pk_fma_f32 v[254:255], v[94:95], v[78:79], v[254:255] op_sel_hi:[1,0,1]
    v_pk_mul_f32 v[252:253], v[252:253], v[78:79] op_sel:[0,1] op_sel_hi:[1,1]
    v_pk_mul_f32 v[254:255], v[254:255], v[78:79] op_sel:[0,1] op_sel_hi:[1,1]
    v_cvt_pk_bf16_f32 v118, v252, v253
    v_cvt_pk_bf16_f32 v119, v254, v255
    ds_write_b128 v24, v[116:119] offset:6400
    s_lshl_b32 s33, s33, 3
    s_add_u32 s24, s24, s33
    v_pk_fma_f32 v[128:129], v[80:81], v[64:65], v[128:129] op_sel_hi:[1,0,1]
    v_pk_fma_f32 v[130:131], v[82:83], v[64:65], v[130:131] op_sel_hi:[1,0,1]
    v_pk_fma_f32 v[192:193], v[88:89], v[64:65], v[192:193] op_sel_hi:[1,0,1]
    v_pk_fma_f32 v[194:195], v[90:91], v[64:65], v[194:195] op_sel_hi:[1,0,1]
    v_max_f32 v128, 0, v128
    v_max_f32 v129, 0, v129
    v_max_f32 v130, 0, v130
    v_max_f32 v131, 0, v131
    v_pk_mul_f32 v[192:193], v[192:193], v[96:97] op_sel_hi:[1,0]
    v_pk_mul_f32 v[194:195], v[194:195], v[96:97] op_sel_hi:[1,0]
    v_pk_mul_f32 v[128:129], v[128:129], v[192:193]
    v_pk_mul_f32 v[130:131], v[130:131], v[194:195]
    v_cvt_pk_bf16_f32 v161, v130, v131
    v_cvt_pk_bf16_f32 v160, v128, v129
    buffer_store_dwordx2 v[160:161], v4, s[36:39], s24 offen offset:0 sc1
    v_pk_fma_f32 v[132:133], v[80:81], v[66:67], v[132:133] op_sel_hi:[1,0,1]
    v_pk_fma_f32 v[134:135], v[82:83], v[66:67], v[134:135] op_sel_hi:[1,0,1]
    v_pk_fma_f32 v[196:197], v[88:89], v[66:67], v[196:197] op_sel_hi:[1,0,1]
    v_pk_fma_f32 v[198:199], v[90:91], v[66:67], v[198:199] op_sel_hi:[1,0,1]
    v_max_f32 v132, 0, v132
    v_max_f32 v133, 0, v133
    v_max_f32 v134, 0, v134
    v_max_f32 v135, 0, v135
    v_pk_mul_f32 v[196:197], v[196:197], v[96:97] op_sel:[0,1] op_sel_hi:[1,1]
    v_pk_mul_f32 v[198:199], v[198:199], v[96:97] op_sel:[0,1] op_sel_hi:[1,1]
    v_pk_mul_f32 v[132:133], v[132:133], v[196:197]
    v_pk_mul_f32 v[134:135], v[134:135], v[198:199]
    v_cvt_pk_bf16_f32 v165, v134, v135
    v_cvt_pk_bf16_f32 v164, v132, v133
    v_pk_fma_f32 v[136:137], v[80:81], v[68:69], v[136:137] op_sel_hi:[1,0,1]
    v_pk_fma_f32 v[138:139], v[82:83], v[68:69], v[138:139] op_sel_hi:[1,0,1]
    v_pk_fma_f32 v[200:201], v[88:89], v[68:69], v[200:201] op_sel_hi:[1,0,1]
    v_pk_fma_f32 v[202:203], v[90:91], v[68:69], v[202:203] op_sel_hi:[1,0,1]
    v_max_f32 v136, 0, v136
    v_max_f32 v137, 0, v137
    v_max_f32 v138, 0, v138
    v_max_f32 v139, 0, v139
    v_pk_mul_f32 v[200:201], v[200:201], v[98:99] op_sel_hi:[1,0]
    v_pk_mul_f32 v[202:203], v[202:203], v[98:99] op_sel_hi:[1,0]
    v_pk_mul_f32 v[136:137], v[136:137], v[200:201]
    v_pk_mul_f32 v[138:139], v[138:139], v[202:203]
    v_cvt_pk_bf16_f32 v169, v138, v139
    v_cvt_pk_bf16_f32 v168, v136, v137
    buffer_store_dwordx2 v[164:165], v4, s[36:39], s24 offen offset:256 sc1
    v_pk_fma_f32 v[140:141], v[80:81], v[70:71], v[140:141] op_sel_hi:[1,0,1]
    v_pk_fma_f32 v[142:143], v[82:83], v[70:71], v[142:143] op_sel_hi:[1,0,1]
    v_pk_fma_f32 v[204:205], v[88:89], v[70:71], v[204:205] op_sel_hi:[1,0,1]
    v_pk_fma_f32 v[206:207], v[90:91], v[70:71], v[206:207] op_sel_hi:[1,0,1]
    v_max_f32 v140, 0, v140
    v_max_f32 v141, 0, v141
    v_max_f32 v142, 0, v142
    v_max_f32 v143, 0, v143
    v_pk_mul_f32 v[204:205], v[204:205], v[98:99] op_sel:[0,1] op_sel_hi:[1,1]
    v_pk_mul_f32 v[206:207], v[206:207], v[98:99] op_sel:[0,1] op_sel_hi:[1,1]
    v_pk_mul_f32 v[140:141], v[140:141], v[204:205]
    v_pk_mul_f32 v[142:143], v[142:143], v[206:207]
    v_cvt_pk_bf16_f32 v173, v142, v143
    v_cvt_pk_bf16_f32 v172, v140, v141
    v_pk_fma_f32 v[144:145], v[80:81], v[72:73], v[144:145] op_sel_hi:[1,0,1]
    v_pk_fma_f32 v[146:147], v[82:83], v[72:73], v[146:147] op_sel_hi:[1,0,1]
    v_pk_fma_f32 v[208:209], v[88:89], v[72:73], v[208:209] op_sel_hi:[1,0,1]
    v_pk_fma_f32 v[210:211], v[90:91], v[72:73], v[210:211] op_sel_hi:[1,0,1]
    v_max_f32 v144, 0, v144
    v_max_f32 v145, 0, v145
    v_max_f32 v146, 0, v146
    v_max_f32 v147, 0, v147
    v_pk_mul_f32 v[208:209], v[208:209], v[100:101] op_sel_hi:[1,0]
    v_pk_mul_f32 v[210:211], v[210:211], v[100:101] op_sel_hi:[1,0]
    v_pk_mul_f32 v[144:145], v[144:145], v[208:209]
    v_pk_mul_f32 v[146:147], v[146:147], v[210:211]
    v_cvt_pk_bf16_f32 v177, v146, v147
    v_cvt_pk_bf16_f32 v176, v144, v145
    buffer_store_dwordx2 v[168:169], v4, s[36:39], s24 offen offset:2048 sc1
    v_pk_fma_f32 v[148:149], v[80:81], v[74:75], v[148:149] op_sel_hi:[1,0,1]
    v_pk_fma_f32 v[150:151], v[82:83], v[74:75], v[150:151] op_sel_hi:[1,0,1]
    v_pk_fma_f32 v[212:213], v[88:89], v[74:75], v[212:213] op_sel_hi:[1,0,1]
    v_pk_fma_f32 v[214:215], v[90:91], v[74:75], v[214:215] op_sel_hi:[1,0,1]
    v_max_f32 v148, 0, v148
    v_max_f32 v149, 0, v149
    v_max_f32 v150, 0, v150
    v_max_f32 v151, 0, v151
    v_pk_mul_f32 v[212:213], v[212:213], v[100:101] op_sel:[0,1] op_sel_hi:[1,1]
    v_pk_mul_f32 v[214:215], v[214:215], v[100:101] op_sel:[0,1] op_sel_hi:[1,1]
    v_pk_mul_f32 v[148:149], v[148:149], v[212:213]
    v_pk_mul_f32 v[150:151], v[150:151], v[214:215]
    v_cvt_pk_bf16_f32 v181, v150, v151
    v_cvt_pk_bf16_f32 v180, v148, v149
    v_pk_fma_f32 v[152:153], v[80:81], v[76:77], v[152:153] op_sel_hi:[1,0,1]
    v_pk_fma_f32 v[154:155], v[82:83], v[76:77], v[154:155] op_sel_hi:[1,0,1]
    v_pk_fma_f32 v[216:217], v[88:89], v[76:77], v[216:217] op_sel_hi:[1,0,1]
    v_pk_fma_f32 v[218:219], v[90:91], v[76:77], v[218:219] op_sel_hi:[1,0,1]
    v_max_f32 v152, 0, v152
    v_max_f32 v153, 0, v153
    v_max_f32 v154, 0, v154
    v_max_f32 v155, 0, v155
    v_pk_mul_f32 v[216:217], v[216:217], v[102:103] op_sel_hi:[1,0]
    v_pk_mul_f32 v[218:219], v[218:219], v[102:103] op_sel_hi:[1,0]
    v_pk_mul_f32 v[152:153], v[152:153], v[216:217]
    v_pk_mul_f32 v[154:155], v[154:155], v[218:219]
    v_cvt_pk_bf16_f32 v185, v154, v155
    v_cvt_pk_bf16_f32 v184, v152, v153
    buffer_store_dwordx2 v[172:173], v4, s[36:39], s24 offen offset:2304 sc1
    v_pk_fma_f32 v[156:157], v[80:81], v[78:79], v[156:157] op_sel_hi:[1,0,1]
    v_pk_fma_f32 v[158:159], v[82:83], v[78:79], v[158:159] op_sel_hi:[1,0,1]
    v_pk_fma_f32 v[220:221], v[88:89], v[78:79], v[220:221] op_sel_hi:[1,0,1]
    v_pk_fma_f32 v[222:223], v[90:91], v[78:79], v[222:223] op_sel_hi:[1,0,1]
    v_max_f32 v156, 0, v156
    v_max_f32 v157, 0, v157
    v_max_f32 v158, 0, v158
    v_max_f32 v159, 0, v159
    v_pk_mul_f32 v[220:221], v[220:221], v[102:103] op_sel:[0,1] op_sel_hi:[1,1]
    v_pk_mul_f32 v[222:223], v[222:223], v[102:103] op_sel:[0,1] op_sel_hi:[1,1]
    v_pk_mul_f32 v[156:157], v[156:157], v[220:221]
    v_pk_mul_f32 v[158:159], v[158:159], v[222:223]
    v_cvt_pk_bf16_f32 v189, v158, v159
    v_cvt_pk_bf16_f32 v188, v156, v157
P1_EPD:
    s_add_u32 s96, s6, 33554432
    s_addc_u32 s97, s7, 0
    s_mov_b32 s98, 8388608
    s_mov_b32 s99, 0x20000
    s_lshl_b32 s35, s3, 10
    v_add_u32 v20, s35, v19
    v_lshlrev_b32 v3, 1, v16
    v_xor_b32 v3, v3, v17
    v_lshlrev_b32 v3, 4, v3
    v_lshl_add_u32 v3, v16, 11, v3
    s_lshl_b32 s32, s3, 13
    s_lshl_b32 s33, s53, 8
    s_add_u32 s32, s32, s33
    s_lshl_b32 s33, s29, 7
    v_xor_b32 v21, s33, v3
    v_add_u32 v21, s32, v21
    s_mul_i32 s32, s52, 144
    s_mul_i32 s33, s54, 56
    s_add_u32 s32, s32, s33
    s_lshl_b32 s21, s32, 13
    s_lshl_b32 s22, s33, 16
    s_mov_b32 s57, 0
    v_lshlrev_b32 v31, 6, v1
    s_lshr_b32 s32, s2, 3
    s_lshl_b32 s32, s32, 12
    s_add_u32 s4, s22, s32
    s_lshl_b32 s32, s53, 12
    s_add_u32 s5, s21, s32
    v_lshlrev_b32 v26, 11, v17
    v_and_b32 v27, 1, v16
    v_lshl_add_u32 v26, v27, 5, v26
    v_lshrrev_b32 v27, 1, v16
    v_lshl_add_u32 v8, v27, 4, v26
    v_add_u32 v9, 32768, v8
    v_add_u32 v10, 65536, v8
    v_add_u32 v11, 98304, v8
    s_lshl_b32 s50, s52, 18
    s_lshl_b32 s32, s30, 17
    s_add_u32 s50, s50, s32
    s_lshl_b32 s32, s53, 8
    s_add_u32 s50, s50, s32
    s_lshl_b32 s32, s54, 7
    s_add_u32 s50, s50, s32
    s_lshl_b32 s32, s29, 6
    s_add_u32 s50, s50, s32
    s_mov_b32 s12, s44
    s_mov_b32 s13, s45
    s_mov_b32 s14, 4194304
    s_mov_b32 s15, 0x20000
    v_lshrrev_b32 v25, 2, v1
    v_xor_b32 v25, v25, v16
    v_and_b32 v25, 1, v25
    v_and_b32 v26, 3, v1
    v_or_b32 v25, v25, v26
    v_cmp_eq_u32 vcc, 0, v25
    v_mov_b32 v26, 0x3f803f80
    v_mov_b32 v27, 0
    s_waitcnt vmcnt(4) lgkmcnt(0)
    s_barrier
    ds_read_b128 v[32:35], v14 offset:0
    ds_read_b128 v[36:39], v14 offset:1024
    ds_read_b128 v[40:43], v18 offset:20480
    ds_read_b128 v[44:47], v18 offset:21504
    ds_read_b128 v[48:51], v18 offset:22528
    ds_read_b128 v[52:55], v18 offset:23552
    v_cndmask_b32 v88, v27, v26, vcc
    v_cndmask_b32 v89, v27, v26, vcc
    v_cndmask_b32 v90, v27, v26, vcc
    v_cndmask_b32 v91, v27, v26, vcc
    v_mov_b32 v92, 0
    v_mov_b32 v93, 0
    v_mov_b32 v94, 0
    v_mov_b32 v95, 0
    v_mov_b32 v128, 0
    v_mov_b32 v129, 0
    v_mov_b32 v130, 0
    v_mov_b32 v131, 0
    v_mov_b32 v132, 0
    v_mov_b32 v133, 0
    v_mov_b32 v134, 0
    v_mov_b32 v135, 0
    v_mov_b32 v136, 0
    v_mov_b32 v137, 0
    v_mov_b32 v138, 0
    v_mov_b32 v139, 0
    v_mov_b32 v140, 0
    v_mov_b32 v141, 0
    v_mov_b32 v142, 0
    v_mov_b32 v143, 0
    s_waitcnt lgkmcnt(0)
    v_mfma_f32_32x32x16_bf16 v[96:111], v[40:43], v[32:35], 0
    v_mfma_f32_32x32x16_bf16 v[96:111], v[44:47], v[36:39], v[96:111]
    s_nop 11
    v_max3_f32 v26, v96, v97, v98
    v_max3_f32 v26, v26, v99, v100
    v_max3_f32 v26, v26, v101, v102
    v_max3_f32 v26, v26, v103, v104
    v_max3_f32 v26, v26, v105, v106
    v_max3_f32 v26, v26, v107, v108
    v_max3_f32 v26, v26, v109, v110
    v_max_f32 v26, v26, v111
    v_mov_b32 v27, v26
    s_nop 1
    v_permlane32_swap_b32 v26, v27
    s_nop 0
    v_max_f32 v26, v26, v27
    v_sub_f32 v144, 0, v26
    v_sub_f32 v145, 0, v26
    v_sub_f32 v146, 0, v26
    v_sub_f32 v147, 0, v26
    v_sub_f32 v148, 0, v26
    v_sub_f32 v149, 0, v26
    v_sub_f32 v150, 0, v26
    v_sub_f32 v151, 0, v26
    v_sub_f32 v152, 0, v26
    v_sub_f32 v153, 0, v26
    v_sub_f32 v154, 0, v26
    v_sub_f32 v155, 0, v26
    v_sub_f32 v156, 0, v26
    v_sub_f32 v157, 0, v26
    v_sub_f32 v158, 0, v26
    v_sub_f32 v159, 0, v26
    v_sub_f32 v96, v96, v26
    v_sub_f32 v97, v97, v26
    v_sub_f32 v98, v98, v26
    v_sub_f32 v99, v99, v26
    v_sub_f32 v100, v100, v26
    v_sub_f32 v101, v101, v26
    v_sub_f32 v102, v102, v26
    v_sub_f32 v103, v103, v26
    v_sub_f32 v104, v104, v26
    v_sub_f32 v105, v105, v26
    v_sub_f32 v106, v106, v26
    v_sub_f32 v107, v107, v26
    v_sub_f32 v108, v108, v26
    v_sub_f32 v109, v109, v26
    v_sub_f32 v110, v110, v26
    v_sub_f32 v111, v111, v26
    s_waitcnt vmcnt(4) lgkmcnt(0)
    s_barrier
    v_mfma_f32_32x32x16_bf16 v[112:127], v[48:51], v[32:35], v[144:159]
    s_mov_b32 m0, s56
    s_xor_b32 s56, s56, 0x4000
    buffer_load_dwordx4 v19, s[40:43], s55 offen sc1 lds
    v_exp_f32 v96, v96
    v_exp_f32 v97, v97
    v_exp_f32 v98, v98
    buffer_load_dwordx4 v19, s[40:43], s55 offen offset:1024 sc1 lds
    s_add_u32 s55, s55, 8192
    v_cvt_pk_bf16_f32 v72, v96, v97
    v_mfma_f32_32x32x16_bf16 v[112:127], v[52:55], v[36:39], v[112:127]
    ds_read_b128 v[40:43], v18 offset:0
    v_exp_f32 v99, v99
    v_exp_f32 v100, v100
    v_cvt_pk_bf16_f32 v73, v98, v99
    ds_read_b128 v[44:47], v18 offset:1024
    v_exp_f32 v101, v101
    v_exp_f32 v102, v102
    v_cvt_pk_bf16_f32 v74, v100, v101
    v_exp_f32 v103, v103
    v_exp_f32 v104, v104
    ds_read_b128 v[56:59], v18 offset:8192
    v_cvt_pk_bf16_f32 v75, v102, v103
    v_exp_f32 v105, v105
    v_exp_f32 v106, v106
    v_cvt_pk_bf16_f32 v76, v104, v105
    v_exp_f32 v107, v107
    v_exp_f32 v108, v108
    v_cvt_pk_bf16_f32 v77, v106, v107
    v_exp_f32 v109, v109
    v_exp_f32 v110, v110
    v_cvt_pk_bf16_f32 v78, v108, v109
    v_exp_f32 v111, v111
    s_nop 0
    v_cvt_pk_bf16_f32 v79, v110, v111
    ds_read_b128 v[60:63], v18 offset:9216
    s_waitcnt lgkmcnt(0)
    v_mfma_f32_32x32x16_bf16 v[96:111], v[40:43], v[32:35], v[144:159]
    ds_read_b128 v[48:51], v18 offset:2048
    v_exp_f32 v112, v112
    v_exp_f32 v113, v113
    v_exp_f32 v114, v114
    v_cvt_pk_bf16_f32 v80, v112, v113
    v_mfma_f32_32x32x16_bf16 v[96:111], v[44:47], v[36:39], v[96:111]
    ds_read_b128 v[52:55], v18 offset:3072
    v_exp_f32 v115, v115
    v_exp_f32 v116, v116
    v_cvt_pk_bf16_f32 v81, v114, v115
    v_exp_f32 v117, v117
    v_exp_f32 v118, v118
    v_mfma_f32_32x32x16_bf16 v[128:143], v[56:59], v[72:75], v[128:143]
    ds_read_b128 v[64:67], v18 offset:10240
    v_cvt_pk_bf16_f32 v82, v116, v117
    v_exp_f32 v119, v119
    v_exp_f32 v120, v120
    v_cvt_pk_bf16_f32 v83, v118, v119
    v_mfma_f32_16x16x32_bf16 v[92:95], v[88:91], v[72:75], v[92:95]
    ds_read_b128 v[68:71], v18 offset:11264
    v_exp_f32 v121, v121
    v_exp_f32 v122, v122
    v_cvt_pk_bf16_f32 v84, v120, v121
    v_mfma_f32_32x32x16_bf16 v[128:143], v[60:63], v[76:79], v[128:143]
    v_exp_f32 v123, v123
    v_exp_f32 v124, v124
    v_cvt_pk_bf16_f32 v85, v122, v123
    v_exp_f32 v125, v125
    v_exp_f32 v126, v126
    v_mfma_f32_16x16x32_bf16 v[92:95], v[88:91], v[76:79], v[92:95]
    v_cvt_pk_bf16_f32 v86, v124, v125
    v_exp_f32 v127, v127
    s_nop 0
    v_cvt_pk_bf16_f32 v87, v126, v127
    s_waitcnt lgkmcnt(0)
    v_mfma_f32_32x32x16_bf16 v[112:127], v[48:51], v[32:35], v[144:159]
    s_cmp_eq_u32 s31, 3
    s_cbranch_scc1 HS4A
    buffer_store_dwordx4 v[176:179], v5, s[36:39], s24 offen offset:0 sc1
    s_branch HS4B
HS4A:
    buffer_store_dwordx2 v[176:177], v5, s[36:39], s24 offen offset:0 sc1
HS4B:
    v_exp_f32 v96, v96
    v_exp_f32 v97, v97
    v_exp_f32 v98, v98
    v_cvt_pk_bf16_f32 v72, v96, v97
    v_mfma_f32_32x32x16_bf16 v[112:127], v[52:55], v[36:39], v[112:127]
    ds_read_b128 v[40:43], v18 offset:4096
    v_exp_f32 v99, v99
    v_exp_f32 v100, v100
    v_cvt_pk_bf16_f32 v73, v98, v99
    v_exp_f32 v101, v101
    v_exp_f32 v102, v102
    v_mfma_f32_32x32x16_bf16 v[128:143], v[64:67], v[80:83], v[128:143]
    ds_read_b128 v[44:47], v18 offset:5120
    v_cvt_pk_bf16_f32 v74, v100, v101
    v_exp_f32 v103, v103
    v_exp_f32 v104, v104
    v_cvt_pk_bf16_f32 v75, v102, v103
    v_mfma_f32_16x16x32_bf16 v[92:95], v[88:91], v[80:83], v[92:95]
    ds_read_b128 v[56:59], v18 offset:12288
    v_exp_f32 v105, v105
    v_exp_f32 v106, v106
    v_cvt_pk_bf16_f32 v76, v104, v105
    v_mfma_f32_32x32x16_bf16 v[128:143], v[68:71], v[84:87], v[128:143]
    ds_read_b128 v[60:63], v18 offset:13312
    v_exp_f32 v107, v107
    v_exp_f32 v108, v108
    v_cvt_pk_bf16_f32 v77, v106, v107
    v_exp_f32 v109, v109
    v_exp_f32 v110, v110
    v_mfma_f32_16x16x32_bf16 v[92:95], v[88:91], v[84:87], v[92:95]
    v_cvt_pk_bf16_f32 v78, v108, v109
    v_exp_f32 v111, v111
    s_nop 0
    v_cvt_pk_bf16_f32 v79, v110, v111
    s_waitcnt lgkmcnt(0)
    v_mfma_f32_32x32x16_bf16 v[96:111], v[40:43], v[32:35], v[144:159]
    s_cmp_eq_u32 s31, 3
    s_cbranch_scc1 HS5A
    buffer_store_dwordx4 v[180:183], v5, s[36:39], s24 offen offset:256 sc1
    s_branch HS5B
HS5A:
    buffer_store_dwordx2 v[180:181], v5, s[36:39], s24 offen offset:256 sc1
HS5B:
    v_exp_f32 v112, v112
    v_exp_f32 v113, v113
    v_exp_f32 v114, v114
    v_cvt_pk_bf16_f32 v80, v112, v113
    v_mfma_f32_32x32x16_bf16 v[96:111], v[44:47], v[36:39], v[96:111]
    ds_read_b128 v[48:51], v18 offset:6144
    v_exp_f32 v115, v115
    v_exp_f32 v116, v116
    v_cvt_pk_bf16_f32 v81, v114, v115
    v_exp_f32 v117, v117
    v_exp_f32 v118, v118
    v_mfma_f32_32x32x16_bf16 v[128:143], v[56:59], v[72:75], v[128:143]
    ds_read_b128 v[52:55], v18 offset:7168
    v_cvt_pk_bf16_f32 v82, v116, v117
    v_exp_f32 v119, v119
    v_exp_f32 v120, v120
    v_cvt_pk_bf16_f32 v83, v118, v119
    v_mfma_f32_16x16x32_bf16 v[92:95], v[88:91], v[72:75], v[92:95]
    ds_read_b128 v[64:67], v18 offset:14336
    v_exp_f32 v121, v121
    v_exp_f32 v122, v122
    v_cvt_pk_bf16_f32 v84, v120, v121
    v_mfma_f32_32x32x16_bf16 v[128:143], v[60:63], v[76:79], v[128:143]
    ds_read_b128 v[68:71], v18 offset:15360
    v_exp_f32 v123, v123
    v_exp_f32 v124, v124
    v_cvt_pk_bf16_f32 v85, v122, v123
    v_exp_f32 v125, v125
    v_exp_f32 v126, v126
    v_mfma_f32_16x16x32_bf16 v[92:95], v[88:91], v[76:79], v[92:95]
    v_cvt_pk_bf16_f32 v86, v124, v125
    v_exp_f32 v127, v127
    s_nop 0
    v_cvt_pk_bf16_f32 v87, v126, v127
    s_waitcnt vmcnt(2) lgkmcnt(0)
    s_barrier
    v_xor_b32 v18, 0x4000, v18
    v_mfma_f32_32x32x16_bf16 v[112:127], v[48:51], v[32:35], v[144:159]
    s_mov_b32 m0, s56
    s_xor_b32 s56, s56, 0x4000
    buffer_load_dwordx4 v19, s[40:43], s55 offen sc1 lds
    v_exp_f32 v96, v96
    v_exp_f32 v97, v97
    v_exp_f32 v98, v98
    v_cvt_pk_bf16_f32 v72, v96, v97
    v_mfma_f32_32x32x16_bf16 v[112:127], v[52:55], v[36:39], v[112:127]
    buffer_load_dwordx4 v19, s[40:43], s55 offen offset:1024 sc1 lds
    s_add_u32 s55, s55, 8192
    v_exp_f32 v99, v99
    v_exp_f32 v100, v100
    v_cvt_pk_bf16_f32 v73, v98, v99
    v_exp_f32 v101, v101
    v_exp_f32 v102, v102
    v_mfma_f32_32x32x16_bf16 v[128:143], v[64:67], v[80:83], v[128:143]
    ds_read_b128 v[40:43], v18 offset:0
    v_cvt_pk_bf16_f32 v74, v100, v101
    v_exp_f32 v103, v103
    v_exp_f32 v104, v104
    v_cvt_pk_bf16_f32 v75, v102, v103
    v_mfma_f32_16x16x32_bf16 v[92:95], v[88:91], v[80:83], v[92:95]
    ds_read_b128 v[44:47], v18 offset:1024
    v_exp_f32 v105, v105
    v_exp_f32 v106, v106
    v_cvt_pk_bf16_f32 v76, v104, v105
    v_mfma_f32_32x32x16_bf16 v[128:143], v[68:71], v[84:87], v[128:143]
    ds_read_b128 v[56:59], v18 offset:8192
    v_exp_f32 v107, v107
    v_exp_f32 v108, v108
    v_cvt_pk_bf16_f32 v77, v106, v107
    v_exp_f32 v109, v109
    v_exp_f32 v110, v110
    v_mfma_f32_16x16x32_bf16 v[92:95], v[88:91], v[84:87], v[92:95]
    ds_read_b128 v[60:63], v18 offset:9216
    v_cvt_pk_bf16_f32 v78, v108, v109
    v_exp_f32 v111, v111
    s_nop 0
    v_cvt_pk_bf16_f32 v79, v110, v111
    s_waitcnt lgkmcnt(0)
    v_mfma_f32_32x32x16_bf16 v[96:111], v[40:43], v[32:35], v[144:159]
    ds_read_b128 v[48:51], v18 offset:2048
    v_exp_f32 v112, v112
    v_exp_f32 v113, v113
    v_exp_f32 v114, v114
    v_cvt_pk_bf16_f32 v80, v112, v113
    v_mfma_f32_32x32x16_bf16 v[96:111], v[44:47], v[36:39], v[96:111]
    ds_read_b128 v[52:55], v18 offset:3072
    v_exp_f32 v115, v115
    v_exp_f32 v116, v116
    v_cvt_pk_bf16_f32 v81, v114, v115
    v_exp_f32 v117, v117
    v_exp_f32 v118, v118
    v_mfma_f32_32x32x16_bf16 v[128:143], v[56:59], v[72:75], v[128:143]
    ds_read_b128 v[64:67], v18 offset:10240
    v_cvt_pk_bf16_f32 v82, v116, v117
    v_exp_f32 v119, v119
    v_exp_f32 v120, v120
    v_cvt_pk_bf16_f32 v83, v118, v119
    v_mfma_f32_16x16x32_bf16 v[92:95], v[88:91], v[72:75], v[92:95]
    ds_read_b128 v[68:71], v18 offset:11264
    v_exp_f32 v121, v121
    v_exp_f32 v122, v122
    v_cvt_pk_bf16_f32 v84, v120, v121
    v_mfma_f32_32x32x16_bf16 v[128:143], v[60:63], v[76:79], v[128:143]
    v_exp_f32 v123, v123
    v_exp_f32 v124, v124
    v_cvt_pk_bf16_f32 v85, v122, v123
    v_exp_f32 v125, v125
    v_exp_f32 v126, v126
    v_mfma_f32_16x16x32_bf16 v[92:95], v[88:91], v[76:79], v[92:95]
    v_cvt_pk_bf16_f32 v86, v124, v125
    v_exp_f32 v127, v127
    s_nop 0
    v_cvt_pk_bf16_f32 v87, v126, v127
    s_waitcnt lgkmcnt(0)
    v_mfma_f32_32x32x16_bf16 v[112:127], v[48:51], v[32:35], v[144:159]
    s_cmp_eq_u32 s31, 3
    s_cbranch_scc1 HS6A
    buffer_store_dwordx4 v[184:187], v5, s[36:39], s24 offen offset:2048 sc1
    s_branch HS6B
HS6A:
    buffer_store_dwordx2 v[184:185], v5, s[36:39], s24 offen offset:2048 sc1
HS6B:
    v_exp_f32 v96, v96
    v_exp_f32 v97, v97
    v_exp_f32 v98, v98
    v_cvt_pk_bf16_f32 v72, v96, v97
    v_mfma_f32_32x32x16_bf16 v[112:127], v[52:55], v[36:39], v[112:127]
    ds_read_b128 v[40:43], v18 offset:4096
    v_exp_f32 v99, v99
    v_exp_f32 v100, v100
    v_cvt_pk_bf16_f32 v73, v98, v99
    v_exp_f32 v101, v101
    v_exp_f32 v102, v102
    v_mfma_f32_32x32x16_bf16 v[128:143], v[64:67], v[80:83], v[128:143]
    ds_read_b128 v[44:47], v18 offset:5120
    v_cvt_pk_bf16_f32 v74, v100, v101
    v_exp_f32 v103, v103
    v_exp_f32 v104, v104
    v_cvt_pk_bf16_f32 v75, v102, v103
    v_mfma_f32_16x16x32_bf16 v[92:95], v[88:91], v[80:83], v[92:95]
    ds_read_b128 v[56:59], v18 offset:12288
    v_exp_f32 v105, v105
    v_exp_f32 v106, v106
    v_cvt_pk_bf16_f32 v76, v104, v105
    v_mfma_f32_32x32x16_bf16 v[128:143], v[68:71], v[84:87], v[128:143]
    ds_read_b128 v[60:63], v18 offset:13312
    v_exp_f32 v107, v107
    v_exp_f32 v108, v108
    v_cvt_pk_bf16_f32 v77, v106, v107
    v_exp_f32 v109, v109
    v_exp_f32 v110, v110
    v_mfma_f32_16x16x32_bf16 v[92:95], v[88:91], v[84:87], v[92:95]
    v_cvt_pk_bf16_f32 v78, v108, v109
    v_exp_f32 v111, v111
    s_nop 0
    v_cvt_pk_bf16_f32 v79, v110, v111
    s_waitcnt lgkmcnt(0)
    v_mfma_f32_32x32x16_bf16 v[96:111], v[40:43], v[32:35], v[144:159]
    s_cmp_eq_u32 s31, 3
    s_cbranch_scc1 HS7A
    buffer_store_dwordx4 v[188:191], v5, s[36:39], s24 offen offset:2304 sc1
    s_branch HS7B
HS7A:
    buffer_store_dwordx2 v[188:189], v5, s[36:39], s24 offen offset:2304 sc1
HS7B:
    v_exp_f32 v112, v112
    v_exp_f32 v113, v113
    v_exp_f32 v114, v114
    v_cvt_pk_bf16_f32 v80, v112, v113
    v_mfma_f32_32x32x16_bf16 v[96:111], v[44:47], v[36:39], v[96:111]
    ds_read_b128 v[48:51], v18 offset:6144
    v_exp_f32 v115, v115
    v_exp_f32 v116, v116
    v_cvt_pk_bf16_f32 v81, v114, v115
    v_exp_f32 v117, v117
    v_exp_f32 v118, v118
    v_mfma_f32_32x32x16_bf16 v[128:143], v[56:59], v[72:75], v[128:143]
    ds_read_b128 v[52:55], v18 offset:7168
    v_cvt_pk_bf16_f32 v82, v116, v117
    v_exp_f32 v119, v119
    v_exp_f32 v120, v120
    v_cvt_pk_bf16_f32 v83, v118, v119
    v_mfma_f32_16x16x32_bf16 v[92:95], v[88:91], v[72:75], v[92:95]
    ds_read_b128 v[64:67], v18 offset:14336
    v_exp_f32 v121, v121
    v_exp_f32 v122, v122
    v_cvt_pk_bf16_f32 v84, v120, v121
    v_mfma_f32_32x32x16_bf16 v[128:143], v[60:63], v[76:79], v[128:143]
    ds_read_b128 v[68:71], v18 offset:15360
    v_exp_f32 v123, v123
    v_exp_f32 v124, v124
    v_cvt_pk_bf16_f32 v85, v122, v123
    v_exp_f32 v125, v125
    v_exp_f32 v126, v126
    v_mfma_f32_16x16x32_bf16 v[92:95], v[88:91], v[76:79], v[92:95]
    v_cvt_pk_bf16_f32 v86, v124, v125
    v_exp_f32 v127, v127
    s_nop 0
    v_cvt_pk_bf16_f32 v87, v126, v127
    s_waitcnt vmcnt(2) lgkmcnt(0)
    s_barrier
    v_xor_b32 v18, 0x4000, v18
    v_mfma_f32_32x32x16_bf16 v[112:127], v[48:51], v[32:35], v[144:159]
    s_mov_b32 m0, s56
    s_xor_b32 s56, s56, 0x4000
    buffer_load_dwordx4 v19, s[40:43], s55 offen sc1 lds
    v_exp_f32 v96, v96
    v_exp_f32 v97, v97
    v_exp_f32 v98, v98
    v_cvt_pk_bf16_f32 v72, v96, v97
    v_mfma_f32_32x32x16_bf16 v[112:127], v[52:55], v[36:39], v[112:127]
    buffer_load_dwordx4 v19, s[40:43], s55 offen offset:1024 sc1 lds
    s_add_u32 s55, s55, 8192
    v_exp_f32 v99, v99
    v_exp_f32 v100, v100
    v_cvt_pk_bf16_f32 v73, v98, v99
    v_exp_f32 v101, v101
    v_exp_f32 v102, v102
    v_mfma_f32_32x32x16_bf16 v[128:143], v[64:67], v[80:83], v[128:143]
    ds_read_b128 v[40:43], v18 offset:0
    v_cvt_pk_bf16_f32 v74, v100, v101
    v_exp_f32 v103, v103
    v_exp_f32 v104, v104
    v_cvt_pk_bf16_f32 v75, v102, v103
    v_mfma_f32_16x16x32_bf16 v[92:95], v[88:91], v[80:83], v[92:95]
    ds_read_b128 v[44:47], v18 offset:1024
    v_exp_f32 v105, v105
    v_exp_f32 v106, v106
    v_cvt_pk_bf16_f32 v76, v104, v105
    v_mfma_f32_32x32x16_bf16 v[128:143], v[68:71], v[84:87], v[128:143]
    ds_read_b128 v[56:59], v18 offset:8192
    v_exp_f32 v107, v107
    v_exp_f32 v108, v108
    v_cvt_pk_bf16_f32 v77, v106, v107
    v_exp_f32 v109, v109
    v_exp_f32 v110, v110
    v_mfma_f32_16x16x32_bf16 v[92:95], v[88:91], v[84:87], v[92:95]
    ds_read_b128 v[60:63], v18 offset:9216
    v_cvt_pk_bf16_f32 v78, v108, v109
    v_exp_f32 v111, v111
    s_nop 0
    v_cvt_pk_bf16_f32 v79, v110, v111
    s_waitcnt lgkmcnt(0)
    v_mfma_f32_32x32x16_bf16 v[96:111], v[40:43], v[32:35], v[144:159]
    ds_read_b128 v[48:51], v18 offset:2048
    v_exp_f32 v112, v112
    v_exp_f32 v113, v113
    v_exp_f32 v114, v114
    v_cvt_pk_bf16_f32 v80, v112, v113
    v_mfma_f32_32x32x16_bf16 v[96:111], v[44:47], v[36:39], v[96:111]
    ds_read_b128 v[52:55], v18 offset:3072
    v_exp_f32 v115, v115
    v_exp_f32 v116, v116
    v_cvt_pk_bf16_f32 v81, v114, v115
    v_exp_f32 v117, v117
    v_exp_f32 v118, v118
    v_mfma_f32_32x32x16_bf16 v[128:143], v[56:59], v[72:75], v[128:143]
    ds_read_b128 v[64:67], v18 offset:10240
    v_cvt_pk_bf16_f32 v82, v116, v117
    v_exp_f32 v119, v119
    v_exp_f32 v120, v120
    v_cvt_pk_bf16_f32 v83, v118, v119
    v_mfma_f32_16x16x32_bf16 v[92:95], v[88:91], v[72:75], v[92:95]
    ds_read_b128 v[68:71], v18 offset:11264
    v_exp_f32 v121, v121
    v_exp_f32 v122, v122
    v_cvt_pk_bf16_f32 v84, v120, v121
    v_mfma_f32_32x32x16_bf16 v[128:143], v[60:63], v[76:79], v[128:143]
    v_exp_f32 v123, v123
    v_exp_f32 v124, v124
    v_cvt_pk_bf16_f32 v85, v122, v123
    v_exp_f32 v125, v125
    v_exp_f32 v126, v126
    v_mfma_f32_16x16x32_bf16 v[92:95], v[88:91], v[76:79], v[92:95]
    v_cvt_pk_bf16_f32 v86, v124, v125
    v_exp_f32 v127, v127
    s_nop 0
    v_cvt_pk_bf16_f32 v87, v126, v127
    s_waitcnt lgkmcnt(0)
    v_mfma_f32_32x32x16_bf16 v[112:127], v[48:51], v[32:35], v[144:159]
    ds_read_b128 v[40:43], v18 offset:4096
    v_exp_f32 v96, v96
    v_exp_f32 v97, v97
    v_exp_f32 v98, v98
    v_cvt_pk_bf16_f32 v72, v96, v97
    v_mfma_f32_32x32x16_bf16 v[112:127], v[52:55], v[36:39], v[112:127]
    ds_read_b128 v[44:47], v18 offset:5120
    v_exp_f32 v99, v99
    v_exp_f32 v100, v100
    v_cvt_pk_bf16_f32 v73, v98, v99
    v_exp_f32 v101, v101
    v_exp_f32 v102, v102
    v_mfma_f32_32x32x16_bf16 v[128:143], v[64:67], v[80:83], v[128:143]
    ds_read_b128 v[56:59], v18 offset:12288
    v_cvt_pk_bf16_f32 v74, v100, v101
    v_exp_f32 v103, v103
    v_exp_f32 v104, v104
    v_cvt_pk_bf16_f32 v75, v102, v103
    v_mfma_f32_16x16x32_bf16 v[92:95], v[88:91], v[80:83], v[92:95]
    ds_read_b128 v[60:63], v18 offset:13312
    v_exp_f32 v105, v105
    v_exp_f32 v106, v106
    v_cvt_pk_bf16_f32 v76, v104, v105
    v_mfma_f32_32x32x16_bf16 v[128:143], v[68:71], v[84:87], v[128:143]
    v_exp_f32 v107, v107
    v_exp_f32 v108, v108
    v_cvt_pk_bf16_f32 v77, v106, v107
    v_exp_f32 v109, v109
    v_exp_f32 v110, v110
    v_mfma_f32_16x16x32_bf16 v[92:95], v[88:91], v[84:87], v[92:95]
    v_cvt_pk_bf16_f32 v78, v108, v109
    v_exp_f32 v111, v111
    s_nop 0
    v_cvt_pk_bf16_f32 v79, v110, v111
    s_waitcnt lgkmcnt(0)
    v_mfma_f32_32x32x16_bf16 v[96:111], v[40:43], v[32:35], v[144:159]
    ds_read_b128 v[48:51], v18 offset:6144
    v_exp_f32 v112, v112
    v_exp_f32 v113, v113
    v_exp_f32 v114, v114
    v_cvt_pk_bf16_f32 v80, v112, v113
    v_mfma_f32_32x32x16_bf16 v[96:111], v[44:47], v[36:39], v[96:111]
    ds_read_b128 v[52:55], v18 offset:7168
    v_exp_f32 v115, v115
    v_exp_f32 v116, v116
    v_cvt_pk_bf16_f32 v81, v114, v115
    v_exp_f32 v117, v117
    v_exp_f32 v118, v118
    v_mfma_f32_32x32x16_bf16 v[128:143], v[56:59], v[72:75], v[128:143]
    ds_read_b128 v[64:67], v18 offset:14336
    v_cvt_pk_bf16_f32 v82, v116, v117
    v_exp_f32 v119, v119
    v_exp_f32 v120, v120
    v_cvt_pk_bf16_f32 v83, v118, v119
    v_mfma_f32_16x16x32_bf16 v[92:95], v[88:91], v[72:75], v[92:95]
    ds_read_b128 v[68:71], v18 offset:15360
    v_exp_f32 v121, v121
    v_exp_f32 v122, v122
    v_cvt_pk_bf16_f32 v84, v120, v121
    v_mfma_f32_32x32x16_bf16 v[128:143], v[60:63], v[76:79], v[128:143]
    v_exp_f32 v123, v123
    v_exp_f32 v124, v124
    v_cvt_pk_bf16_f32 v85, v122, v123
    v_exp_f32 v125, v125
    v_exp_f32 v126, v126
    v_mfma_f32_16x16x32_bf16 v[92:95], v[88:91], v[76:79], v[92:95]
    v_cvt_pk_bf16_f32 v86, v124, v125
    v_exp_f32 v127, v127
    s_nop 0
    v_cvt_pk_bf16_f32 v87, v126, v127
    s_waitcnt vmcnt(0) lgkmcnt(0)
    s_barrier
    v_xor_b32 v18, 0x4000, v18
    v_mfma_f32_32x32x16_bf16 v[112:127], v[48:51], v[32:35], v[144:159]
    s_mov_b32 m0, s56
    s_xor_b32 s56, s56, 0x4000
    buffer_load_dwordx4 v19, s[40:43], s55 offen sc1 lds
    v_exp_f32 v96, v96
    v_exp_f32 v97, v97
    v_exp_f32 v98, v98
    v_cvt_pk_bf16_f32 v72, v96, v97
    v_mfma_f32_32x32x16_bf16 v[112:127], v[52:55], v[36:39], v[112:127]
    buffer_load_dwordx4 v19, s[40:43], s55 offen offset:1024 sc1 lds
    s_add_u32 s55, s55, 8192
    v_exp_f32 v99, v99
    v_exp_f32 v100, v100
    v_cvt_pk_bf16_f32 v73, v98, v99
    v_exp_f32 v101, v101
    v_exp_f32 v102, v102
    v_mfma_f32_32x32x16_bf16 v[128:143], v[64:67], v[80:83], v[128:143]
    ds_read_b128 v[40:43], v18 offset:0
    v_cvt_pk_bf16_f32 v74, v100, v101
    v_exp_f32 v103, v103
    v_exp_f32 v104, v104
    v_cvt_pk_bf16_f32 v75, v102, v103
    v_mfma_f32_16x16x32_bf16 v[92:95], v[88:91], v[80:83], v[92:95]
    ds_read_b128 v[44:47], v18 offset:1024
    v_exp_f32 v105, v105
    v_exp_f32 v106, v106
    v_cvt_pk_bf16_f32 v76, v104, v105
    v_mfma_f32_32x32x16_bf16 v[128:143], v[68:71], v[84:87], v[128:143]
    ds_read_b128 v[56:59], v18 offset:8192
    v_exp_f32 v107, v107
    v_exp_f32 v108, v108
    v_cvt_pk_bf16_f32 v77, v106, v107
    v_exp_f32 v109, v109
    v_exp_f32 v110, v110
    v_mfma_f32_16x16x32_bf16 v[92:95], v[88:91], v[84:87], v[92:95]
    ds_read_b128 v[60:63], v18 offset:9216
    v_cvt_pk_bf16_f32 v78, v108, v109
    v_exp_f32 v111, v111
    s_nop 0
    v_cvt_pk_bf16_f32 v79, v110, v111
    s_waitcnt lgkmcnt(0)
    v_mfma_f32_32x32x16_bf16 v[96:111], v[40:43], v[32:35], v[144:159]
    ds_read_b128 v[48:51], v18 offset:2048
    v_exp_f32 v112, v112
    v_exp_f32 v113, v113
    v_exp_f32 v114, v114
    v_cvt_pk_bf16_f32 v80, v112, v113
    v_mfma_f32_32x32x16_bf16 v[96:111], v[44:47], v[36:39], v[96:111]
    ds_read_b128 v[52:55], v18 offset:3072
    v_exp_f32 v115, v115
    v_exp_f32 v116, v116
    v_cvt_pk_bf16_f32 v81, v114, v115
    v_exp_f32 v117, v117
    v_exp_f32 v118, v118
    v_mfma_f32_32x32x16_bf16 v[128:143], v[56:59], v[72:75], v[128:143]
    ds_read_b128 v[64:67], v18 offset:10240
    v_cvt_pk_bf16_f32 v82, v116, v117
    v_exp_f32 v119, v119
    v_exp_f32 v120, v120
    v_cvt_pk_bf16_f32 v83, v118, v119
    v_mfma_f32_16x16x32_bf16 v[92:95], v[88:91], v[72:75], v[92:95]
    ds_read_b128 v[68:71], v18 offset:11264
    v_exp_f32 v121, v121
    v_exp_f32 v122, v122
    v_cvt_pk_bf16_f32 v84, v120, v121
    v_mfma_f32_32x32x16_bf16 v[128:143], v[60:63], v[76:79], v[128:143]
    v_exp_f32 v123, v123
    v_exp_f32 v124, v124
    v_cvt_pk_bf16_f32 v85, v122, v123
    v_exp_f32 v125, v125
    v_exp_f32 v126, v126
    v_mfma_f32_16x16x32_bf16 v[92:95], v[88:91], v[76:79], v[92:95]
    v_cvt_pk_bf16_f32 v86, v124, v125
    v_exp_f32 v127, v127
    s_nop 0
    v_cvt_pk_bf16_f32 v87, v126, v127
    s_waitcnt lgkmcnt(0)
    v_mfma_f32_32x32x16_bf16 v[112:127], v[48:51], v[32:35], v[144:159]
    ds_read_b128 v[40:43], v18 offset:4096
    v_exp_f32 v96, v96
    v_exp_f32 v97, v97
    v_exp_f32 v98, v98
    v_cvt_pk_bf16_f32 v72, v96, v97
    v_mfma_f32_32x32x16_bf16 v[112:127], v[52:55], v[36:39], v[112:127]
    ds_read_b128 v[44:47], v18 offset:5120
    v_exp_f32 v99, v99
    v_exp_f32 v100, v100
    v_cvt_pk_bf16_f32 v73, v98, v99
    v_exp_f32 v101, v101
    v_exp_f32 v102, v102
    v_mfma_f32_32x32x16_bf16 v[128:143], v[64:67], v[80:83], v[128:143]
    ds_read_b128 v[56:59], v18 offset:12288
    v_cvt_pk_bf16_f32 v74, v100, v101
    v_exp_f32 v103, v103
    v_exp_f32 v104, v104
    v_cvt_pk_bf16_f32 v75, v102, v103
    v_mfma_f32_16x16x32_bf16 v[92:95], v[88:91], v[80:83], v[92:95]
    ds_read_b128 v[60:63], v18 offset:13312
    v_exp_f32 v105, v105
    v_exp_f32 v106, v106
    v_cvt_pk_bf16_f32 v76, v104, v105
    v_mfma_f32_32x32x16_bf16 v[128:143], v[68:71], v[84:87], v[128:143]
    v_exp_f32 v107, v107
    v_exp_f32 v108, v108
    v_cvt_pk_bf16_f32 v77, v106, v107
    v_exp_f32 v109, v109
    v_exp_f32 v110, v110
    v_mfma_f32_16x16x32_bf16 v[92:95], v[88:91], v[84:87], v[92:95]
    v_cvt_pk_bf16_f32 v78, v108, v109
    v_exp_f32 v111, v111
    s_nop 0
    v_cvt_pk_bf16_f32 v79, v110, v111
    s_waitcnt lgkmcnt(0)
    v_mfma_f32_32x32x16_bf16 v[96:111], v[40:43], v[32:35], v[144:159]
    ds_read_b128 v[48:51], v18 offset:6144
    v_exp_f32 v112, v112
    v_exp_f32 v113, v113
    v_exp_f32 v114, v114
    v_cvt_pk_bf16_f32 v80, v112, v113
    v_mfma_f32_32x32x16_bf16 v[96:111], v[44:47], v[36:39], v[96:111]
    ds_read_b128 v[52:55], v18 offset:7168
    v_exp_f32 v115, v115
    v_exp_f32 v116, v116
    v_cvt_pk_bf16_f32 v81, v114, v115
    v_exp_f32 v117, v117
    v_exp_f32 v118, v118
    v_mfma_f32_32x32x16_bf16 v[128:143], v[56:59], v[72:75], v[128:143]
    ds_read_b128 v[64:67], v18 offset:14336
    v_cvt_pk_bf16_f32 v82, v116, v117
    v_exp_f32 v119, v119
    v_exp_f32 v120, v120
    v_cvt_pk_bf16_f32 v83, v118, v119
    v_mfma_f32_16x16x32_bf16 v[92:95], v[88:91], v[72:75], v[92:95]
    ds_read_b128 v[68:71], v18 offset:15360
    v_exp_f32 v121, v121
    v_exp_f32 v122, v122
    v_cvt_pk_bf16_f32 v84, v120, v121
    v_mfma_f32_32x32x16_bf16 v[128:143], v[60:63], v[76:79], v[128:143]
    v_exp_f32 v123, v123
    v_exp_f32 v124, v124
    v_cvt_pk_bf16_f32 v85, v122, v123
    v_exp_f32 v125, v125
    v_exp_f32 v126, v126
    v_mfma_f32_16x16x32_bf16 v[92:95], v[88:91], v[76:79], v[92:95]
    v_cvt_pk_bf16_f32 v86, v124, v125
    v_exp_f32 v127, v127
    s_nop 0
    v_cvt_pk_bf16_f32 v87, v126, v127
    s_waitcnt vmcnt(0) lgkmcnt(0)
    s_barrier
    v_xor_b32 v18, 0x4000, v18
    v_mfma_f32_32x32x16_bf16 v[112:127], v[48:51], v[32:35], v[144:159]
    s_mov_b32 m0, s56
    s_xor_b32 s56, s56, 0x4000
    buffer_load_dwordx4 v19, s[40:43], s55 offen sc1 lds
    v_exp_f32 v96, v96
    v_exp_f32 v97, v97
    v_exp_f32 v98, v98
    v_cvt_pk_bf16_f32 v72, v96, v97
    v_mfma_f32_32x32x16_bf16 v[112:127], v[52:55], v[36:39], v[112:127]
    buffer_load_dwordx4 v19, s[40:43], s55 offen offset:1024 sc1 lds
    s_add_u32 s55, s55, 8192
    v_exp_f32 v99, v99
    v_exp_f32 v100, v100
    v_cvt_pk_bf16_f32 v73, v98, v99
    v_exp_f32 v101, v101
    v_exp_f32 v102, v102
    v_mfma_f32_32x32x16_bf16 v[128:143], v[64:67], v[80:83], v[128:143]
    ds_read_b128 v[40:43], v18 offset:0
    v_cvt_pk_bf16_f32 v74, v100, v101
    v_exp_f32 v103, v103
    v_exp_f32 v104, v104
    v_cvt_pk_bf16_f32 v75, v102, v103
    v_mfma_f32_16x16x32_bf16 v[92:95], v[88:91], v[80:83], v[92:95]
    ds_read_b128 v[44:47], v18 offset:1024
    v_exp_f32 v105, v105
    v_exp_f32 v106, v106
    v_cvt_pk_bf16_f32 v76, v104, v105
    v_mfma_f32_32x32x16_bf16 v[128:143], v[68:71], v[84:87], v[128:143]
    ds_read_b128 v[56:59], v18 offset:8192
    v_exp_f32 v107, v107
    v_exp_f32 v108, v108
    v_cvt_pk_bf16_f32 v77, v106, v107
    v_exp_f32 v109, v109
    v_exp_f32 v110, v110
    v_mfma_f32_16x16x32_bf16 v[92:95], v[88:91], v[84:87], v[92:95]
    ds_read_b128 v[60:63], v18 offset:9216
    v_cvt_pk_bf16_f32 v78, v108, v109
    v_exp_f32 v111, v111
    s_nop 0
    v_cvt_pk_bf16_f32 v79, v110, v111
    s_waitcnt lgkmcnt(0)
    v_mfma_f32_32x32x16_bf16 v[96:111], v[40:43], v[32:35], v[144:159]
    ds_read_b128 v[48:51], v18 offset:2048
    v_exp_f32 v112, v112
    v_exp_f32 v113, v113
    v_exp_f32 v114, v114
    v_cvt_pk_bf16_f32 v80, v112, v113
    v_mfma_f32_32x32x16_bf16 v[96:111], v[44:47], v[36:39], v[96:111]
    ds_read_b128 v[52:55], v18 offset:3072
    v_exp_f32 v115, v115
    v_exp_f32 v116, v116
    v_cvt_pk_bf16_f32 v81, v114, v115
    v_exp_f32 v117, v117
    v_exp_f32 v118, v118
    v_mfma_f32_32x32x16_bf16 v[128:143], v[56:59], v[72:75], v[128:143]
    ds_read_b128 v[64:67], v18 offset:10240
    v_cvt_pk_bf16_f32 v82, v116, v117
    v_exp_f32 v119, v119
    v_exp_f32 v120, v120
    v_cvt_pk_bf16_f32 v83, v118, v119
    v_mfma_f32_16x16x32_bf16 v[92:95], v[88:91], v[72:75], v[92:95]
    ds_read_b128 v[68:71], v18 offset:11264
    v_exp_f32 v121, v121
    v_exp_f32 v122, v122
    v_cvt_pk_bf16_f32 v84, v120, v121
    v_mfma_f32_32x32x16_bf16 v[128:143], v[60:63], v[76:79], v[128:143]
    v_exp_f32 v123, v123
    v_exp_f32 v124, v124
    v_cvt_pk_bf16_f32 v85, v122, v123
    v_exp_f32 v125, v125
    v_exp_f32 v126, v126
    v_mfma_f32_16x16x32_bf16 v[92:95], v[88:91], v[76:79], v[92:95]
    v_cvt_pk_bf16_f32 v86, v124, v125
    v_exp_f32 v127, v127
    s_nop 0
    v_cvt_pk_bf16_f32 v87, v126, v127
    s_waitcnt lgkmcnt(0)
    v_mfma_f32_32x32x16_bf16 v[112:127], v[48:51], v[32:35], v[144:159]
    ds_read_b128 v[40:43], v18 offset:4096
    v_exp_f32 v96, v96
    v_exp_f32 v97, v97
    v_exp_f32 v98, v98
    v_cvt_pk_bf16_f32 v72, v96, v97
    v_mfma_f32_32x32x16_bf16 v[112:127], v[52:55], v[36:39], v[112:127]
    ds_read_b128 v[44:47], v18 offset:5120
    v_exp_f32 v99, v99
    v_exp_f32 v100, v100
    v_cvt_pk_bf16_f32 v73, v98, v99
    v_exp_f32 v101, v101
    v_exp_f32 v102, v102
    v_mfma_f32_32x32x16_bf16 v[128:143], v[64:67], v[80:83], v[128:143]
    ds_read_b128 v[56:59], v18 offset:12288
    v_cvt_pk_bf16_f32 v74, v100, v101
    v_exp_f32 v103, v103
    v_exp_f32 v104, v104
    v_cvt_pk_bf16_f32 v75, v102, v103
    v_mfma_f32_16x16x32_bf16 v[92:95], v[88:91], v[80:83], v[92:95]
    ds_read_b128 v[60:63], v18 offset:13312
    v_exp_f32 v105, v105
    v_exp_f32 v106, v106
    v_cvt_pk_bf16_f32 v76, v104, v105
    v_mfma_f32_32x32x16_bf16 v[128:143], v[68:71], v[84:87], v[128:143]
    v_exp_f32 v107, v107
    v_exp_f32 v108, v108
    v_cvt_pk_bf16_f32 v77, v106, v107
    v_exp_f32 v109, v109
    v_exp_f32 v110, v110
    v_mfma_f32_16x16x32_bf16 v[92:95], v[88:91], v[84:87], v[92:95]
    v_cvt_pk_bf16_f32 v78, v108, v109
    v_exp_f32 v111, v111
    s_nop 0
    v_cvt_pk_bf16_f32 v79, v110, v111
    s_waitcnt lgkmcnt(0)
    v_mfma_f32_32x32x16_bf16 v[96:111], v[40:43], v[32:35], v[144:159]
    ds_read_b128 v[48:51], v18 offset:6144
    v_exp_f32 v112, v112
    v_exp_f32 v113, v113
    v_exp_f32 v114, v114
    v_cvt_pk_bf16_f32 v80, v112, v113
    v_mfma_f32_32x32x16_bf16 v[96:111], v[44:47], v[36:39], v[96:111]
    ds_read_b128 v[52:55], v18 offset:7168
    v_exp_f32 v115, v115
    v_exp_f32 v116, v116
    v_cvt_pk_bf16_f32 v81, v114, v115
    v_exp_f32 v117, v117
    v_exp_f32 v118, v118
    v_mfma_f32_32x32x16_bf16 v[128:143], v[56:59], v[72:75], v[128:143]
    ds_read_b128 v[64:67], v18 offset:14336
    v_cvt_pk_bf16_f32 v82, v116, v117
    v_exp_f32 v119, v119
    v_exp_f32 v120, v120
    v_cvt_pk_bf16_f32 v83, v118, v119
    v_mfma_f32_16x16x32_bf16 v[92:95], v[88:91], v[72:75], v[92:95]
    ds_read_b128 v[68:71], v18 offset:15360
    v_exp_f32 v121, v121
    v_exp_f32 v122, v122
    v_cvt_pk_bf16_f32 v84, v120, v121
    v_mfma_f32_32x32x16_bf16 v[128:143], v[60:63], v[76:79], v[128:143]
    v_exp_f32 v123, v123
    v_exp_f32 v124, v124
    v_cvt_pk_bf16_f32 v85, v122, v123
    v_exp_f32 v125, v125
    v_exp_f32 v126, v126
    v_mfma_f32_16x16x32_bf16 v[92:95], v[88:91], v[76:79], v[92:95]
    v_cvt_pk_bf16_f32 v86, v124, v125
    v_exp_f32 v127, v127
    s_nop 0
    v_cvt_pk_bf16_f32 v87, v126, v127
    s_waitcnt vmcnt(0) lgkmcnt(0)
    s_barrier
    v_xor_b32 v18, 0x4000, v18
    s_cmp_lg_u32 s3, 0
    s_cbranch_scc1 W0_6
    v_mov_b32 v22, s20
    v_mov_b32 v24, s8
    v_mov_b32 v25, s9
    s_mov_b64 exec, 1
    global_store_dwordx2 v22, v[24:25], s[58:59] sc1
    s_mov_b64 exec, -1
W0_6:
    v_mfma_f32_32x32x16_bf16 v[112:127], v[48:51], v[32:35], v[144:159]
    s_mov_b32 m0, s56
    s_xor_b32 s56, s56, 0x4000
    buffer_load_dwordx4 v19, s[40:43], s55 offen sc1 lds
    v_exp_f32 v96, v96
    v_exp_f32 v97, v97
    v_exp_f32 v98, v98
    v_cvt_pk_bf16_f32 v72, v96, v97
    v_mfma_f32_32x32x16_bf16 v[112:127], v[52:55], v[36:39], v[112:127]
    buffer_load_dwordx4 v19, s[40:43], s55 offen offset:1024 sc1 lds
    s_add_u32 s55, s55, 8192
    v_exp_f32 v99, v99
    v_exp_f32 v100, v100
    v_cvt_pk_bf16_f32 v73, v98, v99
    v_exp_f32 v101, v101
    v_exp_f32 v102, v102
    v_mfma_f32_32x32x16_bf16 v[128:143], v[64:67], v[80:83], v[128:143]
    ds_read_b128 v[40:43], v18 offset:0
    v_cvt_pk_bf16_f32 v74, v100, v101
    v_exp_f32 v103, v103
    v_exp_f32 v104, v104
    v_cvt_pk_bf16_f32 v75, v102, v103
    v_mfma_f32_16x16x32_bf16 v[92:95], v[88:91], v[80:83], v[92:95]
    ds_read_b128 v[44:47], v18 offset:1024
    v_exp_f32 v105, v105
    v_exp_f32 v106, v106
    v_cvt_pk_bf16_f32 v76, v104, v105
    v_mfma_f32_32x32x16_bf16 v[128:143], v[68:71], v[84:87], v[128:143]
    ds_read_b128 v[56:59], v18 offset:8192
    v_exp_f32 v107, v107
    v_exp_f32 v108, v108
    v_cvt_pk_bf16_f32 v77, v106, v107
    v_exp_f32 v109, v109
    v_exp_f32 v110, v110
    v_mfma_f32_16x16x32_bf16 v[92:95], v[88:91], v[84:87], v[92:95]
    ds_read_b128 v[60:63], v18 offset:9216
    v_cvt_pk_bf16_f32 v78, v108, v109
    v_exp_f32 v111, v111
    s_nop 0
    v_cvt_pk_bf16_f32 v79, v110, v111
    s_waitcnt lgkmcnt(0)
    v_mfma_f32_32x32x16_bf16 v[96:111], v[40:43], v[32:35], v[144:159]
    s_lshl_b32 s32, s2, 13
    s_add_u32 s32, s32, s35
    buffer_load_dword v30, v19, s[92:95], s32 offen
    v_exp_f32 v112, v112
    v_exp_f32 v113, v113
    v_exp_f32 v114, v114
    v_cvt_pk_bf16_f32 v80, v112, v113
    v_mfma_f32_32x32x16_bf16 v[96:111], v[44:47], v[36:39], v[96:111]
    ds_read_b128 v[48:51], v18 offset:2048
    v_exp_f32 v115, v115
    v_exp_f32 v116, v116
    v_cvt_pk_bf16_f32 v81, v114, v115
    v_exp_f32 v117, v117
    v_exp_f32 v118, v118
    v_mfma_f32_32x32x16_bf16 v[128:143], v[56:59], v[72:75], v[128:143]
    ds_read_b128 v[52:55], v18 offset:3072
    v_cvt_pk_bf16_f32 v82, v116, v117
    v_exp_f32 v119, v119
    v_exp_f32 v120, v120
    v_cvt_pk_bf16_f32 v83, v118, v119
    v_mfma_f32_16x16x32_bf16 v[92:95], v[88:91], v[72:75], v[92:95]
    ds_read_b128 v[64:67], v18 offset:10240
    v_exp_f32 v121, v121
    v_exp_f32 v122, v122
    v_cvt_pk_bf16_f32 v84, v120, v121
    v_mfma_f32_32x32x16_bf16 v[128:143], v[60:63], v[76:79], v[128:143]
    ds_read_b128 v[68:71], v18 offset:11264
    v_exp_f32 v123, v123
    v_exp_f32 v124, v124
    v_cvt_pk_bf16_f32 v85, v122, v123
    v_exp_f32 v125, v125
    v_exp_f32 v126, v126
    v_mfma_f32_16x16x32_bf16 v[92:95], v[88:91], v[76:79], v[92:95]
    v_cvt_pk_bf16_f32 v86, v124, v125
    v_exp_f32 v127, v127
    s_nop 0
    v_cvt_pk_bf16_f32 v87, v126, v127
    s_waitcnt lgkmcnt(0)
    v_mfma_f32_32x32x16_bf16 v[112:127], v[48:51], v[32:35], v[144:159]
    ds_read_b128 v[40:43], v18 offset:4096
    v_exp_f32 v96, v96
    v_exp_f32 v97, v97
    v_exp_f32 v98, v98
    v_cvt_pk_bf16_f32 v72, v96, v97
    v_mfma_f32_32x32x16_bf16 v[112:127], v[52:55], v[36:39], v[112:127]
    ds_read_b128 v[44:47], v18 offset:5120
    v_exp_f32 v99, v99
    v_exp_f32 v100, v100
    v_cvt_pk_bf16_f32 v73, v98, v99
    v_exp_f32 v101, v101
    v_exp_f32 v102, v102
    v_mfma_f32_32x32x16_bf16 v[128:143], v[64:67], v[80:83], v[128:143]
    ds_read_b128 v[56:59], v18 offset:12288
    v_cvt_pk_bf16_f32 v74, v100, v101
    v_exp_f32 v103, v103
    v_exp_f32 v104, v104
    v_cvt_pk_bf16_f32 v75, v102, v103
    v_mfma_f32_16x16x32_bf16 v[92:95], v[88:91], v[80:83], v[92:95]
    ds_read_b128 v[60:63], v18 offset:13312
    v_exp_f32 v105, v105
    v_exp_f32 v106, v106
    v_cvt_pk_bf16_f32 v76, v104, v105
    v_mfma_f32_32x32x16_bf16 v[128:143], v[68:71], v[84:87], v[128:143]
    v_exp_f32 v107, v107
    v_exp_f32 v108, v108
    v_cvt_pk_bf16_f32 v77, v106, v107
    v_exp_f32 v109, v109
    v_exp_f32 v110, v110
    v_mfma_f32_16x16x32_bf16 v[92:95], v[88:91], v[84:87], v[92:95]
    v_cvt_pk_bf16_f32 v78, v108, v109
    v_exp_f32 v111, v111
    s_nop 0
    v_cvt_pk_bf16_f32 v79, v110, v111
    s_waitcnt lgkmcnt(0)
    v_mfma_f32_32x32x16_bf16 v[96:111], v[40:43], v[32:35], v[144:159]
    ds_read_b128 v[48:51], v18 offset:6144
    v_exp_f32 v112, v112
    v_exp_f32 v113, v113
    v_exp_f32 v114, v114
    v_cvt_pk_bf16_f32 v80, v112, v113
    v_mfma_f32_32x32x16_bf16 v[96:111], v[44:47], v[36:39], v[96:111]
    ds_read_b128 v[52:55], v18 offset:7168
    v_exp_f32 v115, v115
    v_exp_f32 v116, v116
    v_cvt_pk_bf16_f32 v81, v114, v115
    v_exp_f32 v117, v117
    v_exp_f32 v118, v118
    v_mfma_f32_32x32x16_bf16 v[128:143], v[56:59], v[72:75], v[128:143]
    ds_read_b128 v[64:67], v18 offset:14336
    v_cvt_pk_bf16_f32 v82, v116, v117
    v_exp_f32 v119, v119
    v_exp_f32 v120, v120
    v_cvt_pk_bf16_f32 v83, v118, v119
    v_mfma_f32_16x16x32_bf16 v[92:95], v[88:91], v[72:75], v[92:95]
    ds_read_b128 v[68:71], v18 offset:15360
    v_exp_f32 v121, v121
    v_exp_f32 v122, v122
    v_cvt_pk_bf16_f32 v84, v120, v121
    v_mfma_f32_32x32x16_bf16 v[128:143], v[60:63], v[76:79], v[128:143]
    v_exp_f32 v123, v123
    v_exp_f32 v124, v124
    v_cvt_pk_bf16_f32 v85, v122, v123
    v_exp_f32 v125, v125
    v_exp_f32 v126, v126
    v_mfma_f32_16x16x32_bf16 v[92:95], v[88:91], v[76:79], v[92:95]
    v_cvt_pk_bf16_f32 v86, v124, v125
    v_exp_f32 v127, v127
    s_nop 0
    v_cvt_pk_bf16_f32 v87, v126, v127
    s_waitcnt vmcnt(1) lgkmcnt(0)
    s_barrier
    v_xor_b32 v18, 0x4000, v18
    v_mfma_f32_32x32x16_bf16 v[112:127], v[48:51], v[32:35], v[144:159]
    s_mov_b32 m0, s56
    s_xor_b32 s56, s56, 0x4000
    buffer_load_dwordx4 v19, s[40:43], s55 offen sc1 lds
    v_exp_f32 v96, v96
    v_exp_f32 v97, v97
    v_exp_f32 v98, v98
    v_cvt_pk_bf16_f32 v72, v96, v97
    v_mfma_f32_32x32x16_bf16 v[112:127], v[52:55], v[36:39], v[112:127]
    buffer_load_dwordx4 v19, s[40:43], s55 offen offset:1024 sc1 lds
    s_add_u32 s55, s55, 8192
    v_exp_f32 v99, v99
    v_exp_f32 v100, v100
    v_cvt_pk_bf16_f32 v73, v98, v99
    v_exp_f32 v101, v101
    v_exp_f32 v102, v102
    v_mfma_f32_32x32x16_bf16 v[128:143], v[64:67], v[80:83], v[128:143]
    ds_read_b128 v[40:43], v18 offset:0
    v_cvt_pk_bf16_f32 v74, v100, v101
    v_exp_f32 v103, v103
    v_exp_f32 v104, v104
    v_cvt_pk_bf16_f32 v75, v102, v103
    v_mfma_f32_16x16x32_bf16 v[92:95], v[88:91], v[80:83], v[92:95]
    ds_read_b128 v[44:47], v18 offset:1024
    v_exp_f32 v105, v105
    v_exp_f32 v106, v106
    v_cvt_pk_bf16_f32 v76, v104, v105
    v_mfma_f32_32x32x16_bf16 v[128:143], v[68:71], v[84:87], v[128:143]
    ds_read_b128 v[56:59], v18 offset:8192
    v_exp_f32 v107, v107
    v_exp_f32 v108, v108
    v_cvt_pk_bf16_f32 v77, v106, v107
    v_exp_f32 v109, v109
    v_exp_f32 v110, v110
    v_mfma_f32_16x16x32_bf16 v[92:95], v[88:91], v[84:87], v[92:95]
    ds_read_b128 v[60:63], v18 offset:9216
    v_cvt_pk_bf16_f32 v78, v108, v109
    v_exp_f32 v111, v111
    s_nop 0
    v_cvt_pk_bf16_f32 v79, v110, v111
    s_waitcnt lgkmcnt(0)
    v_mfma_f32_32x32x16_bf16 v[96:111], v[40:43], v[32:35], v[144:159]
    s_add_u32 s32, s3, 20
    s_lshl_b32 s32, s32, 17
    s_add_u32 s32, s32, s4
    buffer_load_dword v30, v31, s[16:19], s32 offen
    v_exp_f32 v112, v112
    v_exp_f32 v113, v113
    v_exp_f32 v114, v114
    v_cvt_pk_bf16_f32 v80, v112, v113
    v_mfma_f32_32x32x16_bf16 v[96:111], v[44:47], v[36:39], v[96:111]
    ds_read_b128 v[48:51], v18 offset:2048
    v_exp_f32 v115, v115
    v_exp_f32 v116, v116
    v_cvt_pk_bf16_f32 v81, v114, v115
    v_exp_f32 v117, v117
    v_exp_f32 v118, v118
    v_mfma_f32_32x32x16_bf16 v[128:143], v[56:59], v[72:75], v[128:143]
    ds_read_b128 v[52:55], v18 offset:3072
    v_cvt_pk_bf16_f32 v82, v116, v117
    v_exp_f32 v119, v119
    v_exp_f32 v120, v120
    v_cvt_pk_bf16_f32 v83, v118, v119
    v_mfma_f32_16x16x32_bf16 v[92:95], v[88:91], v[72:75], v[92:95]
    ds_read_b128 v[64:67], v18 offset:10240
    v_exp_f32 v121, v121
    v_exp_f32 v122, v122
    v_cvt_pk_bf16_f32 v84, v120, v121
    v_mfma_f32_32x32x16_bf16 v[128:143], v[60:63], v[76:79], v[128:143]
    ds_read_b128 v[68:71], v18 offset:11264
    v_exp_f32 v123, v123
    v_exp_f32 v124, v124
    v_cvt_pk_bf16_f32 v85, v122, v123
    v_exp_f32 v125, v125
    v_exp_f32 v126, v126
    v_mfma_f32_16x16x32_bf16 v[92:95], v[88:91], v[76:79], v[92:95]
    v_cvt_pk_bf16_f32 v86, v124, v125
    v_exp_f32 v127, v127
    s_nop 0
    v_cvt_pk_bf16_f32 v87, v126, v127
    s_waitcnt lgkmcnt(0)
    v_mfma_f32_32x32x16_bf16 v[112:127], v[48:51], v[32:35], v[144:159]
    ds_read_b128 v[40:43], v18 offset:4096
    v_exp_f32 v96, v96
    v_exp_f32 v97, v97
    v_exp_f32 v98, v98
    v_cvt_pk_bf16_f32 v72, v96, v97
    v_mfma_f32_32x32x16_bf16 v[112:127], v[52:55], v[36:39], v[112:127]
    ds_read_b128 v[44:47], v18 offset:5120
    v_exp_f32 v99, v99
    v_exp_f32 v100, v100
    v_cvt_pk_bf16_f32 v73, v98, v99
    v_exp_f32 v101, v101
    v_exp_f32 v102, v102
    v_mfma_f32_32x32x16_bf16 v[128:143], v[64:67], v[80:83], v[128:143]
    ds_read_b128 v[56:59], v18 offset:12288
    v_cvt_pk_bf16_f32 v74, v100, v101
    v_exp_f32 v103, v103
    v_exp_f32 v104, v104
    v_cvt_pk_bf16_f32 v75, v102, v103
    v_mfma_f32_16x16x32_bf16 v[92:95], v[88:91], v[80:83], v[92:95]
    ds_read_b128 v[60:63], v18 offset:13312
    v_exp_f32 v105, v105
    v_exp_f32 v106, v106
    v_cvt_pk_bf16_f32 v76, v104, v105
    v_mfma_f32_32x32x16_bf16 v[128:143], v[68:71], v[84:87], v[128:143]
    v_exp_f32 v107, v107
    v_exp_f32 v108, v108
    v_cvt_pk_bf16_f32 v77, v106, v107
    v_exp_f32 v109, v109
    v_exp_f32 v110, v110
    v_mfma_f32_16x16x32_bf16 v[92:95], v[88:91], v[84:87], v[92:95]
    v_cvt_pk_bf16_f32 v78, v108, v109
    v_exp_f32 v111, v111
    s_nop 0
    v_cvt_pk_bf16_f32 v79, v110, v111
    s_waitcnt lgkmcnt(0)
    v_mfma_f32_32x32x16_bf16 v[96:111], v[40:43], v[32:35], v[144:159]
    ds_read_b128 v[48:51], v18 offset:6144
    v_exp_f32 v112, v112
    v_exp_f32 v113, v113
    v_exp_f32 v114, v114
    v_cvt_pk_bf16_f32 v80, v112, v113
    v_mfma_f32_32x32x16_bf16 v[96:111], v[44:47], v[36:39], v[96:111]
    ds_read_b128 v[52:55], v18 offset:7168
    v_exp_f32 v115, v115
    v_exp_f32 v116, v116
    v_cvt_pk_bf16_f32 v81, v114, v115
    v_exp_f32 v117, v117
    v_exp_f32 v118, v118
    v_mfma_f32_32x32x16_bf16 v[128:143], v[56:59], v[72:75], v[128:143]
    ds_read_b128 v[64:67], v18 offset:14336
    v_cvt_pk_bf16_f32 v82, v116, v117
    v_exp_f32 v119, v119
    v_exp_f32 v120, v120
    v_cvt_pk_bf16_f32 v83, v118, v119
    v_mfma_f32_16x16x32_bf16 v[92:95], v[88:91], v[72:75], v[92:95]
    ds_read_b128 v[68:71], v18 offset:15360
    v_exp_f32 v121, v121
    v_exp_f32 v122, v122
    v_cvt_pk_bf16_f32 v84, v120, v121
    v_mfma_f32_32x32x16_bf16 v[128:143], v[60:63], v[76:79], v[128:143]
    v_exp_f32 v123, v123
    v_exp_f32 v124, v124
    v_cvt_pk_bf16_f32 v85, v122, v123
    v_exp_f32 v125, v125
    v_exp_f32 v126, v126
    v_mfma_f32_16x16x32_bf16 v[92:95], v[88:91], v[76:79], v[92:95]
    v_cvt_pk_bf16_f32 v86, v124, v125
    v_exp_f32 v127, v127
    s_nop 0
    v_cvt_pk_bf16_f32 v87, v126, v127
    s_waitcnt vmcnt(1) lgkmcnt(0)
    s_barrier
    v_xor_b32 v18, 0x4000, v18
    v_mfma_f32_32x32x16_bf16 v[112:127], v[48:51], v[32:35], v[144:159]
    s_mov_b32 m0, s56
    s_xor_b32 s56, s56, 0x4000
    buffer_load_dwordx4 v19, s[40:43], s55 offen sc1 lds
    v_exp_f32 v96, v96
    v_exp_f32 v97, v97
    v_exp_f32 v98, v98
    v_cvt_pk_bf16_f32 v72, v96, v97
    v_mfma_f32_32x32x16_bf16 v[112:127], v[52:55], v[36:39], v[112:127]
    buffer_load_dwordx4 v19, s[40:43], s55 offen offset:1024 sc1 lds
    s_add_u32 s55, s55, 8192
    v_exp_f32 v99, v99
    v_exp_f32 v100, v100
    v_cvt_pk_bf16_f32 v73, v98, v99
    v_exp_f32 v101, v101
    v_exp_f32 v102, v102
    v_mfma_f32_32x32x16_bf16 v[128:143], v[64:67], v[80:83], v[128:143]
    ds_read_b128 v[40:43], v18 offset:0
    v_cvt_pk_bf16_f32 v74, v100, v101
    v_exp_f32 v103, v103
    v_exp_f32 v104, v104
    v_cvt_pk_bf16_f32 v75, v102, v103
    v_mfma_f32_16x16x32_bf16 v[92:95], v[88:91], v[80:83], v[92:95]
    ds_read_b128 v[44:47], v18 offset:1024
    v_exp_f32 v105, v105
    v_exp_f32 v106, v106
    v_cvt_pk_bf16_f32 v76, v104, v105
    v_mfma_f32_32x32x16_bf16 v[128:143], v[68:71], v[84:87], v[128:143]
    ds_read_b128 v[56:59], v18 offset:8192
    v_exp_f32 v107, v107
    v_exp_f32 v108, v108
    v_cvt_pk_bf16_f32 v77, v106, v107
    v_exp_f32 v109, v109
    v_exp_f32 v110, v110
    v_mfma_f32_16x16x32_bf16 v[92:95], v[88:91], v[84:87], v[92:95]
    ds_read_b128 v[60:63], v18 offset:9216
    v_cvt_pk_bf16_f32 v78, v108, v109
    v_exp_f32 v111, v111
    s_nop 0
    v_cvt_pk_bf16_f32 v79, v110, v111
    s_waitcnt lgkmcnt(0)
    v_mfma_f32_32x32x16_bf16 v[96:111], v[40:43], v[32:35], v[144:159]
    s_add_u32 s32, s3, 12
    s_lshl_b32 s32, s32, 17
    s_add_u32 s32, s32, s4
    buffer_load_dword v30, v31, s[16:19], s32 offen
    v_exp_f32 v112, v112
    v_exp_f32 v113, v113
    v_exp_f32 v114, v114
    v_cvt_pk_bf16_f32 v80, v112, v113
    v_mfma_f32_32x32x16_bf16 v[96:111], v[44:47], v[36:39], v[96:111]
    ds_read_b128 v[48:51], v18 offset:2048
    v_exp_f32 v115, v115
    v_exp_f32 v116, v116
    v_cvt_pk_bf16_f32 v81, v114, v115
    v_exp_f32 v117, v117
    v_exp_f32 v118, v118
    v_mfma_f32_32x32x16_bf16 v[128:143], v[56:59], v[72:75], v[128:143]
    ds_read_b128 v[52:55], v18 offset:3072
    v_cvt_pk_bf16_f32 v82, v116, v117
    v_exp_f32 v119, v119
    v_exp_f32 v120, v120
    v_cvt_pk_bf16_f32 v83, v118, v119
    v_mfma_f32_16x16x32_bf16 v[92:95], v[88:91], v[72:75], v[92:95]
    ds_read_b128 v[64:67], v18 offset:10240
    v_exp_f32 v121, v121
    v_exp_f32 v122, v122
    v_cvt_pk_bf16_f32 v84, v120, v121
    v_mfma_f32_32x32x16_bf16 v[128:143], v[60:63], v[76:79], v[128:143]
    ds_read_b128 v[68:71], v18 offset:11264
    v_exp_f32 v123, v123
    v_exp_f32 v124, v124
    v_cvt_pk_bf16_f32 v85, v122, v123
    v_exp_f32 v125, v125
    v_exp_f32 v126, v126
    v_mfma_f32_16x16x32_bf16 v[92:95], v[88:91], v[76:79], v[92:95]
    v_cvt_pk_bf16_f32 v86, v124, v125
    v_exp_f32 v127, v127
    s_nop 0
    v_cvt_pk_bf16_f32 v87, v126, v127
    s_waitcnt lgkmcnt(0)
    v_mfma_f32_32x32x16_bf16 v[112:127], v[48:51], v[32:35], v[144:159]
    ds_read_b128 v[40:43], v18 offset:4096
    v_exp_f32 v96, v96
    v_exp_f32 v97, v97
    v_exp_f32 v98, v98
    v_cvt_pk_bf16_f32 v72, v96, v97
    v_mfma_f32_32x32x16_bf16 v[112:127], v[52:55], v[36:39], v[112:127]
    ds_read_b128 v[44:47], v18 offset:5120
    v_exp_f32 v99, v99
    v_exp_f32 v100, v100
    v_cvt_pk_bf16_f32 v73, v98, v99
    v_exp_f32 v101, v101
    v_exp_f32 v102, v102
    v_mfma_f32_32x32x16_bf16 v[128:143], v[64:67], v[80:83], v[128:143]
    ds_read_b128 v[56:59], v18 offset:12288
    v_cvt_pk_bf16_f32 v74, v100, v101
    v_exp_f32 v103, v103
    v_exp_f32 v104, v104
    v_cvt_pk_bf16_f32 v75, v102, v103
    v_mfma_f32_16x16x32_bf16 v[92:95], v[88:91], v[80:83], v[92:95]
    ds_read_b128 v[60:63], v18 offset:13312
    v_exp_f32 v105, v105
    v_exp_f32 v106, v106
    v_cvt_pk_bf16_f32 v76, v104, v105
    v_mfma_f32_32x32x16_bf16 v[128:143], v[68:71], v[84:87], v[128:143]
    v_exp_f32 v107, v107
    v_exp_f32 v108, v108
    v_cvt_pk_bf16_f32 v77, v106, v107
    v_exp_f32 v109, v109
    v_exp_f32 v110, v110
    v_mfma_f32_16x16x32_bf16 v[92:95], v[88:91], v[84:87], v[92:95]
    v_cvt_pk_bf16_f32 v78, v108, v109
    v_exp_f32 v111, v111
    s_nop 0
    v_cvt_pk_bf16_f32 v79, v110, v111
    s_waitcnt lgkmcnt(0)
    v_mfma_f32_32x32x16_bf16 v[96:111], v[40:43], v[32:35], v[144:159]
    ds_read_b128 v[48:51], v18 offset:6144
    v_exp_f32 v112, v112
    v_exp_f32 v113, v113
    v_exp_f32 v114, v114
    v_cvt_pk_bf16_f32 v80, v112, v113
    v_mfma_f32_32x32x16_bf16 v[96:111], v[44:47], v[36:39], v[96:111]
    ds_read_b128 v[52:55], v18 offset:7168
    v_exp_f32 v115, v115
    v_exp_f32 v116, v116
    v_cvt_pk_bf16_f32 v81, v114, v115
    v_exp_f32 v117, v117
    v_exp_f32 v118, v118
    v_mfma_f32_32x32x16_bf16 v[128:143], v[56:59], v[72:75], v[128:143]
    ds_read_b128 v[64:67], v18 offset:14336
    v_cvt_pk_bf16_f32 v82, v116, v117
    v_exp_f32 v119, v119
    v_exp_f32 v120, v120
    v_cvt_pk_bf16_f32 v83, v118, v119
    v_mfma_f32_16x16x32_bf16 v[92:95], v[88:91], v[72:75], v[92:95]
    ds_read_b128 v[68:71], v18 offset:15360
    v_exp_f32 v121, v121
    v_exp_f32 v122, v122
    v_cvt_pk_bf16_f32 v84, v120, v121
    v_mfma_f32_32x32x16_bf16 v[128:143], v[60:63], v[76:79], v[128:143]
    v_exp_f32 v123, v123
    v_exp_f32 v124, v124
    v_cvt_pk_bf16_f32 v85, v122, v123
    v_exp_f32 v125, v125
    v_exp_f32 v126, v126
    v_mfma_f32_16x16x32_bf16 v[92:95], v[88:91], v[76:79], v[92:95]
    v_cvt_pk_bf16_f32 v86, v124, v125
    v_exp_f32 v127, v127
    s_nop 0
    v_cvt_pk_bf16_f32 v87, v126, v127
    s_waitcnt vmcnt(1) lgkmcnt(0)
    s_barrier
    v_xor_b32 v18, 0x4000, v18
    v_mfma_f32_32x32x16_bf16 v[112:127], v[48:51], v[32:35], v[144:159]
    s_mov_b32 m0, s56
    s_xor_b32 s56, s56, 0x4000
    buffer_load_dwordx4 v19, s[40:43], s55 offen sc1 lds
    v_exp_f32 v96, v96
    v_exp_f32 v97, v97
    v_exp_f32 v98, v98
    v_cvt_pk_bf16_f32 v72, v96, v97
    v_mfma_f32_32x32x16_bf16 v[112:127], v[52:55], v[36:39], v[112:127]
    buffer_load_dwordx4 v19, s[40:43], s55 offen offset:1024 sc1 lds
    s_add_u32 s55, s55, 8192
    v_exp_f32 v99, v99
    v_exp_f32 v100, v100
    v_cvt_pk_bf16_f32 v73, v98, v99
    v_exp_f32 v101, v101
    v_exp_f32 v102, v102
    v_mfma_f32_32x32x16_bf16 v[128:143], v[64:67], v[80:83], v[128:143]
    ds_read_b128 v[40:43], v18 offset:0
    v_cvt_pk_bf16_f32 v74, v100, v101
    v_exp_f32 v103, v103
    v_exp_f32 v104, v104
    v_cvt_pk_bf16_f32 v75, v102, v103
    v_mfma_f32_16x16x32_bf16 v[92:95], v[88:91], v[80:83], v[92:95]
    ds_read_b128 v[44:47], v18 offset:1024
    v_exp_f32 v105, v105
    v_exp_f32 v106, v106
    v_cvt_pk_bf16_f32 v76, v104, v105
    v_mfma_f32_32x32x16_bf16 v[128:143], v[68:71], v[84:87], v[128:143]
    ds_read_b128 v[56:59], v18 offset:8192
    v_exp_f32 v107, v107
    v_exp_f32 v108, v108
    v_cvt_pk_bf16_f32 v77, v106, v107
    v_exp_f32 v109, v109
    v_exp_f32 v110, v110
    v_mfma_f32_16x16x32_bf16 v[92:95], v[88:91], v[84:87], v[92:95]
    ds_read_b128 v[60:63], v18 offset:9216
    v_cvt_pk_bf16_f32 v78, v108, v109
    v_exp_f32 v111, v111
    s_nop 0
    v_cvt_pk_bf16_f32 v79, v110, v111
    s_waitcnt lgkmcnt(0)
    v_mfma_f32_32x32x16_bf16 v[96:111], v[40:43], v[32:35], v[144:159]
    s_cmp_lg_u32 s28, 0
    s_cbranch_scc1 P2_NX
    buffer_load_dwordx4 v[224:227], v8, s[12:15], s50 offen
    buffer_load_dwordx4 v[228:231], v9, s[12:15], s50 offen
    buffer_load_dwordx4 v[232:235], v10, s[12:15], s50 offen
    buffer_load_dwordx4 v[236:239], v11, s[12:15], s50 offen
P2_NX:
    v_exp_f32 v112, v112
    v_exp_f32 v113, v113
    v_exp_f32 v114, v114
    v_cvt_pk_bf16_f32 v80, v112, v113
    v_mfma_f32_32x32x16_bf16 v[96:111], v[44:47], v[36:39], v[96:111]
    ds_read_b128 v[48:51], v18 offset:2048
    v_exp_f32 v115, v115
    v_exp_f32 v116, v116
    v_cvt_pk_bf16_f32 v81, v114, v115
    v_exp_f32 v117, v117
    v_exp_f32 v118, v118
    v_mfma_f32_32x32x16_bf16 v[128:143], v[56:59], v[72:75], v[128:143]
    ds_read_b128 v[52:55], v18 offset:3072
    v_cvt_pk_bf16_f32 v82, v116, v117
    v_exp_f32 v119, v119
    v_exp_f32 v120, v120
    v_cvt_pk_bf16_f32 v83, v118, v119
    v_mfma_f32_16x16x32_bf16 v[92:95], v[88:91], v[72:75], v[92:95]
    ds_read_b128 v[64:67], v18 offset:10240
    v_exp_f32 v121, v121
    v_exp_f32 v122, v122
    v_cvt_pk_bf16_f32 v84, v120, v121
    v_mfma_f32_32x32x16_bf16 v[128:143], v[60:63], v[76:79], v[128:143]
    ds_read_b128 v[68:71], v18 offset:11264
    v_exp_f32 v123, v123
    v_exp_f32 v124, v124
    v_cvt_pk_bf16_f32 v85, v122, v123
    v_exp_f32 v125, v125
    v_exp_f32 v126, v126
    v_mfma_f32_16x16x32_bf16 v[92:95], v[88:91], v[76:79], v[92:95]
    v_cvt_pk_bf16_f32 v86, v124, v125
    v_exp_f32 v127, v127
    s_nop 0
    v_cvt_pk_bf16_f32 v87, v126, v127
    s_waitcnt lgkmcnt(0)
    v_mfma_f32_32x32x16_bf16 v[112:127], v[48:51], v[32:35], v[144:159]
    ds_read_b128 v[40:43], v18 offset:4096
    v_exp_f32 v96, v96
    v_exp_f32 v97, v97
    v_exp_f32 v98, v98
    v_cvt_pk_bf16_f32 v72, v96, v97
    v_mfma_f32_32x32x16_bf16 v[112:127], v[52:55], v[36:39], v[112:127]
    ds_read_b128 v[44:47], v18 offset:5120
    v_exp_f32 v99, v99
    v_exp_f32 v100, v100
    v_cvt_pk_bf16_f32 v73, v98, v99
    v_exp_f32 v101, v101
    v_exp_f32 v102, v102
    v_mfma_f32_32x32x16_bf16 v[128:143], v[64:67], v[80:83], v[128:143]
    ds_read_b128 v[56:59], v18 offset:12288
    v_cvt_pk_bf16_f32 v74, v100, v101
    v_exp_f32 v103, v103
    v_exp_f32 v104, v104
    v_cvt_pk_bf16_f32 v75, v102, v103
    v_mfma_f32_16x16x32_bf16 v[92:95], v[88:91], v[80:83], v[92:95]
    ds_read_b128 v[60:63], v18 offset:13312
    v_exp_f32 v105, v105
    v_exp_f32 v106, v106
    v_cvt_pk_bf16_f32 v76, v104, v105
    v_mfma_f32_32x32x16_bf16 v[128:143], v[68:71], v[84:87], v[128:143]
    v_exp_f32 v107, v107
    v_exp_f32 v108, v108
    v_cvt_pk_bf16_f32 v77, v106, v107
    v_exp_f32 v109, v109
    v_exp_f32 v110, v110
    v_mfma_f32_16x16x32_bf16 v[92:95], v[88:91], v[84:87], v[92:95]
    v_cvt_pk_bf16_f32 v78, v108, v109
    v_exp_f32 v111, v111
    s_nop 0
    v_cvt_pk_bf16_f32 v79, v110, v111
    s_waitcnt lgkmcnt(0)
    v_mfma_f32_32x32x16_bf16 v[96:111], v[40:43], v[32:35], v[144:159]
    ds_read_b128 v[48:51], v18 offset:6144
    v_exp_f32 v112, v112
    v_exp_f32 v113, v113
    v_exp_f32 v114, v114
    v_cvt_pk_bf16_f32 v80, v112, v113
    v_mfma_f32_32x32x16_bf16 v[96:111], v[44:47], v[36:39], v[96:111]
    ds_read_b128 v[52:55], v18 offset:7168
    v_exp_f32 v115, v115
    v_exp_f32 v116, v116
    v_cvt_pk_bf16_f32 v81, v114, v115
    v_exp_f32 v117, v117
    v_exp_f32 v118, v118
    v_mfma_f32_32x32x16_bf16 v[128:143], v[56:59], v[72:75], v[128:143]
    ds_read_b128 v[64:67], v18 offset:14336
    v_cvt_pk_bf16_f32 v82, v116, v117
    v_exp_f32 v119, v119
    v_exp_f32 v120, v120
    v_cvt_pk_bf16_f32 v83, v118, v119
    v_mfma_f32_16x16x32_bf16 v[92:95], v[88:91], v[72:75], v[92:95]
    ds_read_b128 v[68:71], v18 offset:15360
    v_exp_f32 v121, v121
    v_exp_f32 v122, v122
    v_cvt_pk_bf16_f32 v84, v120, v121
    v_mfma_f32_32x32x16_bf16 v[128:143], v[60:63], v[76:79], v[128:143]
    v_exp_f32 v123, v123
    v_exp_f32 v124, v124
    v_cvt_pk_bf16_f32 v85, v122, v123
    v_exp_f32 v125, v125
    v_exp_f32 v126, v126
    v_mfma_f32_16x16x32_bf16 v[92:95], v[88:91], v[76:79], v[92:95]
    v_cvt_pk_bf16_f32 v86, v124, v125
    v_exp_f32 v127, v127
    s_nop 0
    v_cvt_pk_bf16_f32 v87, v126, v127
    s_waitcnt vmcnt(0) lgkmcnt(0)
    s_barrier
    v_xor_b32 v18, 0x4000, v18
    s_cmp_lg_u32 s3, 0
    s_cbranch_scc1 W0_7
    s_lshr_b32 s32, s52, 1
    s_lshl_b32 s32, s32, 8
    s_lshl_b32 s33, s54, 7
    s_add_u32 s32, s32, s33
    s_add_u32 s32, s32, 12288
    v_and_b32 v27, 15, v1
    v_lshlrev_b32 v27, 3, v27
    v_add_u32 v27, s32, v27
    global_load_dwordx2 v[28:29], v27, s[58:59] sc1
W0_7:
    v_mfma_f32_32x32x16_bf16 v[112:127], v[48:51], v[32:35], v[144:159]
    s_mov_b32 m0, s56
    s_xor_b32 s56, s56, 0x4000
    buffer_load_dwordx4 v19, s[40:43], s55 offen sc1 lds
    v_exp_f32 v96, v96
    v_exp_f32 v97, v97
    v_exp_f32 v98, v98
    v_cvt_pk_bf16_f32 v72, v96, v97
    v_mfma_f32_32x32x16_bf16 v[112:127], v[52:55], v[36:39], v[112:127]
    buffer_load_dwordx4 v19, s[40:43], s55 offen offset:1024 sc1 lds
    s_add_u32 s55, s55, 8192
    v_exp_f32 v99, v99
    v_exp_f32 v100, v100
    v_cvt_pk_bf16_f32 v73, v98, v99
    v_exp_f32 v101, v101
    v_exp_f32 v102, v102
    v_mfma_f32_32x32x16_bf16 v[128:143], v[64:67], v[80:83], v[128:143]
    ds_read_b128 v[40:43], v18 offset:0
    v_cvt_pk_bf16_f32 v74, v100, v101
    v_exp_f32 v103, v103
    v_exp_f32 v104, v104
    v_cvt_pk_bf16_f32 v75, v102, v103
    v_mfma_f32_16x16x32_bf16 v[92:95], v[88:91], v[80:83], v[92:95]
    ds_read_b128 v[44:47], v18 offset:1024
    v_exp_f32 v105, v105
    v_exp_f32 v106, v106
    v_cvt_pk_bf16_f32 v76, v104, v105
    v_mfma_f32_32x32x16_bf16 v[128:143], v[68:71], v[84:87], v[128:143]
    ds_read_b128 v[56:59], v18 offset:8192
    v_exp_f32 v107, v107
    v_exp_f32 v108, v108
    v_cvt_pk_bf16_f32 v77, v106, v107
    v_exp_f32 v109, v109
    v_exp_f32 v110, v110
    v_mfma_f32_16x16x32_bf16 v[92:95], v[88:91], v[84:87], v[92:95]
    ds_read_b128 v[60:63], v18 offset:9216
    v_cvt_pk_bf16_f32 v78, v108, v109
    v_exp_f32 v111, v111
    s_nop 0
    v_cvt_pk_bf16_f32 v79, v110, v111
    s_waitcnt lgkmcnt(0)
    v_mfma_f32_32x32x16_bf16 v[96:111], v[40:43], v[32:35], v[144:159]
    s_add_u32 s32, s3, 4
    s_lshl_b32 s32, s32, 17
    s_add_u32 s32, s32, s4
    buffer_load_dword v30, v31, s[16:19], s32 offen
    v_exp_f32 v112, v112
    v_exp_f32 v113, v113
    v_exp_f32 v114, v114
    v_cvt_pk_bf16_f32 v80, v112, v113
    v_mfma_f32_32x32x16_bf16 v[96:111], v[44:47], v[36:39], v[96:111]
    ds_read_b128 v[48:51], v18 offset:2048
    v_exp_f32 v115, v115
    v_exp_f32 v116, v116
    v_cvt_pk_bf16_f32 v81, v114, v115
    v_exp_f32 v117, v117
    v_exp_f32 v118, v118
    v_mfma_f32_32x32x16_bf16 v[128:143], v[56:59], v[72:75], v[128:143]
    ds_read_b128 v[52:55], v18 offset:3072
    v_cvt_pk_bf16_f32 v82, v116, v117
    v_exp_f32 v119, v119
    v_exp_f32 v120, v120
    v_cvt_pk_bf16_f32 v83, v118, v119
    v_mfma_f32_16x16x32_bf16 v[92:95], v[88:91], v[72:75], v[92:95]
    ds_read_b128 v[64:67], v18 offset:10240
    v_exp_f32 v121, v121
    v_exp_f32 v122, v122
    v_cvt_pk_bf16_f32 v84, v120, v121
    v_mfma_f32_32x32x16_bf16 v[128:143], v[60:63], v[76:79], v[128:143]
    ds_read_b128 v[68:71], v18 offset:11264
    v_exp_f32 v123, v123
    v_exp_f32 v124, v124
    v_cvt_pk_bf16_f32 v85, v122, v123
    v_exp_f32 v125, v125
    v_exp_f32 v126, v126
    v_mfma_f32_16x16x32_bf16 v[92:95], v[88:91], v[76:79], v[92:95]
    v_cvt_pk_bf16_f32 v86, v124, v125
    v_exp_f32 v127, v127
    s_nop 0
    v_cvt_pk_bf16_f32 v87, v126, v127
    s_waitcnt lgkmcnt(0)
    v_mfma_f32_32x32x16_bf16 v[112:127], v[48:51], v[32:35], v[144:159]
    ds_read_b128 v[40:43], v18 offset:4096
    v_exp_f32 v96, v96
    v_exp_f32 v97, v97
    v_exp_f32 v98, v98
    v_cvt_pk_bf16_f32 v72, v96, v97
    v_mfma_f32_32x32x16_bf16 v[112:127], v[52:55], v[36:39], v[112:127]
    ds_read_b128 v[44:47], v18 offset:5120
    v_exp_f32 v99, v99
    v_exp_f32 v100, v100
    v_cvt_pk_bf16_f32 v73, v98, v99
    v_exp_f32 v101, v101
    v_exp_f32 v102, v102
    v_mfma_f32_32x32x16_bf16 v[128:143], v[64:67], v[80:83], v[128:143]
    ds_read_b128 v[56:59], v18 offset:12288
    v_cvt_pk_bf16_f32 v74, v100, v101
    v_exp_f32 v103, v103
    v_exp_f32 v104, v104
    v_cvt_pk_bf16_f32 v75, v102, v103
    v_mfma_f32_16x16x32_bf16 v[92:95], v[88:91], v[80:83], v[92:95]
    ds_read_b128 v[60:63], v18 offset:13312
    v_exp_f32 v105, v105
    v_exp_f32 v106, v106
    v_cvt_pk_bf16_f32 v76, v104, v105
    v_mfma_f32_32x32x16_bf16 v[128:143], v[68:71], v[84:87], v[128:143]
    v_exp_f32 v107, v107
    v_exp_f32 v108, v108
    v_cvt_pk_bf16_f32 v77, v106, v107
    v_exp_f32 v109, v109
    v_exp_f32 v110, v110
    v_mfma_f32_16x16x32_bf16 v[92:95], v[88:91], v[84:87], v[92:95]
    v_cvt_pk_bf16_f32 v78, v108, v109
    v_exp_f32 v111, v111
    s_nop 0
    v_cvt_pk_bf16_f32 v79, v110, v111
    s_waitcnt lgkmcnt(0)
    v_mfma_f32_32x32x16_bf16 v[96:111], v[40:43], v[32:35], v[144:159]
    ds_read_b128 v[48:51], v18 offset:6144
    v_exp_f32 v112, v112
    v_exp_f32 v113, v113
    v_exp_f32 v114, v114
    v_cvt_pk_bf16_f32 v80, v112, v113
    v_mfma_f32_32x32x16_bf16 v[96:111], v[44:47], v[36:39], v[96:111]
    ds_read_b128 v[52:55], v18 offset:7168
    v_exp_f32 v115, v115
    v_exp_f32 v116, v116
    v_cvt_pk_bf16_f32 v81, v114, v115
    v_exp_f32 v117, v117
    v_exp_f32 v118, v118
    v_mfma_f32_32x32x16_bf16 v[128:143], v[56:59], v[72:75], v[128:143]
    ds_read_b128 v[64:67], v18 offset:14336
    v_cvt_pk_bf16_f32 v82, v116, v117
    v_exp_f32 v119, v119
    v_exp_f32 v120, v120
    v_cvt_pk_bf16_f32 v83, v118, v119
    v_mfma_f32_16x16x32_bf16 v[92:95], v[88:91], v[72:75], v[92:95]
    ds_read_b128 v[68:71], v18 offset:15360
    v_exp_f32 v121, v121
    v_exp_f32 v122, v122
    v_cvt_pk_bf16_f32 v84, v120, v121
    v_mfma_f32_32x32x16_bf16 v[128:143], v[60:63], v[76:79], v[128:143]
    v_exp_f32 v123, v123
    v_exp_f32 v124, v124
    v_cvt_pk_bf16_f32 v85, v122, v123
    v_exp_f32 v125, v125
    v_exp_f32 v126, v126
    v_mfma_f32_16x16x32_bf16 v[92:95], v[88:91], v[76:79], v[92:95]
    v_cvt_pk_bf16_f32 v86, v124, v125
    v_exp_f32 v127, v127
    s_nop 0
    v_cvt_pk_bf16_f32 v87, v126, v127
    s_waitcnt vmcnt(1) lgkmcnt(0)
    s_barrier
    v_xor_b32 v18, 0x4000, v18
    s_cmp_lg_u32 s3, 0
    s_cbranch_scc1 W0_8
    s_mov_b32 s33, 2097152
PL9:
    v_cmp_eq_u64 vcc, s[8:9], v[28:29]
    s_cmp_eq_u64 vcc, -1
    s_cbranch_scc1 PD9
    s_sub_u32 s33, s33, 1
    s_cbranch_scc1 PD9
    s_sleep 1
    global_load_dwordx2 v[28:29], v27, s[58:59] sc1
    s_waitcnt vmcnt(0)
    s_branch PL9
PD9:
W0_8:
    v_mfma_f32_32x32x16_bf16 v[112:127], v[48:51], v[32:35], v[144:159]
    s_mov_b32 m0, s56
    s_xor_b32 s56, s56, 0x4000
    buffer_load_dwordx4 v19, s[40:43], s55 offen sc1 lds
    v_exp_f32 v96, v96
    v_exp_f32 v97, v97
    v_exp_f32 v98, v98
    v_cvt_pk_bf16_f32 v72, v96, v97
    v_mfma_f32_32x32x16_bf16 v[112:127], v[52:55], v[36:39], v[112:127]
    buffer_load_dwordx4 v19, s[40:43], s55 offen offset:1024 sc1 lds
    s_add_u32 s55, s55, 8192
    v_exp_f32 v99, v99
    v_exp_f32 v100, v100
    v_cvt_pk_bf16_f32 v73, v98, v99
    v_exp_f32 v101, v101
    v_exp_f32 v102, v102
    v_mfma_f32_32x32x16_bf16 v[128:143], v[64:67], v[80:83], v[128:143]
    ds_read_b128 v[40:43], v18 offset:0
    v_cvt_pk_bf16_f32 v74, v100, v101
    v_exp_f32 v103, v103
    v_exp_f32 v104, v104
    v_cvt_pk_bf16_f32 v75, v102, v103
    v_mfma_f32_16x16x32_bf16 v[92:95], v[88:91], v[80:83], v[92:95]
    ds_read_b128 v[44:47], v18 offset:1024
    v_exp_f32 v105, v105
    v_exp_f32 v106, v106
    v_cvt_pk_bf16_f32 v76, v104, v105
    v_mfma_f32_32x32x16_bf16 v[128:143], v[68:71], v[84:87], v[128:143]
    ds_read_b128 v[56:59], v18 offset:8192
    v_exp_f32 v107, v107
    v_exp_f32 v108, v108
    v_cvt_pk_bf16_f32 v77, v106, v107
    v_exp_f32 v109, v109
    v_exp_f32 v110, v110
    v_mfma_f32_16x16x32_bf16 v[92:95], v[88:91], v[84:87], v[92:95]
    ds_read_b128 v[60:63], v18 offset:9216
    v_cvt_pk_bf16_f32 v78, v108, v109
    v_exp_f32 v111, v111
    s_nop 0
    v_cvt_pk_bf16_f32 v79, v110, v111
    s_waitcnt lgkmcnt(0)
    v_mfma_f32_32x32x16_bf16 v[96:111], v[40:43], v[32:35], v[144:159]
    ds_read_b128 v[48:51], v18 offset:2048
    v_exp_f32 v112, v112
    v_exp_f32 v113, v113
    v_exp_f32 v114, v114
    v_cvt_pk_bf16_f32 v80, v112, v113
    v_mfma_f32_32x32x16_bf16 v[96:111], v[44:47], v[36:39], v[96:111]
    ds_read_b128 v[52:55], v18 offset:3072
    v_exp_f32 v115, v115
    v_exp_f32 v116, v116
    v_cvt_pk_bf16_f32 v81, v114, v115
    v_exp_f32 v117, v117
    v_exp_f32 v118, v118
    v_mfma_f32_32x32x16_bf16 v[128:143], v[56:59], v[72:75], v[128:143]
    ds_read_b128 v[64:67], v18 offset:10240
    v_cvt_pk_bf16_f32 v82, v116, v117
    v_exp_f32 v119, v119
    v_exp_f32 v120, v120
    v_cvt_pk_bf16_f32 v83, v118, v119
    v_mfma_f32_16x16x32_bf16 v[92:95], v[88:91], v[72:75], v[92:95]
    ds_read_b128 v[68:71], v18 offset:11264
    v_exp_f32 v121, v121
    v_exp_f32 v122, v122
    v_cvt_pk_bf16_f32 v84, v120, v121
    v_mfma_f32_32x32x16_bf16 v[128:143], v[60:63], v[76:79], v[128:143]
    v_exp_f32 v123, v123
    v_exp_f32 v124, v124
    v_cvt_pk_bf16_f32 v85, v122, v123
    v_exp_f32 v125, v125
    v_exp_f32 v126, v126
    v_mfma_f32_16x16x32_bf16 v[92:95], v[88:91], v[76:79], v[92:95]
    v_cvt_pk_bf16_f32 v86, v124, v125
    v_exp_f32 v127, v127
    s_nop 0
    v_cvt_pk_bf16_f32 v87, v126, v127
    s_waitcnt lgkmcnt(0)
    v_mfma_f32_32x32x16_bf16 v[112:127], v[48:51], v[32:35], v[144:159]
    ds_read_b128 v[40:43], v18 offset:4096
    v_exp_f32 v96, v96
    v_exp_f32 v97, v97
    v_exp_f32 v98, v98
    v_cvt_pk_bf16_f32 v72, v96, v97
    v_mfma_f32_32x32x16_bf16 v[112:127], v[52:55], v[36:39], v[112:127]
    ds_read_b128 v[44:47], v18 offset:5120
    v_exp_f32 v99, v99
    v_exp_f32 v100, v100
    v_cvt_pk_bf16_f32 v73, v98, v99
    v_exp_f32 v101, v101
    v_exp_f32 v102, v102
    v_mfma_f32_32x32x16_bf16 v[128:143], v[64:67], v[80:83], v[128:143]
    ds_read_b128 v[56:59], v18 offset:12288
    v_cvt_pk_bf16_f32 v74, v100, v101
    v_exp_f32 v103, v103
    v_exp_f32 v104, v104
    v_cvt_pk_bf16_f32 v75, v102, v103
    v_mfma_f32_16x16x32_bf16 v[92:95], v[88:91], v[80:83], v[92:95]
    ds_read_b128 v[60:63], v18 offset:13312
    v_exp_f32 v105, v105
    v_exp_f32 v106, v106
    v_cvt_pk_bf16_f32 v76, v104, v105
    v_mfma_f32_32x32x16_bf16 v[128:143], v[68:71], v[84:87], v[128:143]
    v_exp_f32 v107, v107
    v_exp_f32 v108, v108
    v_cvt_pk_bf16_f32 v77, v106, v107
    v_exp_f32 v109, v109
    v_exp_f32 v110, v110
    v_mfma_f32_16x16x32_bf16 v[92:95], v[88:91], v[84:87], v[92:95]
    v_cvt_pk_bf16_f32 v78, v108, v109
    v_exp_f32 v111, v111
    s_nop 0
    v_cvt_pk_bf16_f32 v79, v110, v111
    s_waitcnt lgkmcnt(0)
    v_mfma_f32_32x32x16_bf16 v[96:111], v[40:43], v[32:35], v[144:159]
    ds_read_b128 v[48:51], v18 offset:6144
    v_exp_f32 v112, v112
    v_exp_f32 v113, v113
    v_exp_f32 v114, v114
    v_cvt_pk_bf16_f32 v80, v112, v113
    v_mfma_f32_32x32x16_bf16 v[96:111], v[44:47], v[36:39], v[96:111]
    ds_read_b128 v[52:55], v18 offset:7168
    v_exp_f32 v115, v115
    v_exp_f32 v116, v116
    v_cvt_pk_bf16_f32 v81, v114, v115
    v_exp_f32 v117, v117
    v_exp_f32 v118, v118
    v_mfma_f32_32x32x16_bf16 v[128:143], v[56:59], v[72:75], v[128:143]
    ds_read_b128 v[64:67], v18 offset:14336
    v_cvt_pk_bf16_f32 v82, v116, v117
    v_exp_f32 v119, v119
    v_exp_f32 v120, v120
    v_cvt_pk_bf16_f32 v83, v118, v119
    v_mfma_f32_16x16x32_bf16 v[92:95], v[88:91], v[72:75], v[92:95]
    ds_read_b128 v[68:71], v18 offset:15360
    v_exp_f32 v121, v121
    v_exp_f32 v122, v122
    v_cvt_pk_bf16_f32 v84, v120, v121
    v_mfma_f32_32x32x16_bf16 v[128:143], v[60:63], v[76:79], v[128:143]
    v_exp_f32 v123, v123
    v_exp_f32 v124, v124
    v_cvt_pk_bf16_f32 v85, v122, v123
    v_exp_f32 v125, v125
    v_exp_f32 v126, v126
    v_mfma_f32_16x16x32_bf16 v[92:95], v[88:91], v[76:79], v[92:95]
    v_cvt_pk_bf16_f32 v86, v124, v125
    v_exp_f32 v127, v127
    s_nop 0
    v_cvt_pk_bf16_f32 v87, v126, v127
    s_waitcnt vmcnt(0) lgkmcnt(0)
    s_barrier
    v_xor_b32 v18, 0x4000, v18
    v_mfma_f32_32x32x16_bf16 v[112:127], v[48:51], v[32:35], v[144:159]
    s_mov_b32 m0, s56
    s_xor_b32 s56, s56, 0x4000
    buffer_load_dwordx4 v19, s[40:43], s55 offen sc1 lds
    v_exp_f32 v96, v96
    v_exp_f32 v97, v97
    v_exp_f32 v98, v98
    v_cvt_pk_bf16_f32 v72, v96, v97
    v_mfma_f32_32x32x16_bf16 v[112:127], v[52:55], v[36:39], v[112:127]
    buffer_load_dwordx4 v19, s[40:43], s55 offen offset:1024 sc1 lds
    s_add_u32 s55, s55, 8192
    v_exp_f32 v99, v99
    v_exp_f32 v100, v100
    v_cvt_pk_bf16_f32 v73, v98, v99
    v_exp_f32 v101, v101
    v_exp_f32 v102, v102
    v_mfma_f32_32x32x16_bf16 v[128:143], v[64:67], v[80:83], v[128:143]
    ds_read_b128 v[40:43], v18 offset:0
    v_cvt_pk_bf16_f32 v74, v100, v101
    v_exp_f32 v103, v103
    v_exp_f32 v104, v104
    v_cvt_pk_bf16_f32 v75, v102, v103
    v_mfma_f32_16x16x32_bf16 v[92:95], v[88:91], v[80:83], v[92:95]
    ds_read_b128 v[44:47], v18 offset:1024
    v_exp_f32 v105, v105
    v_exp_f32 v106, v106
    v_cvt_pk_bf16_f32 v76, v104, v105
    v_mfma_f32_32x32x16_bf16 v[128:143], v[68:71], v[84:87], v[128:143]
    ds_read_b128 v[56:59], v18 offset:8192
    v_exp_f32 v107, v107
    v_exp_f32 v108, v108
    v_cvt_pk_bf16_f32 v77, v106, v107
    v_exp_f32 v109, v109
    v_exp_f32 v110, v110
    v_mfma_f32_16x16x32_bf16 v[92:95], v[88:91], v[84:87], v[92:95]
    ds_read_b128 v[60:63], v18 offset:9216
    v_cvt_pk_bf16_f32 v78, v108, v109
    v_exp_f32 v111, v111
    s_nop 0
    v_cvt_pk_bf16_f32 v79, v110, v111
    s_waitcnt lgkmcnt(0)
    v_mfma_f32_32x32x16_bf16 v[96:111], v[40:43], v[32:35], v[144:159]
    s_add_u32 m0, s57, s35
    s_nop 0
    buffer_load_dwordx4 v20, s[36:39], s21 offen sc1 lds
    s_add_u32 s21, s21, 8192
    v_exp_f32 v112, v112
    v_exp_f32 v113, v113
    v_exp_f32 v114, v114
    v_cvt_pk_bf16_f32 v80, v112, v113
    v_mfma_f32_32x32x16_bf16 v[96:111], v[44:47], v[36:39], v[96:111]
    s_add_u32 m0, m0, 8192
    s_add_u32 s57, s57, 16384
    buffer_load_dwordx4 v21, s[16:19], s22 offen sc1 lds
    s_add_u32 s22, s22, 65536
    v_exp_f32 v115, v115
    v_exp_f32 v116, v116
    v_cvt_pk_bf16_f32 v81, v114, v115
    v_exp_f32 v117, v117
    v_exp_f32 v118, v118
    v_mfma_f32_32x32x16_bf16 v[128:143], v[56:59], v[72:75], v[128:143]
    ds_read_b128 v[48:51], v18 offset:2048
    v_cvt_pk_bf16_f32 v82, v116, v117
    v_exp_f32 v119, v119
    v_exp_f32 v120, v120
    v_cvt_pk_bf16_f32 v83, v118, v119
    v_mfma_f32_16x16x32_bf16 v[92:95], v[88:91], v[72:75], v[92:95]
    ds_read_b128 v[52:55], v18 offset:3072
    v_exp_f32 v121, v121
    v_exp_f32 v122, v122
    v_cvt_pk_bf16_f32 v84, v120, v121
    v_mfma_f32_32x32x16_bf16 v[128:143], v[60:63], v[76:79], v[128:143]
    ds_read_b128 v[64:67], v18 offset:10240
    v_exp_f32 v123, v123
    v_exp_f32 v124, v124
    v_cvt_pk_bf16_f32 v85, v122, v123
    v_exp_f32 v125, v125
    v_exp_f32 v126, v126
    v_mfma_f32_16x16x32_bf16 v[92:95], v[88:91], v[76:79], v[92:95]
    ds_read_b128 v[68:71], v18 offset:11264
    v_cvt_pk_bf16_f32 v86, v124, v125
    v_exp_f32 v127, v127
    s_nop 0
    v_cvt_pk_bf16_f32 v87, v126, v127
    s_waitcnt lgkmcnt(0)
    v_mfma_f32_32x32x16_bf16 v[112:127], v[48:51], v[32:35], v[144:159]
    s_add_u32 m0, s57, s35
    s_nop 0
    buffer_load_dwordx4 v20, s[36:39], s21 offen sc1 lds
    s_add_u32 s21, s21, 8192
    v_exp_f32 v96, v96
    v_exp_f32 v97, v97
    v_exp_f32 v98, v98
    v_cvt_pk_bf16_f32 v72, v96, v97
    v_mfma_f32_32x32x16_bf16 v[112:127], v[52:55], v[36:39], v[112:127]
    s_add_u32 m0, m0, 8192
    s_add_u32 s57, s57, 16384
    buffer_load_dwordx4 v21, s[16:19], s22 offen sc1 lds
    s_add_u32 s22, s22, 65536
    v_exp_f32 v99, v99
    v_exp_f32 v100, v100
    v_cvt_pk_bf16_f32 v73, v98, v99
    v_exp_f32 v101, v101
    v_exp_f32 v102, v102
    v_mfma_f32_32x32x16_bf16 v[128:143], v[64:67], v[80:83], v[128:143]
    ds_read_b128 v[40:43], v18 offset:4096
    v_cvt_pk_bf16_f32 v74, v100, v101
    v_exp_f32 v103, v103
    v_exp_f32 v104, v104
    v_cvt_pk_bf16_f32 v75, v102, v103
    v_mfma_f32_16x16x32_bf16 v[92:95], v[88:91], v[80:83], v[92:95]
    ds_read_b128 v[44:47], v18 offset:5120
    v_exp_f32 v105, v105
    v_exp_f32 v106, v106
    v_cvt_pk_bf16_f32 v76, v104, v105
    v_mfma_f32_32x32x16_bf16 v[128:143], v[68:71], v[84:87], v[128:143]
    ds_read_b128 v[56:59], v18 offset:12288
    v_exp_f32 v107, v107
    v_exp_f32 v108, v108
    v_cvt_pk_bf16_f32 v77, v106, v107
    v_exp_f32 v109, v109
    v_exp_f32 v110, v110
    v_mfma_f32_16x16x32_bf16 v[92:95], v[88:91], v[84:87], v[92:95]
    ds_read_b128 v[60:63], v18 offset:13312
    v_cvt_pk_bf16_f32 v78, v108, v109
    v_exp_f32 v111, v111
    s_nop 0
    v_cvt_pk_bf16_f32 v79, v110, v111
    s_waitcnt lgkmcnt(0)
    v_mfma_f32_32x32x16_bf16 v[96:111], v[40:43], v[32:35], v[144:159]
    s_add_u32 s32, s3, 6
    s_lshl_b32 s32, s32, 15
    s_add_u32 s32, s32, s5
    buffer_load_dword v30, v31, s[36:39], s32 offen
    v_exp_f32 v112, v112
    v_exp_f32 v113, v113
    v_exp_f32 v114, v114
    v_cvt_pk_bf16_f32 v80, v112, v113
    v_mfma_f32_32x32x16_bf16 v[96:111], v[44:47], v[36:39], v[96:111]
    ds_read_b128 v[48:51], v18 offset:6144
    v_exp_f32 v115, v115
    v_exp_f32 v116, v116
    v_cvt_pk_bf16_f32 v81, v114, v115
    v_exp_f32 v117, v117
    v_exp_f32 v118, v118
    v_mfma_f32_32x32x16_bf16 v[128:143], v[56:59], v[72:75], v[128:143]
    ds_read_b128 v[52:55], v18 offset:7168
    v_cvt_pk_bf16_f32 v82, v116, v117
    v_exp_f32 v119, v119
    v_exp_f32 v120, v120
    v_cvt_pk_bf16_f32 v83, v118, v119
    v_mfma_f32_16x16x32_bf16 v[92:95], v[88:91], v[72:75], v[92:95]
    ds_read_b128 v[64:67], v18 offset:14336
    v_exp_f32 v121, v121
    v_exp_f32 v122, v122
    v_cvt_pk_bf16_f32 v84, v120, v121
    v_mfma_f32_32x32x16_bf16 v[128:143], v[60:63], v[76:79], v[128:143]
    ds_read_b128 v[68:71], v18 offset:15360
    v_exp_f32 v123, v123
    v_exp_f32 v124, v124
    v_cvt_pk_bf16_f32 v85, v122, v123
    v_exp_f32 v125, v125
    v_exp_f32 v126, v126
    v_mfma_f32_16x16x32_bf16 v[92:95], v[88:91], v[76:79], v[92:95]
    v_cvt_pk_bf16_f32 v86, v124, v125
    v_exp_f32 v127, v127
    s_nop 0
    v_cvt_pk_bf16_f32 v87, v126, v127
    s_waitcnt vmcnt(5) lgkmcnt(0)
    s_barrier
    v_xor_b32 v18, 0x4000, v18
    v_mfma_f32_32x32x16_bf16 v[112:127], v[48:51], v[32:35], v[144:159]
    s_mov_b32 m0, s56
    s_xor_b32 s56, s56, 0x4000
    buffer_load_dwordx4 v19, s[40:43], s55 offen sc1 lds
    v_exp_f32 v96, v96
    v_exp_f32 v97, v97
    v_exp_f32 v98, v98
    v_cvt_pk_bf16_f32 v72, v96, v97
    v_mfma_f32_32x32x16_bf16 v[112:127], v[52:55], v[36:39], v[112:127]
    buffer_load_dwordx4 v19, s[40:43], s55 offen offset:1024 sc1 lds
    s_add_u32 s55, s55, 8192
    v_exp_f32 v99, v99
    v_exp_f32 v100, v100
    v_cvt_pk_bf16_f32 v73, v98, v99
    v_exp_f32 v101, v101
    v_exp_f32 v102, v102
    v_mfma_f32_32x32x16_bf16 v[128:143], v[64:67], v[80:83], v[128:143]
    ds_read_b128 v[40:43], v18 offset:0
    v_cvt_pk_bf16_f32 v74, v100, v101
    v_exp_f32 v103, v103
    v_exp_f32 v104, v104
    v_cvt_pk_bf16_f32 v75, v102, v103
    v_mfma_f32_16x16x32_bf16 v[92:95], v[88:91], v[80:83], v[92:95]
    ds_read_b128 v[44:47], v18 offset:1024
    v_exp_f32 v105, v105
    v_exp_f32 v106, v106
    v_cvt_pk_bf16_f32 v76, v104, v105
    v_mfma_f32_32x32x16_bf16 v[128:143], v[68:71], v[84:87], v[128:143]
    ds_read_b128 v[56:59], v18 offset:8192
    v_exp_f32 v107, v107
    v_exp_f32 v108, v108
    v_cvt_pk_bf16_f32 v77, v106, v107
    v_exp_f32 v109, v109
    v_exp_f32 v110, v110
    v_mfma_f32_16x16x32_bf16 v[92:95], v[88:91], v[84:87], v[92:95]
    ds_read_b128 v[60:63], v18 offset:9216
    v_cvt_pk_bf16_f32 v78, v108, v109
    v_exp_f32 v111, v111
    s_nop 0
    v_cvt_pk_bf16_f32 v79, v110, v111
    s_waitcnt lgkmcnt(0)
    v_mfma_f32_32x32x16_bf16 v[96:111], v[40:43], v[32:35], v[144:159]
    s_add_u32 m0, s57, s35
    s_nop 0
    buffer_load_dwordx4 v20, s[36:39], s21 offen sc1 lds
    s_add_u32 s21, s21, 8192
    v_exp_f32 v112, v112
    v_exp_f32 v113, v113
    v_exp_f32 v114, v114
    v_cvt_pk_bf16_f32 v80, v112, v113
    v_mfma_f32_32x32x16_bf16 v[96:111], v[44:47], v[36:39], v[96:111]
    s_add_u32 m0, m0, 8192
    s_add_u32 s57, s57, 16384
    buffer_load_dwordx4 v21, s[16:19], s22 offen sc1 lds
    s_add_u32 s22, s22, 65536
    v_exp_f32 v115, v115
    v_exp_f32 v116, v116
    v_cvt_pk_bf16_f32 v81, v114, v115
    v_exp_f32 v117, v117
    v_exp_f32 v118, v118
    v_mfma_f32_32x32x16_bf16 v[128:143], v[56:59], v[72:75], v[128:143]
    ds_read_b128 v[48:51], v18 offset:2048
    v_cvt_pk_bf16_f32 v82, v116, v117
    v_exp_f32 v119, v119
    v_exp_f32 v120, v120
    v_cvt_pk_bf16_f32 v83, v118, v119
    v_mfma_f32_16x16x32_bf16 v[92:95], v[88:91], v[72:75], v[92:95]
    ds_read_b128 v[52:55], v18 offset:3072
    v_exp_f32 v121, v121
    v_exp_f32 v122, v122
    v_cvt_pk_bf16_f32 v84, v120, v121
    v_mfma_f32_32x32x16_bf16 v[128:143], v[60:63], v[76:79], v[128:143]
    ds_read_b128 v[64:67], v18 offset:10240
    v_exp_f32 v123, v123
    v_exp_f32 v124, v124
    v_cvt_pk_bf16_f32 v85, v122, v123
    v_exp_f32 v125, v125
    v_exp_f32 v126, v126
    v_mfma_f32_16x16x32_bf16 v[92:95], v[88:91], v[76:79], v[92:95]
    ds_read_b128 v[68:71], v18 offset:11264
    v_cvt_pk_bf16_f32 v86, v124, v125
    v_exp_f32 v127, v127
    s_nop 0
    v_cvt_pk_bf16_f32 v87, v126, v127
    s_waitcnt lgkmcnt(0)
    v_mfma_f32_32x32x16_bf16 v[112:127], v[48:51], v[32:35], v[144:159]
    s_add_u32 m0, s57, s35
    s_nop 0
    buffer_load_dwordx4 v20, s[36:39], s21 offen sc1 lds
    s_add_u32 s21, s21, 8192
    v_exp_f32 v96, v96
    v_exp_f32 v97, v97
    v_exp_f32 v98, v98
    v_cvt_pk_bf16_f32 v72, v96, v97
    v_mfma_f32_32x32x16_bf16 v[112:127], v[52:55], v[36:39], v[112:127]
    s_add_u32 m0, m0, 8192
    s_add_u32 s57, s57, 16384
    buffer_load_dwordx4 v21, s[16:19], s22 offen sc1 lds
    s_add_u32 s22, s22, 65536
    v_exp_f32 v99, v99
    v_exp_f32 v100, v100
    v_cvt_pk_bf16_f32 v73, v98, v99
    v_exp_f32 v101, v101
    v_exp_f32 v102, v102
    v_mfma_f32_32x32x16_bf16 v[128:143], v[64:67], v[80:83], v[128:143]
    ds_read_b128 v[40:43], v18 offset:4096
    v_cvt_pk_bf16_f32 v74, v100, v101
    v_exp_f32 v103, v103
    v_exp_f32 v104, v104
    v_cvt_pk_bf16_f32 v75, v102, v103
    v_mfma_f32_16x16x32_bf16 v[92:95], v[88:91], v[80:83], v[92:95]
    ds_read_b128 v[44:47], v18 offset:5120
    v_exp_f32 v105, v105
    v_exp_f32 v106, v106
    v_cvt_pk_bf16_f32 v76, v104, v105
    v_mfma_f32_32x32x16_bf16 v[128:143], v[68:71], v[84:87], v[128:143]
    ds_read_b128 v[56:59], v18 offset:12288
    v_exp_f32 v107, v107
    v_exp_f32 v108, v108
    v_cvt_pk_bf16_f32 v77, v106, v107
    v_exp_f32 v109, v109
    v_exp_f32 v110, v110
    v_mfma_f32_16x16x32_bf16 v[92:95], v[88:91], v[84:87], v[92:95]
    ds_read_b128 v[60:63], v18 offset:13312
    v_cvt_pk_bf16_f32 v78, v108, v109
    v_exp_f32 v111, v111
    s_nop 0
    v_cvt_pk_bf16_f32 v79, v110, v111
    s_waitcnt lgkmcnt(0)
    v_mfma_f32_32x32x16_bf16 v[96:111], v[40:43], v[32:35], v[144:159]
    s_add_u32 s32, s3, 0
    s_lshl_b32 s32, s32, 15
    s_add_u32 s32, s32, s5
    buffer_load_dword v30, v31, s[36:39], s32 offen
    v_exp_f32 v112, v112
    v_exp_f32 v113, v113
    v_exp_f32 v114, v114
    v_cvt_pk_bf16_f32 v80, v112, v113
    v_mfma_f32_32x32x16_bf16 v[96:111], v[44:47], v[36:39], v[96:111]
    ds_read_b128 v[48:51], v18 offset:6144
    v_exp_f32 v115, v115
    v_exp_f32 v116, v116
    v_cvt_pk_bf16_f32 v81, v114, v115
    v_exp_f32 v117, v117
    v_exp_f32 v118, v118
    v_mfma_f32_32x32x16_bf16 v[128:143], v[56:59], v[72:75], v[128:143]
    ds_read_b128 v[52:55], v18 offset:7168
    v_cvt_pk_bf16_f32 v82, v116, v117
    v_exp_f32 v119, v119
    v_exp_f32 v120, v120
    v_cvt_pk_bf16_f32 v83, v118, v119
    v_mfma_f32_16x16x32_bf16 v[92:95], v[88:91], v[72:75], v[92:95]
    ds_read_b128 v[64:67], v18 offset:14336
    v_exp_f32 v121, v121
    v_exp_f32 v122, v122
    v_cvt_pk_bf16_f32 v84, v120, v121
    v_mfma_f32_32x32x16_bf16 v[128:143], v[60:63], v[76:79], v[128:143]
    ds_read_b128 v[68:71], v18 offset:15360
    v_exp_f32 v123, v123
    v_exp_f32 v124, v124
    v_cvt_pk_bf16_f32 v85, v122, v123
    v_exp_f32 v125, v125
    v_exp_f32 v126, v126
    v_mfma_f32_16x16x32_bf16 v[92:95], v[88:91], v[76:79], v[92:95]
    v_cvt_pk_bf16_f32 v86, v124, v125
    v_exp_f32 v127, v127
    s_nop 0
    v_cvt_pk_bf16_f32 v87, v126, v127
    s_waitcnt vmcnt(5) lgkmcnt(0)
    s_barrier
    v_xor_b32 v18, 0x4000, v18
    v_mfma_f32_32x32x16_bf16 v[112:127], v[48:51], v[32:35], v[144:159]
    s_mov_b32 m0, s56
    s_xor_b32 s56, s56, 0x4000
    buffer_load_dwordx4 v19, s[40:43], s55 offen sc1 lds
    v_exp_f32 v96, v96
    v_exp_f32 v97, v97
    v_exp_f32 v98, v98
    v_cvt_pk_bf16_f32 v72, v96, v97
    v_mfma_f32_32x32x16_bf16 v[112:127], v[52:55], v[36:39], v[112:127]
    buffer_load_dwordx4 v19, s[40:43], s55 offen offset:1024 sc1 lds
    s_add_u32 s55, s55, 8192
    v_exp_f32 v99, v99
    v_exp_f32 v100, v100
    v_cvt_pk_bf16_f32 v73, v98, v99
    v_exp_f32 v101, v101
    v_exp_f32 v102, v102
    v_mfma_f32_32x32x16_bf16 v[128:143], v[64:67], v[80:83], v[128:143]
    ds_read_b128 v[40:43], v18 offset:0
    v_cvt_pk_bf16_f32 v74, v100, v101
    v_exp_f32 v103, v103
    v_exp_f32 v104, v104
    v_cvt_pk_bf16_f32 v75, v102, v103
    v_mfma_f32_16x16x32_bf16 v[92:95], v[88:91], v[80:83], v[92:95]
    ds_read_b128 v[44:47], v18 offset:1024
    v_exp_f32 v105, v105
    v_exp_f32 v106, v106
    v_cvt_pk_bf16_f32 v76, v104, v105
    v_mfma_f32_32x32x16_bf16 v[128:143], v[68:71], v[84:87], v[128:143]
    ds_read_b128 v[56:59], v18 offset:8192
    v_exp_f32 v107, v107
    v_exp_f32 v108, v108
    v_cvt_pk_bf16_f32 v77, v106, v107
    v_exp_f32 v109, v109
    v_exp_f32 v110, v110
    v_mfma_f32_16x16x32_bf16 v[92:95], v[88:91], v[84:87], v[92:95]
    ds_read_b128 v[60:63], v18 offset:9216
    v_cvt_pk_bf16_f32 v78, v108, v109
    v_exp_f32 v111, v111
    s_nop 0
    v_cvt_pk_bf16_f32 v79, v110, v111
    s_waitcnt lgkmcnt(0)
    v_mfma_f32_32x32x16_bf16 v[96:111], v[40:43], v[32:35], v[144:159]
    s_add_u32 m0, s57, s35
    s_nop 0
    buffer_load_dwordx4 v20, s[36:39], s21 offen sc1 lds
    s_add_u32 s21, s21, 8192
    v_exp_f32 v112, v112
    v_exp_f32 v113, v113
    v_exp_f32 v114, v114
    v_cvt_pk_bf16_f32 v80, v112, v113
    v_mfma_f32_32x32x16_bf16 v[96:111], v[44:47], v[36:39], v[96:111]
    s_add_u32 m0, m0, 8192
    s_add_u32 s57, s57, 16384
    buffer_load_dwordx4 v21, s[16:19], s22 offen sc1 lds
    s_add_u32 s22, s22, 65536
    v_exp_f32 v115, v115
    v_exp_f32 v116, v116
    v_cvt_pk_bf16_f32 v81, v114, v115
    v_exp_f32 v117, v117
    v_exp_f32 v118, v118
    v_mfma_f32_32x32x16_bf16 v[128:143], v[56:59], v[72:75], v[128:143]
    ds_read_b128 v[48:51], v18 offset:2048
    v_cvt_pk_bf16_f32 v82, v116, v117
    v_exp_f32 v119, v119
    v_exp_f32 v120, v120
    v_cvt_pk_bf16_f32 v83, v118, v119
    v_mfma_f32_16x16x32_bf16 v[92:95], v[88:91], v[72:75], v[92:95]
    ds_read_b128 v[52:55], v18 offset:3072
    v_exp_f32 v121, v121
    v_exp_f32 v122, v122
    v_cvt_pk_bf16_f32 v84, v120, v121
    v_mfma_f32_32x32x16_bf16 v[128:143], v[60:63], v[76:79], v[128:143]
    ds_read_b128 v[64:67], v18 offset:10240
    v_exp_f32 v123, v123
    v_exp_f32 v124, v124
    v_cvt_pk_bf16_f32 v85, v122, v123
    v_exp_f32 v125, v125
    v_exp_f32 v126, v126
    v_mfma_f32_16x16x32_bf16 v[92:95], v[88:91], v[76:79], v[92:95]
    ds_read_b128 v[68:71], v18 offset:11264
    v_cvt_pk_bf16_f32 v86, v124, v125
    v_exp_f32 v127, v127
    s_nop 0
    v_cvt_pk_bf16_f32 v87, v126, v127
    s_waitcnt lgkmcnt(0)
    v_mfma_f32_32x32x16_bf16 v[112:127], v[48:51], v[32:35], v[144:159]
    s_add_u32 m0, s57, s35
    s_nop 0
    buffer_load_dwordx4 v20, s[36:39], s21 offen sc1 lds
    s_add_u32 s21, s21, 8192
    v_exp_f32 v96, v96
    v_exp_f32 v97, v97
    v_exp_f32 v98, v98
    v_cvt_pk_bf16_f32 v72, v96, v97
    v_mfma_f32_32x32x16_bf16 v[112:127], v[52:55], v[36:39], v[112:127]
    s_add_u32 m0, m0, 8192
    s_add_u32 s57, s57, 16384
    buffer_load_dwordx4 v21, s[16:19], s22 offen sc1 lds
    s_add_u32 s22, s22, 65536
    v_exp_f32 v99, v99
    v_exp_f32 v100, v100
    v_cvt_pk_bf16_f32 v73, v98, v99
    v_exp_f32 v101, v101
    v_exp_f32 v102, v102
    v_mfma_f32_32x32x16_bf16 v[128:143], v[64:67], v[80:83], v[128:143]
    ds_read_b128 v[40:43], v18 offset:4096
    v_cvt_pk_bf16_f32 v74, v100, v101
    v_exp_f32 v103, v103
    v_exp_f32 v104, v104
    v_cvt_pk_bf16_f32 v75, v102, v103
    v_mfma_f32_16x16x32_bf16 v[92:95], v[88:91], v[80:83], v[92:95]
    ds_read_b128 v[44:47], v18 offset:5120
    v_exp_f32 v105, v105
    v_exp_f32 v106, v106
    v_cvt_pk_bf16_f32 v76, v104, v105
    v_mfma_f32_32x32x16_bf16 v[128:143], v[68:71], v[84:87], v[128:143]
    ds_read_b128 v[56:59], v18 offset:12288
    v_exp_f32 v107, v107
    v_exp_f32 v108, v108
    v_cvt_pk_bf16_f32 v77, v106, v107
    v_exp_f32 v109, v109
    v_exp_f32 v110, v110
    v_mfma_f32_16x16x32_bf16 v[92:95], v[88:91], v[84:87], v[92:95]
    ds_read_b128 v[60:63], v18 offset:13312
    v_cvt_pk_bf16_f32 v78, v108, v109
    v_exp_f32 v111, v111
    s_nop 0
    v_cvt_pk_bf16_f32 v79, v110, v111
    s_waitcnt lgkmcnt(0)
    v_mfma_f32_32x32x16_bf16 v[96:111], v[40:43], v[32:35], v[144:159]
    ds_read_b128 v[48:51], v18 offset:6144
    v_exp_f32 v112, v112
    v_exp_f32 v113, v113
    v_exp_f32 v114, v114
    v_cvt_pk_bf16_f32 v80, v112, v113
    v_mfma_f32_32x32x16_bf16 v[96:111], v[44:47], v[36:39], v[96:111]
    ds_read_b128 v[52:55], v18 offset:7168
    v_exp_f32 v115, v115
    v_exp_f32 v116, v116
    v_cvt_pk_bf16_f32 v81, v114, v115
    v_exp_f32 v117, v117
    v_exp_f32 v118, v118
    v_mfma_f32_32x32x16_bf16 v[128:143], v[56:59], v[72:75], v[128:143]
    ds_read_b128 v[64:67], v18 offset:14336
    v_cvt_pk_bf16_f32 v82, v116, v117
    v_exp_f32 v119, v119
    v_exp_f32 v120, v120
    v_cvt_pk_bf16_f32 v83, v118, v119
    v_mfma_f32_16x16x32_bf16 v[92:95], v[88:91], v[72:75], v[92:95]
    ds_read_b128 v[68:71], v18 offset:15360
    v_exp_f32 v121, v121
    v_exp_f32 v122, v122
    v_cvt_pk_bf16_f32 v84, v120, v121
    v_mfma_f32_32x32x16_bf16 v[128:143], v[60:63], v[76:79], v[128:143]
    v_exp_f32 v123, v123
    v_exp_f32 v124, v124
    v_cvt_pk_bf16_f32 v85, v122, v123
    v_exp_f32 v125, v125
    v_exp_f32 v126, v126
    v_mfma_f32_16x16x32_bf16 v[92:95], v[88:91], v[76:79], v[92:95]
    v_cvt_pk_bf16_f32 v86, v124, v125
    v_exp_f32 v127, v127
    s_nop 0
    v_cvt_pk_bf16_f32 v87, v126, v127
    s_waitcnt vmcnt(4) lgkmcnt(0)
    s_barrier
    v_xor_b32 v18, 0x4000, v18
    v_mfma_f32_32x32x16_bf16 v[112:127], v[48:51], v[32:35], v[144:159]
    s_mov_b32 m0, s56
    s_xor_b32 s56, s56, 0x4000
    buffer_load_dwordx4 v19, s[40:43], s55 offen sc1 lds
    v_exp_f32 v96, v96
    v_exp_f32 v97, v97
    v_exp_f32 v98, v98
    v_cvt_pk_bf16_f32 v72, v96, v97
    v_mfma_f32_32x32x16_bf16 v[112:127], v[52:55], v[36:39], v[112:127]
    buffer_load_dwordx4 v19, s[40:43], s55 offen offset:1024 sc1 lds
    s_add_u32 s55, s55, 8192
    v_exp_f32 v99, v99
    v_exp_f32 v100, v100
    v_cvt_pk_bf16_f32 v73, v98, v99
    v_exp_f32 v101, v101
    v_exp_f32 v102, v102
    v_mfma_f32_32x32x16_bf16 v[128:143], v[64:67], v[80:83], v[128:143]
    ds_read_b128 v[40:43], v18 offset:0
    v_cvt_pk_bf16_f32 v74, v100, v101
    v_exp_f32 v103, v103
    v_exp_f32 v104, v104
    v_cvt_pk_bf16_f32 v75, v102, v103
    v_mfma_f32_16x16x32_bf16 v[92:95], v[88:91], v[80:83], v[92:95]
    ds_read_b128 v[44:47], v18 offset:1024
    v_exp_f32 v105, v105
    v_exp_f32 v106, v106
    v_cvt_pk_bf16_f32 v76, v104, v105
    v_mfma_f32_32x32x16_bf16 v[128:143], v[68:71], v[84:87], v[128:143]
    ds_read_b128 v[56:59], v18 offset:8192
    v_exp_f32 v107, v107
    v_exp_f32 v108, v108
    v_cvt_pk_bf16_f32 v77, v106, v107
    v_exp_f32 v109, v109
    v_exp_f32 v110, v110
    v_mfma_f32_16x16x32_bf16 v[92:95], v[88:91], v[84:87], v[92:95]
    ds_read_b128 v[60:63], v18 offset:9216
    v_cvt_pk_bf16_f32 v78, v108, v109
    v_exp_f32 v111, v111
    s_nop 0
    v_cvt_pk_bf16_f32 v79, v110, v111
    s_waitcnt lgkmcnt(0)
    v_mfma_f32_32x32x16_bf16 v[96:111], v[40:43], v[32:35], v[144:159]
    s_add_u32 m0, s57, s35
    s_nop 0
    buffer_load_dwordx4 v20, s[36:39], s21 offen sc1 lds
    s_add_u32 s21, s21, 8192
    v_exp_f32 v112, v112
    v_exp_f32 v113, v113
    v_exp_f32 v114, v114
    v_cvt_pk_bf16_f32 v80, v112, v113
    v_mfma_f32_32x32x16_bf16 v[96:111], v[44:47], v[36:39], v[96:111]
    s_add_u32 m0, m0, 8192
    s_add_u32 s57, s57, 16384
    buffer_load_dwordx4 v21, s[16:19], s22 offen sc1 lds
    s_add_u32 s22, s22, 65536
    v_exp_f32 v115, v115
    v_exp_f32 v116, v116
    v_cvt_pk_bf16_f32 v81, v114, v115
    v_exp_f32 v117, v117
    v_exp_f32 v118, v118
    v_mfma_f32_32x32x16_bf16 v[128:143], v[56:59], v[72:75], v[128:143]
    ds_read_b128 v[48:51], v18 offset:2048
    v_cvt_pk_bf16_f32 v82, v116, v117
    v_exp_f32 v119, v119
    v_exp_f32 v120, v120
    v_cvt_pk_bf16_f32 v83, v118, v119
    v_mfma_f32_16x16x32_bf16 v[92:95], v[88:91], v[72:75], v[92:95]
    ds_read_b128 v[52:55], v18 offset:3072
    v_exp_f32 v121, v121
    v_exp_f32 v122, v122
    v_cvt_pk_bf16_f32 v84, v120, v121
    v_mfma_f32_32x32x16_bf16 v[128:143], v[60:63], v[76:79], v[128:143]
    ds_read_b128 v[64:67], v18 offset:10240
    v_exp_f32 v123, v123
    v_exp_f32 v124, v124
    v_cvt_pk_bf16_f32 v85, v122, v123
    v_exp_f32 v125, v125
    v_exp_f32 v126, v126
    v_mfma_f32_16x16x32_bf16 v[92:95], v[88:91], v[76:79], v[92:95]
    ds_read_b128 v[68:71], v18 offset:11264
    v_cvt_pk_bf16_f32 v86, v124, v125
    v_exp_f32 v127, v127
    s_nop 0
    v_cvt_pk_bf16_f32 v87, v126, v127
    s_waitcnt lgkmcnt(0)
    v_mfma_f32_32x32x16_bf16 v[112:127], v[48:51], v[32:35], v[144:159]
    s_add_u32 m0, s57, s35
    s_nop 0
    buffer_load_dwordx4 v20, s[36:39], s21 offen sc1 lds
    s_add_u32 s21, s21, 8192
    v_exp_f32 v96, v96
    v_exp_f32 v97, v97
    v_exp_f32 v98, v98
    v_cvt_pk_bf16_f32 v72, v96, v97
    v_mfma_f32_32x32x16_bf16 v[112:127], v[52:55], v[36:39], v[112:127]
    s_add_u32 m0, m0, 8192
    s_add_u32 s57, s57, 16384
    buffer_load_dwordx4 v21, s[16:19], s22 offen sc1 lds
    s_add_u32 s22, s22, 65536
    v_exp_f32 v99, v99
    v_exp_f32 v100, v100
    v_cvt_pk_bf16_f32 v73, v98, v99
    v_exp_f32 v101, v101
    v_exp_f32 v102, v102
    v_mfma_f32_32x32x16_bf16 v[128:143], v[64:67], v[80:83], v[128:143]
    ds_read_b128 v[40:43], v18 offset:4096
    v_cvt_pk_bf16_f32 v74, v100, v101
    v_exp_f32 v103, v103
    v_exp_f32 v104, v104
    v_cvt_pk_bf16_f32 v75, v102, v103
    v_mfma_f32_16x16x32_bf16 v[92:95], v[88:91], v[80:83], v[92:95]
    ds_read_b128 v[44:47], v18 offset:5120
    v_exp_f32 v105, v105
    v_exp_f32 v106, v106
    v_cvt_pk_bf16_f32 v76, v104, v105
    v_mfma_f32_32x32x16_bf16 v[128:143], v[68:71], v[84:87], v[128:143]
    ds_read_b128 v[56:59], v18 offset:12288
    v_exp_f32 v107, v107
    v_exp_f32 v108, v108
    v_cvt_pk_bf16_f32 v77, v106, v107
    v_exp_f32 v109, v109
    v_exp_f32 v110, v110
    v_mfma_f32_16x16x32_bf16 v[92:95], v[88:91], v[84:87], v[92:95]
    ds_read_b128 v[60:63], v18 offset:13312
    v_cvt_pk_bf16_f32 v78, v108, v109
    v_exp_f32 v111, v111
    s_nop 0
    v_cvt_pk_bf16_f32 v79, v110, v111
    s_waitcnt lgkmcnt(0)
    v_mfma_f32_32x32x16_bf16 v[96:111], v[40:43], v[32:35], v[144:159]
    ds_read_b128 v[48:51], v18 offset:6144
    v_exp_f32 v112, v112
    v_exp_f32 v113, v113
    v_exp_f32 v114, v114
    v_cvt_pk_bf16_f32 v80, v112, v113
    v_mfma_f32_32x32x16_bf16 v[96:111], v[44:47], v[36:39], v[96:111]
    ds_read_b128 v[52:55], v18 offset:7168
    v_exp_f32 v115, v115
    v_exp_f32 v116, v116
    v_cvt_pk_bf16_f32 v81, v114, v115
    v_exp_f32 v117, v117
    v_exp_f32 v118, v118
    v_mfma_f32_32x32x16_bf16 v[128:143], v[56:59], v[72:75], v[128:143]
    ds_read_b128 v[64:67], v18 offset:14336
    v_cvt_pk_bf16_f32 v82, v116, v117
    v_exp_f32 v119, v119
    v_exp_f32 v120, v120
    v_cvt_pk_bf16_f32 v83, v118, v119
    v_mfma_f32_16x16x32_bf16 v[92:95], v[88:91], v[72:75], v[92:95]
    ds_read_b128 v[68:71], v18 offset:15360
    v_exp_f32 v121, v121
    v_exp_f32 v122, v122
    v_cvt_pk_bf16_f32 v84, v120, v121
    v_mfma_f32_32x32x16_bf16 v[128:143], v[60:63], v[76:79], v[128:143]
    v_exp_f32 v123, v123
    v_exp_f32 v124, v124
    v_cvt_pk_bf16_f32 v85, v122, v123
    v_exp_f32 v125, v125
    v_exp_f32 v126, v126
    v_mfma_f32_16x16x32_bf16 v[92:95], v[88:91], v[76:79], v[92:95]
    v_cvt_pk_bf16_f32 v86, v124, v125
    v_exp_f32 v127, v127
    s_nop 0
    v_cvt_pk_bf16_f32 v87, v126, v127
    s_waitcnt vmcnt(0) lgkmcnt(0)
    s_barrier
    v_xor_b32 v18, 0x4000, v18
    v_mfma_f32_32x32x16_bf16 v[112:127], v[48:51], v[32:35], v[144:159]
    ds_read_b128 v[40:43], v18 offset:0
    v_exp_f32 v96, v96
    v_exp_f32 v97, v97
    v_exp_f32 v98, v98
    v_cvt_pk_bf16_f32 v72, v96, v97
    v_mfma_f32_32x32x16_bf16 v[112:127], v[52:55], v[36:39], v[112:127]
    ds_read_b128 v[44:47], v18 offset:1024
    v_exp_f32 v99, v99
    v_exp_f32 v100, v100
    v_cvt_pk_bf16_f32 v73, v98, v99
    v_exp_f32 v101, v101
    v_exp_f32 v102, v102
    v_mfma_f32_32x32x16_bf16 v[128:143], v[64:67], v[80:83], v[128:143]
    ds_read_b128 v[56:59], v18 offset:8192
    v_cvt_pk_bf16_f32 v74, v100, v101
    v_exp_f32 v103, v103
    v_exp_f32 v104, v104
    v_cvt_pk_bf16_f32 v75, v102, v103
    v_mfma_f32_16x16x32_bf16 v[92:95], v[88:91], v[80:83], v[92:95]
    ds_read_b128 v[60:63], v18 offset:9216
    v_exp_f32 v105, v105
    v_exp_f32 v106, v106
    v_cvt_pk_bf16_f32 v76, v104, v105
    v_mfma_f32_32x32x16_bf16 v[128:143], v[68:71], v[84:87], v[128:143]
    v_exp_f32 v107, v107
    v_exp_f32 v108, v108
    v_cvt_pk_bf16_f32 v77, v106, v107
    v_exp_f32 v109, v109
    v_exp_f32 v110, v110
    v_mfma_f32_16x16x32_bf16 v[92:95], v[88:91], v[84:87], v[92:95]
    v_cvt_pk_bf16_f32 v78, v108, v109
    v_exp_f32 v111, v111
    s_nop 0
    v_cvt_pk_bf16_f32 v79, v110, v111
    s_waitcnt lgkmcnt(0)
    v_mfma_f32_32x32x16_bf16 v[96:111], v[40:43], v[32:35], v[144:159]
    ds_read_b128 v[48:51], v18 offset:2048
    v_exp_f32 v112, v112
    v_exp_f32 v113, v113
    v_exp_f32 v114, v114
    v_cvt_pk_bf16_f32 v80, v112, v113
    v_mfma_f32_32x32x16_bf16 v[96:111], v[44:47], v[36:39], v[96:111]
    ds_read_b128 v[52:55], v18 offset:3072
    v_exp_f32 v115, v115
    v_exp_f32 v116, v116
    v_cvt_pk_bf16_f32 v81, v114, v115
    v_exp_f32 v117, v117
    v_exp_f32 v118, v118
    v_mfma_f32_32x32x16_bf16 v[128:143], v[56:59], v[72:75], v[128:143]
    ds_read_b128 v[64:67], v18 offset:10240
    v_cvt_pk_bf16_f32 v82, v116, v117
    v_exp_f32 v119, v119
    v_exp_f32 v120, v120
    v_cvt_pk_bf16_f32 v83, v118, v119
    v_mfma_f32_16x16x32_bf16 v[92:95], v[88:91], v[72:75], v[92:95]
    ds_read_b128 v[68:71], v18 offset:11264
    v_exp_f32 v121, v121
    v_exp_f32 v122, v122
    v_cvt_pk_bf16_f32 v84, v120, v121
    v_mfma_f32_32x32x16_bf16 v[128:143], v[60:63], v[76:79], v[128:143]
    v_exp_f32 v123, v123
    v_exp_f32 v124, v124
    v_cvt_pk_bf16_f32 v85, v122, v123
    v_exp_f32 v125, v125
    v_exp_f32 v126, v126
    v_mfma_f32_16x16x32_bf16 v[92:95], v[88:91], v[76:79], v[92:95]
    v_cvt_pk_bf16_f32 v86, v124, v125
    v_exp_f32 v127, v127
    s_nop 0
    v_cvt_pk_bf16_f32 v87, v126, v127
    s_waitcnt lgkmcnt(0)
    v_mfma_f32_32x32x16_bf16 v[112:127], v[48:51], v[32:35], v[144:159]
    ds_read_b128 v[40:43], v18 offset:4096
    v_exp_f32 v96, v96
    v_exp_f32 v97, v97
    v_exp_f32 v98, v98
    v_cvt_pk_bf16_f32 v72, v96, v97
    v_mfma_f32_32x32x16_bf16 v[112:127], v[52:55], v[36:39], v[112:127]
    ds_read_b128 v[44:47], v18 offset:5120
    v_exp_f32 v99, v99
    v_exp_f32 v100, v100
    v_cvt_pk_bf16_f32 v73, v98, v99
    v_exp_f32 v101, v101
    v_exp_f32 v102, v102
    v_mfma_f32_32x32x16_bf16 v[128:143], v[64:67], v[80:83], v[128:143]
    ds_read_b128 v[56:59], v18 offset:12288
    v_cvt_pk_bf16_f32 v74, v100, v101
    v_exp_f32 v103, v103
    v_exp_f32 v104, v104
    v_cvt_pk_bf16_f32 v75, v102, v103
    v_mfma_f32_16x16x32_bf16 v[92:95], v[88:91], v[80:83], v[92:95]
    ds_read_b128 v[60:63], v18 offset:13312
    v_exp_f32 v105, v105
    v_exp_f32 v106, v106
    v_cvt_pk_bf16_f32 v76, v104, v105
    v_mfma_f32_32x32x16_bf16 v[128:143], v[68:71], v[84:87], v[128:143]
    v_exp_f32 v107, v107
    v_exp_f32 v108, v108
    v_cvt_pk_bf16_f32 v77, v106, v107
    v_exp_f32 v109, v109
    v_exp_f32 v110, v110
    v_mfma_f32_16x16x32_bf16 v[92:95], v[88:91], v[84:87], v[92:95]
    v_cvt_pk_bf16_f32 v78, v108, v109
    v_exp_f32 v111, v111
    s_nop 0
    v_cvt_pk_bf16_f32 v79, v110, v111
    s_waitcnt lgkmcnt(0)
    v_mfma_f32_32x32x16_bf16 v[128:143], v[56:59], v[72:75], v[128:143]
    ds_read_b128 v[48:51], v18 offset:6144
    v_exp_f32 v112, v112
    v_exp_f32 v113, v113
    v_exp_f32 v114, v114
    v_cvt_pk_bf16_f32 v80, v112, v113
    v_mfma_f32_16x16x32_bf16 v[92:95], v[88:91], v[72:75], v[92:95]
    ds_read_b128 v[52:55], v18 offset:7168
    v_exp_f32 v115, v115
    v_exp_f32 v116, v116
    v_cvt_pk_bf16_f32 v81, v114, v115
    v_exp_f32 v117, v117
    v_exp_f32 v118, v118
    v_mfma_f32_32x32x16_bf16 v[128:143], v[60:63], v[76:79], v[128:143]
    ds_read_b128 v[64:67], v18 offset:14336
    v_cvt_pk_bf16_f32 v82, v116, v117
    v_exp_f32 v119, v119
    v_exp_f32 v120, v120
    v_cvt_pk_bf16_f32 v83, v118, v119
    v_mfma_f32_16x16x32_bf16 v[92:95], v[88:91], v[76:79], v[92:95]
    ds_read_b128 v[68:71], v18 offset:15360
    v_exp_f32 v121, v121
    v_exp_f32 v122, v122
    v_cvt_pk_bf16_f32 v84, v120, v121
    v_exp_f32 v123, v123
    v_exp_f32 v124, v124
    v_cvt_pk_bf16_f32 v85, v122, v123
    v_exp_f32 v125, v125
    v_exp_f32 v126, v126
    v_cvt_pk_bf16_f32 v86, v124, v125
    v_exp_f32 v127, v127
    s_nop 0
    v_cvt_pk_bf16_f32 v87, v126, v127
    s_waitcnt lgkmcnt(0)
    v_mfma_f32_32x32x16_bf16 v[128:143], v[64:67], v[80:83], v[128:143]
    v_mfma_f32_16x16x32_bf16 v[92:95], v[88:91], v[80:83], v[92:95]
    v_mfma_f32_32x32x16_bf16 v[128:143], v[68:71], v[84:87], v[128:143]
    v_mfma_f32_16x16x32_bf16 v[92:95], v[88:91], v[84:87], v[92:95]
    s_add_u32 s20, s20, 4096
    s_lshl_b32 s32, s27, 1
    s_add_u32 s32, s32, s28
    s_mul_i32 s32, s32, 144
    s_add_u32 s32, s32, s26
    s_add_u32 s32, s32, 112
    s_lshl_b32 s32, s32, 13
    s_lshl_b32 s33, s31, 11
    s_add_u32 s25, s32, s33
    s_nop 4
    v_mul_f32 v26, 0, v92
    v_fma_f32 v26, v128, 0, v26
    v_fma_f32 v26, v129, 0, v26
    v_fma_f32 v26, v130, 0, v26
    v_fma_f32 v26, v131, 0, v26
    v_fma_f32 v26, v132, 0, v26
    v_fma_f32 v26, v133, 0, v26
    v_fma_f32 v26, v134, 0, v26
    v_fma_f32 v26, v135, 0, v26
    v_fma_f32 v26, v136, 0, v26
    v_fma_f32 v26, v137, 0, v26
    v_fma_f32 v26, v138, 0, v26
    v_fma_f32 v26, v139, 0, v26
    v_fma_f32 v26, v140, 0, v26
    v_fma_f32 v26, v141, 0, v26
    v_fma_f32 v26, v142, 0, v26
    v_fma_f32 v26, v143, 0, v26
    v_cmp_u_f32 vcc, v26, v26
    s_cmp_lg_u64 vcc, 0
    s_cbranch_scc1 P2_SLOW
P2_FIN:
    v_rcp_f32 v26, v92
    s_nop 0
    v_mul_f32 v128, v128, v26
    v_mul_f32 v129, v129, v26
    v_mul_f32 v130, v130, v26
    v_mul_f32 v131, v131, v26
    v_mul_f32 v132, v132, v26
    v_mul_f32 v133, v133, v26
    v_mul_f32 v134, v134, v26
    v_mul_f32 v135, v135, v26
    v_mul_f32 v136, v136, v26
    v_mul_f32 v137, v137, v26
    v_mul_f32 v138, v138, v26
    v_mul_f32 v139, v139, v26
    v_mul_f32 v140, v140, v26
    v_mul_f32 v141, v141, v26
    v_mul_f32 v142, v142, v26
    v_mul_f32 v143, v143, v26
    v_cvt_pk_bf16_f32 v72, v128, v129
    v_cvt_pk_bf16_f32 v73, v130, v131
    v_cvt_pk_bf16_f32 v74, v136, v137
    v_cvt_pk_bf16_f32 v75, v138, v139
    v_cvt_pk_bf16_f32 v76, v132, v133
    v_cvt_pk_bf16_f32 v77, v134, v135
    v_cvt_pk_bf16_f32 v78, v140, v141
    v_cvt_pk_bf16_f32 v79, v142, v143
    buffer_store_dwordx4 v[72:75], v19, s[36:39], s25 offen sc1
    buffer_store_dwordx4 v[76:79], v19, s[36:39], s25 offen offset:1024 sc1
    s_cmp_lg_u32 s28, 0
    s_cbranch_scc1 P3_L
    s_lshr_b32 s32, s31, 1
    s_lshl_b32 s32, s32, 12
    v_lshlrev_b32 v22, 9, v16
    v_lshl_add_u32 v22, v17, 4, v22
    v_add_u32 v96, s32, v22
    v_lshrrev_b32 v22, 2, v17
    v_lshl_add_u32 v22, v16, 2, v22
    s_lshl_b32 s32, s54, 2
    s_lshl_b32 s33, s29, 1
    s_add_u32 s32, s32, s33
    v_and_b32 v23, 7, v22
    v_xor_b32 v23, s32, v23
    v_lshlrev_b32 v23, 5, v23
    v_lshl_add_u32 v23, v22, 8, v23
    v_and_b32 v27, 3, v1
    v_lshl_add_u32 v99, v27, 3, v23
    v_xor_b32 v102, 32, v99
    v_xor_b32 v105, 128, v99
    v_xor_b32 v108, 160, v99
    ds_read_b64_tr_b16 v[48:49], v99 offset:8192
    ds_read_b64_tr_b16 v[50:51], v99 offset:12288
    ds_read_b64_tr_b16 v[52:53], v102 offset:8192
    ds_read_b64_tr_b16 v[54:55], v102 offset:12288
    ds_read_b64_tr_b16 v[56:57], v105 offset:8192
    ds_read_b64_tr_b16 v[58:59], v105 offset:12288
    ds_read_b64_tr_b16 v[60:61], v108 offset:8192
    ds_read_b64_tr_b16 v[62:63], v108 offset:12288
    ds_read_b128 v[32:35], v96 offset:0
    ds_read_b128 v[36:39], v96 offset:256
    ds_read_b128 v[40:43], v96 offset:2048
    ds_read_b128 v[44:47], v96 offset:2304
    v_add_u32 v97, 0x10000, v96
    v_add_u32 v98, 0x20000, v96
    v_add_u32 v100, 0x10000, v99
    v_add_u32 v101, 0x20000, v99
    v_add_u32 v103, 0x10000, v102
    v_add_u32 v104, 0x20000, v102
    v_add_u32 v106, 0x10000, v105
    v_add_u32 v107, 0x20000, v105
    v_add_u32 v109, 0x10000, v108
    v_add_u32 v110, 0x20000, v108
    v_bfe_u32 v23, v22, 1, 2
    v_xor_b32 v23, s33, v23
    v_lshlrev_b32 v23, 5, v23
    v_lshl_add_u32 v23, v22, 7, v23
    v_lshl_add_u32 v111, v27, 3, v23
    v_xor_b32 v114, 32, v111
    v_add_u32 v112, 0x10000, v111
    v_add_u32 v113, 0x20000, v111
    v_add_u32 v115, 0x10000, v114
    v_add_u32 v116, 0x20000, v114
    s_mov_b32 s21, s50
    s_mov_b32 s40, s46
    s_mov_b32 s41, s47
    s_mov_b32 s42, 4194304
    s_mov_b32 s43, 0x20000
    s_lshl_b32 s32, s31, 12
    s_lshl_b32 s57, s2, 14
    s_add_u32 s57, s57, s32
    s_xor_b32 s22, s57, 16384
    s_barrier
    s_waitcnt lgkmcnt(2)
    v_mfma_f32_16x16x32_bf16 v[128:131], v[48:51], v[32:35], 0
    ds_read_b64_tr_b16 v[80:81], v99 offset:24576
    v_mfma_f32_16x16x32_bf16 v[144:147], v[52:55], v[32:35], 0
    ds_read_b64_tr_b16 v[82:83], v99 offset:28672
    v_mfma_f32_16x16x32_bf16 v[160:163], v[56:59], v[32:35], 0
    ds_read_b64_tr_b16 v[84:85], v102 offset:24576
    v_mfma_f32_16x16x32_bf16 v[176:179], v[60:63], v[32:35], 0
    ds_read_b64_tr_b16 v[86:87], v102 offset:28672
    v_mfma_f32_16x16x32_bf16 v[180:183], v[60:63], v[36:39], 0
    ds_read_b64_tr_b16 v[88:89], v105 offset:24576
    v_mfma_f32_16x16x32_bf16 v[164:167], v[56:59], v[36:39], 0
    ds_read_b64_tr_b16 v[90:91], v105 offset:28672
    v_mfma_f32_16x16x32_bf16 v[148:151], v[52:55], v[36:39], 0
    ds_read_b64_tr_b16 v[92:93], v108 offset:24576
    v_mfma_f32_16x16x32_bf16 v[132:135], v[48:51], v[36:39], 0
    ds_read_b64_tr_b16 v[94:95], v108 offset:28672
    s_waitcnt lgkmcnt(8)
    v_mfma_f32_16x16x32_bf16 v[136:139], v[48:51], v[40:43], 0
    ds_read_b128 v[64:67], v96 offset:16384
    v_mfma_f32_16x16x32_bf16 v[152:155], v[52:55], v[40:43], 0
    ds_read_b128 v[68:71], v96 offset:16640
    v_mfma_f32_16x16x32_bf16 v[168:171], v[56:59], v[40:43], 0
    ds_read_b128 v[72:75], v96 offset:18432
    v_mfma_f32_16x16x32_bf16 v[184:187], v[60:63], v[40:43], 0
    ds_read_b128 v[76:79], v96 offset:18688
    v_mfma_f32_16x16x32_bf16 v[188:191], v[60:63], v[44:47], 0
    v_mfma_f32_16x16x32_bf16 v[172:175], v[56:59], v[44:47], 0
    v_mfma_f32_16x16x32_bf16 v[156:159], v[52:55], v[44:47], 0
    v_mfma_f32_16x16x32_bf16 v[140:143], v[48:51], v[44:47], 0
    s_waitcnt lgkmcnt(2)
    v_mfma_f32_16x16x32_bf16 v[128:131], v[80:83], v[64:67], v[128:131]
    ds_read_b64_tr_b16 v[48:49], v99 offset:40960
    v_mfma_f32_16x16x32_bf16 v[144:147], v[84:87], v[64:67], v[144:147]
    ds_read_b64_tr_b16 v[50:51], v99 offset:45056
    v_mfma_f32_16x16x32_bf16 v[160:163], v[88:91], v[64:67], v[160:163]
    ds_read_b64_tr_b16 v[52:53], v102 offset:40960
    v_mfma_f32_16x16x32_bf16 v[176:179], v[92:95], v[64:67], v[176:179]
    ds_read_b64_tr_b16 v[54:55], v102 offset:45056
    v_mfma_f32_16x16x32_bf16 v[180:183], v[92:95], v[68:71], v[180:183]
    ds_read_b64_tr_b16 v[56:57], v105 offset:40960
    v_mfma_f32_16x16x32_bf16 v[164:167], v[88:91], v[68:71], v[164:167]
    ds_read_b64_tr_b16 v[58:59], v105 offset:45056
    v_mfma_f32_16x16x32_bf16 v[148:151], v[84:87], v[68:71], v[148:151]
    ds_read_b64_tr_b16 v[60:61], v108 offset:40960
    v_mfma_f32_16x16x32_bf16 v[132:135], v[80:83], v[68:71], v[132:135]
    ds_read_b64_tr_b16 v[62:63], v108 offset:45056
    s_waitcnt lgkmcnt(8)
    v_mfma_f32_16x16x32_bf16 v[136:139], v[80:83], v[72:75], v[136:139]
    ds_read_b128 v[32:35], v96 offset:32768
    v_mfma_f32_16x16x32_bf16 v[152:155], v[84:87], v[72:75], v[152:155]
    ds_read_b128 v[36:39], v96 offset:33024
    v_mfma_f32_16x16x32_bf16 v[168:171], v[88:91], v[72:75], v[168:171]
    ds_read_b128 v[40:43], v96 offset:34816
    v_mfma_f32_16x16x32_bf16 v[184:187], v[92:95], v[72:75], v[184:187]
    ds_read_b128 v[44:47], v96 offset:35072
    v_mfma_f32_16x16x32_bf16 v[188:191], v[92:95], v[76:79], v[188:191]
    v_mfma_f32_16x16x32_bf16 v[172:175], v[88:91], v[76:79], v[172:175]
    v_mfma_f32_16x16x32_bf16 v[156:159], v[84:87], v[76:79], v[156:159]
    v_mfma_f32_16x16x32_bf16 v[140:143], v[80:83], v[76:79], v[140:143]
    s_barrier
    s_waitcnt lgkmcnt(2)
    v_mfma_f32_16x16x32_bf16 v[128:131], v[48:51], v[32:35], v[128:131]
    ds_read_b64_tr_b16 v[80:81], v99 offset:57344
    v_mfma_f32_16x16x32_bf16 v[144:147], v[52:55], v[32:35], v[144:147]
    ds_read_b64_tr_b16 v[82:83], v99 offset:61440
    v_mfma_f32_16x16x32_bf16 v[160:163], v[56:59], v[32:35], v[160:163]
    ds_read_b64_tr_b16 v[84:85], v102 offset:57344
    v_mfma_f32_16x16x32_bf16 v[176:179], v[60:63], v[32:35], v[176:179]
    ds_read_b64_tr_b16 v[86:87], v102 offset:61440
    v_mfma_f32_16x16x32_bf16 v[180:183], v[60:63], v[36:39], v[180:183]
    ds_read_b64_tr_b16 v[88:89], v105 offset:57344
    v_mfma_f32_16x16x32_bf16 v[164:167], v[56:59], v[36:39], v[164:167]
    ds_read_b64_tr_b16 v[90:91], v105 offset:61440
    v_mfma_f32_16x16x32_bf16 v[148:151], v[52:55], v[36:39], v[148:151]
    ds_read_b64_tr_b16 v[92:93], v108 offset:57344
    v_mfma_f32_16x16x32_bf16 v[132:135], v[48:51], v[36:39], v[132:135]
    ds_read_b64_tr_b16 v[94:95], v108 offset:61440
    s_waitcnt lgkmcnt(8)
    v_mfma_f32_16x16x32_bf16 v[136:139], v[48:51], v[40:43], v[136:139]
    ds_read_b128 v[64:67], v96 offset:49152
    v_mfma_f32_16x16x32_bf16 v[152:155], v[52:55], v[40:43], v[152:155]
    ds_read_b128 v[68:71], v96 offset:49408
    v_mfma_f32_16x16x32_bf16 v[168:171], v[56:59], v[40:43], v[168:171]
    ds_read_b128 v[72:75], v96 offset:51200
    v_mfma_f32_16x16x32_bf16 v[184:187], v[60:63], v[40:43], v[184:187]
    ds_read_b128 v[76:79], v96 offset:51456
    v_mfma_f32_16x16x32_bf16 v[188:191], v[60:63], v[44:47], v[188:191]
    v_mfma_f32_16x16x32_bf16 v[172:175], v[56:59], v[44:47], v[172:175]
    v_mfma_f32_16x16x32_bf16 v[156:159], v[52:55], v[44:47], v[156:159]
    v_mfma_f32_16x16x32_bf16 v[140:143], v[48:51], v[44:47], v[140:143]
    s_waitcnt lgkmcnt(2)
    v_mfma_f32_16x16x32_bf16 v[128:131], v[80:83], v[64:67], v[128:131]
    ds_read_b64_tr_b16 v[48:49], v100 offset:8192
    v_mfma_f32_16x16x32_bf16 v[144:147], v[84:87], v[64:67], v[144:147]
    ds_read_b64_tr_b16 v[50:51], v100 offset:12288
    v_mfma_f32_16x16x32_bf16 v[160:163], v[88:91], v[64:67], v[160:163]
    ds_read_b64_tr_b16 v[52:53], v103 offset:8192
    v_mfma_f32_16x16x32_bf16 v[176:179], v[92:95], v[64:67], v[176:179]
    ds_read_b64_tr_b16 v[54:55], v103 offset:12288
    v_mfma_f32_16x16x32_bf16 v[180:183], v[92:95], v[68:71], v[180:183]
    ds_read_b64_tr_b16 v[56:57], v106 offset:8192
    v_mfma_f32_16x16x32_bf16 v[164:167], v[88:91], v[68:71], v[164:167]
    ds_read_b64_tr_b16 v[58:59], v106 offset:12288
    v_mfma_f32_16x16x32_bf16 v[148:151], v[84:87], v[68:71], v[148:151]
    ds_read_b64_tr_b16 v[60:61], v109 offset:8192
    v_mfma_f32_16x16x32_bf16 v[132:135], v[80:83], v[68:71], v[132:135]
    ds_read_b64_tr_b16 v[62:63], v109 offset:12288
    s_waitcnt lgkmcnt(8)
    v_mfma_f32_16x16x32_bf16 v[136:139], v[80:83], v[72:75], v[136:139]
    ds_read_b128 v[32:35], v97 offset:0
    v_mfma_f32_16x16x32_bf16 v[152:155], v[84:87], v[72:75], v[152:155]
    ds_read_b128 v[36:39], v97 offset:256
    v_mfma_f32_16x16x32_bf16 v[168:171], v[88:91], v[72:75], v[168:171]
    ds_read_b128 v[40:43], v97 offset:2048
    v_mfma_f32_16x16x32_bf16 v[184:187], v[92:95], v[72:75], v[184:187]
    ds_read_b128 v[44:47], v97 offset:2304
    v_mfma_f32_16x16x32_bf16 v[188:191], v[92:95], v[76:79], v[188:191]
    v_mfma_f32_16x16x32_bf16 v[172:175], v[88:91], v[76:79], v[172:175]
    v_mfma_f32_16x16x32_bf16 v[156:159], v[84:87], v[76:79], v[156:159]
    v_mfma_f32_16x16x32_bf16 v[140:143], v[80:83], v[76:79], v[140:143]
    s_barrier
    s_waitcnt lgkmcnt(2)
    v_mfma_f32_16x16x32_bf16 v[128:131], v[48:51], v[32:35], v[128:131]
    ds_read_b64_tr_b16 v[80:81], v100 offset:24576
    v_mfma_f32_16x16x32_bf16 v[144:147], v[52:55], v[32:35], v[144:147]
    ds_read_b64_tr_b16 v[82:83], v100 offset:28672
    v_mfma_f32_16x16x32_bf16 v[160:163], v[56:59], v[32:35], v[160:163]
    ds_read_b64_tr_b16 v[84:85], v103 offset:24576
    v_mfma_f32_16x16x32_bf16 v[176:179], v[60:63], v[32:35], v[176:179]
    ds_read_b64_tr_b16 v[86:87], v103 offset:28672
    v_mfma_f32_16x16x32_bf16 v[180:183], v[60:63], v[36:39], v[180:183]
    ds_read_b64_tr_b16 v[88:89], v106 offset:24576
    v_mfma_f32_16x16x32_bf16 v[164:167], v[56:59], v[36:39], v[164:167]
    ds_read_b64_tr_b16 v[90:91], v106 offset:28672
    v_mfma_f32_16x16x32_bf16 v[148:151], v[52:55], v[36:39], v[148:151]
    ds_read_b64_tr_b16 v[92:93], v109 offset:24576
    v_mfma_f32_16x16x32_bf16 v[132:135], v[48:51], v[36:39], v[132:135]
    ds_read_b64_tr_b16 v[94:95], v109 offset:28672
    s_waitcnt lgkmcnt(8)
    v_mfma_f32_16x16x32_bf16 v[136:139], v[48:51], v[40:43], v[136:139]
    ds_read_b128 v[64:67], v97 offset:16384
    v_mfma_f32_16x16x32_bf16 v[152:155], v[52:55], v[40:43], v[152:155]
    ds_read_b128 v[68:71], v97 offset:16640
    v_mfma_f32_16x16x32_bf16 v[168:171], v[56:59], v[40:43], v[168:171]
    ds_read_b128 v[72:75], v97 offset:18432
    v_mfma_f32_16x16x32_bf16 v[184:187], v[60:63], v[40:43], v[184:187]
    ds_read_b128 v[76:79], v97 offset:18688
    v_mfma_f32_16x16x32_bf16 v[188:191], v[60:63], v[44:47], v[188:191]
    v_mfma_f32_16x16x32_bf16 v[172:175], v[56:59], v[44:47], v[172:175]
    v_mfma_f32_16x16x32_bf16 v[156:159], v[52:55], v[44:47], v[156:159]
    v_mfma_f32_16x16x32_bf16 v[140:143], v[48:51], v[44:47], v[140:143]
    s_waitcnt lgkmcnt(2)
    v_mfma_f32_16x16x32_bf16 v[128:131], v[80:83], v[64:67], v[128:131]
    ds_read_b64_tr_b16 v[48:49], v100 offset:40960
    v_mfma_f32_16x16x32_bf16 v[144:147], v[84:87], v[64:67], v[144:147]
    ds_read_b64_tr_b16 v[50:51], v100 offset:45056
    v_mfma_f32_16x16x32_bf16 v[160:163], v[88:91], v[64:67], v[160:163]
    ds_read_b64_tr_b16 v[52:53], v103 offset:40960
    v_mfma_f32_16x16x32_bf16 v[176:179], v[92:95], v[64:67], v[176:179]
    ds_read_b64_tr_b16 v[54:55], v103 offset:45056
    v_mfma_f32_16x16x32_bf16 v[180:183], v[92:95], v[68:71], v[180:183]
    ds_read_b64_tr_b16 v[56:57], v106 offset:40960
    v_mfma_f32_16x16x32_bf16 v[164:167], v[88:91], v[68:71], v[164:167]
    ds_read_b64_tr_b16 v[58:59], v106 offset:45056
    v_mfma_f32_16x16x32_bf16 v[148:151], v[84:87], v[68:71], v[148:151]
    ds_read_b64_tr_b16 v[60:61], v109 offset:40960
    v_mfma_f32_16x16x32_bf16 v[132:135], v[80:83], v[68:71], v[132:135]
    ds_read_b64_tr_b16 v[62:63], v109 offset:45056
    s_waitcnt lgkmcnt(8)
    v_mfma_f32_16x16x32_bf16 v[136:139], v[80:83], v[72:75], v[136:139]
    ds_read_b128 v[32:35], v97 offset:32768
    v_mfma_f32_16x16x32_bf16 v[152:155], v[84:87], v[72:75], v[152:155]
    ds_read_b128 v[36:39], v97 offset:33024
    v_mfma_f32_16x16x32_bf16 v[168:171], v[88:91], v[72:75], v[168:171]
    ds_read_b128 v[40:43], v97 offset:34816
    v_mfma_f32_16x16x32_bf16 v[184:187], v[92:95], v[72:75], v[184:187]
    ds_read_b128 v[44:47], v97 offset:35072
    v_mfma_f32_16x16x32_bf16 v[188:191], v[92:95], v[76:79], v[188:191]
    v_mfma_f32_16x16x32_bf16 v[172:175], v[88:91], v[76:79], v[172:175]
    v_mfma_f32_16x16x32_bf16 v[156:159], v[84:87], v[76:79], v[156:159]
    v_mfma_f32_16x16x32_bf16 v[140:143], v[80:83], v[76:79], v[140:143]
    s_waitcnt vmcnt(0)
    s_barrier
    s_waitcnt lgkmcnt(2)
    v_mfma_f32_16x16x32_bf16 v[128:131], v[48:51], v[32:35], v[128:131]
    ds_read_b64_tr_b16 v[80:81], v100 offset:57344
    v_mfma_f32_16x16x32_bf16 v[144:147], v[52:55], v[32:35], v[144:147]
    ds_read_b64_tr_b16 v[82:83], v100 offset:61440
    v_mfma_f32_16x16x32_bf16 v[160:163], v[56:59], v[32:35], v[160:163]
    ds_read_b64_tr_b16 v[84:85], v103 offset:57344
    v_mfma_f32_16x16x32_bf16 v[176:179], v[60:63], v[32:35], v[176:179]
    ds_read_b64_tr_b16 v[86:87], v103 offset:61440
    v_mfma_f32_16x16x32_bf16 v[180:183], v[60:63], v[36:39], v[180:183]
    ds_read_b64_tr_b16 v[88:89], v106 offset:57344
    v_mfma_f32_16x16x32_bf16 v[164:167], v[56:59], v[36:39], v[164:167]
    ds_read_b64_tr_b16 v[90:91], v106 offset:61440
    v_mfma_f32_16x16x32_bf16 v[148:151], v[52:55], v[36:39], v[148:151]
    ds_read_b64_tr_b16 v[92:93], v109 offset:57344
    v_mfma_f32_16x16x32_bf16 v[132:135], v[48:51], v[36:39], v[132:135]
    ds_read_b64_tr_b16 v[94:95], v109 offset:61440
    s_waitcnt lgkmcnt(8)
    v_mfma_f32_16x16x32_bf16 v[136:139], v[48:51], v[40:43], v[136:139]
    ds_read_b128 v[64:67], v97 offset:49152
    v_mfma_f32_16x16x32_bf16 v[152:155], v[52:55], v[40:43], v[152:155]
    ds_read_b128 v[68:71], v97 offset:49408
    v_mfma_f32_16x16x32_bf16 v[168:171], v[56:59], v[40:43], v[168:171]
    ds_read_b128 v[72:75], v97 offset:51200
    v_mfma_f32_16x16x32_bf16 v[184:187], v[60:63], v[40:43], v[184:187]
    ds_read_b128 v[76:79], v97 offset:51456
    v_mfma_f32_16x16x32_bf16 v[188:191], v[60:63], v[44:47], v[188:191]
    v_mfma_f32_16x16x32_bf16 v[172:175], v[56:59], v[44:47], v[172:175]
    v_mfma_f32_16x16x32_bf16 v[156:159], v[52:55], v[44:47], v[156:159]
    v_mfma_f32_16x16x32_bf16 v[140:143], v[48:51], v[44:47], v[140:143]
    s_waitcnt lgkmcnt(2)
    v_mfma_f32_16x16x32_bf16 v[128:131], v[80:83], v[64:67], v[128:131]
    ds_read_b64_tr_b16 v[48:49], v101 offset:8192
    v_mfma_f32_16x16x32_bf16 v[144:147], v[84:87], v[64:67], v[144:147]
    ds_read_b64_tr_b16 v[50:51], v101 offset:12288
    v_mfma_f32_16x16x32_bf16 v[160:163], v[88:91], v[64:67], v[160:163]
    ds_read_b64_tr_b16 v[52:53], v104 offset:8192
    v_mfma_f32_16x16x32_bf16 v[176:179], v[92:95], v[64:67], v[176:179]
    ds_read_b64_tr_b16 v[54:55], v104 offset:12288
    v_mfma_f32_16x16x32_bf16 v[180:183], v[92:95], v[68:71], v[180:183]
    ds_read_b64_tr_b16 v[56:57], v107 offset:8192
    v_mfma_f32_16x16x32_bf16 v[164:167], v[88:91], v[68:71], v[164:167]
    ds_read_b64_tr_b16 v[58:59], v107 offset:12288
    v_mfma_f32_16x16x32_bf16 v[148:151], v[84:87], v[68:71], v[148:151]
    ds_read_b64_tr_b16 v[60:61], v110 offset:8192
    v_mfma_f32_16x16x32_bf16 v[132:135], v[80:83], v[68:71], v[132:135]
    ds_read_b64_tr_b16 v[62:63], v110 offset:12288
    s_waitcnt lgkmcnt(8)
    v_mfma_f32_16x16x32_bf16 v[136:139], v[80:83], v[72:75], v[136:139]
    ds_read_b128 v[32:35], v98 offset:0
    v_mfma_f32_16x16x32_bf16 v[152:155], v[84:87], v[72:75], v[152:155]
    ds_read_b128 v[36:39], v98 offset:256
    v_mfma_f32_16x16x32_bf16 v[168:171], v[88:91], v[72:75], v[168:171]
    ds_read_b128 v[40:43], v98 offset:2048
    v_mfma_f32_16x16x32_bf16 v[184:187], v[92:95], v[72:75], v[184:187]
    ds_read_b128 v[44:47], v98 offset:2304
    v_mfma_f32_16x16x32_bf16 v[188:191], v[92:95], v[76:79], v[188:191]
    v_mfma_f32_16x16x32_bf16 v[172:175], v[88:91], v[76:79], v[172:175]
    v_mfma_f32_16x16x32_bf16 v[156:159], v[84:87], v[76:79], v[156:159]
    v_mfma_f32_16x16x32_bf16 v[140:143], v[80:83], v[76:79], v[140:143]
    s_barrier
    s_waitcnt lgkmcnt(2)
    v_mfma_f32_16x16x32_bf16 v[128:131], v[48:51], v[32:35], v[128:131]
    ds_read_b64_tr_b16 v[80:81], v101 offset:24576
    v_mfma_f32_16x16x32_bf16 v[144:147], v[52:55], v[32:35], v[144:147]
    ds_read_b64_tr_b16 v[82:83], v101 offset:28672
    v_mfma_f32_16x16x32_bf16 v[160:163], v[56:59], v[32:35], v[160:163]
    ds_read_b64_tr_b16 v[84:85], v104 offset:24576
    v_mfma_f32_16x16x32_bf16 v[176:179], v[60:63], v[32:35], v[176:179]
    ds_read_b64_tr_b16 v[86:87], v104 offset:28672
    v_mfma_f32_16x16x32_bf16 v[180:183], v[60:63], v[36:39], v[180:183]
    ds_read_b64_tr_b16 v[88:89], v107 offset:24576
    v_mfma_f32_16x16x32_bf16 v[164:167], v[56:59], v[36:39], v[164:167]
    ds_read_b64_tr_b16 v[90:91], v107 offset:28672
    v_mfma_f32_16x16x32_bf16 v[148:151], v[52:55], v[36:39], v[148:151]
    ds_read_b64_tr_b16 v[92:93], v110 offset:24576
    v_mfma_f32_16x16x32_bf16 v[132:135], v[48:51], v[36:39], v[132:135]
    ds_read_b64_tr_b16 v[94:95], v110 offset:28672
    s_waitcnt lgkmcnt(8)
    v_mfma_f32_16x16x32_bf16 v[136:139], v[48:51], v[40:43], v[136:139]
    ds_read_b128 v[64:67], v98 offset:16384
    v_mfma_f32_16x16x32_bf16 v[152:155], v[52:55], v[40:43], v[152:155]
    ds_read_b128 v[68:71], v98 offset:16640
    v_mfma_f32_16x16x32_bf16 v[168:171], v[56:59], v[40:43], v[168:171]
    ds_read_b128 v[72:75], v98 offset:18432
    v_mfma_f32_16x16x32_bf16 v[184:187], v[60:63], v[40:43], v[184:187]
    ds_read_b128 v[76:79], v98 offset:18688
    v_mfma_f32_16x16x32_bf16 v[188:191], v[60:63], v[44:47], v[188:191]
    v_mfma_f32_16x16x32_bf16 v[172:175], v[56:59], v[44:47], v[172:175]
    v_mfma_f32_16x16x32_bf16 v[156:159], v[52:55], v[44:47], v[156:159]
    v_mfma_f32_16x16x32_bf16 v[140:143], v[48:51], v[44:47], v[140:143]
    s_waitcnt lgkmcnt(2)
    v_mfma_f32_16x16x32_bf16 v[128:131], v[80:83], v[64:67], v[128:131]
    ds_read_b64_tr_b16 v[48:49], v99 offset:8192
    v_mfma_f32_16x16x32_bf16 v[144:147], v[84:87], v[64:67], v[144:147]
    ds_read_b64_tr_b16 v[50:51], v99 offset:12288
    v_mfma_f32_16x16x32_bf16 v[160:163], v[88:91], v[64:67], v[160:163]
    ds_read_b64_tr_b16 v[52:53], v102 offset:8192
    v_mfma_f32_16x16x32_bf16 v[176:179], v[92:95], v[64:67], v[176:179]
    ds_read_b64_tr_b16 v[54:55], v102 offset:12288
    v_mfma_f32_16x16x32_bf16 v[180:183], v[92:95], v[68:71], v[180:183]
    ds_read_b64_tr_b16 v[56:57], v105 offset:8192
    v_mfma_f32_16x16x32_bf16 v[164:167], v[88:91], v[68:71], v[164:167]
    ds_read_b64_tr_b16 v[58:59], v105 offset:12288
    v_mfma_f32_16x16x32_bf16 v[148:151], v[84:87], v[68:71], v[148:151]
    ds_read_b64_tr_b16 v[60:61], v108 offset:8192
    v_mfma_f32_16x16x32_bf16 v[132:135], v[80:83], v[68:71], v[132:135]
    ds_read_b64_tr_b16 v[62:63], v108 offset:12288
    s_waitcnt lgkmcnt(8)
    v_mfma_f32_16x16x32_bf16 v[136:139], v[80:83], v[72:75], v[136:139]
    ds_read_b128 v[32:35], v96 offset:0
    v_mfma_f32_16x16x32_bf16 v[152:155], v[84:87], v[72:75], v[152:155]
    ds_read_b128 v[36:39], v96 offset:256
    v_mfma_f32_16x16x32_bf16 v[168:171], v[88:91], v[72:75], v[168:171]
    ds_read_b128 v[40:43], v96 offset:2048
    v_mfma_f32_16x16x32_bf16 v[184:187], v[92:95], v[72:75], v[184:187]
    ds_read_b128 v[44:47], v96 offset:2304
    v_mfma_f32_16x16x32_bf16 v[188:191], v[92:95], v[76:79], v[188:191]
    v_mfma_f32_16x16x32_bf16 v[172:175], v[88:91], v[76:79], v[172:175]
    v_mfma_f32_16x16x32_bf16 v[156:159], v[84:87], v[76:79], v[156:159]
    v_mfma_f32_16x16x32_bf16 v[140:143], v[80:83], v[76:79], v[140:143]
    s_barrier
    s_waitcnt lgkmcnt(2)
    v_mfma_f32_16x16x32_bf16 v[128:131], v[48:51], v[32:35], v[128:131]
    ds_read_b64_tr_b16 v[80:81], v99 offset:24576
    v_mfma_f32_16x16x32_bf16 v[144:147], v[52:55], v[32:35], v[144:147]
    ds_read_b64_tr_b16 v[82:83], v99 offset:28672
    v_mfma_f32_16x16x32_bf16 v[160:163], v[56:59], v[32:35], v[160:163]
    ds_read_b64_tr_b16 v[84:85], v102 offset:24576
    v_mfma_f32_16x16x32_bf16 v[176:179], v[60:63], v[32:35], v[176:179]
    ds_read_b64_tr_b16 v[86:87], v102 offset:28672
    v_mfma_f32_16x16x32_bf16 v[180:183], v[60:63], v[36:39], v[180:183]
    ds_read_b64_tr_b16 v[88:89], v105 offset:24576
    v_mfma_f32_16x16x32_bf16 v[164:167], v[56:59], v[36:39], v[164:167]
    ds_read_b64_tr_b16 v[90:91], v105 offset:28672
    v_mfma_f32_16x16x32_bf16 v[148:151], v[52:55], v[36:39], v[148:151]
    ds_read_b64_tr_b16 v[92:93], v108 offset:24576
    v_mfma_f32_16x16x32_bf16 v[132:135], v[48:51], v[36:39], v[132:135]
    ds_read_b64_tr_b16 v[94:95], v108 offset:28672
    s_waitcnt lgkmcnt(8)
    v_mfma_f32_16x16x32_bf16 v[136:139], v[48:51], v[40:43], v[136:139]
    ds_read_b128 v[64:67], v96 offset:16384
    v_mfma_f32_16x16x32_bf16 v[152:155], v[52:55], v[40:43], v[152:155]
    ds_read_b128 v[68:71], v96 offset:16640
    v_mfma_f32_16x16x32_bf16 v[168:171], v[56:59], v[40:43], v[168:171]
    ds_read_b128 v[72:75], v96 offset:18432
    v_mfma_f32_16x16x32_bf16 v[184:187], v[60:63], v[40:43], v[184:187]
    ds_read_b128 v[76:79], v96 offset:18688
    v_mfma_f32_16x16x32_bf16 v[188:191], v[60:63], v[44:47], v[188:191]
    v_mfma_f32_16x16x32_bf16 v[172:175], v[56:59], v[44:47], v[172:175]
    v_mfma_f32_16x16x32_bf16 v[156:159], v[52:55], v[44:47], v[156:159]
    v_mfma_f32_16x16x32_bf16 v[140:143], v[48:51], v[44:47], v[140:143]
    s_waitcnt lgkmcnt(2)
    v_mfma_f32_16x16x32_bf16 v[128:131], v[80:83], v[64:67], v[128:131]
    ds_read_b64_tr_b16 v[48:49], v99 offset:40960
    v_mfma_f32_16x16x32_bf16 v[144:147], v[84:87], v[64:67], v[144:147]
    ds_read_b64_tr_b16 v[50:51], v99 offset:45056
    v_mfma_f32_16x16x32_bf16 v[160:163], v[88:91], v[64:67], v[160:163]
    ds_read_b64_tr_b16 v[52:53], v102 offset:40960
    v_mfma_f32_16x16x32_bf16 v[176:179], v[92:95], v[64:67], v[176:179]
    ds_read_b64_tr_b16 v[54:55], v102 offset:45056
    v_mfma_f32_16x16x32_bf16 v[180:183], v[92:95], v[68:71], v[180:183]
    ds_read_b64_tr_b16 v[56:57], v105 offset:40960
    v_mfma_f32_16x16x32_bf16 v[164:167], v[88:91], v[68:71], v[164:167]
    ds_read_b64_tr_b16 v[58:59], v105 offset:45056
    v_mfma_f32_16x16x32_bf16 v[148:151], v[84:87], v[68:71], v[148:151]
    ds_read_b64_tr_b16 v[60:61], v108 offset:40960
    v_mfma_f32_16x16x32_bf16 v[132:135], v[80:83], v[68:71], v[132:135]
    ds_read_b64_tr_b16 v[62:63], v108 offset:45056
    s_waitcnt lgkmcnt(8)
    v_mfma_f32_16x16x32_bf16 v[136:139], v[80:83], v[72:75], v[136:139]
    ds_read_b128 v[32:35], v96 offset:32768
    v_mfma_f32_16x16x32_bf16 v[152:155], v[84:87], v[72:75], v[152:155]
    ds_read_b128 v[36:39], v96 offset:33024
    v_mfma_f32_16x16x32_bf16 v[168:171], v[88:91], v[72:75], v[168:171]
    ds_read_b128 v[40:43], v96 offset:34816
    v_mfma_f32_16x16x32_bf16 v[184:187], v[92:95], v[72:75], v[184:187]
    ds_read_b128 v[44:47], v96 offset:35072
    v_mfma_f32_16x16x32_bf16 v[188:191], v[92:95], v[76:79], v[188:191]
    v_mfma_f32_16x16x32_bf16 v[172:175], v[88:91], v[76:79], v[172:175]
    v_mfma_f32_16x16x32_bf16 v[156:159], v[84:87], v[76:79], v[156:159]
    v_mfma_f32_16x16x32_bf16 v[140:143], v[80:83], v[76:79], v[140:143]
    s_barrier
    s_waitcnt lgkmcnt(2)
    v_mfma_f32_16x16x32_bf16 v[128:131], v[48:51], v[32:35], v[128:131]
    ds_read_b64_tr_b16 v[80:81], v99 offset:57344
    v_mfma_f32_16x16x32_bf16 v[144:147], v[52:55], v[32:35], v[144:147]
    ds_read_b64_tr_b16 v[82:83], v99 offset:61440
    v_mfma_f32_16x16x32_bf16 v[160:163], v[56:59], v[32:35], v[160:163]
    ds_read_b64_tr_b16 v[84:85], v102 offset:57344
    v_mfma_f32_16x16x32_bf16 v[176:179], v[60:63], v[32:35], v[176:179]
    ds_read_b64_tr_b16 v[86:87], v102 offset:61440
    v_mfma_f32_16x16x32_bf16 v[180:183], v[60:63], v[36:39], v[180:183]
    ds_read_b64_tr_b16 v[88:89], v105 offset:57344
    v_mfma_f32_16x16x32_bf16 v[164:167], v[56:59], v[36:39], v[164:167]
    ds_read_b64_tr_b16 v[90:91], v105 offset:61440
    v_mfma_f32_16x16x32_bf16 v[148:151], v[52:55], v[36:39], v[148:151]
    ds_read_b64_tr_b16 v[92:93], v108 offset:57344
    v_mfma_f32_16x16x32_bf16 v[132:135], v[48:51], v[36:39], v[132:135]
    ds_read_b64_tr_b16 v[94:95], v108 offset:61440
    s_waitcnt lgkmcnt(8)
    v_mfma_f32_16x16x32_bf16 v[136:139], v[48:51], v[40:43], v[136:139]
    ds_read_b128 v[64:67], v96 offset:49152
    v_mfma_f32_16x16x32_bf16 v[152:155], v[52:55], v[40:43], v[152:155]
    ds_read_b128 v[68:71], v96 offset:49408
    v_mfma_f32_16x16x32_bf16 v[168:171], v[56:59], v[40:43], v[168:171]
    ds_read_b128 v[72:75], v96 offset:51200
    v_mfma_f32_16x16x32_bf16 v[184:187], v[60:63], v[40:43], v[184:187]
    ds_read_b128 v[76:79], v96 offset:51456
    v_mfma_f32_16x16x32_bf16 v[188:191], v[60:63], v[44:47], v[188:191]
    v_mfma_f32_16x16x32_bf16 v[172:175], v[56:59], v[44:47], v[172:175]
    v_mfma_f32_16x16x32_bf16 v[156:159], v[52:55], v[44:47], v[156:159]
    v_mfma_f32_16x16x32_bf16 v[140:143], v[48:51], v[44:47], v[140:143]
    s_waitcnt lgkmcnt(2)
    v_mfma_f32_16x16x32_bf16 v[128:131], v[80:83], v[64:67], v[128:131]
    ds_read_b64_tr_b16 v[48:49], v100 offset:8192
    v_mfma_f32_16x16x32_bf16 v[144:147], v[84:87], v[64:67], v[144:147]
    ds_read_b64_tr_b16 v[50:51], v100 offset:12288
    v_mfma_f32_16x16x32_bf16 v[160:163], v[88:91], v[64:67], v[160:163]
    ds_read_b64_tr_b16 v[52:53], v103 offset:8192
    v_mfma_f32_16x16x32_bf16 v[176:179], v[92:95], v[64:67], v[176:179]
    ds_read_b64_tr_b16 v[54:55], v103 offset:12288
    v_mfma_f32_16x16x32_bf16 v[180:183], v[92:95], v[68:71], v[180:183]
    ds_read_b64_tr_b16 v[56:57], v106 offset:8192
    v_mfma_f32_16x16x32_bf16 v[164:167], v[88:91], v[68:71], v[164:167]
    ds_read_b64_tr_b16 v[58:59], v106 offset:12288
    v_mfma_f32_16x16x32_bf16 v[148:151], v[84:87], v[68:71], v[148:151]
    ds_read_b64_tr_b16 v[60:61], v109 offset:8192
    v_mfma_f32_16x16x32_bf16 v[132:135], v[80:83], v[68:71], v[132:135]
    ds_read_b64_tr_b16 v[62:63], v109 offset:12288
    s_waitcnt lgkmcnt(8)
    v_mfma_f32_16x16x32_bf16 v[136:139], v[80:83], v[72:75], v[136:139]
    ds_read_b128 v[32:35], v97 offset:0
    v_mfma_f32_16x16x32_bf16 v[152:155], v[84:87], v[72:75], v[152:155]
    ds_read_b128 v[36:39], v97 offset:256
    v_mfma_f32_16x16x32_bf16 v[168:171], v[88:91], v[72:75], v[168:171]
    ds_read_b128 v[40:43], v97 offset:2048
    v_mfma_f32_16x16x32_bf16 v[184:187], v[92:95], v[72:75], v[184:187]
    ds_read_b128 v[44:47], v97 offset:2304
    v_mfma_f32_16x16x32_bf16 v[188:191], v[92:95], v[76:79], v[188:191]
    v_mfma_f32_16x16x32_bf16 v[172:175], v[88:91], v[76:79], v[172:175]
    v_mfma_f32_16x16x32_bf16 v[156:159], v[84:87], v[76:79], v[156:159]
    v_mfma_f32_16x16x32_bf16 v[140:143], v[80:83], v[76:79], v[140:143]
    s_barrier
    s_waitcnt lgkmcnt(2)
    v_mfma_f32_16x16x32_bf16 v[128:131], v[48:51], v[32:35], v[128:131]
    ds_read_b64_tr_b16 v[80:81], v100 offset:24576
    v_mfma_f32_16x16x32_bf16 v[144:147], v[52:55], v[32:35], v[144:147]
    ds_read_b64_tr_b16 v[82:83], v100 offset:28672
    v_mfma_f32_16x16x32_bf16 v[160:163], v[56:59], v[32:35], v[160:163]
    ds_read_b64_tr_b16 v[84:85], v103 offset:24576
    v_mfma_f32_16x16x32_bf16 v[176:179], v[60:63], v[32:35], v[176:179]
    ds_read_b64_tr_b16 v[86:87], v103 offset:28672
    v_mfma_f32_16x16x32_bf16 v[180:183], v[60:63], v[36:39], v[180:183]
    ds_read_b64_tr_b16 v[88:89], v106 offset:24576
    v_mfma_f32_16x16x32_bf16 v[164:167], v[56:59], v[36:39], v[164:167]
    ds_read_b64_tr_b16 v[90:91], v106 offset:28672
    v_mfma_f32_16x16x32_bf16 v[148:151], v[52:55], v[36:39], v[148:151]
    ds_read_b64_tr_b16 v[92:93], v109 offset:24576
    v_mfma_f32_16x16x32_bf16 v[132:135], v[48:51], v[36:39], v[132:135]
    ds_read_b64_tr_b16 v[94:95], v109 offset:28672
    s_waitcnt lgkmcnt(8)
    v_mfma_f32_16x16x32_bf16 v[136:139], v[48:51], v[40:43], v[136:139]
    ds_read_b128 v[64:67], v97 offset:16384
    v_mfma_f32_16x16x32_bf16 v[152:155], v[52:55], v[40:43], v[152:155]
    ds_read_b128 v[68:71], v97 offset:16640
    v_mfma_f32_16x16x32_bf16 v[168:171], v[56:59], v[40:43], v[168:171]
    ds_read_b128 v[72:75], v97 offset:18432
    v_mfma_f32_16x16x32_bf16 v[184:187], v[60:63], v[40:43], v[184:187]
    ds_read_b128 v[76:79], v97 offset:18688
    v_mfma_f32_16x16x32_bf16 v[188:191], v[60:63], v[44:47], v[188:191]
    v_mfma_f32_16x16x32_bf16 v[172:175], v[56:59], v[44:47], v[172:175]
    v_mfma_f32_16x16x32_bf16 v[156:159], v[52:55], v[44:47], v[156:159]
    v_mfma_f32_16x16x32_bf16 v[140:143], v[48:51], v[44:47], v[140:143]
    s_waitcnt lgkmcnt(2)
    v_mfma_f32_16x16x32_bf16 v[128:131], v[80:83], v[64:67], v[128:131]
    ds_read_b64_tr_b16 v[48:49], v100 offset:40960
    v_mfma_f32_16x16x32_bf16 v[144:147], v[84:87], v[64:67], v[144:147]
    ds_read_b64_tr_b16 v[50:51], v100 offset:45056
    v_mfma_f32_16x16x32_bf16 v[160:163], v[88:91], v[64:67], v[160:163]
    ds_read_b64_tr_b16 v[52:53], v103 offset:40960
    v_mfma_f32_16x16x32_bf16 v[176:179], v[92:95], v[64:67], v[176:179]
    ds_read_b64_tr_b16 v[54:55], v103 offset:45056
    v_mfma_f32_16x16x32_bf16 v[180:183], v[92:95], v[68:71], v[180:183]
    ds_read_b64_tr_b16 v[56:57], v106 offset:40960
    v_mfma_f32_16x16x32_bf16 v[164:167], v[88:91], v[68:71], v[164:167]
    ds_read_b64_tr_b16 v[58:59], v106 offset:45056
    v_mfma_f32_16x16x32_bf16 v[148:151], v[84:87], v[68:71], v[148:151]
    ds_read_b64_tr_b16 v[60:61], v109 offset:40960
    v_mfma_f32_16x16x32_bf16 v[132:135], v[80:83], v[68:71], v[132:135]
    ds_read_b64_tr_b16 v[62:63], v109 offset:45056
    s_waitcnt lgkmcnt(8)
    v_mfma_f32_16x16x32_bf16 v[136:139], v[80:83], v[72:75], v[136:139]
    ds_read_b128 v[32:35], v97 offset:32768
    v_mfma_f32_16x16x32_bf16 v[152:155], v[84:87], v[72:75], v[152:155]
    ds_read_b128 v[36:39], v97 offset:33024
    v_mfma_f32_16x16x32_bf16 v[168:171], v[88:91], v[72:75], v[168:171]
    ds_read_b128 v[40:43], v97 offset:34816
    v_mfma_f32_16x16x32_bf16 v[184:187], v[92:95], v[72:75], v[184:187]
    ds_read_b128 v[44:47], v97 offset:35072
    v_mfma_f32_16x16x32_bf16 v[188:191], v[92:95], v[76:79], v[188:191]
    v_mfma_f32_16x16x32_bf16 v[172:175], v[88:91], v[76:79], v[172:175]
    v_mfma_f32_16x16x32_bf16 v[156:159], v[84:87], v[76:79], v[156:159]
    v_mfma_f32_16x16x32_bf16 v[140:143], v[80:83], v[76:79], v[140:143]
    s_barrier
    s_waitcnt lgkmcnt(2)
    v_mfma_f32_16x16x32_bf16 v[128:131], v[48:51], v[32:35], v[128:131]
    ds_read_b64_tr_b16 v[80:81], v100 offset:57344
    v_mfma_f32_16x16x32_bf16 v[144:147], v[52:55], v[32:35], v[144:147]
    ds_read_b64_tr_b16 v[82:83], v100 offset:61440
    v_mfma_f32_16x16x32_bf16 v[160:163], v[56:59], v[32:35], v[160:163]
    ds_read_b64_tr_b16 v[84:85], v103 offset:57344
    v_mfma_f32_16x16x32_bf16 v[176:179], v[60:63], v[32:35], v[176:179]
    ds_read_b64_tr_b16 v[86:87], v103 offset:61440
    v_mfma_f32_16x16x32_bf16 v[180:183], v[60:63], v[36:39], v[180:183]
    ds_read_b64_tr_b16 v[88:89], v106 offset:57344
    v_mfma_f32_16x16x32_bf16 v[164:167], v[56:59], v[36:39], v[164:167]
    ds_read_b64_tr_b16 v[90:91], v106 offset:61440
    v_mfma_f32_16x16x32_bf16 v[148:151], v[52:55], v[36:39], v[148:151]
    ds_read_b64_tr_b16 v[92:93], v109 offset:57344
    v_mfma_f32_16x16x32_bf16 v[132:135], v[48:51], v[36:39], v[132:135]
    ds_read_b64_tr_b16 v[94:95], v109 offset:61440
    s_waitcnt lgkmcnt(8)
    v_mfma_f32_16x16x32_bf16 v[136:139], v[48:51], v[40:43], v[136:139]
    ds_read_b128 v[64:67], v97 offset:49152
    v_mfma_f32_16x16x32_bf16 v[152:155], v[52:55], v[40:43], v[152:155]
    ds_read_b128 v[68:71], v97 offset:49408
    v_mfma_f32_16x16x32_bf16 v[168:171], v[56:59], v[40:43], v[168:171]
    ds_read_b128 v[72:75], v97 offset:51200
    v_mfma_f32_16x16x32_bf16 v[184:187], v[60:63], v[40:43], v[184:187]
    ds_read_b128 v[76:79], v97 offset:51456
    v_mfma_f32_16x16x32_bf16 v[188:191], v[60:63], v[44:47], v[188:191]
    v_mfma_f32_16x16x32_bf16 v[172:175], v[56:59], v[44:47], v[172:175]
    v_mfma_f32_16x16x32_bf16 v[156:159], v[52:55], v[44:47], v[156:159]
    v_mfma_f32_16x16x32_bf16 v[140:143], v[48:51], v[44:47], v[140:143]
    s_waitcnt lgkmcnt(2)
    v_mfma_f32_16x16x32_bf16 v[128:131], v[80:83], v[64:67], v[128:131]
    ds_read_b64_tr_b16 v[48:49], v101 offset:8192
    v_mfma_f32_16x16x32_bf16 v[144:147], v[84:87], v[64:67], v[144:147]
    ds_read_b64_tr_b16 v[50:51], v101 offset:12288
    v_mfma_f32_16x16x32_bf16 v[160:163], v[88:91], v[64:67], v[160:163]
    ds_read_b64_tr_b16 v[52:53], v104 offset:8192
    v_mfma_f32_16x16x32_bf16 v[176:179], v[92:95], v[64:67], v[176:179]
    ds_read_b64_tr_b16 v[54:55], v104 offset:12288
    v_mfma_f32_16x16x32_bf16 v[180:183], v[92:95], v[68:71], v[180:183]
    ds_read_b64_tr_b16 v[56:57], v107 offset:8192
    v_mfma_f32_16x16x32_bf16 v[164:167], v[88:91], v[68:71], v[164:167]
    ds_read_b64_tr_b16 v[58:59], v107 offset:12288
    v_mfma_f32_16x16x32_bf16 v[148:151], v[84:87], v[68:71], v[148:151]
    ds_read_b64_tr_b16 v[60:61], v110 offset:8192
    v_mfma_f32_16x16x32_bf16 v[132:135], v[80:83], v[68:71], v[132:135]
    ds_read_b64_tr_b16 v[62:63], v110 offset:12288
    s_waitcnt lgkmcnt(8)
    v_mfma_f32_16x16x32_bf16 v[136:139], v[80:83], v[72:75], v[136:139]
    ds_read_b128 v[32:35], v98 offset:0
    v_mfma_f32_16x16x32_bf16 v[152:155], v[84:87], v[72:75], v[152:155]
    ds_read_b128 v[36:39], v98 offset:256
    v_mfma_f32_16x16x32_bf16 v[168:171], v[88:91], v[72:75], v[168:171]
    ds_read_b128 v[40:43], v98 offset:2048
    v_mfma_f32_16x16x32_bf16 v[184:187], v[92:95], v[72:75], v[184:187]
    ds_read_b128 v[44:47], v98 offset:2304
    v_mfma_f32_16x16x32_bf16 v[188:191], v[92:95], v[76:79], v[188:191]
    v_mfma_f32_16x16x32_bf16 v[172:175], v[88:91], v[76:79], v[172:175]
    v_mfma_f32_16x16x32_bf16 v[156:159], v[84:87], v[76:79], v[156:159]
    v_mfma_f32_16x16x32_bf16 v[140:143], v[80:83], v[76:79], v[140:143]
    s_barrier
    s_waitcnt lgkmcnt(2)
    v_mfma_f32_16x16x32_bf16 v[128:131], v[48:51], v[32:35], v[128:131]
    ds_read_b64_tr_b16 v[80:81], v101 offset:24576
    v_mfma_f32_16x16x32_bf16 v[144:147], v[52:55], v[32:35], v[144:147]
    ds_read_b64_tr_b16 v[82:83], v101 offset:28672
    v_mfma_f32_16x16x32_bf16 v[160:163], v[56:59], v[32:35], v[160:163]
    ds_read_b64_tr_b16 v[84:85], v104 offset:24576
    v_mfma_f32_16x16x32_bf16 v[176:179], v[60:63], v[32:35], v[176:179]
    ds_read_b64_tr_b16 v[86:87], v104 offset:28672
    v_mfma_f32_16x16x32_bf16 v[180:183], v[60:63], v[36:39], v[180:183]
    ds_read_b64_tr_b16 v[88:89], v107 offset:24576
    v_mfma_f32_16x16x32_bf16 v[164:167], v[56:59], v[36:39], v[164:167]
    ds_read_b64_tr_b16 v[90:91], v107 offset:28672
    v_mfma_f32_16x16x32_bf16 v[148:151], v[52:55], v[36:39], v[148:151]
    ds_read_b64_tr_b16 v[92:93], v110 offset:24576
    v_mfma_f32_16x16x32_bf16 v[132:135], v[48:51], v[36:39], v[132:135]
    ds_read_b64_tr_b16 v[94:95], v110 offset:28672
    s_waitcnt lgkmcnt(8)
    v_mfma_f32_16x16x32_bf16 v[136:139], v[48:51], v[40:43], v[136:139]
    ds_read_b128 v[64:67], v98 offset:16384
    v_mfma_f32_16x16x32_bf16 v[152:155], v[52:55], v[40:43], v[152:155]
    ds_read_b128 v[68:71], v98 offset:16640
    v_mfma_f32_16x16x32_bf16 v[168:171], v[56:59], v[40:43], v[168:171]
    ds_read_b128 v[72:75], v98 offset:18432
    v_mfma_f32_16x16x32_bf16 v[184:187], v[60:63], v[40:43], v[184:187]
    ds_read_b128 v[76:79], v98 offset:18688
    v_mfma_f32_16x16x32_bf16 v[188:191], v[60:63], v[44:47], v[188:191]
    v_mfma_f32_16x16x32_bf16 v[172:175], v[56:59], v[44:47], v[172:175]
    v_mfma_f32_16x16x32_bf16 v[156:159], v[52:55], v[44:47], v[156:159]
    v_mfma_f32_16x16x32_bf16 v[140:143], v[48:51], v[44:47], v[140:143]
    s_waitcnt lgkmcnt(2)
    v_mfma_f32_16x16x32_bf16 v[128:131], v[80:83], v[64:67], v[128:131]
    ds_read_b64_tr_b16 v[48:49], v99 offset:8192
    v_mfma_f32_16x16x32_bf16 v[144:147], v[84:87], v[64:67], v[144:147]
    ds_read_b64_tr_b16 v[50:51], v99 offset:12288
    v_mfma_f32_16x16x32_bf16 v[160:163], v[88:91], v[64:67], v[160:163]
    ds_read_b64_tr_b16 v[52:53], v102 offset:8192
    v_mfma_f32_16x16x32_bf16 v[176:179], v[92:95], v[64:67], v[176:179]
    ds_read_b64_tr_b16 v[54:55], v102 offset:12288
    v_mfma_f32_16x16x32_bf16 v[180:183], v[92:95], v[68:71], v[180:183]
    ds_read_b64_tr_b16 v[56:57], v105 offset:8192
    v_mfma_f32_16x16x32_bf16 v[164:167], v[88:91], v[68:71], v[164:167]
    ds_read_b64_tr_b16 v[58:59], v105 offset:12288
    v_mfma_f32_16x16x32_bf16 v[148:151], v[84:87], v[68:71], v[148:151]
    ds_read_b64_tr_b16 v[60:61], v108 offset:8192
    v_mfma_f32_16x16x32_bf16 v[132:135], v[80:83], v[68:71], v[132:135]
    ds_read_b64_tr_b16 v[62:63], v108 offset:12288
    s_waitcnt lgkmcnt(8)
    v_mfma_f32_16x16x32_bf16 v[136:139], v[80:83], v[72:75], v[136:139]
    ds_read_b128 v[32:35], v96 offset:0
    v_mfma_f32_16x16x32_bf16 v[152:155], v[84:87], v[72:75], v[152:155]
    ds_read_b128 v[36:39], v96 offset:256
    v_mfma_f32_16x16x32_bf16 v[168:171], v[88:91], v[72:75], v[168:171]
    ds_read_b128 v[40:43], v96 offset:2048
    v_mfma_f32_16x16x32_bf16 v[184:187], v[92:95], v[72:75], v[184:187]
    ds_read_b128 v[44:47], v96 offset:2304
    v_mfma_f32_16x16x32_bf16 v[188:191], v[92:95], v[76:79], v[188:191]
    v_mfma_f32_16x16x32_bf16 v[172:175], v[88:91], v[76:79], v[172:175]
    v_mfma_f32_16x16x32_bf16 v[156:159], v[84:87], v[76:79], v[156:159]
    v_mfma_f32_16x16x32_bf16 v[140:143], v[80:83], v[76:79], v[140:143]
    s_barrier
    s_waitcnt lgkmcnt(2)
    v_mfma_f32_16x16x32_bf16 v[128:131], v[48:51], v[32:35], v[128:131]
    ds_read_b64_tr_b16 v[80:81], v99 offset:24576
    v_mfma_f32_16x16x32_bf16 v[144:147], v[52:55], v[32:35], v[144:147]
    ds_read_b64_tr_b16 v[82:83], v99 offset:28672
    v_mfma_f32_16x16x32_bf16 v[160:163], v[56:59], v[32:35], v[160:163]
    ds_read_b64_tr_b16 v[84:85], v102 offset:24576
    v_mfma_f32_16x16x32_bf16 v[176:179], v[60:63], v[32:35], v[176:179]
    ds_read_b64_tr_b16 v[86:87], v102 offset:28672
    v_mfma_f32_16x16x32_bf16 v[180:183], v[60:63], v[36:39], v[180:183]
    ds_read_b64_tr_b16 v[88:89], v105 offset:24576
    v_mfma_f32_16x16x32_bf16 v[164:167], v[56:59], v[36:39], v[164:167]
    ds_read_b64_tr_b16 v[90:91], v105 offset:28672
    v_mfma_f32_16x16x32_bf16 v[148:151], v[52:55], v[36:39], v[148:151]
    ds_read_b64_tr_b16 v[92:93], v108 offset:24576
    v_mfma_f32_16x16x32_bf16 v[132:135], v[48:51], v[36:39], v[132:135]
    ds_read_b64_tr_b16 v[94:95], v108 offset:28672
    s_waitcnt lgkmcnt(8)
    v_mfma_f32_16x16x32_bf16 v[136:139], v[48:51], v[40:43], v[136:139]
    ds_read_b128 v[64:67], v96 offset:16384
    v_mfma_f32_16x16x32_bf16 v[152:155], v[52:55], v[40:43], v[152:155]
    ds_read_b128 v[68:71], v96 offset:16640
    v_mfma_f32_16x16x32_bf16 v[168:171], v[56:59], v[40:43], v[168:171]
    ds_read_b128 v[72:75], v96 offset:18432
    v_mfma_f32_16x16x32_bf16 v[184:187], v[60:63], v[40:43], v[184:187]
    ds_read_b128 v[76:79], v96 offset:18688
    v_mfma_f32_16x16x32_bf16 v[188:191], v[60:63], v[44:47], v[188:191]
    v_mfma_f32_16x16x32_bf16 v[172:175], v[56:59], v[44:47], v[172:175]
    v_mfma_f32_16x16x32_bf16 v[156:159], v[52:55], v[44:47], v[156:159]
    v_mfma_f32_16x16x32_bf16 v[140:143], v[48:51], v[44:47], v[140:143]
    s_waitcnt lgkmcnt(2)
    v_mfma_f32_16x16x32_bf16 v[128:131], v[80:83], v[64:67], v[128:131]
    ds_read_b64_tr_b16 v[48:49], v99 offset:40960
    v_mfma_f32_16x16x32_bf16 v[144:147], v[84:87], v[64:67], v[144:147]
    ds_read_b64_tr_b16 v[50:51], v99 offset:45056
    v_mfma_f32_16x16x32_bf16 v[160:163], v[88:91], v[64:67], v[160:163]
    ds_read_b64_tr_b16 v[52:53], v102 offset:40960
    v_mfma_f32_16x16x32_bf16 v[176:179], v[92:95], v[64:67], v[176:179]
    ds_read_b64_tr_b16 v[54:55], v102 offset:45056
    v_mfma_f32_16x16x32_bf16 v[180:183], v[92:95], v[68:71], v[180:183]
    ds_read_b64_tr_b16 v[56:57], v105 offset:40960
    v_mfma_f32_16x16x32_bf16 v[164:167], v[88:91], v[68:71], v[164:167]
    ds_read_b64_tr_b16 v[58:59], v105 offset:45056
    v_mfma_f32_16x16x32_bf16 v[148:151], v[84:87], v[68:71], v[148:151]
    ds_read_b64_tr_b16 v[60:61], v108 offset:40960
    v_mfma_f32_16x16x32_bf16 v[132:135], v[80:83], v[68:71], v[132:135]
    ds_read_b64_tr_b16 v[62:63], v108 offset:45056
    s_waitcnt lgkmcnt(8)
    v_mfma_f32_16x16x32_bf16 v[136:139], v[80:83], v[72:75], v[136:139]
    ds_read_b128 v[32:35], v96 offset:32768
    v_mfma_f32_16x16x32_bf16 v[152:155], v[84:87], v[72:75], v[152:155]
    ds_read_b128 v[36:39], v96 offset:33024
    v_mfma_f32_16x16x32_bf16 v[168:171], v[88:91], v[72:75], v[168:171]
    ds_read_b128 v[40:43], v96 offset:34816
    v_mfma_f32_16x16x32_bf16 v[184:187], v[92:95], v[72:75], v[184:187]
    ds_read_b128 v[44:47], v96 offset:35072
    v_mfma_f32_16x16x32_bf16 v[188:191], v[92:95], v[76:79], v[188:191]
    v_mfma_f32_16x16x32_bf16 v[172:175], v[88:91], v[76:79], v[172:175]
    v_mfma_f32_16x16x32_bf16 v[156:159], v[84:87], v[76:79], v[156:159]
    v_mfma_f32_16x16x32_bf16 v[140:143], v[80:83], v[76:79], v[140:143]
    s_barrier
    s_waitcnt lgkmcnt(2)
    v_mfma_f32_16x16x32_bf16 v[128:131], v[48:51], v[32:35], v[128:131]
    ds_read_b64_tr_b16 v[80:81], v99 offset:57344
    v_mfma_f32_16x16x32_bf16 v[144:147], v[52:55], v[32:35], v[144:147]
    ds_read_b64_tr_b16 v[82:83], v99 offset:61440
    v_mfma_f32_16x16x32_bf16 v[160:163], v[56:59], v[32:35], v[160:163]
    ds_read_b64_tr_b16 v[84:85], v102 offset:57344
    v_mfma_f32_16x16x32_bf16 v[176:179], v[60:63], v[32:35], v[176:179]
    ds_read_b64_tr_b16 v[86:87], v102 offset:61440
    v_mfma_f32_16x16x32_bf16 v[180:183], v[60:63], v[36:39], v[180:183]
    ds_read_b64_tr_b16 v[88:89], v105 offset:57344
    v_mfma_f32_16x16x32_bf16 v[164:167], v[56:59], v[36:39], v[164:167]
    ds_read_b64_tr_b16 v[90:91], v105 offset:61440
    v_mfma_f32_16x16x32_bf16 v[148:151], v[52:55], v[36:39], v[148:151]
    ds_read_b64_tr_b16 v[92:93], v108 offset:57344
    v_mfma_f32_16x16x32_bf16 v[132:135], v[48:51], v[36:39], v[132:135]
    ds_read_b64_tr_b16 v[94:95], v108 offset:61440
    s_waitcnt lgkmcnt(8)
    v_mfma_f32_16x16x32_bf16 v[136:139], v[48:51], v[40:43], v[136:139]
    ds_read_b128 v[64:67], v96 offset:49152
    v_mfma_f32_16x16x32_bf16 v[152:155], v[52:55], v[40:43], v[152:155]
    ds_read_b128 v[68:71], v96 offset:49408
    v_mfma_f32_16x16x32_bf16 v[168:171], v[56:59], v[40:43], v[168:171]
    ds_read_b128 v[72:75], v96 offset:51200
    v_mfma_f32_16x16x32_bf16 v[184:187], v[60:63], v[40:43], v[184:187]
    ds_read_b128 v[76:79], v96 offset:51456
    v_mfma_f32_16x16x32_bf16 v[188:191], v[60:63], v[44:47], v[188:191]
    v_mfma_f32_16x16x32_bf16 v[172:175], v[56:59], v[44:47], v[172:175]
    v_mfma_f32_16x16x32_bf16 v[156:159], v[52:55], v[44:47], v[156:159]
    v_mfma_f32_16x16x32_bf16 v[140:143], v[48:51], v[44:47], v[140:143]
    s_waitcnt lgkmcnt(2)
    v_mfma_f32_16x16x32_bf16 v[128:131], v[80:83], v[64:67], v[128:131]
    ds_read_b64_tr_b16 v[48:49], v100 offset:8192
    v_mfma_f32_16x16x32_bf16 v[144:147], v[84:87], v[64:67], v[144:147]
    ds_read_b64_tr_b16 v[50:51], v100 offset:12288
    v_mfma_f32_16x16x32_bf16 v[160:163], v[88:91], v[64:67], v[160:163]
    ds_read_b64_tr_b16 v[52:53], v103 offset:8192
    v_mfma_f32_16x16x32_bf16 v[176:179], v[92:95], v[64:67], v[176:179]
    ds_read_b64_tr_b16 v[54:55], v103 offset:12288
    v_mfma_f32_16x16x32_bf16 v[180:183], v[92:95], v[68:71], v[180:183]
    ds_read_b64_tr_b16 v[56:57], v106 offset:8192
    v_mfma_f32_16x16x32_bf16 v[164:167], v[88:91], v[68:71], v[164:167]
    ds_read_b64_tr_b16 v[58:59], v106 offset:12288
    v_mfma_f32_16x16x32_bf16 v[148:151], v[84:87], v[68:71], v[148:151]
    ds_read_b64_tr_b16 v[60:61], v109 offset:8192
    v_mfma_f32_16x16x32_bf16 v[132:135], v[80:83], v[68:71], v[132:135]
    ds_read_b64_tr_b16 v[62:63], v109 offset:12288
    s_waitcnt lgkmcnt(8)
    v_mfma_f32_16x16x32_bf16 v[136:139], v[80:83], v[72:75], v[136:139]
    ds_read_b128 v[32:35], v97 offset:0
    v_mfma_f32_16x16x32_bf16 v[152:155], v[84:87], v[72:75], v[152:155]
    ds_read_b128 v[36:39], v97 offset:256
    v_mfma_f32_16x16x32_bf16 v[168:171], v[88:91], v[72:75], v[168:171]
    ds_read_b128 v[40:43], v97 offset:2048
    v_mfma_f32_16x16x32_bf16 v[184:187], v[92:95], v[72:75], v[184:187]
    ds_read_b128 v[44:47], v97 offset:2304
    v_mfma_f32_16x16x32_bf16 v[188:191], v[92:95], v[76:79], v[188:191]
    v_mfma_f32_16x16x32_bf16 v[172:175], v[88:91], v[76:79], v[172:175]
    v_mfma_f32_16x16x32_bf16 v[156:159], v[84:87], v[76:79], v[156:159]
    v_mfma_f32_16x16x32_bf16 v[140:143], v[80:83], v[76:79], v[140:143]
    s_barrier
    s_waitcnt lgkmcnt(2)
    v_mfma_f32_16x16x32_bf16 v[128:131], v[48:51], v[32:35], v[128:131]
    ds_read_b64_tr_b16 v[80:81], v100 offset:24576
    v_mfma_f32_16x16x32_bf16 v[144:147], v[52:55], v[32:35], v[144:147]
    ds_read_b64_tr_b16 v[82:83], v100 offset:28672
    v_mfma_f32_16x16x32_bf16 v[160:163], v[56:59], v[32:35], v[160:163]
    ds_read_b64_tr_b16 v[84:85], v103 offset:24576
    v_mfma_f32_16x16x32_bf16 v[176:179], v[60:63], v[32:35], v[176:179]
    ds_read_b64_tr_b16 v[86:87], v103 offset:28672
    v_mfma_f32_16x16x32_bf16 v[180:183], v[60:63], v[36:39], v[180:183]
    ds_read_b64_tr_b16 v[88:89], v106 offset:24576
    v_mfma_f32_16x16x32_bf16 v[164:167], v[56:59], v[36:39], v[164:167]
    ds_read_b64_tr_b16 v[90:91], v106 offset:28672
    v_mfma_f32_16x16x32_bf16 v[148:151], v[52:55], v[36:39], v[148:151]
    ds_read_b64_tr_b16 v[92:93], v109 offset:24576
    v_mfma_f32_16x16x32_bf16 v[132:135], v[48:51], v[36:39], v[132:135]
    ds_read_b64_tr_b16 v[94:95], v109 offset:28672
    s_waitcnt lgkmcnt(8)
    v_mfma_f32_16x16x32_bf16 v[136:139], v[48:51], v[40:43], v[136:139]
    ds_read_b128 v[64:67], v97 offset:16384
    v_mfma_f32_16x16x32_bf16 v[152:155], v[52:55], v[40:43], v[152:155]
    ds_read_b128 v[68:71], v97 offset:16640
    v_mfma_f32_16x16x32_bf16 v[168:171], v[56:59], v[40:43], v[168:171]
    ds_read_b128 v[72:75], v97 offset:18432
    v_mfma_f32_16x16x32_bf16 v[184:187], v[60:63], v[40:43], v[184:187]
    ds_read_b128 v[76:79], v97 offset:18688
    v_mfma_f32_16x16x32_bf16 v[188:191], v[60:63], v[44:47], v[188:191]
    v_mfma_f32_16x16x32_bf16 v[172:175], v[56:59], v[44:47], v[172:175]
    v_mfma_f32_16x16x32_bf16 v[156:159], v[52:55], v[44:47], v[156:159]
    v_mfma_f32_16x16x32_bf16 v[140:143], v[48:51], v[44:47], v[140:143]
    s_waitcnt lgkmcnt(2)
    v_mfma_f32_16x16x32_bf16 v[128:131], v[80:83], v[64:67], v[128:131]
    ds_read_b64_tr_b16 v[48:49], v100 offset:40960
    v_mfma_f32_16x16x32_bf16 v[144:147], v[84:87], v[64:67], v[144:147]
    ds_read_b64_tr_b16 v[50:51], v100 offset:45056
    v_mfma_f32_16x16x32_bf16 v[160:163], v[88:91], v[64:67], v[160:163]
    ds_read_b64_tr_b16 v[52:53], v103 offset:40960
    v_mfma_f32_16x16x32_bf16 v[176:179], v[92:95], v[64:67], v[176:179]
    ds_read_b64_tr_b16 v[54:55], v103 offset:45056
    v_mfma_f32_16x16x32_bf16 v[180:183], v[92:95], v[68:71], v[180:183]
    ds_read_b64_tr_b16 v[56:57], v106 offset:40960
    v_mfma_f32_16x16x32_bf16 v[164:167], v[88:91], v[68:71], v[164:167]
    ds_read_b64_tr_b16 v[58:59], v106 offset:45056
    v_mfma_f32_16x16x32_bf16 v[148:151], v[84:87], v[68:71], v[148:151]
    ds_read_b64_tr_b16 v[60:61], v109 offset:40960
    v_mfma_f32_16x16x32_bf16 v[132:135], v[80:83], v[68:71], v[132:135]
    ds_read_b64_tr_b16 v[62:63], v109 offset:45056
    s_waitcnt lgkmcnt(8)
    v_mfma_f32_16x16x32_bf16 v[136:139], v[80:83], v[72:75], v[136:139]
    ds_read_b128 v[32:35], v97 offset:32768
    v_mfma_f32_16x16x32_bf16 v[152:155], v[84:87], v[72:75], v[152:155]
    ds_read_b128 v[36:39], v97 offset:33024
    v_mfma_f32_16x16x32_bf16 v[168:171], v[88:91], v[72:75], v[168:171]
    ds_read_b128 v[40:43], v97 offset:34816
    v_mfma_f32_16x16x32_bf16 v[184:187], v[92:95], v[72:75], v[184:187]
    ds_read_b128 v[44:47], v97 offset:35072
    v_mfma_f32_16x16x32_bf16 v[188:191], v[92:95], v[76:79], v[188:191]
    v_mfma_f32_16x16x32_bf16 v[172:175], v[88:91], v[76:79], v[172:175]
    v_mfma_f32_16x16x32_bf16 v[156:159], v[84:87], v[76:79], v[156:159]
    v_mfma_f32_16x16x32_bf16 v[140:143], v[80:83], v[76:79], v[140:143]
    s_barrier
    s_waitcnt lgkmcnt(2)
    v_mfma_f32_16x16x32_bf16 v[128:131], v[48:51], v[32:35], v[128:131]
    ds_read_b64_tr_b16 v[80:81], v100 offset:57344
    v_mfma_f32_16x16x32_bf16 v[144:147], v[52:55], v[32:35], v[144:147]
    ds_read_b64_tr_b16 v[82:83], v100 offset:61440
    v_mfma_f32_16x16x32_bf16 v[160:163], v[56:59], v[32:35], v[160:163]
    ds_read_b64_tr_b16 v[84:85], v103 offset:57344
    v_mfma_f32_16x16x32_bf16 v[176:179], v[60:63], v[32:35], v[176:179]
    ds_read_b64_tr_b16 v[86:87], v103 offset:61440
    v_mfma_f32_16x16x32_bf16 v[180:183], v[60:63], v[36:39], v[180:183]
    ds_read_b64_tr_b16 v[88:89], v106 offset:57344
    v_mfma_f32_16x16x32_bf16 v[164:167], v[56:59], v[36:39], v[164:167]
    ds_read_b64_tr_b16 v[90:91], v106 offset:61440
    v_mfma_f32_16x16x32_bf16 v[148:151], v[52:55], v[36:39], v[148:151]
    ds_read_b64_tr_b16 v[92:93], v109 offset:57344
    v_mfma_f32_16x16x32_bf16 v[132:135], v[48:51], v[36:39], v[132:135]
    ds_read_b64_tr_b16 v[94:95], v109 offset:61440
    s_waitcnt lgkmcnt(8)
    v_mfma_f32_16x16x32_bf16 v[136:139], v[48:51], v[40:43], v[136:139]
    ds_read_b128 v[64:67], v97 offset:49152
    v_mfma_f32_16x16x32_bf16 v[152:155], v[52:55], v[40:43], v[152:155]
    ds_read_b128 v[68:71], v97 offset:49408
    v_mfma_f32_16x16x32_bf16 v[168:171], v[56:59], v[40:43], v[168:171]
    ds_read_b128 v[72:75], v97 offset:51200
    v_mfma_f32_16x16x32_bf16 v[184:187], v[60:63], v[40:43], v[184:187]
    ds_read_b128 v[76:79], v97 offset:51456
    v_mfma_f32_16x16x32_bf16 v[188:191], v[60:63], v[44:47], v[188:191]
    v_mfma_f32_16x16x32_bf16 v[172:175], v[56:59], v[44:47], v[172:175]
    v_mfma_f32_16x16x32_bf16 v[156:159], v[52:55], v[44:47], v[156:159]
    v_mfma_f32_16x16x32_bf16 v[140:143], v[48:51], v[44:47], v[140:143]
    s_waitcnt lgkmcnt(2)
    v_mfma_f32_16x16x32_bf16 v[128:131], v[80:83], v[64:67], v[128:131]
    ds_read_b64_tr_b16 v[48:49], v101 offset:8192
    v_mfma_f32_16x16x32_bf16 v[144:147], v[84:87], v[64:67], v[144:147]
    ds_read_b64_tr_b16 v[50:51], v101 offset:12288
    v_mfma_f32_16x16x32_bf16 v[160:163], v[88:91], v[64:67], v[160:163]
    ds_read_b64_tr_b16 v[52:53], v104 offset:8192
    v_mfma_f32_16x16x32_bf16 v[176:179], v[92:95], v[64:67], v[176:179]
    ds_read_b64_tr_b16 v[54:55], v104 offset:12288
    v_mfma_f32_16x16x32_bf16 v[180:183], v[92:95], v[68:71], v[180:183]
    ds_read_b64_tr_b16 v[56:57], v107 offset:8192
    v_mfma_f32_16x16x32_bf16 v[164:167], v[88:91], v[68:71], v[164:167]
    ds_read_b64_tr_b16 v[58:59], v107 offset:12288
    v_mfma_f32_16x16x32_bf16 v[148:151], v[84:87], v[68:71], v[148:151]
    ds_read_b64_tr_b16 v[60:61], v110 offset:8192
    v_mfma_f32_16x16x32_bf16 v[132:135], v[80:83], v[68:71], v[132:135]
    ds_read_b64_tr_b16 v[62:63], v110 offset:12288
    s_waitcnt lgkmcnt(8)
    v_mfma_f32_16x16x32_bf16 v[136:139], v[80:83], v[72:75], v[136:139]
    ds_read_b128 v[32:35], v98 offset:0
    v_mfma_f32_16x16x32_bf16 v[152:155], v[84:87], v[72:75], v[152:155]
    ds_read_b128 v[36:39], v98 offset:256
    v_mfma_f32_16x16x32_bf16 v[168:171], v[88:91], v[72:75], v[168:171]
    ds_read_b128 v[40:43], v98 offset:2048
    v_mfma_f32_16x16x32_bf16 v[184:187], v[92:95], v[72:75], v[184:187]
    ds_read_b128 v[44:47], v98 offset:2304
    v_mfma_f32_16x16x32_bf16 v[188:191], v[92:95], v[76:79], v[188:191]
    v_mfma_f32_16x16x32_bf16 v[172:175], v[88:91], v[76:79], v[172:175]
    v_mfma_f32_16x16x32_bf16 v[156:159], v[84:87], v[76:79], v[156:159]
    v_mfma_f32_16x16x32_bf16 v[140:143], v[80:83], v[76:79], v[140:143]
    s_barrier
    s_waitcnt lgkmcnt(2)
    v_mfma_f32_16x16x32_bf16 v[128:131], v[48:51], v[32:35], v[128:131]
    ds_read_b64_tr_b16 v[80:81], v101 offset:24576
    v_mfma_f32_16x16x32_bf16 v[144:147], v[52:55], v[32:35], v[144:147]
    ds_read_b64_tr_b16 v[82:83], v101 offset:28672
    v_mfma_f32_16x16x32_bf16 v[160:163], v[56:59], v[32:35], v[160:163]
    ds_read_b64_tr_b16 v[84:85], v104 offset:24576
    v_mfma_f32_16x16x32_bf16 v[176:179], v[60:63], v[32:35], v[176:179]
    ds_read_b64_tr_b16 v[86:87], v104 offset:28672
    v_mfma_f32_16x16x32_bf16 v[180:183], v[60:63], v[36:39], v[180:183]
    ds_read_b64_tr_b16 v[88:89], v107 offset:24576
    v_mfma_f32_16x16x32_bf16 v[164:167], v[56:59], v[36:39], v[164:167]
    ds_read_b64_tr_b16 v[90:91], v107 offset:28672
    v_mfma_f32_16x16x32_bf16 v[148:151], v[52:55], v[36:39], v[148:151]
    ds_read_b64_tr_b16 v[92:93], v110 offset:24576
    v_mfma_f32_16x16x32_bf16 v[132:135], v[48:51], v[36:39], v[132:135]
    ds_read_b64_tr_b16 v[94:95], v110 offset:28672
    s_waitcnt lgkmcnt(8)
    v_mfma_f32_16x16x32_bf16 v[136:139], v[48:51], v[40:43], v[136:139]
    ds_read_b128 v[64:67], v98 offset:16384
    v_mfma_f32_16x16x32_bf16 v[152:155], v[52:55], v[40:43], v[152:155]
    ds_read_b128 v[68:71], v98 offset:16640
    v_mfma_f32_16x16x32_bf16 v[168:171], v[56:59], v[40:43], v[168:171]
    ds_read_b128 v[72:75], v98 offset:18432
    v_mfma_f32_16x16x32_bf16 v[184:187], v[60:63], v[40:43], v[184:187]
    ds_read_b128 v[76:79], v98 offset:18688
    v_mfma_f32_16x16x32_bf16 v[188:191], v[60:63], v[44:47], v[188:191]
    v_mfma_f32_16x16x32_bf16 v[172:175], v[56:59], v[44:47], v[172:175]
    v_mfma_f32_16x16x32_bf16 v[156:159], v[52:55], v[44:47], v[156:159]
    v_mfma_f32_16x16x32_bf16 v[140:143], v[48:51], v[44:47], v[140:143]
    s_waitcnt lgkmcnt(2)
    v_mfma_f32_16x16x32_bf16 v[128:131], v[80:83], v[64:67], v[128:131]
    ds_read_b64_tr_b16 v[48:49], v99 offset:8192
    v_mfma_f32_16x16x32_bf16 v[144:147], v[84:87], v[64:67], v[144:147]
    ds_read_b64_tr_b16 v[50:51], v99 offset:12288
    v_mfma_f32_16x16x32_bf16 v[160:163], v[88:91], v[64:67], v[160:163]
    ds_read_b64_tr_b16 v[52:53], v102 offset:8192
    v_mfma_f32_16x16x32_bf16 v[176:179], v[92:95], v[64:67], v[176:179]
    ds_read_b64_tr_b16 v[54:55], v102 offset:12288
    v_mfma_f32_16x16x32_bf16 v[180:183], v[92:95], v[68:71], v[180:183]
    ds_read_b64_tr_b16 v[56:57], v105 offset:8192
    v_mfma_f32_16x16x32_bf16 v[164:167], v[88:91], v[68:71], v[164:167]
    ds_read_b64_tr_b16 v[58:59], v105 offset:12288
    v_mfma_f32_16x16x32_bf16 v[148:151], v[84:87], v[68:71], v[148:151]
    ds_read_b64_tr_b16 v[60:61], v108 offset:8192
    v_mfma_f32_16x16x32_bf16 v[132:135], v[80:83], v[68:71], v[132:135]
    ds_read_b64_tr_b16 v[62:63], v108 offset:12288
    s_waitcnt lgkmcnt(8)
    v_mfma_f32_16x16x32_bf16 v[136:139], v[80:83], v[72:75], v[136:139]
    ds_read_b128 v[32:35], v96 offset:0
    v_mfma_f32_16x16x32_bf16 v[152:155], v[84:87], v[72:75], v[152:155]
    ds_read_b128 v[36:39], v96 offset:256
    v_mfma_f32_16x16x32_bf16 v[168:171], v[88:91], v[72:75], v[168:171]
    ds_read_b128 v[40:43], v96 offset:2048
    v_mfma_f32_16x16x32_bf16 v[184:187], v[92:95], v[72:75], v[184:187]
    ds_read_b128 v[44:47], v96 offset:2304
    v_mfma_f32_16x16x32_bf16 v[188:191], v[92:95], v[76:79], v[188:191]
    v_mfma_f32_16x16x32_bf16 v[172:175], v[88:91], v[76:79], v[172:175]
    v_mfma_f32_16x16x32_bf16 v[156:159], v[84:87], v[76:79], v[156:159]
    v_mfma_f32_16x16x32_bf16 v[140:143], v[80:83], v[76:79], v[140:143]
    s_barrier
    s_waitcnt lgkmcnt(2)
    v_mfma_f32_16x16x32_bf16 v[128:131], v[48:51], v[32:35], v[128:131]
    ds_read_b64_tr_b16 v[80:81], v99 offset:24576
    v_mfma_f32_16x16x32_bf16 v[144:147], v[52:55], v[32:35], v[144:147]
    ds_read_b64_tr_b16 v[82:83], v99 offset:28672
    v_mfma_f32_16x16x32_bf16 v[160:163], v[56:59], v[32:35], v[160:163]
    ds_read_b64_tr_b16 v[84:85], v102 offset:24576
    v_mfma_f32_16x16x32_bf16 v[176:179], v[60:63], v[32:35], v[176:179]
    ds_read_b64_tr_b16 v[86:87], v102 offset:28672
    v_mfma_f32_16x16x32_bf16 v[180:183], v[60:63], v[36:39], v[180:183]
    ds_read_b64_tr_b16 v[88:89], v105 offset:24576
    v_mfma_f32_16x16x32_bf16 v[164:167], v[56:59], v[36:39], v[164:167]
    ds_read_b64_tr_b16 v[90:91], v105 offset:28672
    v_mfma_f32_16x16x32_bf16 v[148:151], v[52:55], v[36:39], v[148:151]
    ds_read_b64_tr_b16 v[92:93], v108 offset:24576
    v_mfma_f32_16x16x32_bf16 v[132:135], v[48:51], v[36:39], v[132:135]
    ds_read_b64_tr_b16 v[94:95], v108 offset:28672
    s_waitcnt lgkmcnt(8)
    v_mfma_f32_16x16x32_bf16 v[136:139], v[48:51], v[40:43], v[136:139]
    ds_read_b128 v[64:67], v96 offset:16384
    v_mfma_f32_16x16x32_bf16 v[152:155], v[52:55], v[40:43], v[152:155]
    ds_read_b128 v[68:71], v96 offset:16640
    v_mfma_f32_16x16x32_bf16 v[168:171], v[56:59], v[40:43], v[168:171]
    ds_read_b128 v[72:75], v96 offset:18432
    v_mfma_f32_16x16x32_bf16 v[184:187], v[60:63], v[40:43], v[184:187]
    ds_read_b128 v[76:79], v96 offset:18688
    v_mfma_f32_16x16x32_bf16 v[188:191], v[60:63], v[44:47], v[188:191]
    v_mfma_f32_16x16x32_bf16 v[172:175], v[56:59], v[44:47], v[172:175]
    v_mfma_f32_16x16x32_bf16 v[156:159], v[52:55], v[44:47], v[156:159]
    v_mfma_f32_16x16x32_bf16 v[140:143], v[48:51], v[44:47], v[140:143]
    s_waitcnt lgkmcnt(2)
    v_mfma_f32_16x16x32_bf16 v[128:131], v[80:83], v[64:67], v[128:131]
    ds_read_b64_tr_b16 v[48:49], v99 offset:40960
    v_mfma_f32_16x16x32_bf16 v[144:147], v[84:87], v[64:67], v[144:147]
    ds_read_b64_tr_b16 v[50:51], v99 offset:45056
    v_mfma_f32_16x16x32_bf16 v[160:163], v[88:91], v[64:67], v[160:163]
    ds_read_b64_tr_b16 v[52:53], v102 offset:40960
    v_mfma_f32_16x16x32_bf16 v[176:179], v[92:95], v[64:67], v[176:179]
    ds_read_b64_tr_b16 v[54:55], v102 offset:45056
    v_mfma_f32_16x16x32_bf16 v[180:183], v[92:95], v[68:71], v[180:183]
    ds_read_b64_tr_b16 v[56:57], v105 offset:40960
    v_mfma_f32_16x16x32_bf16 v[164:167], v[88:91], v[68:71], v[164:167]
    ds_read_b64_tr_b16 v[58:59], v105 offset:45056
    v_mfma_f32_16x16x32_bf16 v[148:151], v[84:87], v[68:71], v[148:151]
    ds_read_b64_tr_b16 v[60:61], v108 offset:40960
    v_mfma_f32_16x16x32_bf16 v[132:135], v[80:83], v[68:71], v[132:135]
    ds_read_b64_tr_b16 v[62:63], v108 offset:45056
    s_waitcnt lgkmcnt(8)
    v_mfma_f32_16x16x32_bf16 v[136:139], v[80:83], v[72:75], v[136:139]
    ds_read_b128 v[32:35], v96 offset:32768
    v_mfma_f32_16x16x32_bf16 v[152:155], v[84:87], v[72:75], v[152:155]
    ds_read_b128 v[36:39], v96 offset:33024
    v_mfma_f32_16x16x32_bf16 v[168:171], v[88:91], v[72:75], v[168:171]
    ds_read_b128 v[40:43], v96 offset:34816
    v_mfma_f32_16x16x32_bf16 v[184:187], v[92:95], v[72:75], v[184:187]
    ds_read_b128 v[44:47], v96 offset:35072
    v_mfma_f32_16x16x32_bf16 v[188:191], v[92:95], v[76:79], v[188:191]
    v_mfma_f32_16x16x32_bf16 v[172:175], v[88:91], v[76:79], v[172:175]
    v_mfma_f32_16x16x32_bf16 v[156:159], v[84:87], v[76:79], v[156:159]
    v_mfma_f32_16x16x32_bf16 v[140:143], v[80:83], v[76:79], v[140:143]
    s_barrier
    s_waitcnt lgkmcnt(2)
    v_mfma_f32_16x16x32_bf16 v[128:131], v[48:51], v[32:35], v[128:131]
    ds_read_b64_tr_b16 v[80:81], v99 offset:57344
    v_mfma_f32_16x16x32_bf16 v[144:147], v[52:55], v[32:35], v[144:147]
    ds_read_b64_tr_b16 v[82:83], v99 offset:61440
    v_mfma_f32_16x16x32_bf16 v[160:163], v[56:59], v[32:35], v[160:163]
    ds_read_b64_tr_b16 v[84:85], v102 offset:57344
    v_mfma_f32_16x16x32_bf16 v[176:179], v[60:63], v[32:35], v[176:179]
    ds_read_b64_tr_b16 v[86:87], v102 offset:61440
    v_mfma_f32_16x16x32_bf16 v[180:183], v[60:63], v[36:39], v[180:183]
    ds_read_b64_tr_b16 v[88:89], v105 offset:57344
    v_mfma_f32_16x16x32_bf16 v[164:167], v[56:59], v[36:39], v[164:167]
    ds_read_b64_tr_b16 v[90:91], v105 offset:61440
    v_mfma_f32_16x16x32_bf16 v[148:151], v[52:55], v[36:39], v[148:151]
    ds_read_b64_tr_b16 v[92:93], v108 offset:57344
    v_mfma_f32_16x16x32_bf16 v[132:135], v[48:51], v[36:39], v[132:135]
    ds_read_b64_tr_b16 v[94:95], v108 offset:61440
    s_waitcnt lgkmcnt(8)
    v_mfma_f32_16x16x32_bf16 v[136:139], v[48:51], v[40:43], v[136:139]
    ds_read_b128 v[64:67], v96 offset:49152
    v_mfma_f32_16x16x32_bf16 v[152:155], v[52:55], v[40:43], v[152:155]
    ds_read_b128 v[68:71], v96 offset:49408
    v_mfma_f32_16x16x32_bf16 v[168:171], v[56:59], v[40:43], v[168:171]
    ds_read_b128 v[72:75], v96 offset:51200
    v_mfma_f32_16x16x32_bf16 v[184:187], v[60:63], v[40:43], v[184:187]
    ds_read_b128 v[76:79], v96 offset:51456
    v_mfma_f32_16x16x32_bf16 v[188:191], v[60:63], v[44:47], v[188:191]
    v_mfma_f32_16x16x32_bf16 v[172:175], v[56:59], v[44:47], v[172:175]
    v_mfma_f32_16x16x32_bf16 v[156:159], v[52:55], v[44:47], v[156:159]
    v_mfma_f32_16x16x32_bf16 v[140:143], v[48:51], v[44:47], v[140:143]
    s_waitcnt lgkmcnt(2)
    v_mfma_f32_16x16x32_bf16 v[128:131], v[80:83], v[64:67], v[128:131]
    ds_read_b64_tr_b16 v[48:49], v100 offset:8192
    v_mfma_f32_16x16x32_bf16 v[144:147], v[84:87], v[64:67], v[144:147]
    ds_read_b64_tr_b16 v[50:51], v100 offset:12288
    v_mfma_f32_16x16x32_bf16 v[160:163], v[88:91], v[64:67], v[160:163]
    ds_read_b64_tr_b16 v[52:53], v103 offset:8192
    v_mfma_f32_16x16x32_bf16 v[176:179], v[92:95], v[64:67], v[176:179]
    ds_read_b64_tr_b16 v[54:55], v103 offset:12288
    v_mfma_f32_16x16x32_bf16 v[180:183], v[92:95], v[68:71], v[180:183]
    ds_read_b64_tr_b16 v[56:57], v106 offset:8192
    v_mfma_f32_16x16x32_bf16 v[164:167], v[88:91], v[68:71], v[164:167]
    ds_read_b64_tr_b16 v[58:59], v106 offset:12288
    v_mfma_f32_16x16x32_bf16 v[148:151], v[84:87], v[68:71], v[148:151]
    ds_read_b64_tr_b16 v[60:61], v109 offset:8192
    v_mfma_f32_16x16x32_bf16 v[132:135], v[80:83], v[68:71], v[132:135]
    ds_read_b64_tr_b16 v[62:63], v109 offset:12288
    s_waitcnt lgkmcnt(8)
    v_mfma_f32_16x16x32_bf16 v[136:139], v[80:83], v[72:75], v[136:139]
    ds_read_b128 v[32:35], v97 offset:0
    v_mfma_f32_16x16x32_bf16 v[152:155], v[84:87], v[72:75], v[152:155]
    ds_read_b128 v[36:39], v97 offset:256
    v_mfma_f32_16x16x32_bf16 v[168:171], v[88:91], v[72:75], v[168:171]
    ds_read_b128 v[40:43], v97 offset:2048
    v_mfma_f32_16x16x32_bf16 v[184:187], v[92:95], v[72:75], v[184:187]
    ds_read_b128 v[44:47], v97 offset:2304
    v_mfma_f32_16x16x32_bf16 v[188:191], v[92:95], v[76:79], v[188:191]
    v_mfma_f32_16x16x32_bf16 v[172:175], v[88:91], v[76:79], v[172:175]
    v_mfma_f32_16x16x32_bf16 v[156:159], v[84:87], v[76:79], v[156:159]
    v_mfma_f32_16x16x32_bf16 v[140:143], v[80:83], v[76:79], v[140:143]
    s_barrier
    s_waitcnt lgkmcnt(2)
    v_mfma_f32_16x16x32_bf16 v[128:131], v[48:51], v[32:35], v[128:131]
    ds_read_b64_tr_b16 v[80:81], v100 offset:24576
    v_mfma_f32_16x16x32_bf16 v[144:147], v[52:55], v[32:35], v[144:147]
    ds_read_b64_tr_b16 v[82:83], v100 offset:28672
    v_mfma_f32_16x16x32_bf16 v[160:163], v[56:59], v[32:35], v[160:163]
    ds_read_b64_tr_b16 v[84:85], v103 offset:24576
    v_mfma_f32_16x16x32_bf16 v[176:179], v[60:63], v[32:35], v[176:179]
    ds_read_b64_tr_b16 v[86:87], v103 offset:28672
    v_mfma_f32_16x16x32_bf16 v[180:183], v[60:63], v[36:39], v[180:183]
    ds_read_b64_tr_b16 v[88:89], v106 offset:24576
    v_mfma_f32_16x16x32_bf16 v[164:167], v[56:59], v[36:39], v[164:167]
    ds_read_b64_tr_b16 v[90:91], v106 offset:28672
    v_mfma_f32_16x16x32_bf16 v[148:151], v[52:55], v[36:39], v[148:151]
    ds_read_b64_tr_b16 v[92:93], v109 offset:24576
    v_mfma_f32_16x16x32_bf16 v[132:135], v[48:51], v[36:39], v[132:135]
    ds_read_b64_tr_b16 v[94:95], v109 offset:28672
    s_waitcnt lgkmcnt(8)
    v_mfma_f32_16x16x32_bf16 v[136:139], v[48:51], v[40:43], v[136:139]
    ds_read_b128 v[64:67], v97 offset:16384
    v_mfma_f32_16x16x32_bf16 v[152:155], v[52:55], v[40:43], v[152:155]
    ds_read_b128 v[68:71], v97 offset:16640
    v_mfma_f32_16x16x32_bf16 v[168:171], v[56:59], v[40:43], v[168:171]
    ds_read_b128 v[72:75], v97 offset:18432
    v_mfma_f32_16x16x32_bf16 v[184:187], v[60:63], v[40:43], v[184:187]
    ds_read_b128 v[76:79], v97 offset:18688
    v_mfma_f32_16x16x32_bf16 v[188:191], v[60:63], v[44:47], v[188:191]
    v_mfma_f32_16x16x32_bf16 v[172:175], v[56:59], v[44:47], v[172:175]
    v_mfma_f32_16x16x32_bf16 v[156:159], v[52:55], v[44:47], v[156:159]
    v_mfma_f32_16x16x32_bf16 v[140:143], v[48:51], v[44:47], v[140:143]
    s_waitcnt lgkmcnt(2)
    v_mfma_f32_16x16x32_bf16 v[128:131], v[80:83], v[64:67], v[128:131]
    ds_read_b64_tr_b16 v[48:49], v100 offset:40960
    v_mfma_f32_16x16x32_bf16 v[144:147], v[84:87], v[64:67], v[144:147]
    ds_read_b64_tr_b16 v[50:51], v100 offset:45056
    v_mfma_f32_16x16x32_bf16 v[160:163], v[88:91], v[64:67], v[160:163]
    ds_read_b64_tr_b16 v[52:53], v103 offset:40960
    v_mfma_f32_16x16x32_bf16 v[176:179], v[92:95], v[64:67], v[176:179]
    ds_read_b64_tr_b16 v[54:55], v103 offset:45056
    v_mfma_f32_16x16x32_bf16 v[180:183], v[92:95], v[68:71], v[180:183]
    ds_read_b64_tr_b16 v[56:57], v106 offset:40960
    v_mfma_f32_16x16x32_bf16 v[164:167], v[88:91], v[68:71], v[164:167]
    ds_read_b64_tr_b16 v[58:59], v106 offset:45056
    v_mfma_f32_16x16x32_bf16 v[148:151], v[84:87], v[68:71], v[148:151]
    ds_read_b64_tr_b16 v[60:61], v109 offset:40960
    v_mfma_f32_16x16x32_bf16 v[132:135], v[80:83], v[68:71], v[132:135]
    ds_read_b64_tr_b16 v[62:63], v109 offset:45056
    s_waitcnt lgkmcnt(8)
    v_mfma_f32_16x16x32_bf16 v[136:139], v[80:83], v[72:75], v[136:139]
    ds_read_b128 v[32:35], v97 offset:32768
    v_mfma_f32_16x16x32_bf16 v[152:155], v[84:87], v[72:75], v[152:155]
    ds_read_b128 v[36:39], v97 offset:33024
    v_mfma_f32_16x16x32_bf16 v[168:171], v[88:91], v[72:75], v[168:171]
    ds_read_b128 v[40:43], v97 offset:34816
    v_mfma_f32_16x16x32_bf16 v[184:187], v[92:95], v[72:75], v[184:187]
    ds_read_b128 v[44:47], v97 offset:35072
    v_mfma_f32_16x16x32_bf16 v[188:191], v[92:95], v[76:79], v[188:191]
    v_mfma_f32_16x16x32_bf16 v[172:175], v[88:91], v[76:79], v[172:175]
    v_mfma_f32_16x16x32_bf16 v[156:159], v[84:87], v[76:79], v[156:159]
    v_mfma_f32_16x16x32_bf16 v[140:143], v[80:83], v[76:79], v[140:143]
    s_barrier
    s_waitcnt lgkmcnt(2)
    v_mfma_f32_16x16x32_bf16 v[128:131], v[48:51], v[32:35], v[128:131]
    ds_read_b64_tr_b16 v[80:81], v100 offset:57344
    v_mfma_f32_16x16x32_bf16 v[144:147], v[52:55], v[32:35], v[144:147]
    ds_read_b64_tr_b16 v[82:83], v100 offset:61440
    v_mfma_f32_16x16x32_bf16 v[160:163], v[56:59], v[32:35], v[160:163]
    ds_read_b64_tr_b16 v[84:85], v103 offset:57344
    v_mfma_f32_16x16x32_bf16 v[176:179], v[60:63], v[32:35], v[176:179]
    ds_read_b64_tr_b16 v[86:87], v103 offset:61440
    v_mfma_f32_16x16x32_bf16 v[180:183], v[60:63], v[36:39], v[180:183]
    ds_read_b64_tr_b16 v[88:89], v106 offset:57344
    v_mfma_f32_16x16x32_bf16 v[164:167], v[56:59], v[36:39], v[164:167]
    ds_read_b64_tr_b16 v[90:91], v106 offset:61440
    v_mfma_f32_16x16x32_bf16 v[148:151], v[52:55], v[36:39], v[148:151]
    ds_read_b64_tr_b16 v[92:93], v109 offset:57344
    v_mfma_f32_16x16x32_bf16 v[132:135], v[48:51], v[36:39], v[132:135]
    ds_read_b64_tr_b16 v[94:95], v109 offset:61440
    s_waitcnt lgkmcnt(8)
    v_mfma_f32_16x16x32_bf16 v[136:139], v[48:51], v[40:43], v[136:139]
    ds_read_b128 v[64:67], v97 offset:49152
    v_mfma_f32_16x16x32_bf16 v[152:155], v[52:55], v[40:43], v[152:155]
    ds_read_b128 v[68:71], v97 offset:49408
    v_mfma_f32_16x16x32_bf16 v[168:171], v[56:59], v[40:43], v[168:171]
    ds_read_b128 v[72:75], v97 offset:51200
    v_mfma_f32_16x16x32_bf16 v[184:187], v[60:63], v[40:43], v[184:187]
    ds_read_b128 v[76:79], v97 offset:51456
    v_mfma_f32_16x16x32_bf16 v[188:191], v[60:63], v[44:47], v[188:191]
    v_mfma_f32_16x16x32_bf16 v[172:175], v[56:59], v[44:47], v[172:175]
    v_mfma_f32_16x16x32_bf16 v[156:159], v[52:55], v[44:47], v[156:159]
    v_mfma_f32_16x16x32_bf16 v[140:143], v[48:51], v[44:47], v[140:143]
    s_waitcnt lgkmcnt(2)
    v_mfma_f32_16x16x32_bf16 v[128:131], v[80:83], v[64:67], v[128:131]
    ds_read_b64_tr_b16 v[48:49], v101 offset:8192
    v_mfma_f32_16x16x32_bf16 v[144:147], v[84:87], v[64:67], v[144:147]
    ds_read_b64_tr_b16 v[50:51], v101 offset:12288
    v_mfma_f32_16x16x32_bf16 v[160:163], v[88:91], v[64:67], v[160:163]
    ds_read_b64_tr_b16 v[52:53], v104 offset:8192
    v_mfma_f32_16x16x32_bf16 v[176:179], v[92:95], v[64:67], v[176:179]
    ds_read_b64_tr_b16 v[54:55], v104 offset:12288
    v_mfma_f32_16x16x32_bf16 v[180:183], v[92:95], v[68:71], v[180:183]
    ds_read_b64_tr_b16 v[56:57], v107 offset:8192
    v_mfma_f32_16x16x32_bf16 v[164:167], v[88:91], v[68:71], v[164:167]
    ds_read_b64_tr_b16 v[58:59], v107 offset:12288
    v_mfma_f32_16x16x32_bf16 v[148:151], v[84:87], v[68:71], v[148:151]
    ds_read_b64_tr_b16 v[60:61], v110 offset:8192
    v_mfma_f32_16x16x32_bf16 v[132:135], v[80:83], v[68:71], v[132:135]
    ds_read_b64_tr_b16 v[62:63], v110 offset:12288
    s_waitcnt lgkmcnt(8)
    v_mfma_f32_16x16x32_bf16 v[136:139], v[80:83], v[72:75], v[136:139]
    ds_read_b128 v[32:35], v98 offset:0
    v_mfma_f32_16x16x32_bf16 v[152:155], v[84:87], v[72:75], v[152:155]
    ds_read_b128 v[36:39], v98 offset:256
    v_mfma_f32_16x16x32_bf16 v[168:171], v[88:91], v[72:75], v[168:171]
    ds_read_b128 v[40:43], v98 offset:2048
    v_mfma_f32_16x16x32_bf16 v[184:187], v[92:95], v[72:75], v[184:187]
    ds_read_b128 v[44:47], v98 offset:2304
    v_mfma_f32_16x16x32_bf16 v[188:191], v[92:95], v[76:79], v[188:191]
    v_mfma_f32_16x16x32_bf16 v[172:175], v[88:91], v[76:79], v[172:175]
    v_mfma_f32_16x16x32_bf16 v[156:159], v[84:87], v[76:79], v[156:159]
    v_mfma_f32_16x16x32_bf16 v[140:143], v[80:83], v[76:79], v[140:143]
    s_barrier
    s_waitcnt lgkmcnt(2)
    v_mfma_f32_16x16x32_bf16 v[128:131], v[48:51], v[32:35], v[128:131]
    ds_read_b64_tr_b16 v[80:81], v101 offset:24576
    v_mfma_f32_16x16x32_bf16 v[144:147], v[52:55], v[32:35], v[144:147]
    ds_read_b64_tr_b16 v[82:83], v101 offset:28672
    v_mfma_f32_16x16x32_bf16 v[160:163], v[56:59], v[32:35], v[160:163]
    ds_read_b64_tr_b16 v[84:85], v104 offset:24576
    v_mfma_f32_16x16x32_bf16 v[176:179], v[60:63], v[32:35], v[176:179]
    ds_read_b64_tr_b16 v[86:87], v104 offset:28672
    v_mfma_f32_16x16x32_bf16 v[180:183], v[60:63], v[36:39], v[180:183]
    ds_read_b64_tr_b16 v[88:89], v107 offset:24576
    v_mfma_f32_16x16x32_bf16 v[164:167], v[56:59], v[36:39], v[164:167]
    ds_read_b64_tr_b16 v[90:91], v107 offset:28672
    v_mfma_f32_16x16x32_bf16 v[148:151], v[52:55], v[36:39], v[148:151]
    ds_read_b64_tr_b16 v[92:93], v110 offset:24576
    v_mfma_f32_16x16x32_bf16 v[132:135], v[48:51], v[36:39], v[132:135]
    ds_read_b64_tr_b16 v[94:95], v110 offset:28672
    s_waitcnt lgkmcnt(8)
    v_mfma_f32_16x16x32_bf16 v[136:139], v[48:51], v[40:43], v[136:139]
    ds_read_b128 v[64:67], v98 offset:16384
    v_mfma_f32_16x16x32_bf16 v[152:155], v[52:55], v[40:43], v[152:155]
    ds_read_b128 v[68:71], v98 offset:16640
    v_mfma_f32_16x16x32_bf16 v[168:171], v[56:59], v[40:43], v[168:171]
    ds_read_b128 v[72:75], v98 offset:18432
    v_mfma_f32_16x16x32_bf16 v[184:187], v[60:63], v[40:43], v[184:187]
    ds_read_b128 v[76:79], v98 offset:18688
    v_mfma_f32_16x16x32_bf16 v[188:191], v[60:63], v[44:47], v[188:191]
    v_mfma_f32_16x16x32_bf16 v[172:175], v[56:59], v[44:47], v[172:175]
    v_mfma_f32_16x16x32_bf16 v[156:159], v[52:55], v[44:47], v[156:159]
    v_mfma_f32_16x16x32_bf16 v[140:143], v[48:51], v[44:47], v[140:143]
    s_waitcnt lgkmcnt(2)
    v_mfma_f32_16x16x32_bf16 v[128:131], v[80:83], v[64:67], v[128:131]
    ds_read_b64_tr_b16 v[48:49], v99 offset:8192
    v_mfma_f32_16x16x32_bf16 v[144:147], v[84:87], v[64:67], v[144:147]
    ds_read_b64_tr_b16 v[50:51], v99 offset:12288
    v_mfma_f32_16x16x32_bf16 v[160:163], v[88:91], v[64:67], v[160:163]
    ds_read_b64_tr_b16 v[52:53], v102 offset:8192
    v_mfma_f32_16x16x32_bf16 v[176:179], v[92:95], v[64:67], v[176:179]
    ds_read_b64_tr_b16 v[54:55], v102 offset:12288
    v_mfma_f32_16x16x32_bf16 v[180:183], v[92:95], v[68:71], v[180:183]
    ds_read_b64_tr_b16 v[56:57], v105 offset:8192
    v_mfma_f32_16x16x32_bf16 v[164:167], v[88:91], v[68:71], v[164:167]
    ds_read_b64_tr_b16 v[58:59], v105 offset:12288
    v_mfma_f32_16x16x32_bf16 v[148:151], v[84:87], v[68:71], v[148:151]
    ds_read_b64_tr_b16 v[60:61], v108 offset:8192
    v_mfma_f32_16x16x32_bf16 v[132:135], v[80:83], v[68:71], v[132:135]
    ds_read_b64_tr_b16 v[62:63], v108 offset:12288
    s_waitcnt lgkmcnt(8)
    v_mfma_f32_16x16x32_bf16 v[136:139], v[80:83], v[72:75], v[136:139]
    ds_read_b128 v[32:35], v96 offset:0
    v_mfma_f32_16x16x32_bf16 v[152:155], v[84:87], v[72:75], v[152:155]
    ds_read_b128 v[36:39], v96 offset:256
    v_mfma_f32_16x16x32_bf16 v[168:171], v[88:91], v[72:75], v[168:171]
    ds_read_b128 v[40:43], v96 offset:2048
    v_mfma_f32_16x16x32_bf16 v[184:187], v[92:95], v[72:75], v[184:187]
    ds_read_b128 v[44:47], v96 offset:2304
    v_mfma_f32_16x16x32_bf16 v[188:191], v[92:95], v[76:79], v[188:191]
    v_mfma_f32_16x16x32_bf16 v[172:175], v[88:91], v[76:79], v[172:175]
    v_mfma_f32_16x16x32_bf16 v[156:159], v[84:87], v[76:79], v[156:159]
    v_mfma_f32_16x16x32_bf16 v[140:143], v[80:83], v[76:79], v[140:143]
    s_cmp_lg_u32 s54, 0
    s_cbranch_scc1 P3_G1
    s_barrier
    s_waitcnt lgkmcnt(2)
    v_mfma_f32_16x16x32_bf16 v[128:131], v[48:51], v[32:35], v[128:131]
    ds_read_b64_tr_b16 v[80:81], v99 offset:24576
    v_mfma_f32_16x16x32_bf16 v[144:147], v[52:55], v[32:35], v[144:147]
    ds_read_b64_tr_b16 v[82:83], v99 offset:28672
    v_mfma_f32_16x16x32_bf16 v[160:163], v[56:59], v[32:35], v[160:163]
    ds_read_b64_tr_b16 v[84:85], v102 offset:24576
    v_mfma_f32_16x16x32_bf16 v[176:179], v[60:63], v[32:35], v[176:179]
    ds_read_b64_tr_b16 v[86:87], v102 offset:28672
    v_mfma_f32_16x16x32_bf16 v[180:183], v[60:63], v[36:39], v[180:183]
    ds_read_b64_tr_b16 v[88:89], v105 offset:24576
    v_mfma_f32_16x16x32_bf16 v[164:167], v[56:59], v[36:39], v[164:167]
    ds_read_b64_tr_b16 v[90:91], v105 offset:28672
    v_mfma_f32_16x16x32_bf16 v[148:151], v[52:55], v[36:39], v[148:151]
    ds_read_b64_tr_b16 v[92:93], v108 offset:24576
    v_mfma_f32_16x16x32_bf16 v[132:135], v[48:51], v[36:39], v[132:135]
    ds_read_b64_tr_b16 v[94:95], v108 offset:28672
    s_waitcnt lgkmcnt(8)
    v_mfma_f32_16x16x32_bf16 v[136:139], v[48:51], v[40:43], v[136:139]
    ds_read_b128 v[64:67], v96 offset:16384
    v_mfma_f32_16x16x32_bf16 v[152:155], v[52:55], v[40:43], v[152:155]
    ds_read_b128 v[68:71], v96 offset:16640
    v_mfma_f32_16x16x32_bf16 v[168:171], v[56:59], v[40:43], v[168:171]
    ds_read_b128 v[72:75], v96 offset:18432
    v_mfma_f32_16x16x32_bf16 v[184:187], v[60:63], v[40:43], v[184:187]
    ds_read_b128 v[76:79], v96 offset:18688
    v_mfma_f32_16x16x32_bf16 v[188:191], v[60:63], v[44:47], v[188:191]
    v_mfma_f32_16x16x32_bf16 v[172:175], v[56:59], v[44:47], v[172:175]
    v_mfma_f32_16x16x32_bf16 v[156:159], v[52:55], v[44:47], v[156:159]
    v_mfma_f32_16x16x32_bf16 v[140:143], v[48:51], v[44:47], v[140:143]
    s_waitcnt lgkmcnt(2)
    v_mfma_f32_16x16x32_bf16 v[128:131], v[80:83], v[64:67], v[128:131]
    ds_read_b64_tr_b16 v[48:49], v99 offset:40960
    v_mfma_f32_16x16x32_bf16 v[144:147], v[84:87], v[64:67], v[144:147]
    ds_read_b64_tr_b16 v[50:51], v99 offset:45056
    v_mfma_f32_16x16x32_bf16 v[160:163], v[88:91], v[64:67], v[160:163]
    ds_read_b64_tr_b16 v[52:53], v102 offset:40960
    v_mfma_f32_16x16x32_bf16 v[176:179], v[92:95], v[64:67], v[176:179]
    ds_read_b64_tr_b16 v[54:55], v102 offset:45056
    v_mfma_f32_16x16x32_bf16 v[180:183], v[92:95], v[68:71], v[180:183]
    ds_read_b64_tr_b16 v[56:57], v105 offset:40960
    v_mfma_f32_16x16x32_bf16 v[164:167], v[88:91], v[68:71], v[164:167]
    ds_read_b64_tr_b16 v[58:59], v105 offset:45056
    v_mfma_f32_16x16x32_bf16 v[148:151], v[84:87], v[68:71], v[148:151]
    ds_read_b64_tr_b16 v[60:61], v108 offset:40960
    v_mfma_f32_16x16x32_bf16 v[132:135], v[80:83], v[68:71], v[132:135]
    ds_read_b64_tr_b16 v[62:63], v108 offset:45056
    s_waitcnt lgkmcnt(8)
    v_mfma_f32_16x16x32_bf16 v[136:139], v[80:83], v[72:75], v[136:139]
    ds_read_b128 v[32:35], v96 offset:32768
    v_mfma_f32_16x16x32_bf16 v[152:155], v[84:87], v[72:75], v[152:155]
    ds_read_b128 v[36:39], v96 offset:33024
    v_mfma_f32_16x16x32_bf16 v[168:171], v[88:91], v[72:75], v[168:171]
    ds_read_b128 v[40:43], v96 offset:34816
    v_mfma_f32_16x16x32_bf16 v[184:187], v[92:95], v[72:75], v[184:187]
    ds_read_b128 v[44:47], v96 offset:35072
    v_mfma_f32_16x16x32_bf16 v[188:191], v[92:95], v[76:79], v[188:191]
    v_mfma_f32_16x16x32_bf16 v[172:175], v[88:91], v[76:79], v[172:175]
    v_mfma_f32_16x16x32_bf16 v[156:159], v[84:87], v[76:79], v[156:159]
    v_mfma_f32_16x16x32_bf16 v[140:143], v[80:83], v[76:79], v[140:143]
    s_barrier
    s_waitcnt lgkmcnt(2)
    v_mfma_f32_16x16x32_bf16 v[128:131], v[48:51], v[32:35], v[128:131]
    ds_read_b64_tr_b16 v[80:81], v99 offset:57344
    v_mfma_f32_16x16x32_bf16 v[144:147], v[52:55], v[32:35], v[144:147]
    ds_read_b64_tr_b16 v[82:83], v99 offset:61440
    v_mfma_f32_16x16x32_bf16 v[160:163], v[56:59], v[32:35], v[160:163]
    ds_read_b64_tr_b16 v[84:85], v102 offset:57344
    v_mfma_f32_16x16x32_bf16 v[176:179], v[60:63], v[32:35], v[176:179]
    ds_read_b64_tr_b16 v[86:87], v102 offset:61440
    v_mfma_f32_16x16x32_bf16 v[180:183], v[60:63], v[36:39], v[180:183]
    ds_read_b64_tr_b16 v[88:89], v105 offset:57344
    v_mfma_f32_16x16x32_bf16 v[164:167], v[56:59], v[36:39], v[164:167]
    ds_read_b64_tr_b16 v[90:91], v105 offset:61440
    v_mfma_f32_16x16x32_bf16 v[148:151], v[52:55], v[36:39], v[148:151]
    ds_read_b64_tr_b16 v[92:93], v108 offset:57344
    v_mfma_f32_16x16x32_bf16 v[132:135], v[48:51], v[36:39], v[132:135]
    ds_read_b64_tr_b16 v[94:95], v108 offset:61440
    s_waitcnt lgkmcnt(8)
    v_mfma_f32_16x16x32_bf16 v[136:139], v[48:51], v[40:43], v[136:139]
    ds_read_b128 v[64:67], v96 offset:49152
    v_mfma_f32_16x16x32_bf16 v[152:155], v[52:55], v[40:43], v[152:155]
    ds_read_b128 v[68:71], v96 offset:49408
    v_mfma_f32_16x16x32_bf16 v[168:171], v[56:59], v[40:43], v[168:171]
    ds_read_b128 v[72:75], v96 offset:51200
    v_mfma_f32_16x16x32_bf16 v[184:187], v[60:63], v[40:43], v[184:187]
    ds_read_b128 v[76:79], v96 offset:51456
    v_mfma_f32_16x16x32_bf16 v[188:191], v[60:63], v[44:47], v[188:191]
    v_mfma_f32_16x16x32_bf16 v[172:175], v[56:59], v[44:47], v[172:175]
    v_mfma_f32_16x16x32_bf16 v[156:159], v[52:55], v[44:47], v[156:159]
    v_mfma_f32_16x16x32_bf16 v[140:143], v[48:51], v[44:47], v[140:143]
    s_waitcnt lgkmcnt(2)
    v_mfma_f32_16x16x32_bf16 v[128:131], v[80:83], v[64:67], v[128:131]
    ds_read_b64_tr_b16 v[48:49], v100 offset:8192
    v_mfma_f32_16x16x32_bf16 v[144:147], v[84:87], v[64:67], v[144:147]
    ds_read_b64_tr_b16 v[50:51], v100 offset:12288
    v_mfma_f32_16x16x32_bf16 v[160:163], v[88:91], v[64:67], v[160:163]
    ds_read_b64_tr_b16 v[52:53], v103 offset:8192
    v_mfma_f32_16x16x32_bf16 v[176:179], v[92:95], v[64:67], v[176:179]
    ds_read_b64_tr_b16 v[54:55], v103 offset:12288
    v_mfma_f32_16x16x32_bf16 v[180:183], v[92:95], v[68:71], v[180:183]
    ds_read_b64_tr_b16 v[56:57], v106 offset:8192
    v_mfma_f32_16x16x32_bf16 v[164:167], v[88:91], v[68:71], v[164:167]
    ds_read_b64_tr_b16 v[58:59], v106 offset:12288
    v_mfma_f32_16x16x32_bf16 v[148:151], v[84:87], v[68:71], v[148:151]
    ds_read_b64_tr_b16 v[60:61], v109 offset:8192
    v_mfma_f32_16x16x32_bf16 v[132:135], v[80:83], v[68:71], v[132:135]
    ds_read_b64_tr_b16 v[62:63], v109 offset:12288
    s_waitcnt lgkmcnt(8)
    v_mfma_f32_16x16x32_bf16 v[136:139], v[80:83], v[72:75], v[136:139]
    ds_read_b128 v[32:35], v97 offset:0
    v_mfma_f32_16x16x32_bf16 v[152:155], v[84:87], v[72:75], v[152:155]
    ds_read_b128 v[36:39], v97 offset:256
    v_mfma_f32_16x16x32_bf16 v[168:171], v[88:91], v[72:75], v[168:171]
    ds_read_b128 v[40:43], v97 offset:2048
    v_mfma_f32_16x16x32_bf16 v[184:187], v[92:95], v[72:75], v[184:187]
    ds_read_b128 v[44:47], v97 offset:2304
    v_mfma_f32_16x16x32_bf16 v[188:191], v[92:95], v[76:79], v[188:191]
    v_mfma_f32_16x16x32_bf16 v[172:175], v[88:91], v[76:79], v[172:175]
    v_mfma_f32_16x16x32_bf16 v[156:159], v[84:87], v[76:79], v[156:159]
    v_mfma_f32_16x16x32_bf16 v[140:143], v[80:83], v[76:79], v[140:143]
    s_barrier
    s_waitcnt lgkmcnt(2)
    v_mfma_f32_16x16x32_bf16 v[128:131], v[48:51], v[32:35], v[128:131]
    ds_read_b64_tr_b16 v[80:81], v100 offset:24576
    v_mfma_f32_16x16x32_bf16 v[144:147], v[52:55], v[32:35], v[144:147]
    ds_read_b64_tr_b16 v[82:83], v100 offset:28672
    v_mfma_f32_16x16x32_bf16 v[160:163], v[56:59], v[32:35], v[160:163]
    ds_read_b64_tr_b16 v[84:85], v103 offset:24576
    v_mfma_f32_16x16x32_bf16 v[176:179], v[60:63], v[32:35], v[176:179]
    ds_read_b64_tr_b16 v[86:87], v103 offset:28672
    v_mfma_f32_16x16x32_bf16 v[180:183], v[60:63], v[36:39], v[180:183]
    ds_read_b64_tr_b16 v[88:89], v106 offset:24576
    v_mfma_f32_16x16x32_bf16 v[164:167], v[56:59], v[36:39], v[164:167]
    ds_read_b64_tr_b16 v[90:91], v106 offset:28672
    v_mfma_f32_16x16x32_bf16 v[148:151], v[52:55], v[36:39], v[148:151]
    ds_read_b64_tr_b16 v[92:93], v109 offset:24576
    v_mfma_f32_16x16x32_bf16 v[132:135], v[48:51], v[36:39], v[132:135]
    ds_read_b64_tr_b16 v[94:95], v109 offset:28672
    s_waitcnt lgkmcnt(8)
    v_mfma_f32_16x16x32_bf16 v[136:139], v[48:51], v[40:43], v[136:139]
    ds_read_b128 v[64:67], v97 offset:16384
    v_mfma_f32_16x16x32_bf16 v[152:155], v[52:55], v[40:43], v[152:155]
    ds_read_b128 v[68:71], v97 offset:16640
    v_mfma_f32_16x16x32_bf16 v[168:171], v[56:59], v[40:43], v[168:171]
    ds_read_b128 v[72:75], v97 offset:18432
    v_mfma_f32_16x16x32_bf16 v[184:187], v[60:63], v[40:43], v[184:187]
    ds_read_b128 v[76:79], v97 offset:18688
    v_mfma_f32_16x16x32_bf16 v[188:191], v[60:63], v[44:47], v[188:191]
    v_mfma_f32_16x16x32_bf16 v[172:175], v[56:59], v[44:47], v[172:175]
    v_mfma_f32_16x16x32_bf16 v[156:159], v[52:55], v[44:47], v[156:159]
    v_mfma_f32_16x16x32_bf16 v[140:143], v[48:51], v[44:47], v[140:143]
    s_waitcnt lgkmcnt(2)
    v_mfma_f32_16x16x32_bf16 v[128:131], v[80:83], v[64:67], v[128:131]
    ds_read_b64_tr_b16 v[48:49], v100 offset:40960
    v_mfma_f32_16x16x32_bf16 v[144:147], v[84:87], v[64:67], v[144:147]
    ds_read_b64_tr_b16 v[50:51], v100 offset:45056
    v_mfma_f32_16x16x32_bf16 v[160:163], v[88:91], v[64:67], v[160:163]
    ds_read_b64_tr_b16 v[52:53], v103 offset:40960
    v_mfma_f32_16x16x32_bf16 v[176:179], v[92:95], v[64:67], v[176:179]
    ds_read_b64_tr_b16 v[54:55], v103 offset:45056
    v_mfma_f32_16x16x32_bf16 v[180:183], v[92:95], v[68:71], v[180:183]
    ds_read_b64_tr_b16 v[56:57], v106 offset:40960
    v_mfma_f32_16x16x32_bf16 v[164:167], v[88:91], v[68:71], v[164:167]
    ds_read_b64_tr_b16 v[58:59], v106 offset:45056
    v_mfma_f32_16x16x32_bf16 v[148:151], v[84:87], v[68:71], v[148:151]
    ds_read_b64_tr_b16 v[60:61], v109 offset:40960
    v_mfma_f32_16x16x32_bf16 v[132:135], v[80:83], v[68:71], v[132:135]
    ds_read_b64_tr_b16 v[62:63], v109 offset:45056
    s_waitcnt lgkmcnt(8)
    v_mfma_f32_16x16x32_bf16 v[136:139], v[80:83], v[72:75], v[136:139]
    ds_read_b128 v[32:35], v97 offset:32768
    v_mfma_f32_16x16x32_bf16 v[152:155], v[84:87], v[72:75], v[152:155]
    ds_read_b128 v[36:39], v97 offset:33024
    v_mfma_f32_16x16x32_bf16 v[168:171], v[88:91], v[72:75], v[168:171]
    ds_read_b128 v[40:43], v97 offset:34816
    v_mfma_f32_16x16x32_bf16 v[184:187], v[92:95], v[72:75], v[184:187]
    ds_read_b128 v[44:47], v97 offset:35072
    v_mfma_f32_16x16x32_bf16 v[188:191], v[92:95], v[76:79], v[188:191]
    v_mfma_f32_16x16x32_bf16 v[172:175], v[88:91], v[76:79], v[172:175]
    v_mfma_f32_16x16x32_bf16 v[156:159], v[84:87], v[76:79], v[156:159]
    v_mfma_f32_16x16x32_bf16 v[140:143], v[80:83], v[76:79], v[140:143]
    s_barrier
    s_waitcnt lgkmcnt(2)
    v_mfma_f32_16x16x32_bf16 v[128:131], v[48:51], v[32:35], v[128:131]
    ds_read_b64_tr_b16 v[80:81], v100 offset:57344
    v_mfma_f32_16x16x32_bf16 v[144:147], v[52:55], v[32:35], v[144:147]
    ds_read_b64_tr_b16 v[82:83], v100 offset:61440
    v_mfma_f32_16x16x32_bf16 v[160:163], v[56:59], v[32:35], v[160:163]
    ds_read_b64_tr_b16 v[84:85], v103 offset:57344
    v_mfma_f32_16x16x32_bf16 v[176:179], v[60:63], v[32:35], v[176:179]
    ds_read_b64_tr_b16 v[86:87], v103 offset:61440
    v_mfma_f32_16x16x32_bf16 v[180:183], v[60:63], v[36:39], v[180:183]
    ds_read_b64_tr_b16 v[88:89], v106 offset:57344
    v_mfma_f32_16x16x32_bf16 v[164:167], v[56:59], v[36:39], v[164:167]
    ds_read_b64_tr_b16 v[90:91], v106 offset:61440
    v_mfma_f32_16x16x32_bf16 v[148:151], v[52:55], v[36:39], v[148:151]
    ds_read_b64_tr_b16 v[92:93], v109 offset:57344
    v_mfma_f32_16x16x32_bf16 v[132:135], v[48:51], v[36:39], v[132:135]
    ds_read_b64_tr_b16 v[94:95], v109 offset:61440
    s_waitcnt lgkmcnt(8)
    v_mfma_f32_16x16x32_bf16 v[136:139], v[48:51], v[40:43], v[136:139]
    ds_read_b128 v[64:67], v97 offset:49152
    v_mfma_f32_16x16x32_bf16 v[152:155], v[52:55], v[40:43], v[152:155]
    ds_read_b128 v[68:71], v97 offset:49408
    v_mfma_f32_16x16x32_bf16 v[168:171], v[56:59], v[40:43], v[168:171]
    ds_read_b128 v[72:75], v97 offset:51200
    v_mfma_f32_16x16x32_bf16 v[184:187], v[60:63], v[40:43], v[184:187]
    ds_read_b128 v[76:79], v97 offset:51456
    v_mfma_f32_16x16x32_bf16 v[188:191], v[60:63], v[44:47], v[188:191]
    v_mfma_f32_16x16x32_bf16 v[172:175], v[56:59], v[44:47], v[172:175]
    v_mfma_f32_16x16x32_bf16 v[156:159], v[52:55], v[44:47], v[156:159]
    v_mfma_f32_16x16x32_bf16 v[140:143], v[48:51], v[44:47], v[140:143]
    s_waitcnt lgkmcnt(2)
    v_mfma_f32_16x16x32_bf16 v[128:131], v[80:83], v[64:67], v[128:131]
    ds_read_b64_tr_b16 v[48:49], v101 offset:8192
    v_mfma_f32_16x16x32_bf16 v[144:147], v[84:87], v[64:67], v[144:147]
    ds_read_b64_tr_b16 v[50:51], v101 offset:12288
    v_mfma_f32_16x16x32_bf16 v[160:163], v[88:91], v[64:67], v[160:163]
    ds_read_b64_tr_b16 v[52:53], v104 offset:8192
    v_mfma_f32_16x16x32_bf16 v[176:179], v[92:95], v[64:67], v[176:179]
    ds_read_b64_tr_b16 v[54:55], v104 offset:12288
    v_mfma_f32_16x16x32_bf16 v[180:183], v[92:95], v[68:71], v[180:183]
    ds_read_b64_tr_b16 v[56:57], v107 offset:8192
    v_mfma_f32_16x16x32_bf16 v[164:167], v[88:91], v[68:71], v[164:167]
    ds_read_b64_tr_b16 v[58:59], v107 offset:12288
    v_mfma_f32_16x16x32_bf16 v[148:151], v[84:87], v[68:71], v[148:151]
    ds_read_b64_tr_b16 v[60:61], v110 offset:8192
    v_mfma_f32_16x16x32_bf16 v[132:135], v[80:83], v[68:71], v[132:135]
    ds_read_b64_tr_b16 v[62:63], v110 offset:12288
    s_waitcnt lgkmcnt(8)
    v_mfma_f32_16x16x32_bf16 v[136:139], v[80:83], v[72:75], v[136:139]
    ds_read_b128 v[32:35], v98 offset:0
    v_mfma_f32_16x16x32_bf16 v[152:155], v[84:87], v[72:75], v[152:155]
    ds_read_b128 v[36:39], v98 offset:256
    v_mfma_f32_16x16x32_bf16 v[168:171], v[88:91], v[72:75], v[168:171]
    ds_read_b128 v[40:43], v98 offset:2048
    v_mfma_f32_16x16x32_bf16 v[184:187], v[92:95], v[72:75], v[184:187]
    ds_read_b128 v[44:47], v98 offset:2304
    v_mfma_f32_16x16x32_bf16 v[188:191], v[92:95], v[76:79], v[188:191]
    v_mfma_f32_16x16x32_bf16 v[172:175], v[88:91], v[76:79], v[172:175]
    v_mfma_f32_16x16x32_bf16 v[156:159], v[84:87], v[76:79], v[156:159]
    v_mfma_f32_16x16x32_bf16 v[140:143], v[80:83], v[76:79], v[140:143]
    s_barrier
    s_waitcnt lgkmcnt(2)
    v_mfma_f32_16x16x32_bf16 v[128:131], v[48:51], v[32:35], v[128:131]
    ds_read_b64_tr_b16 v[80:81], v101 offset:24576
    v_mfma_f32_16x16x32_bf16 v[144:147], v[52:55], v[32:35], v[144:147]
    ds_read_b64_tr_b16 v[82:83], v101 offset:28672
    v_mfma_f32_16x16x32_bf16 v[160:163], v[56:59], v[32:35], v[160:163]
    ds_read_b64_tr_b16 v[84:85], v104 offset:24576
    v_mfma_f32_16x16x32_bf16 v[176:179], v[60:63], v[32:35], v[176:179]
    ds_read_b64_tr_b16 v[86:87], v104 offset:28672
    v_mfma_f32_16x16x32_bf16 v[180:183], v[60:63], v[36:39], v[180:183]
    ds_read_b64_tr_b16 v[88:89], v107 offset:24576
    v_mfma_f32_16x16x32_bf16 v[164:167], v[56:59], v[36:39], v[164:167]
    ds_read_b64_tr_b16 v[90:91], v107 offset:28672
    v_mfma_f32_16x16x32_bf16 v[148:151], v[52:55], v[36:39], v[148:151]
    ds_read_b64_tr_b16 v[92:93], v110 offset:24576
    v_mfma_f32_16x16x32_bf16 v[132:135], v[48:51], v[36:39], v[132:135]
    ds_read_b64_tr_b16 v[94:95], v110 offset:28672
    s_waitcnt lgkmcnt(8)
    v_mfma_f32_16x16x32_bf16 v[136:139], v[48:51], v[40:43], v[136:139]
    ds_read_b128 v[64:67], v98 offset:16384
    v_mfma_f32_16x16x32_bf16 v[152:155], v[52:55], v[40:43], v[152:155]
    ds_read_b128 v[68:71], v98 offset:16640
    v_mfma_f32_16x16x32_bf16 v[168:171], v[56:59], v[40:43], v[168:171]
    ds_read_b128 v[72:75], v98 offset:18432
    v_mfma_f32_16x16x32_bf16 v[184:187], v[60:63], v[40:43], v[184:187]
    ds_read_b128 v[76:79], v98 offset:18688
    v_mfma_f32_16x16x32_bf16 v[188:191], v[60:63], v[44:47], v[188:191]
    v_mfma_f32_16x16x32_bf16 v[172:175], v[56:59], v[44:47], v[172:175]
    v_mfma_f32_16x16x32_bf16 v[156:159], v[52:55], v[44:47], v[156:159]
    v_mfma_f32_16x16x32_bf16 v[140:143], v[48:51], v[44:47], v[140:143]
    s_waitcnt lgkmcnt(2)
    v_mfma_f32_16x16x32_bf16 v[128:131], v[80:83], v[64:67], v[128:131]
    ds_read_b64_tr_b16 v[48:49], v99 offset:8192
    v_mfma_f32_16x16x32_bf16 v[144:147], v[84:87], v[64:67], v[144:147]
    ds_read_b64_tr_b16 v[50:51], v99 offset:12288
    v_mfma_f32_16x16x32_bf16 v[160:163], v[88:91], v[64:67], v[160:163]
    ds_read_b64_tr_b16 v[52:53], v102 offset:8192
    v_mfma_f32_16x16x32_bf16 v[176:179], v[92:95], v[64:67], v[176:179]
    ds_read_b64_tr_b16 v[54:55], v102 offset:12288
    v_mfma_f32_16x16x32_bf16 v[180:183], v[92:95], v[68:71], v[180:183]
    ds_read_b64_tr_b16 v[56:57], v105 offset:8192
    v_mfma_f32_16x16x32_bf16 v[164:167], v[88:91], v[68:71], v[164:167]
    ds_read_b64_tr_b16 v[58:59], v105 offset:12288
    v_mfma_f32_16x16x32_bf16 v[148:151], v[84:87], v[68:71], v[148:151]
    ds_read_b64_tr_b16 v[60:61], v108 offset:8192
    v_mfma_f32_16x16x32_bf16 v[132:135], v[80:83], v[68:71], v[132:135]
    ds_read_b64_tr_b16 v[62:63], v108 offset:12288
    s_waitcnt lgkmcnt(8)
    v_mfma_f32_16x16x32_bf16 v[136:139], v[80:83], v[72:75], v[136:139]
    ds_read_b128 v[32:35], v96 offset:0
    v_mfma_f32_16x16x32_bf16 v[152:155], v[84:87], v[72:75], v[152:155]
    ds_read_b128 v[36:39], v96 offset:256
    v_mfma_f32_16x16x32_bf16 v[168:171], v[88:91], v[72:75], v[168:171]
    ds_read_b128 v[40:43], v96 offset:2048
    v_mfma_f32_16x16x32_bf16 v[184:187], v[92:95], v[72:75], v[184:187]
    ds_read_b128 v[44:47], v96 offset:2304
    v_mfma_f32_16x16x32_bf16 v[188:191], v[92:95], v[76:79], v[188:191]
    v_mfma_f32_16x16x32_bf16 v[172:175], v[88:91], v[76:79], v[172:175]
    v_mfma_f32_16x16x32_bf16 v[156:159], v[84:87], v[76:79], v[156:159]
    v_mfma_f32_16x16x32_bf16 v[140:143], v[80:83], v[76:79], v[140:143]
    s_barrier
    s_waitcnt lgkmcnt(2)
    v_mfma_f32_16x16x32_bf16 v[128:131], v[48:51], v[32:35], v[128:131]
    ds_read_b64_tr_b16 v[80:81], v99 offset:24576
    v_mfma_f32_16x16x32_bf16 v[144:147], v[52:55], v[32:35], v[144:147]
    ds_read_b64_tr_b16 v[82:83], v99 offset:28672
    v_mfma_f32_16x16x32_bf16 v[160:163], v[56:59], v[32:35], v[160:163]
    ds_read_b64_tr_b16 v[84:85], v102 offset:24576
    v_mfma_f32_16x16x32_bf16 v[176:179], v[60:63], v[32:35], v[176:179]
    ds_read_b64_tr_b16 v[86:87], v102 offset:28672
    v_mfma_f32_16x16x32_bf16 v[180:183], v[60:63], v[36:39], v[180:183]
    ds_read_b64_tr_b16 v[88:89], v105 offset:24576
    v_mfma_f32_16x16x32_bf16 v[164:167], v[56:59], v[36:39], v[164:167]
    ds_read_b64_tr_b16 v[90:91], v105 offset:28672
    v_mfma_f32_16x16x32_bf16 v[148:151], v[52:55], v[36:39], v[148:151]
    ds_read_b64_tr_b16 v[92:93], v108 offset:24576
    v_mfma_f32_16x16x32_bf16 v[132:135], v[48:51], v[36:39], v[132:135]
    ds_read_b64_tr_b16 v[94:95], v108 offset:28672
    s_waitcnt lgkmcnt(8)
    v_mfma_f32_16x16x32_bf16 v[136:139], v[48:51], v[40:43], v[136:139]
    ds_read_b128 v[64:67], v96 offset:16384
    v_mfma_f32_16x16x32_bf16 v[152:155], v[52:55], v[40:43], v[152:155]
    ds_read_b128 v[68:71], v96 offset:16640
    v_mfma_f32_16x16x32_bf16 v[168:171], v[56:59], v[40:43], v[168:171]
    ds_read_b128 v[72:75], v96 offset:18432
    v_mfma_f32_16x16x32_bf16 v[184:187], v[60:63], v[40:43], v[184:187]
    ds_read_b128 v[76:79], v96 offset:18688
    v_mfma_f32_16x16x32_bf16 v[188:191], v[60:63], v[44:47], v[188:191]
    v_mfma_f32_16x16x32_bf16 v[172:175], v[56:59], v[44:47], v[172:175]
    v_mfma_f32_16x16x32_bf16 v[156:159], v[52:55], v[44:47], v[156:159]
    v_mfma_f32_16x16x32_bf16 v[140:143], v[48:51], v[44:47], v[140:143]
    s_waitcnt lgkmcnt(2)
    v_mfma_f32_16x16x32_bf16 v[128:131], v[80:83], v[64:67], v[128:131]
    ds_read_b64_tr_b16 v[48:49], v99 offset:40960
    v_mfma_f32_16x16x32_bf16 v[144:147], v[84:87], v[64:67], v[144:147]
    ds_read_b64_tr_b16 v[50:51], v99 offset:45056
    v_mfma_f32_16x16x32_bf16 v[160:163], v[88:91], v[64:67], v[160:163]
    ds_read_b64_tr_b16 v[52:53], v102 offset:40960
    v_mfma_f32_16x16x32_bf16 v[176:179], v[92:95], v[64:67], v[176:179]
    ds_read_b64_tr_b16 v[54:55], v102 offset:45056
    v_mfma_f32_16x16x32_bf16 v[180:183], v[92:95], v[68:71], v[180:183]
    ds_read_b64_tr_b16 v[56:57], v105 offset:40960
    v_mfma_f32_16x16x32_bf16 v[164:167], v[88:91], v[68:71], v[164:167]
    ds_read_b64_tr_b16 v[58:59], v105 offset:45056
    v_mfma_f32_16x16x32_bf16 v[148:151], v[84:87], v[68:71], v[148:151]
    ds_read_b64_tr_b16 v[60:61], v108 offset:40960
    v_mfma_f32_16x16x32_bf16 v[132:135], v[80:83], v[68:71], v[132:135]
    ds_read_b64_tr_b16 v[62:63], v108 offset:45056
    s_waitcnt lgkmcnt(8)
    v_mfma_f32_16x16x32_bf16 v[136:139], v[80:83], v[72:75], v[136:139]
    ds_read_b128 v[32:35], v96 offset:32768
    v_mfma_f32_16x16x32_bf16 v[152:155], v[84:87], v[72:75], v[152:155]
    ds_read_b128 v[36:39], v96 offset:33024
    v_mfma_f32_16x16x32_bf16 v[168:171], v[88:91], v[72:75], v[168:171]
    ds_read_b128 v[40:43], v96 offset:34816
    v_mfma_f32_16x16x32_bf16 v[184:187], v[92:95], v[72:75], v[184:187]
    ds_read_b128 v[44:47], v96 offset:35072
    v_mfma_f32_16x16x32_bf16 v[188:191], v[92:95], v[76:79], v[188:191]
    v_mfma_f32_16x16x32_bf16 v[172:175], v[88:91], v[76:79], v[172:175]
    v_mfma_f32_16x16x32_bf16 v[156:159], v[84:87], v[76:79], v[156:159]
    v_mfma_f32_16x16x32_bf16 v[140:143], v[80:83], v[76:79], v[140:143]
    s_barrier
    s_waitcnt lgkmcnt(2)
    v_mfma_f32_16x16x32_bf16 v[128:131], v[48:51], v[32:35], v[128:131]
    ds_read_b64_tr_b16 v[80:81], v99 offset:57344
    v_mfma_f32_16x16x32_bf16 v[144:147], v[52:55], v[32:35], v[144:147]
    ds_read_b64_tr_b16 v[82:83], v99 offset:61440
    v_mfma_f32_16x16x32_bf16 v[160:163], v[56:59], v[32:35], v[160:163]
    ds_read_b64_tr_b16 v[84:85], v102 offset:57344
    v_mfma_f32_16x16x32_bf16 v[176:179], v[60:63], v[32:35], v[176:179]
    ds_read_b64_tr_b16 v[86:87], v102 offset:61440
    v_mfma_f32_16x16x32_bf16 v[180:183], v[60:63], v[36:39], v[180:183]
    ds_read_b64_tr_b16 v[88:89], v105 offset:57344
    v_mfma_f32_16x16x32_bf16 v[164:167], v[56:59], v[36:39], v[164:167]
    ds_read_b64_tr_b16 v[90:91], v105 offset:61440
    v_mfma_f32_16x16x32_bf16 v[148:151], v[52:55], v[36:39], v[148:151]
    ds_read_b64_tr_b16 v[92:93], v108 offset:57344
    v_mfma_f32_16x16x32_bf16 v[132:135], v[48:51], v[36:39], v[132:135]
    ds_read_b64_tr_b16 v[94:95], v108 offset:61440
    s_waitcnt lgkmcnt(8)
    v_mfma_f32_16x16x32_bf16 v[136:139], v[48:51], v[40:43], v[136:139]
    ds_read_b128 v[64:67], v96 offset:49152
    v_mfma_f32_16x16x32_bf16 v[152:155], v[52:55], v[40:43], v[152:155]
    ds_read_b128 v[68:71], v96 offset:49408
    v_mfma_f32_16x16x32_bf16 v[168:171], v[56:59], v[40:43], v[168:171]
    ds_read_b128 v[72:75], v96 offset:51200
    v_mfma_f32_16x16x32_bf16 v[184:187], v[60:63], v[40:43], v[184:187]
    ds_read_b128 v[76:79], v96 offset:51456
    v_mfma_f32_16x16x32_bf16 v[188:191], v[60:63], v[44:47], v[188:191]
    v_mfma_f32_16x16x32_bf16 v[172:175], v[56:59], v[44:47], v[172:175]
    v_mfma_f32_16x16x32_bf16 v[156:159], v[52:55], v[44:47], v[156:159]
    v_mfma_f32_16x16x32_bf16 v[140:143], v[48:51], v[44:47], v[140:143]
    s_waitcnt lgkmcnt(2)
    v_mfma_f32_16x16x32_bf16 v[128:131], v[80:83], v[64:67], v[128:131]
    ds_read_b64_tr_b16 v[48:49], v100 offset:8192
    v_mfma_f32_16x16x32_bf16 v[144:147], v[84:87], v[64:67], v[144:147]
    ds_read_b64_tr_b16 v[50:51], v100 offset:12288
    v_mfma_f32_16x16x32_bf16 v[160:163], v[88:91], v[64:67], v[160:163]
    ds_read_b64_tr_b16 v[52:53], v103 offset:8192
    v_mfma_f32_16x16x32_bf16 v[176:179], v[92:95], v[64:67], v[176:179]
    ds_read_b64_tr_b16 v[54:55], v103 offset:12288
    v_mfma_f32_16x16x32_bf16 v[180:183], v[92:95], v[68:71], v[180:183]
    ds_read_b64_tr_b16 v[56:57], v106 offset:8192
    v_mfma_f32_16x16x32_bf16 v[164:167], v[88:91], v[68:71], v[164:167]
    ds_read_b64_tr_b16 v[58:59], v106 offset:12288
    v_mfma_f32_16x16x32_bf16 v[148:151], v[84:87], v[68:71], v[148:151]
    ds_read_b64_tr_b16 v[60:61], v109 offset:8192
    v_mfma_f32_16x16x32_bf16 v[132:135], v[80:83], v[68:71], v[132:135]
    ds_read_b64_tr_b16 v[62:63], v109 offset:12288
    s_waitcnt lgkmcnt(8)
    v_mfma_f32_16x16x32_bf16 v[136:139], v[80:83], v[72:75], v[136:139]
    ds_read_b128 v[32:35], v97 offset:0
    v_mfma_f32_16x16x32_bf16 v[152:155], v[84:87], v[72:75], v[152:155]
    ds_read_b128 v[36:39], v97 offset:256
    v_mfma_f32_16x16x32_bf16 v[168:171], v[88:91], v[72:75], v[168:171]
    ds_read_b128 v[40:43], v97 offset:2048
    v_mfma_f32_16x16x32_bf16 v[184:187], v[92:95], v[72:75], v[184:187]
    ds_read_b128 v[44:47], v97 offset:2304
    v_mfma_f32_16x16x32_bf16 v[188:191], v[92:95], v[76:79], v[188:191]
    v_mfma_f32_16x16x32_bf16 v[172:175], v[88:91], v[76:79], v[172:175]
    v_mfma_f32_16x16x32_bf16 v[156:159], v[84:87], v[76:79], v[156:159]
    v_mfma_f32_16x16x32_bf16 v[140:143], v[80:83], v[76:79], v[140:143]
    s_barrier
    s_waitcnt lgkmcnt(2)
    v_mfma_f32_16x16x32_bf16 v[128:131], v[48:51], v[32:35], v[128:131]
    ds_read_b64_tr_b16 v[80:81], v100 offset:24576
    v_mfma_f32_16x16x32_bf16 v[144:147], v[52:55], v[32:35], v[144:147]
    ds_read_b64_tr_b16 v[82:83], v100 offset:28672
    v_mfma_f32_16x16x32_bf16 v[160:163], v[56:59], v[32:35], v[160:163]
    ds_read_b64_tr_b16 v[84:85], v103 offset:24576
    v_mfma_f32_16x16x32_bf16 v[176:179], v[60:63], v[32:35], v[176:179]
    ds_read_b64_tr_b16 v[86:87], v103 offset:28672
    v_mfma_f32_16x16x32_bf16 v[180:183], v[60:63], v[36:39], v[180:183]
    ds_read_b64_tr_b16 v[88:89], v106 offset:24576
    v_mfma_f32_16x16x32_bf16 v[164:167], v[56:59], v[36:39], v[164:167]
    ds_read_b64_tr_b16 v[90:91], v106 offset:28672
    v_mfma_f32_16x16x32_bf16 v[148:151], v[52:55], v[36:39], v[148:151]
    ds_read_b64_tr_b16 v[92:93], v109 offset:24576
    v_mfma_f32_16x16x32_bf16 v[132:135], v[48:51], v[36:39], v[132:135]
    ds_read_b64_tr_b16 v[94:95], v109 offset:28672
    s_waitcnt lgkmcnt(8)
    v_mfma_f32_16x16x32_bf16 v[136:139], v[48:51], v[40:43], v[136:139]
    ds_read_b128 v[64:67], v97 offset:16384
    v_mfma_f32_16x16x32_bf16 v[152:155], v[52:55], v[40:43], v[152:155]
    ds_read_b128 v[68:71], v97 offset:16640
    v_mfma_f32_16x16x32_bf16 v[168:171], v[56:59], v[40:43], v[168:171]
    ds_read_b128 v[72:75], v97 offset:18432
    v_mfma_f32_16x16x32_bf16 v[184:187], v[60:63], v[40:43], v[184:187]
    ds_read_b128 v[76:79], v97 offset:18688
    v_mfma_f32_16x16x32_bf16 v[188:191], v[60:63], v[44:47], v[188:191]
    v_mfma_f32_16x16x32_bf16 v[172:175], v[56:59], v[44:47], v[172:175]
    v_mfma_f32_16x16x32_bf16 v[156:159], v[52:55], v[44:47], v[156:159]
    v_mfma_f32_16x16x32_bf16 v[140:143], v[48:51], v[44:47], v[140:143]
    s_waitcnt lgkmcnt(2)
    v_mfma_f32_16x16x32_bf16 v[128:131], v[80:83], v[64:67], v[128:131]
    ds_read_b64_tr_b16 v[48:49], v112 offset:40960
    v_mfma_f32_16x16x32_bf16 v[144:147], v[84:87], v[64:67], v[144:147]
    ds_read_b64_tr_b16 v[50:51], v112 offset:43008
    v_mfma_f32_16x16x32_bf16 v[160:163], v[88:91], v[64:67], v[160:163]
    ds_read_b64_tr_b16 v[52:53], v115 offset:40960
    v_mfma_f32_16x16x32_bf16 v[176:179], v[92:95], v[64:67], v[176:179]
    ds_read_b64_tr_b16 v[54:55], v115 offset:43008
    v_mfma_f32_16x16x32_bf16 v[180:183], v[92:95], v[68:71], v[180:183]
    ds_read_b128 v[32:35], v97 offset:32768
    v_mfma_f32_16x16x32_bf16 v[164:167], v[88:91], v[68:71], v[164:167]
    ds_read_b128 v[36:39], v97 offset:33024
    v_mfma_f32_16x16x32_bf16 v[148:151], v[84:87], v[68:71], v[148:151]
    ds_read_b128 v[40:43], v97 offset:34816
    v_mfma_f32_16x16x32_bf16 v[132:135], v[80:83], v[68:71], v[132:135]
    ds_read_b128 v[44:47], v97 offset:35072
    s_waitcnt lgkmcnt(8)
    v_mfma_f32_16x16x32_bf16 v[136:139], v[80:83], v[72:75], v[136:139]
    v_mfma_f32_16x16x32_bf16 v[152:155], v[84:87], v[72:75], v[152:155]
    v_mfma_f32_16x16x32_bf16 v[168:171], v[88:91], v[72:75], v[168:171]
    v_mfma_f32_16x16x32_bf16 v[184:187], v[92:95], v[72:75], v[184:187]
    v_mfma_f32_16x16x32_bf16 v[188:191], v[92:95], v[76:79], v[188:191]
    v_mfma_f32_16x16x32_bf16 v[172:175], v[88:91], v[76:79], v[172:175]
    v_mfma_f32_16x16x32_bf16 v[156:159], v[84:87], v[76:79], v[156:159]
    v_mfma_f32_16x16x32_bf16 v[140:143], v[80:83], v[76:79], v[140:143]
    s_barrier
    s_waitcnt lgkmcnt(2)
    v_mfma_f32_16x16x32_bf16 v[128:131], v[48:51], v[32:35], v[128:131]
    ds_read_b64_tr_b16 v[80:81], v112 offset:53248
    v_mfma_f32_16x16x32_bf16 v[144:147], v[52:55], v[32:35], v[144:147]
    ds_read_b64_tr_b16 v[82:83], v112 offset:55296
    v_mfma_f32_16x16x32_bf16 v[148:151], v[52:55], v[36:39], v[148:151]
    ds_read_b64_tr_b16 v[84:85], v115 offset:53248
    v_mfma_f32_16x16x32_bf16 v[132:135], v[48:51], v[36:39], v[132:135]
    ds_read_b64_tr_b16 v[86:87], v115 offset:55296
    s_waitcnt lgkmcnt(4)
    v_mfma_f32_16x16x32_bf16 v[136:139], v[48:51], v[40:43], v[136:139]
    ds_read_b128 v[64:67], v97 offset:45056
    v_mfma_f32_16x16x32_bf16 v[152:155], v[52:55], v[40:43], v[152:155]
    ds_read_b128 v[68:71], v97 offset:45312
    v_mfma_f32_16x16x32_bf16 v[156:159], v[52:55], v[44:47], v[156:159]
    ds_read_b128 v[72:75], v97 offset:47104
    v_mfma_f32_16x16x32_bf16 v[140:143], v[48:51], v[44:47], v[140:143]
    ds_read_b128 v[76:79], v97 offset:47360
    s_waitcnt lgkmcnt(2)
    v_mfma_f32_16x16x32_bf16 v[128:131], v[80:83], v[64:67], v[128:131]
    ds_read_b64_tr_b16 v[48:49], v113 offset:8192
    v_mfma_f32_16x16x32_bf16 v[144:147], v[84:87], v[64:67], v[144:147]
    ds_read_b64_tr_b16 v[50:51], v113 offset:10240
    v_mfma_f32_16x16x32_bf16 v[148:151], v[84:87], v[68:71], v[148:151]
    ds_read_b64_tr_b16 v[52:53], v116 offset:8192
    v_mfma_f32_16x16x32_bf16 v[132:135], v[80:83], v[68:71], v[132:135]
    ds_read_b64_tr_b16 v[54:55], v116 offset:10240
    s_waitcnt lgkmcnt(4)
    v_mfma_f32_16x16x32_bf16 v[136:139], v[80:83], v[72:75], v[136:139]
    ds_read_b128 v[32:35], v98 offset:0
    v_mfma_f32_16x16x32_bf16 v[152:155], v[84:87], v[72:75], v[152:155]
    ds_read_b128 v[36:39], v98 offset:256
    v_cvt_pk_bf16_f32 v160, v160, v161
    v_cvt_pk_bf16_f32 v161, v162, v163
    v_cvt_pk_bf16_f32 v162, v164, v165
    v_cvt_pk_bf16_f32 v163, v166, v167
    v_mfma_f32_16x16x32_bf16 v[156:159], v[84:87], v[76:79], v[156:159]
    ds_read_b128 v[40:43], v98 offset:2048
    v_cvt_pk_bf16_f32 v168, v168, v169
    v_cvt_pk_bf16_f32 v169, v170, v171
    v_cvt_pk_bf16_f32 v170, v172, v173
    v_cvt_pk_bf16_f32 v171, v174, v175
    v_mfma_f32_16x16x32_bf16 v[140:143], v[80:83], v[76:79], v[140:143]
    ds_read_b128 v[44:47], v98 offset:2304
    buffer_store_dwordx4 v[160:163], v19, s[96:99], s22 offen offset:0 sc1
    s_barrier
    s_waitcnt lgkmcnt(2)
    v_mfma_f32_16x16x32_bf16 v[128:131], v[48:51], v[32:35], v[128:131]
    ds_read_b64_tr_b16 v[80:81], v113 offset:20480
    v_mfma_f32_16x16x32_bf16 v[144:147], v[52:55], v[32:35], v[144:147]
    ds_read_b64_tr_b16 v[82:83], v113 offset:22528
    v_mfma_f32_16x16x32_bf16 v[148:151], v[52:55], v[36:39], v[148:151]
    ds_read_b64_tr_b16 v[84:85], v116 offset:20480
    v_mfma_f32_16x16x32_bf16 v[132:135], v[48:51], v[36:39], v[132:135]
    ds_read_b64_tr_b16 v[86:87], v116 offset:22528
    s_waitcnt lgkmcnt(4)
    v_mfma_f32_16x16x32_bf16 v[136:139], v[48:51], v[40:43], v[136:139]
    ds_read_b128 v[64:67], v98 offset:12288
    v_mfma_f32_16x16x32_bf16 v[152:155], v[52:55], v[40:43], v[152:155]
    ds_read_b128 v[68:71], v98 offset:12544
    v_mfma_f32_16x16x32_bf16 v[156:159], v[52:55], v[44:47], v[156:159]
    ds_read_b128 v[72:75], v98 offset:14336
    v_cvt_pk_bf16_f32 v176, v176, v177
    v_cvt_pk_bf16_f32 v177, v178, v179
    v_cvt_pk_bf16_f32 v178, v180, v181
    v_cvt_pk_bf16_f32 v179, v182, v183
    v_mfma_f32_16x16x32_bf16 v[140:143], v[48:51], v[44:47], v[140:143]
    ds_read_b128 v[76:79], v98 offset:14592
    buffer_store_dwordx4 v[168:171], v19, s[96:99], s22 offen offset:1024 sc1
    s_waitcnt lgkmcnt(2)
    v_mfma_f32_16x16x32_bf16 v[128:131], v[80:83], v[64:67], v[128:131]
    ds_read_b64_tr_b16 v[48:49], v111 offset:8192
    v_mfma_f32_16x16x32_bf16 v[144:147], v[84:87], v[64:67], v[144:147]
    ds_read_b64_tr_b16 v[50:51], v111 offset:10240
    v_mfma_f32_16x16x32_bf16 v[148:151], v[84:87], v[68:71], v[148:151]
    ds_read_b64_tr_b16 v[52:53], v114 offset:8192
    v_mfma_f32_16x16x32_bf16 v[132:135], v[80:83], v[68:71], v[132:135]
    ds_read_b64_tr_b16 v[54:55], v114 offset:10240
    s_waitcnt lgkmcnt(4)
    v_mfma_f32_16x16x32_bf16 v[136:139], v[80:83], v[72:75], v[136:139]
    ds_read_b128 v[32:35], v96 offset:0
    v_mfma_f32_16x16x32_bf16 v[152:155], v[84:87], v[72:75], v[152:155]
    ds_read_b128 v[36:39], v96 offset:256
    v_mfma_f32_16x16x32_bf16 v[156:159], v[84:87], v[76:79], v[156:159]
    ds_read_b128 v[40:43], v96 offset:2048
    v_cvt_pk_bf16_f32 v184, v184, v185
    v_cvt_pk_bf16_f32 v185, v186, v187
    v_cvt_pk_bf16_f32 v186, v188, v189
    v_cvt_pk_bf16_f32 v187, v190, v191
    v_mfma_f32_16x16x32_bf16 v[140:143], v[80:83], v[76:79], v[140:143]
    ds_read_b128 v[44:47], v96 offset:2304
    buffer_store_dwordx4 v[176:179], v19, s[96:99], s22 offen offset:2048 sc1
    s_barrier
    s_waitcnt lgkmcnt(2)
    v_mfma_f32_16x16x32_bf16 v[128:131], v[48:51], v[32:35], v[128:131]
    ds_read_b64_tr_b16 v[80:81], v111 offset:20480
    v_mfma_f32_16x16x32_bf16 v[144:147], v[52:55], v[32:35], v[144:147]
    ds_read_b64_tr_b16 v[82:83], v111 offset:22528
    v_mfma_f32_16x16x32_bf16 v[148:151], v[52:55], v[36:39], v[148:151]
    ds_read_b64_tr_b16 v[84:85], v114 offset:20480
    v_mfma_f32_16x16x32_bf16 v[132:135], v[48:51], v[36:39], v[132:135]
    ds_read_b64_tr_b16 v[86:87], v114 offset:22528
    s_waitcnt lgkmcnt(4)
    v_mfma_f32_16x16x32_bf16 v[136:139], v[48:51], v[40:43], v[136:139]
    ds_read_b128 v[64:67], v96 offset:12288
    v_mfma_f32_16x16x32_bf16 v[152:155], v[52:55], v[40:43], v[152:155]
    ds_read_b128 v[68:71], v96 offset:12544
    v_mfma_f32_16x16x32_bf16 v[156:159], v[52:55], v[44:47], v[156:159]
    ds_read_b128 v[72:75], v96 offset:14336
    v_mfma_f32_16x16x32_bf16 v[140:143], v[48:51], v[44:47], v[140:143]
    ds_read_b128 v[76:79], v96 offset:14592
    buffer_store_dwordx4 v[184:187], v19, s[96:99], s22 offen offset:3072 sc1
    s_waitcnt lgkmcnt(2)
    v_mfma_f32_16x16x32_bf16 v[128:131], v[80:83], v[64:67], v[128:131]
    ds_read_b64_tr_b16 v[48:49], v111 offset:32768
    v_mfma_f32_16x16x32_bf16 v[144:147], v[84:87], v[64:67], v[144:147]
    ds_read_b64_tr_b16 v[50:51], v111 offset:34816
    v_mfma_f32_16x16x32_bf16 v[148:151], v[84:87], v[68:71], v[148:151]
    ds_read_b64_tr_b16 v[52:53], v114 offset:32768
    v_mfma_f32_16x16x32_bf16 v[132:135], v[80:83], v[68:71], v[132:135]
    ds_read_b64_tr_b16 v[54:55], v114 offset:34816
    s_waitcnt lgkmcnt(4)
    v_mfma_f32_16x16x32_bf16 v[136:139], v[80:83], v[72:75], v[136:139]
    ds_read_b128 v[32:35], v96 offset:24576
    v_mfma_f32_16x16x32_bf16 v[152:155], v[84:87], v[72:75], v[152:155]
    ds_read_b128 v[36:39], v96 offset:24832
    v_mfma_f32_16x16x32_bf16 v[156:159], v[84:87], v[76:79], v[156:159]
    ds_read_b128 v[40:43], v96 offset:26624
    v_mfma_f32_16x16x32_bf16 v[140:143], v[80:83], v[76:79], v[140:143]
    ds_read_b128 v[44:47], v96 offset:26880
    s_barrier
    s_waitcnt lgkmcnt(2)
    v_mfma_f32_16x16x32_bf16 v[128:131], v[48:51], v[32:35], v[128:131]
    ds_read_b64_tr_b16 v[80:81], v111 offset:45056
    v_mfma_f32_16x16x32_bf16 v[144:147], v[52:55], v[32:35], v[144:147]
    ds_read_b64_tr_b16 v[82:83], v111 offset:47104
    v_mfma_f32_16x16x32_bf16 v[148:151], v[52:55], v[36:39], v[148:151]
    ds_read_b64_tr_b16 v[84:85], v114 offset:45056
    v_mfma_f32_16x16x32_bf16 v[132:135], v[48:51], v[36:39], v[132:135]
    ds_read_b64_tr_b16 v[86:87], v114 offset:47104
    s_waitcnt lgkmcnt(4)
    v_mfma_f32_16x16x32_bf16 v[136:139], v[48:51], v[40:43], v[136:139]
    ds_read_b128 v[64:67], v96 offset:36864
    v_mfma_f32_16x16x32_bf16 v[152:155], v[52:55], v[40:43], v[152:155]
    ds_read_b128 v[68:71], v96 offset:37120
    v_mfma_f32_16x16x32_bf16 v[156:159], v[52:55], v[44:47], v[156:159]
    ds_read_b128 v[72:75], v96 offset:38912
    v_mfma_f32_16x16x32_bf16 v[140:143], v[48:51], v[44:47], v[140:143]
    ds_read_b128 v[76:79], v96 offset:39168
    s_waitcnt lgkmcnt(2)
    v_mfma_f32_16x16x32_bf16 v[128:131], v[80:83], v[64:67], v[128:131]
    ds_read_b64_tr_b16 v[48:49], v111 offset:57344
    v_mfma_f32_16x16x32_bf16 v[144:147], v[84:87], v[64:67], v[144:147]
    ds_read_b64_tr_b16 v[50:51], v111 offset:59392
    v_mfma_f32_16x16x32_bf16 v[148:151], v[84:87], v[68:71], v[148:151]
    ds_read_b64_tr_b16 v[52:53], v114 offset:57344
    v_mfma_f32_16x16x32_bf16 v[132:135], v[80:83], v[68:71], v[132:135]
    ds_read_b64_tr_b16 v[54:55], v114 offset:59392
    s_waitcnt lgkmcnt(4)
    v_mfma_f32_16x16x32_bf16 v[136:139], v[80:83], v[72:75], v[136:139]
    ds_read_b128 v[32:35], v96 offset:49152
    v_mfma_f32_16x16x32_bf16 v[152:155], v[84:87], v[72:75], v[152:155]
    ds_read_b128 v[36:39], v96 offset:49408
    v_mfma_f32_16x16x32_bf16 v[156:159], v[84:87], v[76:79], v[156:159]
    ds_read_b128 v[40:43], v96 offset:51200
    v_mfma_f32_16x16x32_bf16 v[140:143], v[80:83], v[76:79], v[140:143]
    ds_read_b128 v[44:47], v96 offset:51456
    s_waitcnt vmcnt(0)
    s_barrier
    s_waitcnt lgkmcnt(2)
    v_mfma_f32_16x16x32_bf16 v[128:131], v[48:51], v[32:35], v[128:131]
    ds_read_b64_tr_b16 v[80:81], v112 offset:8192
    v_mfma_f32_16x16x32_bf16 v[144:147], v[52:55], v[32:35], v[144:147]
    ds_read_b64_tr_b16 v[82:83], v112 offset:10240
    v_mfma_f32_16x16x32_bf16 v[148:151], v[52:55], v[36:39], v[148:151]
    ds_read_b64_tr_b16 v[84:85], v115 offset:8192
    v_mfma_f32_16x16x32_bf16 v[132:135], v[48:51], v[36:39], v[132:135]
    ds_read_b64_tr_b16 v[86:87], v115 offset:10240
    s_waitcnt lgkmcnt(4)
    v_mfma_f32_16x16x32_bf16 v[136:139], v[48:51], v[40:43], v[136:139]
    ds_read_b128 v[64:67], v97 offset:0
    v_mfma_f32_16x16x32_bf16 v[152:155], v[52:55], v[40:43], v[152:155]
    ds_read_b128 v[68:71], v97 offset:256
    v_mfma_f32_16x16x32_bf16 v[156:159], v[52:55], v[44:47], v[156:159]
    ds_read_b128 v[72:75], v97 offset:2048
    v_mfma_f32_16x16x32_bf16 v[140:143], v[48:51], v[44:47], v[140:143]
    ds_read_b128 v[76:79], v97 offset:2304
    s_waitcnt lgkmcnt(2)
    v_mfma_f32_16x16x32_bf16 v[128:131], v[80:83], v[64:67], v[128:131]
    ds_read_b64_tr_b16 v[48:49], v112 offset:20480
    v_mfma_f32_16x16x32_bf16 v[144:147], v[84:87], v[64:67], v[144:147]
    ds_read_b64_tr_b16 v[50:51], v112 offset:22528
    v_mfma_f32_16x16x32_bf16 v[148:151], v[84:87], v[68:71], v[148:151]
    ds_read_b64_tr_b16 v[52:53], v115 offset:20480
    v_mfma_f32_16x16x32_bf16 v[132:135], v[80:83], v[68:71], v[132:135]
    ds_read_b64_tr_b16 v[54:55], v115 offset:22528
    s_waitcnt lgkmcnt(4)
    v_mfma_f32_16x16x32_bf16 v[136:139], v[80:83], v[72:75], v[136:139]
    ds_read_b128 v[32:35], v97 offset:12288
    v_mfma_f32_16x16x32_bf16 v[152:155], v[84:87], v[72:75], v[152:155]
    ds_read_b128 v[36:39], v97 offset:12544
    v_mfma_f32_16x16x32_bf16 v[156:159], v[84:87], v[76:79], v[156:159]
    ds_read_b128 v[40:43], v97 offset:14336
    v_mfma_f32_16x16x32_bf16 v[140:143], v[80:83], v[76:79], v[140:143]
    ds_read_b128 v[44:47], v97 offset:14592
    s_barrier
    s_waitcnt lgkmcnt(2)
    v_mfma_f32_16x16x32_bf16 v[128:131], v[48:51], v[32:35], v[128:131]
    ds_read_b64_tr_b16 v[80:81], v112 offset:32768
    v_mfma_f32_16x16x32_bf16 v[144:147], v[52:55], v[32:35], v[144:147]
    ds_read_b64_tr_b16 v[82:83], v112 offset:34816
    v_mfma_f32_16x16x32_bf16 v[148:151], v[52:55], v[36:39], v[148:151]
    ds_read_b64_tr_b16 v[84:85], v115 offset:32768
    v_mfma_f32_16x16x32_bf16 v[132:135], v[48:51], v[36:39], v[132:135]
    ds_read_b64_tr_b16 v[86:87], v115 offset:34816
    s_waitcnt lgkmcnt(4)
    v_mfma_f32_16x16x32_bf16 v[136:139], v[48:51], v[40:43], v[136:139]
    ds_read_b128 v[64:67], v97 offset:24576
    v_mfma_f32_16x16x32_bf16 v[152:155], v[52:55], v[40:43], v[152:155]
    ds_read_b128 v[68:71], v97 offset:24832
    v_mfma_f32_16x16x32_bf16 v[156:159], v[52:55], v[44:47], v[156:159]
    ds_read_b128 v[72:75], v97 offset:26624
    v_mfma_f32_16x16x32_bf16 v[140:143], v[48:51], v[44:47], v[140:143]
    ds_read_b128 v[76:79], v97 offset:26880
    s_waitcnt lgkmcnt(2)
    v_mfma_f32_16x16x32_bf16 v[128:131], v[80:83], v[64:67], v[128:131]
    ds_read_b64_tr_b16 v[48:49], v112 offset:45056
    v_mfma_f32_16x16x32_bf16 v[144:147], v[84:87], v[64:67], v[144:147]
    ds_read_b64_tr_b16 v[50:51], v112 offset:47104
    v_mfma_f32_16x16x32_bf16 v[148:151], v[84:87], v[68:71], v[148:151]
    ds_read_b64_tr_b16 v[52:53], v115 offset:45056
    v_mfma_f32_16x16x32_bf16 v[132:135], v[80:83], v[68:71], v[132:135]
    ds_read_b64_tr_b16 v[54:55], v115 offset:47104
    s_waitcnt lgkmcnt(4)
    v_mfma_f32_16x16x32_bf16 v[136:139], v[80:83], v[72:75], v[136:139]
    ds_read_b128 v[32:35], v97 offset:36864
    v_mfma_f32_16x16x32_bf16 v[152:155], v[84:87], v[72:75], v[152:155]
    ds_read_b128 v[36:39], v97 offset:37120
    v_mfma_f32_16x16x32_bf16 v[156:159], v[84:87], v[76:79], v[156:159]
    ds_read_b128 v[40:43], v97 offset:38912
    v_mfma_f32_16x16x32_bf16 v[140:143], v[80:83], v[76:79], v[140:143]
    ds_read_b128 v[44:47], v97 offset:39168
    s_barrier
    s_waitcnt lgkmcnt(2)
    v_mfma_f32_16x16x32_bf16 v[128:131], v[48:51], v[32:35], v[128:131]
    ds_read_b64_tr_b16 v[80:81], v112 offset:57344
    v_mfma_f32_16x16x32_bf16 v[144:147], v[52:55], v[32:35], v[144:147]
    ds_read_b64_tr_b16 v[82:83], v112 offset:59392
    v_mfma_f32_16x16x32_bf16 v[148:151], v[52:55], v[36:39], v[148:151]
    ds_read_b64_tr_b16 v[84:85], v115 offset:57344
    v_mfma_f32_16x16x32_bf16 v[132:135], v[48:51], v[36:39], v[132:135]
    ds_read_b64_tr_b16 v[86:87], v115 offset:59392
    s_waitcnt lgkmcnt(4)
    v_mfma_f32_16x16x32_bf16 v[136:139], v[48:51], v[40:43], v[136:139]
    ds_read_b128 v[64:67], v97 offset:49152
    v_mfma_f32_16x16x32_bf16 v[152:155], v[52:55], v[40:43], v[152:155]
    ds_read_b128 v[68:71], v97 offset:49408
    v_mfma_f32_16x16x32_bf16 v[156:159], v[52:55], v[44:47], v[156:159]
    ds_read_b128 v[72:75], v97 offset:51200
    v_mfma_f32_16x16x32_bf16 v[140:143], v[48:51], v[44:47], v[140:143]
    ds_read_b128 v[76:79], v97 offset:51456
    s_waitcnt lgkmcnt(2)
    v_mfma_f32_16x16x32_bf16 v[128:131], v[80:83], v[64:67], v[128:131]
    ds_read_b64_tr_b16 v[48:49], v113 offset:8192
    v_mfma_f32_16x16x32_bf16 v[144:147], v[84:87], v[64:67], v[144:147]
    ds_read_b64_tr_b16 v[50:51], v113 offset:10240
    v_mfma_f32_16x16x32_bf16 v[148:151], v[84:87], v[68:71], v[148:151]
    ds_read_b64_tr_b16 v[52:53], v116 offset:8192
    v_mfma_f32_16x16x32_bf16 v[132:135], v[80:83], v[68:71], v[132:135]
    ds_read_b64_tr_b16 v[54:55], v116 offset:10240
    s_waitcnt lgkmcnt(4)
    v_mfma_f32_16x16x32_bf16 v[136:139], v[80:83], v[72:75], v[136:139]
    ds_read_b128 v[32:35], v98 offset:0
    v_mfma_f32_16x16x32_bf16 v[152:155], v[84:87], v[72:75], v[152:155]
    ds_read_b128 v[36:39], v98 offset:256
    v_mfma_f32_16x16x32_bf16 v[156:159], v[84:87], v[76:79], v[156:159]
    ds_read_b128 v[40:43], v98 offset:2048
    v_mfma_f32_16x16x32_bf16 v[140:143], v[80:83], v[76:79], v[140:143]
    ds_read_b128 v[44:47], v98 offset:2304
    s_barrier
    s_waitcnt lgkmcnt(2)
    v_mfma_f32_16x16x32_bf16 v[128:131], v[48:51], v[32:35], v[128:131]
    ds_read_b64_tr_b16 v[80:81], v113 offset:20480
    v_mfma_f32_16x16x32_bf16 v[144:147], v[52:55], v[32:35], v[144:147]
    ds_read_b64_tr_b16 v[82:83], v113 offset:22528
    v_mfma_f32_16x16x32_bf16 v[148:151], v[52:55], v[36:39], v[148:151]
    ds_read_b64_tr_b16 v[84:85], v116 offset:20480
    v_mfma_f32_16x16x32_bf16 v[132:135], v[48:51], v[36:39], v[132:135]
    ds_read_b64_tr_b16 v[86:87], v116 offset:22528
    s_waitcnt lgkmcnt(4)
    v_mfma_f32_16x16x32_bf16 v[136:139], v[48:51], v[40:43], v[136:139]
    ds_read_b128 v[64:67], v98 offset:12288
    v_mfma_f32_16x16x32_bf16 v[152:155], v[52:55], v[40:43], v[152:155]
    ds_read_b128 v[68:71], v98 offset:12544
    v_mfma_f32_16x16x32_bf16 v[156:159], v[52:55], v[44:47], v[156:159]
    ds_read_b128 v[72:75], v98 offset:14336
    buffer_load_dwordx4 v[196:199], v19, s[96:99], s57 offen offset:1024 sc1
    v_mfma_f32_16x16x32_bf16 v[140:143], v[48:51], v[44:47], v[140:143]
    ds_read_b128 v[76:79], v98 offset:14592
    buffer_load_dwordx4 v[192:195], v19, s[96:99], s57 offen offset:0 sc1
    s_waitcnt lgkmcnt(2)
    v_mfma_f32_16x16x32_bf16 v[128:131], v[80:83], v[64:67], v[128:131]
    ds_read_b64_tr_b16 v[48:49], v111 offset:8192
    v_mfma_f32_16x16x32_bf16 v[144:147], v[84:87], v[64:67], v[144:147]
    ds_read_b64_tr_b16 v[50:51], v111 offset:10240
    v_mfma_f32_16x16x32_bf16 v[148:151], v[84:87], v[68:71], v[148:151]
    ds_read_b64_tr_b16 v[52:53], v114 offset:8192
    v_mfma_f32_16x16x32_bf16 v[132:135], v[80:83], v[68:71], v[132:135]
    ds_read_b64_tr_b16 v[54:55], v114 offset:10240
    s_waitcnt lgkmcnt(4)
    v_mfma_f32_16x16x32_bf16 v[136:139], v[80:83], v[72:75], v[136:139]
    ds_read_b128 v[32:35], v96 offset:0
    v_mfma_f32_16x16x32_bf16 v[152:155], v[84:87], v[72:75], v[152:155]
    ds_read_b128 v[36:39], v96 offset:256
    v_mfma_f32_16x16x32_bf16 v[156:159], v[84:87], v[76:79], v[156:159]
    ds_read_b128 v[40:43], v96 offset:2048
    buffer_load_dwordx4 v[204:207], v19, s[96:99], s57 offen offset:3072 sc1
    v_mfma_f32_16x16x32_bf16 v[140:143], v[80:83], v[76:79], v[140:143]
    ds_read_b128 v[44:47], v96 offset:2304
    buffer_load_dwordx4 v[200:203], v19, s[96:99], s57 offen offset:2048 sc1
    s_barrier
    s_waitcnt lgkmcnt(2)
    v_mfma_f32_16x16x32_bf16 v[128:131], v[48:51], v[32:35], v[128:131]
    ds_read_b64_tr_b16 v[80:81], v111 offset:20480
    v_mfma_f32_16x16x32_bf16 v[144:147], v[52:55], v[32:35], v[144:147]
    ds_read_b64_tr_b16 v[82:83], v111 offset:22528
    v_mfma_f32_16x16x32_bf16 v[148:151], v[52:55], v[36:39], v[148:151]
    ds_read_b64_tr_b16 v[84:85], v114 offset:20480
    v_mfma_f32_16x16x32_bf16 v[132:135], v[48:51], v[36:39], v[132:135]
    ds_read_b64_tr_b16 v[86:87], v114 offset:22528
    s_waitcnt lgkmcnt(4)
    v_mfma_f32_16x16x32_bf16 v[136:139], v[48:51], v[40:43], v[136:139]
    ds_read_b128 v[64:67], v96 offset:12288
    v_mfma_f32_16x16x32_bf16 v[152:155], v[52:55], v[40:43], v[152:155]
    ds_read_b128 v[68:71], v96 offset:12544
    v_mfma_f32_16x16x32_bf16 v[156:159], v[52:55], v[44:47], v[156:159]
    ds_read_b128 v[72:75], v96 offset:14336
    v_mfma_f32_16x16x32_bf16 v[140:143], v[48:51], v[44:47], v[140:143]
    ds_read_b128 v[76:79], v96 offset:14592
    s_waitcnt lgkmcnt(2)
    v_mfma_f32_16x16x32_bf16 v[128:131], v[80:83], v[64:67], v[128:131]
    ds_read_b64_tr_b16 v[48:49], v111 offset:32768
    v_mfma_f32_16x16x32_bf16 v[144:147], v[84:87], v[64:67], v[144:147]
    ds_read_b64_tr_b16 v[50:51], v111 offset:34816
    v_mfma_f32_16x16x32_bf16 v[148:151], v[84:87], v[68:71], v[148:151]
    ds_read_b64_tr_b16 v[52:53], v114 offset:32768
    v_mfma_f32_16x16x32_bf16 v[132:135], v[80:83], v[68:71], v[132:135]
    ds_read_b64_tr_b16 v[54:55], v114 offset:34816
    s_waitcnt lgkmcnt(4)
    v_mfma_f32_16x16x32_bf16 v[136:139], v[80:83], v[72:75], v[136:139]
    ds_read_b128 v[32:35], v96 offset:24576
    v_mfma_f32_16x16x32_bf16 v[152:155], v[84:87], v[72:75], v[152:155]
    ds_read_b128 v[36:39], v96 offset:24832
    v_mfma_f32_16x16x32_bf16 v[156:159], v[84:87], v[76:79], v[156:159]
    ds_read_b128 v[40:43], v96 offset:26624
    v_mfma_f32_16x16x32_bf16 v[140:143], v[80:83], v[76:79], v[140:143]
    ds_read_b128 v[44:47], v96 offset:26880
    s_barrier
    s_waitcnt lgkmcnt(2)
    v_mfma_f32_16x16x32_bf16 v[128:131], v[48:51], v[32:35], v[128:131]
    ds_read_b64_tr_b16 v[80:81], v111 offset:45056
    v_mfma_f32_16x16x32_bf16 v[144:147], v[52:55], v[32:35], v[144:147]
    ds_read_b64_tr_b16 v[82:83], v111 offset:47104
    v_mfma_f32_16x16x32_bf16 v[148:151], v[52:55], v[36:39], v[148:151]
    ds_read_b64_tr_b16 v[84:85], v114 offset:45056
    v_mfma_f32_16x16x32_bf16 v[132:135], v[48:51], v[36:39], v[132:135]
    ds_read_b64_tr_b16 v[86:87], v114 offset:47104
    s_waitcnt lgkmcnt(4)
    v_mfma_f32_16x16x32_bf16 v[136:139], v[48:51], v[40:43], v[136:139]
    ds_read_b128 v[64:67], v96 offset:36864
    v_mfma_f32_16x16x32_bf16 v[152:155], v[52:55], v[40:43], v[152:155]
    ds_read_b128 v[68:71], v96 offset:37120
    v_mfma_f32_16x16x32_bf16 v[156:159], v[52:55], v[44:47], v[156:159]
    ds_read_b128 v[72:75], v96 offset:38912
    v_mfma_f32_16x16x32_bf16 v[140:143], v[48:51], v[44:47], v[140:143]
    ds_read_b128 v[76:79], v96 offset:39168
    s_waitcnt lgkmcnt(2)
    v_mfma_f32_16x16x32_bf16 v[128:131], v[80:83], v[64:67], v[128:131]
    v_mfma_f32_16x16x32_bf16 v[144:147], v[84:87], v[64:67], v[144:147]
    v_mfma_f32_16x16x32_bf16 v[148:151], v[84:87], v[68:71], v[148:151]
    v_mfma_f32_16x16x32_bf16 v[132:135], v[80:83], v[68:71], v[132:135]
    s_waitcnt lgkmcnt(0)
    v_mfma_f32_16x16x32_bf16 v[136:139], v[80:83], v[72:75], v[136:139]
    v_mfma_f32_16x16x32_bf16 v[152:155], v[84:87], v[72:75], v[152:155]
    v_mfma_f32_16x16x32_bf16 v[156:159], v[84:87], v[76:79], v[156:159]
    v_mfma_f32_16x16x32_bf16 v[140:143], v[80:83], v[76:79], v[140:143]
    s_branch P3_GE
P3_G1:
    s_barrier
    s_waitcnt lgkmcnt(2)
    v_mfma_f32_16x16x32_bf16 v[128:131], v[48:51], v[32:35], v[128:131]
    ds_read_b64_tr_b16 v[80:81], v99 offset:24576
    v_mfma_f32_16x16x32_bf16 v[144:147], v[52:55], v[32:35], v[144:147]
    ds_read_b64_tr_b16 v[82:83], v99 offset:28672
    v_mfma_f32_16x16x32_bf16 v[160:163], v[56:59], v[32:35], v[160:163]
    ds_read_b64_tr_b16 v[84:85], v102 offset:24576
    v_mfma_f32_16x16x32_bf16 v[176:179], v[60:63], v[32:35], v[176:179]
    ds_read_b64_tr_b16 v[86:87], v102 offset:28672
    v_mfma_f32_16x16x32_bf16 v[180:183], v[60:63], v[36:39], v[180:183]
    ds_read_b64_tr_b16 v[88:89], v105 offset:24576
    v_mfma_f32_16x16x32_bf16 v[164:167], v[56:59], v[36:39], v[164:167]
    ds_read_b64_tr_b16 v[90:91], v105 offset:28672
    v_mfma_f32_16x16x32_bf16 v[148:151], v[52:55], v[36:39], v[148:151]
    ds_read_b64_tr_b16 v[92:93], v108 offset:24576
    v_mfma_f32_16x16x32_bf16 v[132:135], v[48:51], v[36:39], v[132:135]
    ds_read_b64_tr_b16 v[94:95], v108 offset:28672
    s_waitcnt lgkmcnt(8)
    v_mfma_f32_16x16x32_bf16 v[136:139], v[48:51], v[40:43], v[136:139]
    ds_read_b128 v[64:67], v96 offset:16384
    v_mfma_f32_16x16x32_bf16 v[152:155], v[52:55], v[40:43], v[152:155]
    ds_read_b128 v[68:71], v96 offset:16640
    v_mfma_f32_16x16x32_bf16 v[168:171], v[56:59], v[40:43], v[168:171]
    ds_read_b128 v[72:75], v96 offset:18432
    v_mfma_f32_16x16x32_bf16 v[184:187], v[60:63], v[40:43], v[184:187]
    ds_read_b128 v[76:79], v96 offset:18688
    v_mfma_f32_16x16x32_bf16 v[188:191], v[60:63], v[44:47], v[188:191]
    v_mfma_f32_16x16x32_bf16 v[172:175], v[56:59], v[44:47], v[172:175]
    v_mfma_f32_16x16x32_bf16 v[156:159], v[52:55], v[44:47], v[156:159]
    v_mfma_f32_16x16x32_bf16 v[140:143], v[48:51], v[44:47], v[140:143]
    s_waitcnt lgkmcnt(2)
    v_mfma_f32_16x16x32_bf16 v[128:131], v[80:83], v[64:67], v[128:131]
    ds_read_b64_tr_b16 v[48:49], v99 offset:40960
    v_mfma_f32_16x16x32_bf16 v[144:147], v[84:87], v[64:67], v[144:147]
    ds_read_b64_tr_b16 v[50:51], v99 offset:45056
    v_mfma_f32_16x16x32_bf16 v[160:163], v[88:91], v[64:67], v[160:163]
    ds_read_b64_tr_b16 v[52:53], v102 offset:40960
    v_mfma_f32_16x16x32_bf16 v[176:179], v[92:95], v[64:67], v[176:179]
    ds_read_b64_tr_b16 v[54:55], v102 offset:45056
    v_mfma_f32_16x16x32_bf16 v[180:183], v[92:95], v[68:71], v[180:183]
    ds_read_b64_tr_b16 v[56:57], v105 offset:40960
    v_mfma_f32_16x16x32_bf16 v[164:167], v[88:91], v[68:71], v[164:167]
    ds_read_b64_tr_b16 v[58:59], v105 offset:45056
    v_mfma_f32_16x16x32_bf16 v[148:151], v[84:87], v[68:71], v[148:151]
    ds_read_b64_tr_b16 v[60:61], v108 offset:40960
    v_mfma_f32_16x16x32_bf16 v[132:135], v[80:83], v[68:71], v[132:135]
    ds_read_b64_tr_b16 v[62:63], v108 offset:45056
    s_waitcnt lgkmcnt(8)
    v_mfma_f32_16x16x32_bf16 v[136:139], v[80:83], v[72:75], v[136:139]
    ds_read_b128 v[32:35], v96 offset:32768
    v_mfma_f32_16x16x32_bf16 v[152:155], v[84:87], v[72:75], v[152:155]
    ds_read_b128 v[36:39], v96 offset:33024
    v_mfma_f32_16x16x32_bf16 v[168:171], v[88:91], v[72:75], v[168:171]
    ds_read_b128 v[40:43], v96 offset:34816
    v_mfma_f32_16x16x32_bf16 v[184:187], v[92:95], v[72:75], v[184:187]
    ds_read_b128 v[44:47], v96 offset:35072
    v_mfma_f32_16x16x32_bf16 v[188:191], v[92:95], v[76:79], v[188:191]
    v_mfma_f32_16x16x32_bf16 v[172:175], v[88:91], v[76:79], v[172:175]
    v_mfma_f32_16x16x32_bf16 v[156:159], v[84:87], v[76:79], v[156:159]
    v_mfma_f32_16x16x32_bf16 v[140:143], v[80:83], v[76:79], v[140:143]
    s_barrier
    s_waitcnt lgkmcnt(2)
    v_mfma_f32_16x16x32_bf16 v[128:131], v[48:51], v[32:35], v[128:131]
    ds_read_b64_tr_b16 v[80:81], v99 offset:57344
    v_mfma_f32_16x16x32_bf16 v[144:147], v[52:55], v[32:35], v[144:147]
    ds_read_b64_tr_b16 v[82:83], v99 offset:61440
    v_mfma_f32_16x16x32_bf16 v[160:163], v[56:59], v[32:35], v[160:163]
    ds_read_b64_tr_b16 v[84:85], v102 offset:57344
    v_mfma_f32_16x16x32_bf16 v[176:179], v[60:63], v[32:35], v[176:179]
    ds_read_b64_tr_b16 v[86:87], v102 offset:61440
    v_mfma_f32_16x16x32_bf16 v[180:183], v[60:63], v[36:39], v[180:183]
    ds_read_b64_tr_b16 v[88:89], v105 offset:57344
    v_mfma_f32_16x16x32_bf16 v[164:167], v[56:59], v[36:39], v[164:167]
    ds_read_b64_tr_b16 v[90:91], v105 offset:61440
    v_mfma_f32_16x16x32_bf16 v[148:151], v[52:55], v[36:39], v[148:151]
    ds_read_b64_tr_b16 v[92:93], v108 offset:57344
    v_mfma_f32_16x16x32_bf16 v[132:135], v[48:51], v[36:39], v[132:135]
    ds_read_b64_tr_b16 v[94:95], v108 offset:61440
    s_waitcnt lgkmcnt(8)
    v_mfma_f32_16x16x32_bf16 v[136:139], v[48:51], v[40:43], v[136:139]
    ds_read_b128 v[64:67], v96 offset:49152
    v_mfma_f32_16x16x32_bf16 v[152:155], v[52:55], v[40:43], v[152:155]
    ds_read_b128 v[68:71], v96 offset:49408
    v_mfma_f32_16x16x32_bf16 v[168:171], v[56:59], v[40:43], v[168:171]
    ds_read_b128 v[72:75], v96 offset:51200
    v_mfma_f32_16x16x32_bf16 v[184:187], v[60:63], v[40:43], v[184:187]
    ds_read_b128 v[76:79], v96 offset:51456
    v_mfma_f32_16x16x32_bf16 v[188:191], v[60:63], v[44:47], v[188:191]
    v_mfma_f32_16x16x32_bf16 v[172:175], v[56:59], v[44:47], v[172:175]
    v_mfma_f32_16x16x32_bf16 v[156:159], v[52:55], v[44:47], v[156:159]
    v_mfma_f32_16x16x32_bf16 v[140:143], v[48:51], v[44:47], v[140:143]
    s_waitcnt lgkmcnt(2)
    v_mfma_f32_16x16x32_bf16 v[128:131], v[80:83], v[64:67], v[128:131]
    ds_read_b64_tr_b16 v[48:49], v100 offset:8192
    v_mfma_f32_16x16x32_bf16 v[144:147], v[84:87], v[64:67], v[144:147]
    ds_read_b64_tr_b16 v[50:51], v100 offset:12288
    v_mfma_f32_16x16x32_bf16 v[160:163], v[88:91], v[64:67], v[160:163]
    ds_read_b64_tr_b16 v[52:53], v103 offset:8192
    v_mfma_f32_16x16x32_bf16 v[176:179], v[92:95], v[64:67], v[176:179]
    ds_read_b64_tr_b16 v[54:55], v103 offset:12288
    v_mfma_f32_16x16x32_bf16 v[180:183], v[92:95], v[68:71], v[180:183]
    ds_read_b64_tr_b16 v[56:57], v106 offset:8192
    v_mfma_f32_16x16x32_bf16 v[164:167], v[88:91], v[68:71], v[164:167]
    ds_read_b64_tr_b16 v[58:59], v106 offset:12288
    v_mfma_f32_16x16x32_bf16 v[148:151], v[84:87], v[68:71], v[148:151]
    ds_read_b64_tr_b16 v[60:61], v109 offset:8192
    v_mfma_f32_16x16x32_bf16 v[132:135], v[80:83], v[68:71], v[132:135]
    ds_read_b64_tr_b16 v[62:63], v109 offset:12288
    s_waitcnt lgkmcnt(8)
    v_mfma_f32_16x16x32_bf16 v[136:139], v[80:83], v[72:75], v[136:139]
    ds_read_b128 v[32:35], v97 offset:0
    v_mfma_f32_16x16x32_bf16 v[152:155], v[84:87], v[72:75], v[152:155]
    ds_read_b128 v[36:39], v97 offset:256
    v_mfma_f32_16x16x32_bf16 v[168:171], v[88:91], v[72:75], v[168:171]
    ds_read_b128 v[40:43], v97 offset:2048
    v_mfma_f32_16x16x32_bf16 v[184:187], v[92:95], v[72:75], v[184:187]
    ds_read_b128 v[44:47], v97 offset:2304
    v_mfma_f32_16x16x32_bf16 v[188:191], v[92:95], v[76:79], v[188:191]
    v_mfma_f32_16x16x32_bf16 v[172:175], v[88:91], v[76:79], v[172:175]
    v_mfma_f32_16x16x32_bf16 v[156:159], v[84:87], v[76:79], v[156:159]
    v_mfma_f32_16x16x32_bf16 v[140:143], v[80:83], v[76:79], v[140:143]
    s_barrier
    s_waitcnt lgkmcnt(2)
    v_mfma_f32_16x16x32_bf16 v[128:131], v[48:51], v[32:35], v[128:131]
    ds_read_b64_tr_b16 v[80:81], v100 offset:24576
    v_mfma_f32_16x16x32_bf16 v[144:147], v[52:55], v[32:35], v[144:147]
    ds_read_b64_tr_b16 v[82:83], v100 offset:28672
    v_mfma_f32_16x16x32_bf16 v[160:163], v[56:59], v[32:35], v[160:163]
    ds_read_b64_tr_b16 v[84:85], v103 offset:24576
    v_mfma_f32_16x16x32_bf16 v[176:179], v[60:63], v[32:35], v[176:179]
    ds_read_b64_tr_b16 v[86:87], v103 offset:28672
    v_mfma_f32_16x16x32_bf16 v[180:183], v[60:63], v[36:39], v[180:183]
    ds_read_b64_tr_b16 v[88:89], v106 offset:24576
    v_mfma_f32_16x16x32_bf16 v[164:167], v[56:59], v[36:39], v[164:167]
    ds_read_b64_tr_b16 v[90:91], v106 offset:28672
    v_mfma_f32_16x16x32_bf16 v[148:151], v[52:55], v[36:39], v[148:151]
    ds_read_b64_tr_b16 v[92:93], v109 offset:24576
    v_mfma_f32_16x16x32_bf16 v[132:135], v[48:51], v[36:39], v[132:135]
    ds_read_b64_tr_b16 v[94:95], v109 offset:28672
    s_waitcnt lgkmcnt(8)
    v_mfma_f32_16x16x32_bf16 v[136:139], v[48:51], v[40:43], v[136:139]
    ds_read_b128 v[64:67], v97 offset:16384
    v_mfma_f32_16x16x32_bf16 v[152:155], v[52:55], v[40:43], v[152:155]
    ds_read_b128 v[68:71], v97 offset:16640
    v_mfma_f32_16x16x32_bf16 v[168:171], v[56:59], v[40:43], v[168:171]
    ds_read_b128 v[72:75], v97 offset:18432
    v_mfma_f32_16x16x32_bf16 v[184:187], v[60:63], v[40:43], v[184:187]
    ds_read_b128 v[76:79], v97 offset:18688
    v_mfma_f32_16x16x32_bf16 v[188:191], v[60:63], v[44:47], v[188:191]
    v_mfma_f32_16x16x32_bf16 v[172:175], v[56:59], v[44:47], v[172:175]
    v_mfma_f32_16x16x32_bf16 v[156:159], v[52:55], v[44:47], v[156:159]
    v_mfma_f32_16x16x32_bf16 v[140:143], v[48:51], v[44:47], v[140:143]
    s_waitcnt lgkmcnt(2)
    v_mfma_f32_16x16x32_bf16 v[128:131], v[80:83], v[64:67], v[128:131]
    ds_read_b64_tr_b16 v[48:49], v100 offset:40960
    v_mfma_f32_16x16x32_bf16 v[144:147], v[84:87], v[64:67], v[144:147]
    ds_read_b64_tr_b16 v[50:51], v100 offset:45056
    v_mfma_f32_16x16x32_bf16 v[160:163], v[88:91], v[64:67], v[160:163]
    ds_read_b64_tr_b16 v[52:53], v103 offset:40960
    v_mfma_f32_16x16x32_bf16 v[176:179], v[92:95], v[64:67], v[176:179]
    ds_read_b64_tr_b16 v[54:55], v103 offset:45056
    v_mfma_f32_16x16x32_bf16 v[180:183], v[92:95], v[68:71], v[180:183]
    ds_read_b64_tr_b16 v[56:57], v106 offset:40960
    v_mfma_f32_16x16x32_bf16 v[164:167], v[88:91], v[68:71], v[164:167]
    ds_read_b64_tr_b16 v[58:59], v106 offset:45056
    v_mfma_f32_16x16x32_bf16 v[148:151], v[84:87], v[68:71], v[148:151]
    ds_read_b64_tr_b16 v[60:61], v109 offset:40960
    v_mfma_f32_16x16x32_bf16 v[132:135], v[80:83], v[68:71], v[132:135]
    ds_read_b64_tr_b16 v[62:63], v109 offset:45056
    s_waitcnt lgkmcnt(8)
    v_mfma_f32_16x16x32_bf16 v[136:139], v[80:83], v[72:75], v[136:139]
    ds_read_b128 v[32:35], v97 offset:32768
    v_mfma_f32_16x16x32_bf16 v[152:155], v[84:87], v[72:75], v[152:155]
    ds_read_b128 v[36:39], v97 offset:33024
    v_mfma_f32_16x16x32_bf16 v[168:171], v[88:91], v[72:75], v[168:171]
    ds_read_b128 v[40:43], v97 offset:34816
    v_mfma_f32_16x16x32_bf16 v[184:187], v[92:95], v[72:75], v[184:187]
    ds_read_b128 v[44:47], v97 offset:35072
    v_mfma_f32_16x16x32_bf16 v[188:191], v[92:95], v[76:79], v[188:191]
    v_mfma_f32_16x16x32_bf16 v[172:175], v[88:91], v[76:79], v[172:175]
    v_mfma_f32_16x16x32_bf16 v[156:159], v[84:87], v[76:79], v[156:159]
    v_mfma_f32_16x16x32_bf16 v[140:143], v[80:83], v[76:79], v[140:143]
    s_barrier
    s_waitcnt lgkmcnt(2)
    v_mfma_f32_16x16x32_bf16 v[128:131], v[48:51], v[32:35], v[128:131]
    ds_read_b64_tr_b16 v[80:81], v100 offset:57344
    v_mfma_f32_16x16x32_bf16 v[144:147], v[52:55], v[32:35], v[144:147]
    ds_read_b64_tr_b16 v[82:83], v100 offset:61440
    v_mfma_f32_16x16x32_bf16 v[160:163], v[56:59], v[32:35], v[160:163]
    ds_read_b64_tr_b16 v[84:85], v103 offset:57344
    v_mfma_f32_16x16x32_bf16 v[176:179], v[60:63], v[32:35], v[176:179]
    ds_read_b64_tr_b16 v[86:87], v103 offset:61440
    v_mfma_f32_16x16x32_bf16 v[180:183], v[60:63], v[36:39], v[180:183]
    ds_read_b64_tr_b16 v[88:89], v106 offset:57344
    v_mfma_f32_16x16x32_bf16 v[164:167], v[56:59], v[36:39], v[164:167]
    ds_read_b64_tr_b16 v[90:91], v106 offset:61440
    v_mfma_f32_16x16x32_bf16 v[148:151], v[52:55], v[36:39], v[148:151]
    ds_read_b64_tr_b16 v[92:93], v109 offset:57344
    v_mfma_f32_16x16x32_bf16 v[132:135], v[48:51], v[36:39], v[132:135]
    ds_read_b64_tr_b16 v[94:95], v109 offset:61440
    s_waitcnt lgkmcnt(8)
    v_mfma_f32_16x16x32_bf16 v[136:139], v[48:51], v[40:43], v[136:139]
    ds_read_b128 v[64:67], v97 offset:49152
    v_mfma_f32_16x16x32_bf16 v[152:155], v[52:55], v[40:43], v[152:155]
    ds_read_b128 v[68:71], v97 offset:49408
    v_mfma_f32_16x16x32_bf16 v[168:171], v[56:59], v[40:43], v[168:171]
    ds_read_b128 v[72:75], v97 offset:51200
    v_mfma_f32_16x16x32_bf16 v[184:187], v[60:63], v[40:43], v[184:187]
    ds_read_b128 v[76:79], v97 offset:51456
    v_mfma_f32_16x16x32_bf16 v[188:191], v[60:63], v[44:47], v[188:191]
    v_mfma_f32_16x16x32_bf16 v[172:175], v[56:59], v[44:47], v[172:175]
    v_mfma_f32_16x16x32_bf16 v[156:159], v[52:55], v[44:47], v[156:159]
    v_mfma_f32_16x16x32_bf16 v[140:143], v[48:51], v[44:47], v[140:143]
    s_waitcnt lgkmcnt(2)
    v_mfma_f32_16x16x32_bf16 v[128:131], v[80:83], v[64:67], v[128:131]
    ds_read_b64_tr_b16 v[48:49], v101 offset:8192
    v_mfma_f32_16x16x32_bf16 v[144:147], v[84:87], v[64:67], v[144:147]
    ds_read_b64_tr_b16 v[50:51], v101 offset:12288
    v_mfma_f32_16x16x32_bf16 v[160:163], v[88:91], v[64:67], v[160:163]
    ds_read_b64_tr_b16 v[52:53], v104 offset:8192
    v_mfma_f32_16x16x32_bf16 v[176:179], v[92:95], v[64:67], v[176:179]
    ds_read_b64_tr_b16 v[54:55], v104 offset:12288
    v_mfma_f32_16x16x32_bf16 v[180:183], v[92:95], v[68:71], v[180:183]
    ds_read_b64_tr_b16 v[56:57], v107 offset:8192
    v_mfma_f32_16x16x32_bf16 v[164:167], v[88:91], v[68:71], v[164:167]
    ds_read_b64_tr_b16 v[58:59], v107 offset:12288
    v_mfma_f32_16x16x32_bf16 v[148:151], v[84:87], v[68:71], v[148:151]
    ds_read_b64_tr_b16 v[60:61], v110 offset:8192
    v_mfma_f32_16x16x32_bf16 v[132:135], v[80:83], v[68:71], v[132:135]
    ds_read_b64_tr_b16 v[62:63], v110 offset:12288
    s_waitcnt lgkmcnt(8)
    v_mfma_f32_16x16x32_bf16 v[136:139], v[80:83], v[72:75], v[136:139]
    ds_read_b128 v[32:35], v98 offset:0
    v_mfma_f32_16x16x32_bf16 v[152:155], v[84:87], v[72:75], v[152:155]
    ds_read_b128 v[36:39], v98 offset:256
    v_mfma_f32_16x16x32_bf16 v[168:171], v[88:91], v[72:75], v[168:171]
    ds_read_b128 v[40:43], v98 offset:2048
    v_mfma_f32_16x16x32_bf16 v[184:187], v[92:95], v[72:75], v[184:187]
    ds_read_b128 v[44:47], v98 offset:2304
    v_mfma_f32_16x16x32_bf16 v[188:191], v[92:95], v[76:79], v[188:191]
    v_mfma_f32_16x16x32_bf16 v[172:175], v[88:91], v[76:79], v[172:175]
    v_mfma_f32_16x16x32_bf16 v[156:159], v[84:87], v[76:79], v[156:159]
    v_mfma_f32_16x16x32_bf16 v[140:143], v[80:83], v[76:79], v[140:143]
    s_barrier
    s_waitcnt lgkmcnt(2)
    v_mfma_f32_16x16x32_bf16 v[128:131], v[48:51], v[32:35], v[128:131]
    ds_read_b64_tr_b16 v[80:81], v101 offset:24576
    v_mfma_f32_16x16x32_bf16 v[144:147], v[52:55], v[32:35], v[144:147]
    ds_read_b64_tr_b16 v[82:83], v101 offset:28672
    v_mfma_f32_16x16x32_bf16 v[160:163], v[56:59], v[32:35], v[160:163]
    ds_read_b64_tr_b16 v[84:85], v104 offset:24576
    v_mfma_f32_16x16x32_bf16 v[176:179], v[60:63], v[32:35], v[176:179]
    ds_read_b64_tr_b16 v[86:87], v104 offset:28672
    v_mfma_f32_16x16x32_bf16 v[180:183], v[60:63], v[36:39], v[180:183]
    ds_read_b64_tr_b16 v[88:89], v107 offset:24576
    v_mfma_f32_16x16x32_bf16 v[164:167], v[56:59], v[36:39], v[164:167]
    ds_read_b64_tr_b16 v[90:91], v107 offset:28672
    v_mfma_f32_16x16x32_bf16 v[148:151], v[52:55], v[36:39], v[148:151]
    ds_read_b64_tr_b16 v[92:93], v110 offset:24576
    v_mfma_f32_16x16x32_bf16 v[132:135], v[48:51], v[36:39], v[132:135]
    ds_read_b64_tr_b16 v[94:95], v110 offset:28672
    s_waitcnt lgkmcnt(8)
    v_mfma_f32_16x16x32_bf16 v[136:139], v[48:51], v[40:43], v[136:139]
    ds_read_b128 v[64:67], v98 offset:16384
    v_mfma_f32_16x16x32_bf16 v[152:155], v[52:55], v[40:43], v[152:155]
    ds_read_b128 v[68:71], v98 offset:16640
    v_mfma_f32_16x16x32_bf16 v[168:171], v[56:59], v[40:43], v[168:171]
    ds_read_b128 v[72:75], v98 offset:18432
    v_mfma_f32_16x16x32_bf16 v[184:187], v[60:63], v[40:43], v[184:187]
    ds_read_b128 v[76:79], v98 offset:18688
    v_mfma_f32_16x16x32_bf16 v[188:191], v[60:63], v[44:47], v[188:191]
    v_mfma_f32_16x16x32_bf16 v[172:175], v[56:59], v[44:47], v[172:175]
    v_mfma_f32_16x16x32_bf16 v[156:159], v[52:55], v[44:47], v[156:159]
    v_mfma_f32_16x16x32_bf16 v[140:143], v[48:51], v[44:47], v[140:143]
    s_waitcnt lgkmcnt(2)
    v_mfma_f32_16x16x32_bf16 v[128:131], v[80:83], v[64:67], v[128:131]
    ds_read_b64_tr_b16 v[48:49], v99 offset:8192
    v_mfma_f32_16x16x32_bf16 v[144:147], v[84:87], v[64:67], v[144:147]
    ds_read_b64_tr_b16 v[50:51], v99 offset:12288
    v_mfma_f32_16x16x32_bf16 v[160:163], v[88:91], v[64:67], v[160:163]
    ds_read_b64_tr_b16 v[52:53], v102 offset:8192
    v_mfma_f32_16x16x32_bf16 v[176:179], v[92:95], v[64:67], v[176:179]
    ds_read_b64_tr_b16 v[54:55], v102 offset:12288
    v_mfma_f32_16x16x32_bf16 v[180:183], v[92:95], v[68:71], v[180:183]
    ds_read_b64_tr_b16 v[56:57], v105 offset:8192
    v_mfma_f32_16x16x32_bf16 v[164:167], v[88:91], v[68:71], v[164:167]
    ds_read_b64_tr_b16 v[58:59], v105 offset:12288
    v_mfma_f32_16x16x32_bf16 v[148:151], v[84:87], v[68:71], v[148:151]
    ds_read_b64_tr_b16 v[60:61], v108 offset:8192
    v_mfma_f32_16x16x32_bf16 v[132:135], v[80:83], v[68:71], v[132:135]
    ds_read_b64_tr_b16 v[62:63], v108 offset:12288
    s_waitcnt lgkmcnt(8)
    v_mfma_f32_16x16x32_bf16 v[136:139], v[80:83], v[72:75], v[136:139]
    ds_read_b128 v[32:35], v96 offset:0
    v_mfma_f32_16x16x32_bf16 v[152:155], v[84:87], v[72:75], v[152:155]
    ds_read_b128 v[36:39], v96 offset:256
    v_mfma_f32_16x16x32_bf16 v[168:171], v[88:91], v[72:75], v[168:171]
    ds_read_b128 v[40:43], v96 offset:2048
    v_mfma_f32_16x16x32_bf16 v[184:187], v[92:95], v[72:75], v[184:187]
    ds_read_b128 v[44:47], v96 offset:2304
    v_mfma_f32_16x16x32_bf16 v[188:191], v[92:95], v[76:79], v[188:191]
    v_mfma_f32_16x16x32_bf16 v[172:175], v[88:91], v[76:79], v[172:175]
    v_mfma_f32_16x16x32_bf16 v[156:159], v[84:87], v[76:79], v[156:159]
    v_mfma_f32_16x16x32_bf16 v[140:143], v[80:83], v[76:79], v[140:143]
    s_barrier
    s_waitcnt lgkmcnt(2)
    v_mfma_f32_16x16x32_bf16 v[128:131], v[48:51], v[32:35], v[128:131]
    ds_read_b64_tr_b16 v[80:81], v99 offset:24576
    v_mfma_f32_16x16x32_bf16 v[144:147], v[52:55], v[32:35], v[144:147]
    ds_read_b64_tr_b16 v[82:83], v99 offset:28672
    v_mfma_f32_16x16x32_bf16 v[160:163], v[56:59], v[32:35], v[160:163]
    ds_read_b64_tr_b16 v[84:85], v102 offset:24576
    v_mfma_f32_16x16x32_bf16 v[176:179], v[60:63], v[32:35], v[176:179]
    ds_read_b64_tr_b16 v[86:87], v102 offset:28672
    v_mfma_f32_16x16x32_bf16 v[180:183], v[60:63], v[36:39], v[180:183]
    ds_read_b64_tr_b16 v[88:89], v105 offset:24576
    v_mfma_f32_16x16x32_bf16 v[164:167], v[56:59], v[36:39], v[164:167]
    ds_read_b64_tr_b16 v[90:91], v105 offset:28672
    v_mfma_f32_16x16x32_bf16 v[148:151], v[52:55], v[36:39], v[148:151]
    ds_read_b64_tr_b16 v[92:93], v108 offset:24576
    v_mfma_f32_16x16x32_bf16 v[132:135], v[48:51], v[36:39], v[132:135]
    ds_read_b64_tr_b16 v[94:95], v108 offset:28672
    s_waitcnt lgkmcnt(8)
    v_mfma_f32_16x16x32_bf16 v[136:139], v[48:51], v[40:43], v[136:139]
    ds_read_b128 v[64:67], v96 offset:16384
    v_mfma_f32_16x16x32_bf16 v[152:155], v[52:55], v[40:43], v[152:155]
    ds_read_b128 v[68:71], v96 offset:16640
    v_mfma_f32_16x16x32_bf16 v[168:171], v[56:59], v[40:43], v[168:171]
    ds_read_b128 v[72:75], v96 offset:18432
    v_mfma_f32_16x16x32_bf16 v[184:187], v[60:63], v[40:43], v[184:187]
    ds_read_b128 v[76:79], v96 offset:18688
    v_mfma_f32_16x16x32_bf16 v[188:191], v[60:63], v[44:47], v[188:191]
    v_mfma_f32_16x16x32_bf16 v[172:175], v[56:59], v[44:47], v[172:175]
    v_mfma_f32_16x16x32_bf16 v[156:159], v[52:55], v[44:47], v[156:159]
    v_mfma_f32_16x16x32_bf16 v[140:143], v[48:51], v[44:47], v[140:143]
    s_waitcnt lgkmcnt(2)
    v_mfma_f32_16x16x32_bf16 v[128:131], v[80:83], v[64:67], v[128:131]
    ds_read_b64_tr_b16 v[48:49], v99 offset:40960
    v_mfma_f32_16x16x32_bf16 v[144:147], v[84:87], v[64:67], v[144:147]
    ds_read_b64_tr_b16 v[50:51], v99 offset:45056
    v_mfma_f32_16x16x32_bf16 v[160:163], v[88:91], v[64:67], v[160:163]
    ds_read_b64_tr_b16 v[52:53], v102 offset:40960
    v_mfma_f32_16x16x32_bf16 v[176:179], v[92:95], v[64:67], v[176:179]
    ds_read_b64_tr_b16 v[54:55], v102 offset:45056
    v_mfma_f32_16x16x32_bf16 v[180:183], v[92:95], v[68:71], v[180:183]
    ds_read_b64_tr_b16 v[56:57], v105 offset:40960
    v_mfma_f32_16x16x32_bf16 v[164:167], v[88:91], v[68:71], v[164:167]
    ds_read_b64_tr_b16 v[58:59], v105 offset:45056
    v_mfma_f32_16x16x32_bf16 v[148:151], v[84:87], v[68:71], v[148:151]
    ds_read_b64_tr_b16 v[60:61], v108 offset:40960
    v_mfma_f32_16x16x32_bf16 v[132:135], v[80:83], v[68:71], v[132:135]
    ds_read_b64_tr_b16 v[62:63], v108 offset:45056
    s_waitcnt lgkmcnt(8)
    v_mfma_f32_16x16x32_bf16 v[136:139], v[80:83], v[72:75], v[136:139]
    ds_read_b128 v[32:35], v96 offset:32768
    v_mfma_f32_16x16x32_bf16 v[152:155], v[84:87], v[72:75], v[152:155]
    ds_read_b128 v[36:39], v96 offset:33024
    v_mfma_f32_16x16x32_bf16 v[168:171], v[88:91], v[72:75], v[168:171]
    ds_read_b128 v[40:43], v96 offset:34816
    v_mfma_f32_16x16x32_bf16 v[184:187], v[92:95], v[72:75], v[184:187]
    ds_read_b128 v[44:47], v96 offset:35072
    v_mfma_f32_16x16x32_bf16 v[188:191], v[92:95], v[76:79], v[188:191]
    v_mfma_f32_16x16x32_bf16 v[172:175], v[88:91], v[76:79], v[172:175]
    v_mfma_f32_16x16x32_bf16 v[156:159], v[84:87], v[76:79], v[156:159]
    v_mfma_f32_16x16x32_bf16 v[140:143], v[80:83], v[76:79], v[140:143]
    s_barrier
    s_waitcnt lgkmcnt(2)
    v_mfma_f32_16x16x32_bf16 v[128:131], v[48:51], v[32:35], v[128:131]
    ds_read_b64_tr_b16 v[80:81], v99 offset:57344
    v_mfma_f32_16x16x32_bf16 v[144:147], v[52:55], v[32:35], v[144:147]
    ds_read_b64_tr_b16 v[82:83], v99 offset:61440
    v_mfma_f32_16x16x32_bf16 v[160:163], v[56:59], v[32:35], v[160:163]
    ds_read_b64_tr_b16 v[84:85], v102 offset:57344
    v_mfma_f32_16x16x32_bf16 v[176:179], v[60:63], v[32:35], v[176:179]
    ds_read_b64_tr_b16 v[86:87], v102 offset:61440
    v_mfma_f32_16x16x32_bf16 v[180:183], v[60:63], v[36:39], v[180:183]
    ds_read_b64_tr_b16 v[88:89], v105 offset:57344
    v_mfma_f32_16x16x32_bf16 v[164:167], v[56:59], v[36:39], v[164:167]
    ds_read_b64_tr_b16 v[90:91], v105 offset:61440
    v_mfma_f32_16x16x32_bf16 v[148:151], v[52:55], v[36:39], v[148:151]
    ds_read_b64_tr_b16 v[92:93], v108 offset:57344
    v_mfma_f32_16x16x32_bf16 v[132:135], v[48:51], v[36:39], v[132:135]
    ds_read_b64_tr_b16 v[94:95], v108 offset:61440
    s_waitcnt lgkmcnt(8)
    v_mfma_f32_16x16x32_bf16 v[136:139], v[48:51], v[40:43], v[136:139]
    ds_read_b128 v[64:67], v96 offset:49152
    v_mfma_f32_16x16x32_bf16 v[152:155], v[52:55], v[40:43], v[152:155]
    ds_read_b128 v[68:71], v96 offset:49408
    v_mfma_f32_16x16x32_bf16 v[168:171], v[56:59], v[40:43], v[168:171]
    ds_read_b128 v[72:75], v96 offset:51200
    v_mfma_f32_16x16x32_bf16 v[184:187], v[60:63], v[40:43], v[184:187]
    ds_read_b128 v[76:79], v96 offset:51456
    v_mfma_f32_16x16x32_bf16 v[188:191], v[60:63], v[44:47], v[188:191]
    v_mfma_f32_16x16x32_bf16 v[172:175], v[56:59], v[44:47], v[172:175]
    v_mfma_f32_16x16x32_bf16 v[156:159], v[52:55], v[44:47], v[156:159]
    v_mfma_f32_16x16x32_bf16 v[140:143], v[48:51], v[44:47], v[140:143]
    s_waitcnt lgkmcnt(2)
    v_mfma_f32_16x16x32_bf16 v[128:131], v[80:83], v[64:67], v[128:131]
    ds_read_b64_tr_b16 v[48:49], v100 offset:8192
    v_mfma_f32_16x16x32_bf16 v[144:147], v[84:87], v[64:67], v[144:147]
    ds_read_b64_tr_b16 v[50:51], v100 offset:12288
    v_mfma_f32_16x16x32_bf16 v[160:163], v[88:91], v[64:67], v[160:163]
    ds_read_b64_tr_b16 v[52:53], v103 offset:8192
    v_mfma_f32_16x16x32_bf16 v[176:179], v[92:95], v[64:67], v[176:179]
    ds_read_b64_tr_b16 v[54:55], v103 offset:12288
    v_mfma_f32_16x16x32_bf16 v[180:183], v[92:95], v[68:71], v[180:183]
    ds_read_b64_tr_b16 v[56:57], v106 offset:8192
    v_mfma_f32_16x16x32_bf16 v[164:167], v[88:91], v[68:71], v[164:167]
    ds_read_b64_tr_b16 v[58:59], v106 offset:12288
    v_mfma_f32_16x16x32_bf16 v[148:151], v[84:87], v[68:71], v[148:151]
    ds_read_b64_tr_b16 v[60:61], v109 offset:8192
    v_mfma_f32_16x16x32_bf16 v[132:135], v[80:83], v[68:71], v[132:135]
    ds_read_b64_tr_b16 v[62:63], v109 offset:12288
    s_waitcnt lgkmcnt(8)
    v_mfma_f32_16x16x32_bf16 v[136:139], v[80:83], v[72:75], v[136:139]
    ds_read_b128 v[32:35], v97 offset:0
    v_mfma_f32_16x16x32_bf16 v[152:155], v[84:87], v[72:75], v[152:155]
    ds_read_b128 v[36:39], v97 offset:256
    v_mfma_f32_16x16x32_bf16 v[168:171], v[88:91], v[72:75], v[168:171]
    ds_read_b128 v[40:43], v97 offset:2048
    v_mfma_f32_16x16x32_bf16 v[184:187], v[92:95], v[72:75], v[184:187]
    ds_read_b128 v[44:47], v97 offset:2304
    v_mfma_f32_16x16x32_bf16 v[188:191], v[92:95], v[76:79], v[188:191]
    v_mfma_f32_16x16x32_bf16 v[172:175], v[88:91], v[76:79], v[172:175]
    v_mfma_f32_16x16x32_bf16 v[156:159], v[84:87], v[76:79], v[156:159]
    v_mfma_f32_16x16x32_bf16 v[140:143], v[80:83], v[76:79], v[140:143]
    s_barrier
    s_waitcnt lgkmcnt(2)
    v_mfma_f32_16x16x32_bf16 v[128:131], v[48:51], v[32:35], v[128:131]
    ds_read_b64_tr_b16 v[80:81], v100 offset:24576
    v_mfma_f32_16x16x32_bf16 v[144:147], v[52:55], v[32:35], v[144:147]
    ds_read_b64_tr_b16 v[82:83], v100 offset:28672
    v_mfma_f32_16x16x32_bf16 v[160:163], v[56:59], v[32:35], v[160:163]
    ds_read_b64_tr_b16 v[84:85], v103 offset:24576
    v_mfma_f32_16x16x32_bf16 v[176:179], v[60:63], v[32:35], v[176:179]
    ds_read_b64_tr_b16 v[86:87], v103 offset:28672
    v_mfma_f32_16x16x32_bf16 v[180:183], v[60:63], v[36:39], v[180:183]
    ds_read_b64_tr_b16 v[88:89], v106 offset:24576
    v_mfma_f32_16x16x32_bf16 v[164:167], v[56:59], v[36:39], v[164:167]
    ds_read_b64_tr_b16 v[90:91], v106 offset:28672
    v_mfma_f32_16x16x32_bf16 v[148:151], v[52:55], v[36:39], v[148:151]
    ds_read_b64_tr_b16 v[92:93], v109 offset:24576
    v_mfma_f32_16x16x32_bf16 v[132:135], v[48:51], v[36:39], v[132:135]
    ds_read_b64_tr_b16 v[94:95], v109 offset:28672
    s_waitcnt lgkmcnt(8)
    v_mfma_f32_16x16x32_bf16 v[136:139], v[48:51], v[40:43], v[136:139]
    ds_read_b128 v[64:67], v97 offset:16384
    v_mfma_f32_16x16x32_bf16 v[152:155], v[52:55], v[40:43], v[152:155]
    ds_read_b128 v[68:71], v97 offset:16640
    v_mfma_f32_16x16x32_bf16 v[168:171], v[56:59], v[40:43], v[168:171]
    ds_read_b128 v[72:75], v97 offset:18432
    v_mfma_f32_16x16x32_bf16 v[184:187], v[60:63], v[40:43], v[184:187]
    ds_read_b128 v[76:79], v97 offset:18688
    v_mfma_f32_16x16x32_bf16 v[188:191], v[60:63], v[44:47], v[188:191]
    v_mfma_f32_16x16x32_bf16 v[172:175], v[56:59], v[44:47], v[172:175]
    v_mfma_f32_16x16x32_bf16 v[156:159], v[52:55], v[44:47], v[156:159]
    v_mfma_f32_16x16x32_bf16 v[140:143], v[48:51], v[44:47], v[140:143]
    s_waitcnt lgkmcnt(2)
    v_mfma_f32_16x16x32_bf16 v[128:131], v[80:83], v[64:67], v[128:131]
    ds_read_b64_tr_b16 v[48:49], v100 offset:40960
    v_mfma_f32_16x16x32_bf16 v[144:147], v[84:87], v[64:67], v[144:147]
    ds_read_b64_tr_b16 v[50:51], v100 offset:45056
    v_mfma_f32_16x16x32_bf16 v[160:163], v[88:91], v[64:67], v[160:163]
    ds_read_b64_tr_b16 v[52:53], v103 offset:40960
    v_mfma_f32_16x16x32_bf16 v[176:179], v[92:95], v[64:67], v[176:179]
    ds_read_b64_tr_b16 v[54:55], v103 offset:45056
    v_mfma_f32_16x16x32_bf16 v[180:183], v[92:95], v[68:71], v[180:183]
    ds_read_b64_tr_b16 v[56:57], v106 offset:40960
    v_mfma_f32_16x16x32_bf16 v[164:167], v[88:91], v[68:71], v[164:167]
    ds_read_b64_tr_b16 v[58:59], v106 offset:45056
    v_mfma_f32_16x16x32_bf16 v[148:151], v[84:87], v[68:71], v[148:151]
    ds_read_b64_tr_b16 v[60:61], v109 offset:40960
    v_mfma_f32_16x16x32_bf16 v[132:135], v[80:83], v[68:71], v[132:135]
    ds_read_b64_tr_b16 v[62:63], v109 offset:45056
    s_waitcnt lgkmcnt(8)
    v_mfma_f32_16x16x32_bf16 v[136:139], v[80:83], v[72:75], v[136:139]
    ds_read_b128 v[32:35], v97 offset:32768
    v_mfma_f32_16x16x32_bf16 v[152:155], v[84:87], v[72:75], v[152:155]
    ds_read_b128 v[36:39], v97 offset:33024
    v_mfma_f32_16x16x32_bf16 v[168:171], v[88:91], v[72:75], v[168:171]
    ds_read_b128 v[40:43], v97 offset:34816
    v_mfma_f32_16x16x32_bf16 v[184:187], v[92:95], v[72:75], v[184:187]
    ds_read_b128 v[44:47], v97 offset:35072
    v_mfma_f32_16x16x32_bf16 v[188:191], v[92:95], v[76:79], v[188:191]
    v_mfma_f32_16x16x32_bf16 v[172:175], v[88:91], v[76:79], v[172:175]
    v_mfma_f32_16x16x32_bf16 v[156:159], v[84:87], v[76:79], v[156:159]
    v_mfma_f32_16x16x32_bf16 v[140:143], v[80:83], v[76:79], v[140:143]
    s_barrier
    s_waitcnt lgkmcnt(2)
    v_mfma_f32_16x16x32_bf16 v[128:131], v[48:51], v[32:35], v[128:131]
    ds_read_b64_tr_b16 v[80:81], v100 offset:57344
    v_mfma_f32_16x16x32_bf16 v[144:147], v[52:55], v[32:35], v[144:147]
    ds_read_b64_tr_b16 v[82:83], v100 offset:61440
    v_mfma_f32_16x16x32_bf16 v[160:163], v[56:59], v[32:35], v[160:163]
    ds_read_b64_tr_b16 v[84:85], v103 offset:57344
    v_mfma_f32_16x16x32_bf16 v[176:179], v[60:63], v[32:35], v[176:179]
    ds_read_b64_tr_b16 v[86:87], v103 offset:61440
    v_mfma_f32_16x16x32_bf16 v[180:183], v[60:63], v[36:39], v[180:183]
    ds_read_b64_tr_b16 v[88:89], v106 offset:57344
    v_mfma_f32_16x16x32_bf16 v[164:167], v[56:59], v[36:39], v[164:167]
    ds_read_b64_tr_b16 v[90:91], v106 offset:61440
    v_mfma_f32_16x16x32_bf16 v[148:151], v[52:55], v[36:39], v[148:151]
    ds_read_b64_tr_b16 v[92:93], v109 offset:57344
    v_mfma_f32_16x16x32_bf16 v[132:135], v[48:51], v[36:39], v[132:135]
    ds_read_b64_tr_b16 v[94:95], v109 offset:61440
    s_waitcnt lgkmcnt(8)
    v_mfma_f32_16x16x32_bf16 v[136:139], v[48:51], v[40:43], v[136:139]
    ds_read_b128 v[64:67], v97 offset:49152
    v_mfma_f32_16x16x32_bf16 v[152:155], v[52:55], v[40:43], v[152:155]
    ds_read_b128 v[68:71], v97 offset:49408
    v_mfma_f32_16x16x32_bf16 v[168:171], v[56:59], v[40:43], v[168:171]
    ds_read_b128 v[72:75], v97 offset:51200
    v_mfma_f32_16x16x32_bf16 v[184:187], v[60:63], v[40:43], v[184:187]
    ds_read_b128 v[76:79], v97 offset:51456
    v_mfma_f32_16x16x32_bf16 v[188:191], v[60:63], v[44:47], v[188:191]
    v_mfma_f32_16x16x32_bf16 v[172:175], v[56:59], v[44:47], v[172:175]
    v_mfma_f32_16x16x32_bf16 v[156:159], v[52:55], v[44:47], v[156:159]
    v_mfma_f32_16x16x32_bf16 v[140:143], v[48:51], v[44:47], v[140:143]
    s_waitcnt lgkmcnt(2)
    v_mfma_f32_16x16x32_bf16 v[128:131], v[80:83], v[64:67], v[128:131]
    ds_read_b64_tr_b16 v[48:49], v101 offset:8192
    v_mfma_f32_16x16x32_bf16 v[144:147], v[84:87], v[64:67], v[144:147]
    ds_read_b64_tr_b16 v[50:51], v101 offset:12288
    v_mfma_f32_16x16x32_bf16 v[160:163], v[88:91], v[64:67], v[160:163]
    ds_read_b64_tr_b16 v[52:53], v104 offset:8192
    v_mfma_f32_16x16x32_bf16 v[176:179], v[92:95], v[64:67], v[176:179]
    ds_read_b64_tr_b16 v[54:55], v104 offset:12288
    v_mfma_f32_16x16x32_bf16 v[180:183], v[92:95], v[68:71], v[180:183]
    ds_read_b64_tr_b16 v[56:57], v107 offset:8192
    v_mfma_f32_16x16x32_bf16 v[164:167], v[88:91], v[68:71], v[164:167]
    ds_read_b64_tr_b16 v[58:59], v107 offset:12288
    v_mfma_f32_16x16x32_bf16 v[148:151], v[84:87], v[68:71], v[148:151]
    ds_read_b64_tr_b16 v[60:61], v110 offset:8192
    v_mfma_f32_16x16x32_bf16 v[132:135], v[80:83], v[68:71], v[132:135]
    ds_read_b64_tr_b16 v[62:63], v110 offset:12288
    s_waitcnt lgkmcnt(8)
    v_mfma_f32_16x16x32_bf16 v[136:139], v[80:83], v[72:75], v[136:139]
    ds_read_b128 v[32:35], v98 offset:0
    v_mfma_f32_16x16x32_bf16 v[152:155], v[84:87], v[72:75], v[152:155]
    ds_read_b128 v[36:39], v98 offset:256
    v_mfma_f32_16x16x32_bf16 v[168:171], v[88:91], v[72:75], v[168:171]
    ds_read_b128 v[40:43], v98 offset:2048
    v_mfma_f32_16x16x32_bf16 v[184:187], v[92:95], v[72:75], v[184:187]
    ds_read_b128 v[44:47], v98 offset:2304
    v_mfma_f32_16x16x32_bf16 v[188:191], v[92:95], v[76:79], v[188:191]
    v_mfma_f32_16x16x32_bf16 v[172:175], v[88:91], v[76:79], v[172:175]
    v_mfma_f32_16x16x32_bf16 v[156:159], v[84:87], v[76:79], v[156:159]
    v_mfma_f32_16x16x32_bf16 v[140:143], v[80:83], v[76:79], v[140:143]
    s_barrier
    s_waitcnt lgkmcnt(2)
    v_mfma_f32_16x16x32_bf16 v[128:131], v[48:51], v[32:35], v[128:131]
    ds_read_b64_tr_b16 v[80:81], v101 offset:24576
    v_mfma_f32_16x16x32_bf16 v[144:147], v[52:55], v[32:35], v[144:147]
    ds_read_b64_tr_b16 v[82:83], v101 offset:28672
    v_mfma_f32_16x16x32_bf16 v[160:163], v[56:59], v[32:35], v[160:163]
    ds_read_b64_tr_b16 v[84:85], v104 offset:24576
    v_mfma_f32_16x16x32_bf16 v[176:179], v[60:63], v[32:35], v[176:179]
    ds_read_b64_tr_b16 v[86:87], v104 offset:28672
    v_mfma_f32_16x16x32_bf16 v[180:183], v[60:63], v[36:39], v[180:183]
    ds_read_b64_tr_b16 v[88:89], v107 offset:24576
    v_mfma_f32_16x16x32_bf16 v[164:167], v[56:59], v[36:39], v[164:167]
    ds_read_b64_tr_b16 v[90:91], v107 offset:28672
    v_mfma_f32_16x16x32_bf16 v[148:151], v[52:55], v[36:39], v[148:151]
    ds_read_b64_tr_b16 v[92:93], v110 offset:24576
    v_mfma_f32_16x16x32_bf16 v[132:135], v[48:51], v[36:39], v[132:135]
    ds_read_b64_tr_b16 v[94:95], v110 offset:28672
    s_waitcnt lgkmcnt(8)
    v_mfma_f32_16x16x32_bf16 v[136:139], v[48:51], v[40:43], v[136:139]
    ds_read_b128 v[64:67], v98 offset:16384
    v_mfma_f32_16x16x32_bf16 v[152:155], v[52:55], v[40:43], v[152:155]
    ds_read_b128 v[68:71], v98 offset:16640
    v_mfma_f32_16x16x32_bf16 v[168:171], v[56:59], v[40:43], v[168:171]
    ds_read_b128 v[72:75], v98 offset:18432
    v_mfma_f32_16x16x32_bf16 v[184:187], v[60:63], v[40:43], v[184:187]
    ds_read_b128 v[76:79], v98 offset:18688
    v_mfma_f32_16x16x32_bf16 v[188:191], v[60:63], v[44:47], v[188:191]
    v_mfma_f32_16x16x32_bf16 v[172:175], v[56:59], v[44:47], v[172:175]
    v_mfma_f32_16x16x32_bf16 v[156:159], v[52:55], v[44:47], v[156:159]
    v_mfma_f32_16x16x32_bf16 v[140:143], v[48:51], v[44:47], v[140:143]
    s_waitcnt lgkmcnt(2)
    v_mfma_f32_16x16x32_bf16 v[128:131], v[80:83], v[64:67], v[128:131]
    ds_read_b64_tr_b16 v[48:49], v99 offset:8192
    v_mfma_f32_16x16x32_bf16 v[144:147], v[84:87], v[64:67], v[144:147]
    ds_read_b64_tr_b16 v[50:51], v99 offset:12288
    v_mfma_f32_16x16x32_bf16 v[160:163], v[88:91], v[64:67], v[160:163]
    ds_read_b64_tr_b16 v[52:53], v102 offset:8192
    v_mfma_f32_16x16x32_bf16 v[176:179], v[92:95], v[64:67], v[176:179]
    ds_read_b64_tr_b16 v[54:55], v102 offset:12288
    v_mfma_f32_16x16x32_bf16 v[180:183], v[92:95], v[68:71], v[180:183]
    ds_read_b64_tr_b16 v[56:57], v105 offset:8192
    v_mfma_f32_16x16x32_bf16 v[164:167], v[88:91], v[68:71], v[164:167]
    ds_read_b64_tr_b16 v[58:59], v105 offset:12288
    v_mfma_f32_16x16x32_bf16 v[148:151], v[84:87], v[68:71], v[148:151]
    ds_read_b64_tr_b16 v[60:61], v108 offset:8192
    v_mfma_f32_16x16x32_bf16 v[132:135], v[80:83], v[68:71], v[132:135]
    ds_read_b64_tr_b16 v[62:63], v108 offset:12288
    s_waitcnt lgkmcnt(8)
    v_mfma_f32_16x16x32_bf16 v[136:139], v[80:83], v[72:75], v[136:139]
    ds_read_b128 v[32:35], v96 offset:0
    v_mfma_f32_16x16x32_bf16 v[152:155], v[84:87], v[72:75], v[152:155]
    ds_read_b128 v[36:39], v96 offset:256
    v_mfma_f32_16x16x32_bf16 v[168:171], v[88:91], v[72:75], v[168:171]
    ds_read_b128 v[40:43], v96 offset:2048
    v_mfma_f32_16x16x32_bf16 v[184:187], v[92:95], v[72:75], v[184:187]
    ds_read_b128 v[44:47], v96 offset:2304
    v_mfma_f32_16x16x32_bf16 v[188:191], v[92:95], v[76:79], v[188:191]
    v_mfma_f32_16x16x32_bf16 v[172:175], v[88:91], v[76:79], v[172:175]
    v_mfma_f32_16x16x32_bf16 v[156:159], v[84:87], v[76:79], v[156:159]
    v_mfma_f32_16x16x32_bf16 v[140:143], v[80:83], v[76:79], v[140:143]
    s_barrier
    s_waitcnt lgkmcnt(2)
    v_mfma_f32_16x16x32_bf16 v[128:131], v[48:51], v[32:35], v[128:131]
    ds_read_b64_tr_b16 v[80:81], v99 offset:24576
    v_mfma_f32_16x16x32_bf16 v[144:147], v[52:55], v[32:35], v[144:147]
    ds_read_b64_tr_b16 v[82:83], v99 offset:28672
    v_mfma_f32_16x16x32_bf16 v[160:163], v[56:59], v[32:35], v[160:163]
    ds_read_b64_tr_b16 v[84:85], v102 offset:24576
    v_mfma_f32_16x16x32_bf16 v[176:179], v[60:63], v[32:35], v[176:179]
    ds_read_b64_tr_b16 v[86:87], v102 offset:28672
    v_mfma_f32_16x16x32_bf16 v[180:183], v[60:63], v[36:39], v[180:183]
    ds_read_b64_tr_b16 v[88:89], v105 offset:24576
    v_mfma_f32_16x16x32_bf16 v[164:167], v[56:59], v[36:39], v[164:167]
    ds_read_b64_tr_b16 v[90:91], v105 offset:28672
    v_mfma_f32_16x16x32_bf16 v[148:151], v[52:55], v[36:39], v[148:151]
    ds_read_b64_tr_b16 v[92:93], v108 offset:24576
    v_mfma_f32_16x16x32_bf16 v[132:135], v[48:51], v[36:39], v[132:135]
    ds_read_b64_tr_b16 v[94:95], v108 offset:28672
    s_waitcnt lgkmcnt(8)
    v_mfma_f32_16x16x32_bf16 v[136:139], v[48:51], v[40:43], v[136:139]
    ds_read_b128 v[64:67], v96 offset:16384
    v_mfma_f32_16x16x32_bf16 v[152:155], v[52:55], v[40:43], v[152:155]
    ds_read_b128 v[68:71], v96 offset:16640
    v_mfma_f32_16x16x32_bf16 v[168:171], v[56:59], v[40:43], v[168:171]
    ds_read_b128 v[72:75], v96 offset:18432
    v_mfma_f32_16x16x32_bf16 v[184:187], v[60:63], v[40:43], v[184:187]
    ds_read_b128 v[76:79], v96 offset:18688
    v_mfma_f32_16x16x32_bf16 v[188:191], v[60:63], v[44:47], v[188:191]
    v_mfma_f32_16x16x32_bf16 v[172:175], v[56:59], v[44:47], v[172:175]
    v_mfma_f32_16x16x32_bf16 v[156:159], v[52:55], v[44:47], v[156:159]
    v_mfma_f32_16x16x32_bf16 v[140:143], v[48:51], v[44:47], v[140:143]
    s_waitcnt lgkmcnt(2)
    v_mfma_f32_16x16x32_bf16 v[128:131], v[80:83], v[64:67], v[128:131]
    ds_read_b64_tr_b16 v[48:49], v99 offset:40960
    v_mfma_f32_16x16x32_bf16 v[144:147], v[84:87], v[64:67], v[144:147]
    ds_read_b64_tr_b16 v[50:51], v99 offset:45056
    v_mfma_f32_16x16x32_bf16 v[160:163], v[88:91], v[64:67], v[160:163]
    ds_read_b64_tr_b16 v[52:53], v102 offset:40960
    v_mfma_f32_16x16x32_bf16 v[176:179], v[92:95], v[64:67], v[176:179]
    ds_read_b64_tr_b16 v[54:55], v102 offset:45056
    v_mfma_f32_16x16x32_bf16 v[180:183], v[92:95], v[68:71], v[180:183]
    ds_read_b64_tr_b16 v[56:57], v105 offset:40960
    v_mfma_f32_16x16x32_bf16 v[164:167], v[88:91], v[68:71], v[164:167]
    ds_read_b64_tr_b16 v[58:59], v105 offset:45056
    v_mfma_f32_16x16x32_bf16 v[148:151], v[84:87], v[68:71], v[148:151]
    ds_read_b64_tr_b16 v[60:61], v108 offset:40960
    v_mfma_f32_16x16x32_bf16 v[132:135], v[80:83], v[68:71], v[132:135]
    ds_read_b64_tr_b16 v[62:63], v108 offset:45056
    s_waitcnt lgkmcnt(8)
    v_mfma_f32_16x16x32_bf16 v[136:139], v[80:83], v[72:75], v[136:139]
    ds_read_b128 v[32:35], v96 offset:32768
    v_mfma_f32_16x16x32_bf16 v[152:155], v[84:87], v[72:75], v[152:155]
    ds_read_b128 v[36:39], v96 offset:33024
    v_mfma_f32_16x16x32_bf16 v[168:171], v[88:91], v[72:75], v[168:171]
    ds_read_b128 v[40:43], v96 offset:34816
    v_mfma_f32_16x16x32_bf16 v[184:187], v[92:95], v[72:75], v[184:187]
    ds_read_b128 v[44:47], v96 offset:35072
    v_mfma_f32_16x16x32_bf16 v[188:191], v[92:95], v[76:79], v[188:191]
    v_mfma_f32_16x16x32_bf16 v[172:175], v[88:91], v[76:79], v[172:175]
    v_mfma_f32_16x16x32_bf16 v[156:159], v[84:87], v[76:79], v[156:159]
    v_mfma_f32_16x16x32_bf16 v[140:143], v[80:83], v[76:79], v[140:143]
    s_barrier
    s_waitcnt lgkmcnt(2)
    v_mfma_f32_16x16x32_bf16 v[128:131], v[48:51], v[32:35], v[128:131]
    ds_read_b64_tr_b16 v[80:81], v99 offset:57344
    v_mfma_f32_16x16x32_bf16 v[144:147], v[52:55], v[32:35], v[144:147]
    ds_read_b64_tr_b16 v[82:83], v99 offset:61440
    v_mfma_f32_16x16x32_bf16 v[160:163], v[56:59], v[32:35], v[160:163]
    ds_read_b64_tr_b16 v[84:85], v102 offset:57344
    v_mfma_f32_16x16x32_bf16 v[176:179], v[60:63], v[32:35], v[176:179]
    ds_read_b64_tr_b16 v[86:87], v102 offset:61440
    v_mfma_f32_16x16x32_bf16 v[180:183], v[60:63], v[36:39], v[180:183]
    ds_read_b64_tr_b16 v[88:89], v105 offset:57344
    v_mfma_f32_16x16x32_bf16 v[164:167], v[56:59], v[36:39], v[164:167]
    ds_read_b64_tr_b16 v[90:91], v105 offset:61440
    v_mfma_f32_16x16x32_bf16 v[148:151], v[52:55], v[36:39], v[148:151]
    ds_read_b64_tr_b16 v[92:93], v108 offset:57344
    v_mfma_f32_16x16x32_bf16 v[132:135], v[48:51], v[36:39], v[132:135]
    ds_read_b64_tr_b16 v[94:95], v108 offset:61440
    s_waitcnt lgkmcnt(8)
    v_mfma_f32_16x16x32_bf16 v[136:139], v[48:51], v[40:43], v[136:139]
    ds_read_b128 v[64:67], v96 offset:49152
    v_mfma_f32_16x16x32_bf16 v[152:155], v[52:55], v[40:43], v[152:155]
    ds_read_b128 v[68:71], v96 offset:49408
    v_mfma_f32_16x16x32_bf16 v[168:171], v[56:59], v[40:43], v[168:171]
    ds_read_b128 v[72:75], v96 offset:51200
    v_mfma_f32_16x16x32_bf16 v[184:187], v[60:63], v[40:43], v[184:187]
    ds_read_b128 v[76:79], v96 offset:51456
    v_mfma_f32_16x16x32_bf16 v[188:191], v[60:63], v[44:47], v[188:191]
    v_mfma_f32_16x16x32_bf16 v[172:175], v[56:59], v[44:47], v[172:175]
    v_mfma_f32_16x16x32_bf16 v[156:159], v[52:55], v[44:47], v[156:159]
    v_mfma_f32_16x16x32_bf16 v[140:143], v[48:51], v[44:47], v[140:143]
    s_waitcnt lgkmcnt(2)
    v_mfma_f32_16x16x32_bf16 v[128:131], v[80:83], v[64:67], v[128:131]
    ds_read_b64_tr_b16 v[48:49], v100 offset:8192
    v_mfma_f32_16x16x32_bf16 v[144:147], v[84:87], v[64:67], v[144:147]
    ds_read_b64_tr_b16 v[50:51], v100 offset:12288
    v_mfma_f32_16x16x32_bf16 v[160:163], v[88:91], v[64:67], v[160:163]
    ds_read_b64_tr_b16 v[52:53], v103 offset:8192
    v_mfma_f32_16x16x32_bf16 v[176:179], v[92:95], v[64:67], v[176:179]
    ds_read_b64_tr_b16 v[54:55], v103 offset:12288
    v_mfma_f32_16x16x32_bf16 v[180:183], v[92:95], v[68:71], v[180:183]
    ds_read_b64_tr_b16 v[56:57], v106 offset:8192
    v_mfma_f32_16x16x32_bf16 v[164:167], v[88:91], v[68:71], v[164:167]
    ds_read_b64_tr_b16 v[58:59], v106 offset:12288
    v_mfma_f32_16x16x32_bf16 v[148:151], v[84:87], v[68:71], v[148:151]
    ds_read_b64_tr_b16 v[60:61], v109 offset:8192
    v_mfma_f32_16x16x32_bf16 v[132:135], v[80:83], v[68:71], v[132:135]
    ds_read_b64_tr_b16 v[62:63], v109 offset:12288
    s_waitcnt lgkmcnt(8)
    v_mfma_f32_16x16x32_bf16 v[136:139], v[80:83], v[72:75], v[136:139]
    ds_read_b128 v[32:35], v97 offset:0
    v_mfma_f32_16x16x32_bf16 v[152:155], v[84:87], v[72:75], v[152:155]
    ds_read_b128 v[36:39], v97 offset:256
    v_mfma_f32_16x16x32_bf16 v[168:171], v[88:91], v[72:75], v[168:171]
    ds_read_b128 v[40:43], v97 offset:2048
    v_mfma_f32_16x16x32_bf16 v[184:187], v[92:95], v[72:75], v[184:187]
    ds_read_b128 v[44:47], v97 offset:2304
    v_mfma_f32_16x16x32_bf16 v[188:191], v[92:95], v[76:79], v[188:191]
    v_mfma_f32_16x16x32_bf16 v[172:175], v[88:91], v[76:79], v[172:175]
    v_mfma_f32_16x16x32_bf16 v[156:159], v[84:87], v[76:79], v[156:159]
    v_mfma_f32_16x16x32_bf16 v[140:143], v[80:83], v[76:79], v[140:143]
    s_barrier
    s_waitcnt lgkmcnt(2)
    v_mfma_f32_16x16x32_bf16 v[128:131], v[48:51], v[32:35], v[128:131]
    ds_read_b64_tr_b16 v[80:81], v100 offset:24576
    v_mfma_f32_16x16x32_bf16 v[144:147], v[52:55], v[32:35], v[144:147]
    ds_read_b64_tr_b16 v[82:83], v100 offset:28672
    v_mfma_f32_16x16x32_bf16 v[160:163], v[56:59], v[32:35], v[160:163]
    ds_read_b64_tr_b16 v[84:85], v103 offset:24576
    v_mfma_f32_16x16x32_bf16 v[176:179], v[60:63], v[32:35], v[176:179]
    ds_read_b64_tr_b16 v[86:87], v103 offset:28672
    v_mfma_f32_16x16x32_bf16 v[180:183], v[60:63], v[36:39], v[180:183]
    ds_read_b64_tr_b16 v[88:89], v106 offset:24576
    v_mfma_f32_16x16x32_bf16 v[164:167], v[56:59], v[36:39], v[164:167]
    ds_read_b64_tr_b16 v[90:91], v106 offset:28672
    v_mfma_f32_16x16x32_bf16 v[148:151], v[52:55], v[36:39], v[148:151]
    ds_read_b64_tr_b16 v[92:93], v109 offset:24576
    v_mfma_f32_16x16x32_bf16 v[132:135], v[48:51], v[36:39], v[132:135]
    ds_read_b64_tr_b16 v[94:95], v109 offset:28672
    s_waitcnt lgkmcnt(8)
    v_mfma_f32_16x16x32_bf16 v[136:139], v[48:51], v[40:43], v[136:139]
    ds_read_b128 v[64:67], v97 offset:16384
    v_mfma_f32_16x16x32_bf16 v[152:155], v[52:55], v[40:43], v[152:155]
    ds_read_b128 v[68:71], v97 offset:16640
    v_mfma_f32_16x16x32_bf16 v[168:171], v[56:59], v[40:43], v[168:171]
    ds_read_b128 v[72:75], v97 offset:18432
    v_mfma_f32_16x16x32_bf16 v[184:187], v[60:63], v[40:43], v[184:187]
    ds_read_b128 v[76:79], v97 offset:18688
    v_mfma_f32_16x16x32_bf16 v[188:191], v[60:63], v[44:47], v[188:191]
    v_mfma_f32_16x16x32_bf16 v[172:175], v[56:59], v[44:47], v[172:175]
    v_mfma_f32_16x16x32_bf16 v[156:159], v[52:55], v[44:47], v[156:159]
    v_mfma_f32_16x16x32_bf16 v[140:143], v[48:51], v[44:47], v[140:143]
    s_waitcnt lgkmcnt(2)
    v_mfma_f32_16x16x32_bf16 v[128:131], v[80:83], v[64:67], v[128:131]
    ds_read_b64_tr_b16 v[48:49], v100 offset:40960
    v_mfma_f32_16x16x32_bf16 v[144:147], v[84:87], v[64:67], v[144:147]
    ds_read_b64_tr_b16 v[50:51], v100 offset:45056
    v_mfma_f32_16x16x32_bf16 v[160:163], v[88:91], v[64:67], v[160:163]
    ds_read_b64_tr_b16 v[52:53], v103 offset:40960
    v_mfma_f32_16x16x32_bf16 v[176:179], v[92:95], v[64:67], v[176:179]
    ds_read_b64_tr_b16 v[54:55], v103 offset:45056
    v_mfma_f32_16x16x32_bf16 v[180:183], v[92:95], v[68:71], v[180:183]
    ds_read_b64_tr_b16 v[56:57], v106 offset:40960
    v_mfma_f32_16x16x32_bf16 v[164:167], v[88:91], v[68:71], v[164:167]
    ds_read_b64_tr_b16 v[58:59], v106 offset:45056
    v_mfma_f32_16x16x32_bf16 v[148:151], v[84:87], v[68:71], v[148:151]
    ds_read_b64_tr_b16 v[60:61], v109 offset:40960
    v_mfma_f32_16x16x32_bf16 v[132:135], v[80:83], v[68:71], v[132:135]
    ds_read_b64_tr_b16 v[62:63], v109 offset:45056
    s_waitcnt lgkmcnt(8)
    v_mfma_f32_16x16x32_bf16 v[136:139], v[80:83], v[72:75], v[136:139]
    ds_read_b128 v[32:35], v97 offset:32768
    v_mfma_f32_16x16x32_bf16 v[152:155], v[84:87], v[72:75], v[152:155]
    ds_read_b128 v[36:39], v97 offset:33024
    v_mfma_f32_16x16x32_bf16 v[168:171], v[88:91], v[72:75], v[168:171]
    ds_read_b128 v[40:43], v97 offset:34816
    v_mfma_f32_16x16x32_bf16 v[184:187], v[92:95], v[72:75], v[184:187]
    ds_read_b128 v[44:47], v97 offset:35072
    v_mfma_f32_16x16x32_bf16 v[188:191], v[92:95], v[76:79], v[188:191]
    v_mfma_f32_16x16x32_bf16 v[172:175], v[88:91], v[76:79], v[172:175]
    v_mfma_f32_16x16x32_bf16 v[156:159], v[84:87], v[76:79], v[156:159]
    v_mfma_f32_16x16x32_bf16 v[140:143], v[80:83], v[76:79], v[140:143]
    s_barrier
    s_waitcnt lgkmcnt(2)
    v_mfma_f32_16x16x32_bf16 v[128:131], v[48:51], v[32:35], v[128:131]
    ds_read_b64_tr_b16 v[80:81], v100 offset:57344
    v_mfma_f32_16x16x32_bf16 v[144:147], v[52:55], v[32:35], v[144:147]
    ds_read_b64_tr_b16 v[82:83], v100 offset:61440
    v_mfma_f32_16x16x32_bf16 v[160:163], v[56:59], v[32:35], v[160:163]
    ds_read_b64_tr_b16 v[84:85], v103 offset:57344
    v_mfma_f32_16x16x32_bf16 v[176:179], v[60:63], v[32:35], v[176:179]
    ds_read_b64_tr_b16 v[86:87], v103 offset:61440
    v_mfma_f32_16x16x32_bf16 v[180:183], v[60:63], v[36:39], v[180:183]
    ds_read_b64_tr_b16 v[88:89], v106 offset:57344
    v_mfma_f32_16x16x32_bf16 v[164:167], v[56:59], v[36:39], v[164:167]
    ds_read_b64_tr_b16 v[90:91], v106 offset:61440
    v_mfma_f32_16x16x32_bf16 v[148:151], v[52:55], v[36:39], v[148:151]
    ds_read_b64_tr_b16 v[92:93], v109 offset:57344
    v_mfma_f32_16x16x32_bf16 v[132:135], v[48:51], v[36:39], v[132:135]
    ds_read_b64_tr_b16 v[94:95], v109 offset:61440
    s_waitcnt lgkmcnt(8)
    v_mfma_f32_16x16x32_bf16 v[136:139], v[48:51], v[40:43], v[136:139]
    ds_read_b128 v[64:67], v97 offset:49152
    v_mfma_f32_16x16x32_bf16 v[152:155], v[52:55], v[40:43], v[152:155]
    ds_read_b128 v[68:71], v97 offset:49408
    v_mfma_f32_16x16x32_bf16 v[168:171], v[56:59], v[40:43], v[168:171]
    ds_read_b128 v[72:75], v97 offset:51200
    v_mfma_f32_16x16x32_bf16 v[184:187], v[60:63], v[40:43], v[184:187]
    ds_read_b128 v[76:79], v97 offset:51456
    v_mfma_f32_16x16x32_bf16 v[188:191], v[60:63], v[44:47], v[188:191]
    v_mfma_f32_16x16x32_bf16 v[172:175], v[56:59], v[44:47], v[172:175]
    v_mfma_f32_16x16x32_bf16 v[156:159], v[52:55], v[44:47], v[156:159]
    v_mfma_f32_16x16x32_bf16 v[140:143], v[48:51], v[44:47], v[140:143]
    s_waitcnt lgkmcnt(2)
    v_mfma_f32_16x16x32_bf16 v[128:131], v[80:83], v[64:67], v[128:131]
    ds_read_b64_tr_b16 v[48:49], v113 offset:8192
    v_mfma_f32_16x16x32_bf16 v[144:147], v[84:87], v[64:67], v[144:147]
    ds_read_b64_tr_b16 v[50:51], v113 offset:10240
    v_mfma_f32_16x16x32_bf16 v[160:163], v[88:91], v[64:67], v[160:163]
    ds_read_b64_tr_b16 v[52:53], v116 offset:8192
    v_mfma_f32_16x16x32_bf16 v[176:179], v[92:95], v[64:67], v[176:179]
    ds_read_b64_tr_b16 v[54:55], v116 offset:10240
    v_mfma_f32_16x16x32_bf16 v[180:183], v[92:95], v[68:71], v[180:183]
    ds_read_b128 v[32:35], v98 offset:0
    v_mfma_f32_16x16x32_bf16 v[164:167], v[88:91], v[68:71], v[164:167]
    ds_read_b128 v[36:39], v98 offset:256
    v_mfma_f32_16x16x32_bf16 v[148:151], v[84:87], v[68:71], v[148:151]
    ds_read_b128 v[40:43], v98 offset:2048
    v_mfma_f32_16x16x32_bf16 v[132:135], v[80:83], v[68:71], v[132:135]
    ds_read_b128 v[44:47], v98 offset:2304
    s_waitcnt lgkmcnt(8)
    v_mfma_f32_16x16x32_bf16 v[136:139], v[80:83], v[72:75], v[136:139]
    v_mfma_f32_16x16x32_bf16 v[152:155], v[84:87], v[72:75], v[152:155]
    v_mfma_f32_16x16x32_bf16 v[168:171], v[88:91], v[72:75], v[168:171]
    v_mfma_f32_16x16x32_bf16 v[184:187], v[92:95], v[72:75], v[184:187]
    v_mfma_f32_16x16x32_bf16 v[188:191], v[92:95], v[76:79], v[188:191]
    v_mfma_f32_16x16x32_bf16 v[172:175], v[88:91], v[76:79], v[172:175]
    v_mfma_f32_16x16x32_bf16 v[156:159], v[84:87], v[76:79], v[156:159]
    v_mfma_f32_16x16x32_bf16 v[140:143], v[80:83], v[76:79], v[140:143]
    s_barrier
    s_waitcnt lgkmcnt(2)
    v_mfma_f32_16x16x32_bf16 v[128:131], v[48:51], v[32:35], v[128:131]
    ds_read_b64_tr_b16 v[80:81], v113 offset:20480
    v_mfma_f32_16x16x32_bf16 v[144:147], v[52:55], v[32:35], v[144:147]
    ds_read_b64_tr_b16 v[82:83], v113 offset:22528
    v_mfma_f32_16x16x32_bf16 v[148:151], v[52:55], v[36:39], v[148:151]
    ds_read_b64_tr_b16 v[84:85], v116 offset:20480
    v_mfma_f32_16x16x32_bf16 v[132:135], v[48:51], v[36:39], v[132:135]
    ds_read_b64_tr_b16 v[86:87], v116 offset:22528
    s_waitcnt lgkmcnt(4)
    v_mfma_f32_16x16x32_bf16 v[136:139], v[48:51], v[40:43], v[136:139]
    ds_read_b128 v[64:67], v98 offset:12288
    v_mfma_f32_16x16x32_bf16 v[152:155], v[52:55], v[40:43], v[152:155]
    ds_read_b128 v[68:71], v98 offset:12544
    v_mfma_f32_16x16x32_bf16 v[156:159], v[52:55], v[44:47], v[156:159]
    ds_read_b128 v[72:75], v98 offset:14336
    v_mfma_f32_16x16x32_bf16 v[140:143], v[48:51], v[44:47], v[140:143]
    ds_read_b128 v[76:79], v98 offset:14592
    s_waitcnt lgkmcnt(2)
    v_mfma_f32_16x16x32_bf16 v[128:131], v[80:83], v[64:67], v[128:131]
    ds_read_b64_tr_b16 v[48:49], v111 offset:8192
    v_mfma_f32_16x16x32_bf16 v[144:147], v[84:87], v[64:67], v[144:147]
    ds_read_b64_tr_b16 v[50:51], v111 offset:10240
    v_mfma_f32_16x16x32_bf16 v[148:151], v[84:87], v[68:71], v[148:151]
    ds_read_b64_tr_b16 v[52:53], v114 offset:8192
    v_mfma_f32_16x16x32_bf16 v[132:135], v[80:83], v[68:71], v[132:135]
    ds_read_b64_tr_b16 v[54:55], v114 offset:10240
    s_waitcnt lgkmcnt(4)
    v_mfma_f32_16x16x32_bf16 v[136:139], v[80:83], v[72:75], v[136:139]
    ds_read_b128 v[32:35], v96 offset:0
    v_mfma_f32_16x16x32_bf16 v[152:155], v[84:87], v[72:75], v[152:155]
    ds_read_b128 v[36:39], v96 offset:256
    v_cvt_pk_bf16_f32 v160, v160, v161
    v_cvt_pk_bf16_f32 v161, v162, v163
    v_cvt_pk_bf16_f32 v162, v164, v165
    v_cvt_pk_bf16_f32 v163, v166, v167
    v_mfma_f32_16x16x32_bf16 v[156:159], v[84:87], v[76:79], v[156:159]
    ds_read_b128 v[40:43], v96 offset:2048
    v_cvt_pk_bf16_f32 v168, v168, v169
    v_cvt_pk_bf16_f32 v169, v170, v171
    v_cvt_pk_bf16_f32 v170, v172, v173
    v_cvt_pk_bf16_f32 v171, v174, v175
    v_mfma_f32_16x16x32_bf16 v[140:143], v[80:83], v[76:79], v[140:143]
    ds_read_b128 v[44:47], v96 offset:2304
    buffer_store_dwordx4 v[160:163], v19, s[96:99], s22 offen offset:0 sc1
    s_barrier
    s_waitcnt lgkmcnt(2)
    v_mfma_f32_16x16x32_bf16 v[128:131], v[48:51], v[32:35], v[128:131]
    ds_read_b64_tr_b16 v[80:81], v111 offset:20480
    v_mfma_f32_16x16x32_bf16 v[144:147], v[52:55], v[32:35], v[144:147]
    ds_read_b64_tr_b16 v[82:83], v111 offset:22528
    v_mfma_f32_16x16x32_bf16 v[148:151], v[52:55], v[36:39], v[148:151]
    ds_read_b64_tr_b16 v[84:85], v114 offset:20480
    v_mfma_f32_16x16x32_bf16 v[132:135], v[48:51], v[36:39], v[132:135]
    ds_read_b64_tr_b16 v[86:87], v114 offset:22528
    s_waitcnt lgkmcnt(4)
    v_mfma_f32_16x16x32_bf16 v[136:139], v[48:51], v[40:43], v[136:139]
    ds_read_b128 v[64:67], v96 offset:12288
    v_mfma_f32_16x16x32_bf16 v[152:155], v[52:55], v[40:43], v[152:155]
    ds_read_b128 v[68:71], v96 offset:12544
    v_mfma_f32_16x16x32_bf16 v[156:159], v[52:55], v[44:47], v[156:159]
    ds_read_b128 v[72:75], v96 offset:14336
    v_cvt_pk_bf16_f32 v176, v176, v177
    v_cvt_pk_bf16_f32 v177, v178, v179
    v_cvt_pk_bf16_f32 v178, v180, v181
    v_cvt_pk_bf16_f32 v179, v182, v183
    v_mfma_f32_16x16x32_bf16 v[140:143], v[48:51], v[44:47], v[140:143]
    ds_read_b128 v[76:79], v96 offset:14592
    buffer_store_dwordx4 v[168:171], v19, s[96:99], s22 offen offset:1024 sc1
    s_waitcnt lgkmcnt(2)
    v_mfma_f32_16x16x32_bf16 v[128:131], v[80:83], v[64:67], v[128:131]
    ds_read_b64_tr_b16 v[48:49], v111 offset:32768
    v_mfma_f32_16x16x32_bf16 v[144:147], v[84:87], v[64:67], v[144:147]
    ds_read_b64_tr_b16 v[50:51], v111 offset:34816
    v_mfma_f32_16x16x32_bf16 v[148:151], v[84:87], v[68:71], v[148:151]
    ds_read_b64_tr_b16 v[52:53], v114 offset:32768
    v_mfma_f32_16x16x32_bf16 v[132:135], v[80:83], v[68:71], v[132:135]
    ds_read_b64_tr_b16 v[54:55], v114 offset:34816
    s_waitcnt lgkmcnt(4)
    v_mfma_f32_16x16x32_bf16 v[136:139], v[80:83], v[72:75], v[136:139]
    ds_read_b128 v[32:35], v96 offset:24576
    v_mfma_f32_16x16x32_bf16 v[152:155], v[84:87], v[72:75], v[152:155]
    ds_read_b128 v[36:39], v96 offset:24832
    v_mfma_f32_16x16x32_bf16 v[156:159], v[84:87], v[76:79], v[156:159]
    ds_read_b128 v[40:43], v96 offset:26624
    v_cvt_pk_bf16_f32 v184, v184, v185
    v_cvt_pk_bf16_f32 v185, v186, v187
    v_cvt_pk_bf16_f32 v186, v188, v189
    v_cvt_pk_bf16_f32 v187, v190, v191
    v_mfma_f32_16x16x32_bf16 v[140:143], v[80:83], v[76:79], v[140:143]
    ds_read_b128 v[44:47], v96 offset:26880
    buffer_store_dwordx4 v[176:179], v19, s[96:99], s22 offen offset:2048 sc1
    s_barrier
    s_waitcnt lgkmcnt(2)
    v_mfma_f32_16x16x32_bf16 v[128:131], v[48:51], v[32:35], v[128:131]
    ds_read_b64_tr_b16 v[80:81], v111 offset:45056
    v_mfma_f32_16x16x32_bf16 v[144:147], v[52:55], v[32:35], v[144:147]
    ds_read_b64_tr_b16 v[82:83], v111 offset:47104
    v_mfma_f32_16x16x32_bf16 v[148:151], v[52:55], v[36:39], v[148:151]
    ds_read_b64_tr_b16 v[84:85], v114 offset:45056
    v_mfma_f32_16x16x32_bf16 v[132:135], v[48:51], v[36:39], v[132:135]
    ds_read_b64_tr_b16 v[86:87], v114 offset:47104
    s_waitcnt lgkmcnt(4)
    v_mfma_f32_16x16x32_bf16 v[136:139], v[48:51], v[40:43], v[136:139]
    ds_read_b128 v[64:67], v96 offset:36864
    v_mfma_f32_16x16x32_bf16 v[152:155], v[52:55], v[40:43], v[152:155]
    ds_read_b128 v[68:71], v96 offset:37120
    v_mfma_f32_16x16x32_bf16 v[156:159], v[52:55], v[44:47], v[156:159]
    ds_read_b128 v[72:75], v96 offset:38912
    v_mfma_f32_16x16x32_bf16 v[140:143], v[48:51], v[44:47], v[140:143]
    ds_read_b128 v[76:79], v96 offset:39168
    buffer_store_dwordx4 v[184:187], v19, s[96:99], s22 offen offset:3072 sc1
    s_waitcnt lgkmcnt(2)
    v_mfma_f32_16x16x32_bf16 v[128:131], v[80:83], v[64:67], v[128:131]
    ds_read_b64_tr_b16 v[48:49], v111 offset:57344
    v_mfma_f32_16x16x32_bf16 v[144:147], v[84:87], v[64:67], v[144:147]
    ds_read_b64_tr_b16 v[50:51], v111 offset:59392
    v_mfma_f32_16x16x32_bf16 v[148:151], v[84:87], v[68:71], v[148:151]
    ds_read_b64_tr_b16 v[52:53], v114 offset:57344
    v_mfma_f32_16x16x32_bf16 v[132:135], v[80:83], v[68:71], v[132:135]
    ds_read_b64_tr_b16 v[54:55], v114 offset:59392
    s_waitcnt lgkmcnt(4)
    v_mfma_f32_16x16x32_bf16 v[136:139], v[80:83], v[72:75], v[136:139]
    ds_read_b128 v[32:35], v96 offset:49152
    v_mfma_f32_16x16x32_bf16 v[152:155], v[84:87], v[72:75], v[152:155]
    ds_read_b128 v[36:39], v96 offset:49408
    v_mfma_f32_16x16x32_bf16 v[156:159], v[84:87], v[76:79], v[156:159]
    ds_read_b128 v[40:43], v96 offset:51200
    v_mfma_f32_16x16x32_bf16 v[140:143], v[80:83], v[76:79], v[140:143]
    ds_read_b128 v[44:47], v96 offset:51456
    s_barrier
    s_waitcnt lgkmcnt(2)
    v_mfma_f32_16x16x32_bf16 v[128:131], v[48:51], v[32:35], v[128:131]
    ds_read_b64_tr_b16 v[80:81], v112 offset:8192
    v_mfma_f32_16x16x32_bf16 v[144:147], v[52:55], v[32:35], v[144:147]
    ds_read_b64_tr_b16 v[82:83], v112 offset:10240
    v_mfma_f32_16x16x32_bf16 v[148:151], v[52:55], v[36:39], v[148:151]
    ds_read_b64_tr_b16 v[84:85], v115 offset:8192
    v_mfma_f32_16x16x32_bf16 v[132:135], v[48:51], v[36:39], v[132:135]
    ds_read_b64_tr_b16 v[86:87], v115 offset:10240
    s_waitcnt lgkmcnt(4)
    v_mfma_f32_16x16x32_bf16 v[136:139], v[48:51], v[40:43], v[136:139]
    ds_read_b128 v[64:67], v97 offset:0
    v_mfma_f32_16x16x32_bf16 v[152:155], v[52:55], v[40:43], v[152:155]
    ds_read_b128 v[68:71], v97 offset:256
    v_mfma_f32_16x16x32_bf16 v[156:159], v[52:55], v[44:47], v[156:159]
    ds_read_b128 v[72:75], v97 offset:2048
    v_mfma_f32_16x16x32_bf16 v[140:143], v[48:51], v[44:47], v[140:143]
    ds_read_b128 v[76:79], v97 offset:2304
    s_waitcnt lgkmcnt(2)
    v_mfma_f32_16x16x32_bf16 v[128:131], v[80:83], v[64:67], v[128:131]
    ds_read_b64_tr_b16 v[48:49], v112 offset:20480
    v_mfma_f32_16x16x32_bf16 v[144:147], v[84:87], v[64:67], v[144:147]
    ds_read_b64_tr_b16 v[50:51], v112 offset:22528
    v_mfma_f32_16x16x32_bf16 v[148:151], v[84:87], v[68:71], v[148:151]
    ds_read_b64_tr_b16 v[52:53], v115 offset:20480
    v_mfma_f32_16x16x32_bf16 v[132:135], v[80:83], v[68:71], v[132:135]
    ds_read_b64_tr_b16 v[54:55], v115 offset:22528
    s_waitcnt lgkmcnt(4)
    v_mfma_f32_16x16x32_bf16 v[136:139], v[80:83], v[72:75], v[136:139]
    ds_read_b128 v[32:35], v97 offset:12288
    v_mfma_f32_16x16x32_bf16 v[152:155], v[84:87], v[72:75], v[152:155]
    ds_read_b128 v[36:39], v97 offset:12544
    v_mfma_f32_16x16x32_bf16 v[156:159], v[84:87], v[76:79], v[156:159]
    ds_read_b128 v[40:43], v97 offset:14336
    v_mfma_f32_16x16x32_bf16 v[140:143], v[80:83], v[76:79], v[140:143]
    ds_read_b128 v[44:47], v97 offset:14592
    s_waitcnt vmcnt(0)
    s_barrier
    s_waitcnt lgkmcnt(2)
    v_mfma_f32_16x16x32_bf16 v[128:131], v[48:51], v[32:35], v[128:131]
    ds_read_b64_tr_b16 v[80:81], v112 offset:32768
    v_mfma_f32_16x16x32_bf16 v[144:147], v[52:55], v[32:35], v[144:147]
    ds_read_b64_tr_b16 v[82:83], v112 offset:34816
    v_mfma_f32_16x16x32_bf16 v[148:151], v[52:55], v[36:39], v[148:151]
    ds_read_b64_tr_b16 v[84:85], v115 offset:32768
    v_mfma_f32_16x16x32_bf16 v[132:135], v[48:51], v[36:39], v[132:135]
    ds_read_b64_tr_b16 v[86:87], v115 offset:34816
    s_waitcnt lgkmcnt(4)
    v_mfma_f32_16x16x32_bf16 v[136:139], v[48:51], v[40:43], v[136:139]
    ds_read_b128 v[64:67], v97 offset:24576
    v_mfma_f32_16x16x32_bf16 v[152:155], v[52:55], v[40:43], v[152:155]
    ds_read_b128 v[68:71], v97 offset:24832
    v_mfma_f32_16x16x32_bf16 v[156:159], v[52:55], v[44:47], v[156:159]
    ds_read_b128 v[72:75], v97 offset:26624
    v_mfma_f32_16x16x32_bf16 v[140:143], v[48:51], v[44:47], v[140:143]
    ds_read_b128 v[76:79], v97 offset:26880
    s_waitcnt lgkmcnt(2)
    v_mfma_f32_16x16x32_bf16 v[128:131], v[80:83], v[64:67], v[128:131]
    ds_read_b64_tr_b16 v[48:49], v112 offset:45056
    v_mfma_f32_16x16x32_bf16 v[144:147], v[84:87], v[64:67], v[144:147]
    ds_read_b64_tr_b16 v[50:51], v112 offset:47104
    v_mfma_f32_16x16x32_bf16 v[148:151], v[84:87], v[68:71], v[148:151]
    ds_read_b64_tr_b16 v[52:53], v115 offset:45056
    v_mfma_f32_16x16x32_bf16 v[132:135], v[80:83], v[68:71], v[132:135]
    ds_read_b64_tr_b16 v[54:55], v115 offset:47104
    s_waitcnt lgkmcnt(4)
    v_mfma_f32_16x16x32_bf16 v[136:139], v[80:83], v[72:75], v[136:139]
    ds_read_b128 v[32:35], v97 offset:36864
    v_mfma_f32_16x16x32_bf16 v[152:155], v[84:87], v[72:75], v[152:155]
    ds_read_b128 v[36:39], v97 offset:37120
    v_mfma_f32_16x16x32_bf16 v[156:159], v[84:87], v[76:79], v[156:159]
    ds_read_b128 v[40:43], v97 offset:38912
    v_mfma_f32_16x16x32_bf16 v[140:143], v[80:83], v[76:79], v[140:143]
    ds_read_b128 v[44:47], v97 offset:39168
    s_barrier
    s_waitcnt lgkmcnt(2)
    v_mfma_f32_16x16x32_bf16 v[128:131], v[48:51], v[32:35], v[128:131]
    ds_read_b64_tr_b16 v[80:81], v112 offset:57344
    v_mfma_f32_16x16x32_bf16 v[144:147], v[52:55], v[32:35], v[144:147]
    ds_read_b64_tr_b16 v[82:83], v112 offset:59392
    v_mfma_f32_16x16x32_bf16 v[148:151], v[52:55], v[36:39], v[148:151]
    ds_read_b64_tr_b16 v[84:85], v115 offset:57344
    v_mfma_f32_16x16x32_bf16 v[132:135], v[48:51], v[36:39], v[132:135]
    ds_read_b64_tr_b16 v[86:87], v115 offset:59392
    s_waitcnt lgkmcnt(4)
    v_mfma_f32_16x16x32_bf16 v[136:139], v[48:51], v[40:43], v[136:139]
    ds_read_b128 v[64:67], v97 offset:49152
    v_mfma_f32_16x16x32_bf16 v[152:155], v[52:55], v[40:43], v[152:155]
    ds_read_b128 v[68:71], v97 offset:49408
    v_mfma_f32_16x16x32_bf16 v[156:159], v[52:55], v[44:47], v[156:159]
    ds_read_b128 v[72:75], v97 offset:51200
    v_mfma_f32_16x16x32_bf16 v[140:143], v[48:51], v[44:47], v[140:143]
    ds_read_b128 v[76:79], v97 offset:51456
    s_waitcnt lgkmcnt(2)
    v_mfma_f32_16x16x32_bf16 v[128:131], v[80:83], v[64:67], v[128:131]
    ds_read_b64_tr_b16 v[48:49], v113 offset:8192
    v_mfma_f32_16x16x32_bf16 v[144:147], v[84:87], v[64:67], v[144:147]
    ds_read_b64_tr_b16 v[50:51], v113 offset:10240
    v_mfma_f32_16x16x32_bf16 v[148:151], v[84:87], v[68:71], v[148:151]
    ds_read_b64_tr_b16 v[52:53], v116 offset:8192
    v_mfma_f32_16x16x32_bf16 v[132:135], v[80:83], v[68:71], v[132:135]
    ds_read_b64_tr_b16 v[54:55], v116 offset:10240
    s_waitcnt lgkmcnt(4)
    v_mfma_f32_16x16x32_bf16 v[136:139], v[80:83], v[72:75], v[136:139]
    ds_read_b128 v[32:35], v98 offset:0
    v_mfma_f32_16x16x32_bf16 v[152:155], v[84:87], v[72:75], v[152:155]
    ds_read_b128 v[36:39], v98 offset:256
    v_mfma_f32_16x16x32_bf16 v[156:159], v[84:87], v[76:79], v[156:159]
    ds_read_b128 v[40:43], v98 offset:2048
    v_mfma_f32_16x16x32_bf16 v[140:143], v[80:83], v[76:79], v[140:143]
    ds_read_b128 v[44:47], v98 offset:2304
    s_barrier
    s_waitcnt lgkmcnt(2)
    v_mfma_f32_16x16x32_bf16 v[128:131], v[48:51], v[32:35], v[128:131]
    ds_read_b64_tr_b16 v[80:81], v113 offset:20480
    v_mfma_f32_16x16x32_bf16 v[144:147], v[52:55], v[32:35], v[144:147]
    ds_read_b64_tr_b16 v[82:83], v113 offset:22528
    v_mfma_f32_16x16x32_bf16 v[148:151], v[52:55], v[36:39], v[148:151]
    ds_read_b64_tr_b16 v[84:85], v116 offset:20480
    v_mfma_f32_16x16x32_bf16 v[132:135], v[48:51], v[36:39], v[132:135]
    ds_read_b64_tr_b16 v[86:87], v116 offset:22528
    s_waitcnt lgkmcnt(4)
    v_mfma_f32_16x16x32_bf16 v[136:139], v[48:51], v[40:43], v[136:139]
    ds_read_b128 v[64:67], v98 offset:12288
    v_mfma_f32_16x16x32_bf16 v[152:155], v[52:55], v[40:43], v[152:155]
    ds_read_b128 v[68:71], v98 offset:12544
    v_mfma_f32_16x16x32_bf16 v[156:159], v[52:55], v[44:47], v[156:159]
    ds_read_b128 v[72:75], v98 offset:14336
    v_mfma_f32_16x16x32_bf16 v[140:143], v[48:51], v[44:47], v[140:143]
    ds_read_b128 v[76:79], v98 offset:14592
    s_waitcnt lgkmcnt(2)
    v_mfma_f32_16x16x32_bf16 v[128:131], v[80:83], v[64:67], v[128:131]
    ds_read_b64_tr_b16 v[48:49], v111 offset:8192
    v_mfma_f32_16x16x32_bf16 v[144:147], v[84:87], v[64:67], v[144:147]
    ds_read_b64_tr_b16 v[50:51], v111 offset:10240
    v_mfma_f32_16x16x32_bf16 v[148:151], v[84:87], v[68:71], v[148:151]
    ds_read_b64_tr_b16 v[52:53], v114 offset:8192
    v_mfma_f32_16x16x32_bf16 v[132:135], v[80:83], v[68:71], v[132:135]
    ds_read_b64_tr_b16 v[54:55], v114 offset:10240
    s_waitcnt lgkmcnt(4)
    v_mfma_f32_16x16x32_bf16 v[136:139], v[80:83], v[72:75], v[136:139]
    ds_read_b128 v[32:35], v96 offset:0
    v_mfma_f32_16x16x32_bf16 v[152:155], v[84:87], v[72:75], v[152:155]
    ds_read_b128 v[36:39], v96 offset:256
    v_mfma_f32_16x16x32_bf16 v[156:159], v[84:87], v[76:79], v[156:159]
    ds_read_b128 v[40:43], v96 offset:2048
    v_mfma_f32_16x16x32_bf16 v[140:143], v[80:83], v[76:79], v[140:143]
    ds_read_b128 v[44:47], v96 offset:2304
    s_barrier
    s_waitcnt lgkmcnt(2)
    v_mfma_f32_16x16x32_bf16 v[128:131], v[48:51], v[32:35], v[128:131]
    ds_read_b64_tr_b16 v[80:81], v111 offset:20480
    v_mfma_f32_16x16x32_bf16 v[144:147], v[52:55], v[32:35], v[144:147]
    ds_read_b64_tr_b16 v[82:83], v111 offset:22528
    v_mfma_f32_16x16x32_bf16 v[148:151], v[52:55], v[36:39], v[148:151]
    ds_read_b64_tr_b16 v[84:85], v114 offset:20480
    v_mfma_f32_16x16x32_bf16 v[132:135], v[48:51], v[36:39], v[132:135]
    ds_read_b64_tr_b16 v[86:87], v114 offset:22528
    s_waitcnt lgkmcnt(4)
    v_mfma_f32_16x16x32_bf16 v[136:139], v[48:51], v[40:43], v[136:139]
    ds_read_b128 v[64:67], v96 offset:12288
    v_mfma_f32_16x16x32_bf16 v[152:155], v[52:55], v[40:43], v[152:155]
    ds_read_b128 v[68:71], v96 offset:12544
    v_mfma_f32_16x16x32_bf16 v[156:159], v[52:55], v[44:47], v[156:159]
    ds_read_b128 v[72:75], v96 offset:14336
    buffer_load_dwordx4 v[196:199], v19, s[96:99], s57 offen offset:1024 sc1
    v_mfma_f32_16x16x32_bf16 v[140:143], v[48:51], v[44:47], v[140:143]
    ds_read_b128 v[76:79], v96 offset:14592
    buffer_load_dwordx4 v[192:195], v19, s[96:99], s57 offen offset:0 sc1
    s_waitcnt lgkmcnt(2)
    v_mfma_f32_16x16x32_bf16 v[128:131], v[80:83], v[64:67], v[128:131]
    ds_read_b64_tr_b16 v[48:49], v111 offset:32768
    v_mfma_f32_16x16x32_bf16 v[144:147], v[84:87], v[64:67], v[144:147]
    ds_read_b64_tr_b16 v[50:51], v111 offset:34816
    v_mfma_f32_16x16x32_bf16 v[148:151], v[84:87], v[68:71], v[148:151]
    ds_read_b64_tr_b16 v[52:53], v114 offset:32768
    v_mfma_f32_16x16x32_bf16 v[132:135], v[80:83], v[68:71], v[132:135]
    ds_read_b64_tr_b16 v[54:55], v114 offset:34816
    s_waitcnt lgkmcnt(4)
    v_mfma_f32_16x16x32_bf16 v[136:139], v[80:83], v[72:75], v[136:139]
    ds_read_b128 v[32:35], v96 offset:24576
    v_mfma_f32_16x16x32_bf16 v[152:155], v[84:87], v[72:75], v[152:155]
    ds_read_b128 v[36:39], v96 offset:24832
    v_mfma_f32_16x16x32_bf16 v[156:159], v[84:87], v[76:79], v[156:159]
    ds_read_b128 v[40:43], v96 offset:26624
    buffer_load_dwordx4 v[204:207], v19, s[96:99], s57 offen offset:3072 sc1
    v_mfma_f32_16x16x32_bf16 v[140:143], v[80:83], v[76:79], v[140:143]
    ds_read_b128 v[44:47], v96 offset:26880
    buffer_load_dwordx4 v[200:203], v19, s[96:99], s57 offen offset:2048 sc1
    s_barrier
    s_waitcnt lgkmcnt(2)
    v_mfma_f32_16x16x32_bf16 v[128:131], v[48:51], v[32:35], v[128:131]
    ds_read_b64_tr_b16 v[80:81], v111 offset:45056
    v_mfma_f32_16x16x32_bf16 v[144:147], v[52:55], v[32:35], v[144:147]
    ds_read_b64_tr_b16 v[82:83], v111 offset:47104
    v_mfma_f32_16x16x32_bf16 v[148:151], v[52:55], v[36:39], v[148:151]
    ds_read_b64_tr_b16 v[84:85], v114 offset:45056
    v_mfma_f32_16x16x32_bf16 v[132:135], v[48:51], v[36:39], v[132:135]
    ds_read_b64_tr_b16 v[86:87], v114 offset:47104
    s_waitcnt lgkmcnt(4)
    v_mfma_f32_16x16x32_bf16 v[136:139], v[48:51], v[40:43], v[136:139]
    ds_read_b128 v[64:67], v96 offset:36864
    v_mfma_f32_16x16x32_bf16 v[152:155], v[52:55], v[40:43], v[152:155]
    ds_read_b128 v[68:71], v96 offset:37120
    v_mfma_f32_16x16x32_bf16 v[156:159], v[52:55], v[44:47], v[156:159]
    ds_read_b128 v[72:75], v96 offset:38912
    v_mfma_f32_16x16x32_bf16 v[140:143], v[48:51], v[44:47], v[140:143]
    ds_read_b128 v[76:79], v96 offset:39168
    s_waitcnt lgkmcnt(2)
    v_mfma_f32_16x16x32_bf16 v[128:131], v[80:83], v[64:67], v[128:131]
    ds_read_b64_tr_b16 v[48:49], v111 offset:57344
    v_mfma_f32_16x16x32_bf16 v[144:147], v[84:87], v[64:67], v[144:147]
    ds_read_b64_tr_b16 v[50:51], v111 offset:59392
    v_mfma_f32_16x16x32_bf16 v[148:151], v[84:87], v[68:71], v[148:151]
    ds_read_b64_tr_b16 v[52:53], v114 offset:57344
    v_mfma_f32_16x16x32_bf16 v[132:135], v[80:83], v[68:71], v[132:135]
    ds_read_b64_tr_b16 v[54:55], v114 offset:59392
    s_waitcnt lgkmcnt(4)
    v_mfma_f32_16x16x32_bf16 v[136:139], v[80:83], v[72:75], v[136:139]
    ds_read_b128 v[32:35], v96 offset:49152
    v_mfma_f32_16x16x32_bf16 v[152:155], v[84:87], v[72:75], v[152:155]
    ds_read_b128 v[36:39], v96 offset:49408
    v_mfma_f32_16x16x32_bf16 v[156:159], v[84:87], v[76:79], v[156:159]
    ds_read_b128 v[40:43], v96 offset:51200
    v_mfma_f32_16x16x32_bf16 v[140:143], v[80:83], v[76:79], v[140:143]
    ds_read_b128 v[44:47], v96 offset:51456
    s_barrier
    s_waitcnt lgkmcnt(2)
    v_mfma_f32_16x16x32_bf16 v[128:131], v[48:51], v[32:35], v[128:131]
    ds_read_b64_tr_b16 v[80:81], v112 offset:8192
    v_mfma_f32_16x16x32_bf16 v[144:147], v[52:55], v[32:35], v[144:147]
    ds_read_b64_tr_b16 v[82:83], v112 offset:10240
    v_mfma_f32_16x16x32_bf16 v[148:151], v[52:55], v[36:39], v[148:151]
    ds_read_b64_tr_b16 v[84:85], v115 offset:8192
    v_mfma_f32_16x16x32_bf16 v[132:135], v[48:51], v[36:39], v[132:135]
    ds_read_b64_tr_b16 v[86:87], v115 offset:10240
    s_waitcnt lgkmcnt(4)
    v_mfma_f32_16x16x32_bf16 v[136:139], v[48:51], v[40:43], v[136:139]
    ds_read_b128 v[64:67], v97 offset:0
    v_mfma_f32_16x16x32_bf16 v[152:155], v[52:55], v[40:43], v[152:155]
    ds_read_b128 v[68:71], v97 offset:256
    v_mfma_f32_16x16x32_bf16 v[156:159], v[52:55], v[44:47], v[156:159]
    ds_read_b128 v[72:75], v97 offset:2048
    v_mfma_f32_16x16x32_bf16 v[140:143], v[48:51], v[44:47], v[140:143]
    ds_read_b128 v[76:79], v97 offset:2304
    s_waitcnt lgkmcnt(2)
    v_mfma_f32_16x16x32_bf16 v[128:131], v[80:83], v[64:67], v[128:131]
    v_mfma_f32_16x16x32_bf16 v[144:147], v[84:87], v[64:67], v[144:147]
    v_mfma_f32_16x16x32_bf16 v[148:151], v[84:87], v[68:71], v[148:151]
    v_mfma_f32_16x16x32_bf16 v[132:135], v[80:83], v[68:71], v[132:135]
    s_waitcnt lgkmcnt(0)
    v_mfma_f32_16x16x32_bf16 v[136:139], v[80:83], v[72:75], v[136:139]
    v_mfma_f32_16x16x32_bf16 v[152:155], v[84:87], v[72:75], v[152:155]
    v_mfma_f32_16x16x32_bf16 v[156:159], v[84:87], v[76:79], v[156:159]
    v_mfma_f32_16x16x32_bf16 v[140:143], v[80:83], v[76:79], v[140:143]
P3_GE:
    s_mov_b32 s32, 0xffff0000
    s_waitcnt vmcnt(0)
    s_nop 6
    v_lshlrev_b32 v40, 16, v192
    v_and_b32 v41, s32, v192
    v_lshlrev_b32 v42, 16, v193
    v_and_b32 v43, s32, v193
    v_pk_add_f32 v[128:129], v[128:129], v[40:41]
    v_pk_add_f32 v[130:131], v[130:131], v[42:43]
    v_lshlrev_b32 v40, 16, v200
    v_and_b32 v41, s32, v200
    v_lshlrev_b32 v42, 16, v201
    v_and_b32 v43, s32, v201
    v_pk_add_f32 v[144:145], v[144:145], v[40:41]
    v_pk_add_f32 v[146:147], v[146:147], v[42:43]
    v_lshlrev_b32 v32, 16, v224
    v_and_b32 v33, s32, v224
    v_lshlrev_b32 v34, 16, v225
    v_and_b32 v35, s32, v225
    v_lshlrev_b32 v36, 16, v226
    v_and_b32 v37, s32, v226
    v_lshlrev_b32 v38, 16, v227
    v_and_b32 v39, s32, v227
    v_permlane16_swap_b32 v128, v144
    v_permlane16_swap_b32 v129, v145
    v_permlane16_swap_b32 v130, v146
    v_permlane16_swap_b32 v131, v147
    v_pk_add_f32 v[128:129], v[128:129], v[32:33]
    v_pk_add_f32 v[130:131], v[130:131], v[34:35]
    v_pk_add_f32 v[144:145], v[144:145], v[36:37]
    v_pk_add_f32 v[146:147], v[146:147], v[38:39]
    v_cvt_pk_bf16_f32 v224, v128, v129
    v_cvt_pk_bf16_f32 v225, v130, v131
    v_cvt_pk_bf16_f32 v226, v144, v145
    v_cvt_pk_bf16_f32 v227, v146, v147
    buffer_store_dwordx4 v[224:227], v8, s[40:43], s21 offen
    v_lshlrev_b32 v40, 16, v194
    v_and_b32 v41, s32, v194
    v_lshlrev_b32 v42, 16, v195
    v_and_b32 v43, s32, v195
    v_pk_add_f32 v[132:133], v[132:133], v[40:41]
    v_pk_add_f32 v[134:135], v[134:135], v[42:43]
    v_lshlrev_b32 v40, 16, v202
    v_and_b32 v41, s32, v202
    v_lshlrev_b32 v42, 16, v203
    v_and_b32 v43, s32, v203
    v_pk_add_f32 v[148:149], v[148:149], v[40:41]
    v_pk_add_f32 v[150:151], v[150:151], v[42:43]
    v_lshlrev_b32 v32, 16, v228
    v_and_b32 v33, s32, v228
    v_lshlrev_b32 v34, 16, v229
    v_and_b32 v35, s32, v229
    v_lshlrev_b32 v36, 16, v230
    v_and_b32 v37, s32, v230
    v_lshlrev_b32 v38, 16, v231
    v_and_b32 v39, s32, v231
    v_permlane16_swap_b32 v132, v148
    v_permlane16_swap_b32 v133, v149
    v_permlane16_swap_b32 v134, v150
    v_permlane16_swap_b32 v135, v151
    v_pk_add_f32 v[132:133], v[132:133], v[32:33]
    v_pk_add_f32 v[134:135], v[134:135], v[34:35]
    v_pk_add_f32 v[148:149], v[148:149], v[36:37]
    v_pk_add_f32 v[150:151], v[150:151], v[38:39]
    v_cvt_pk_bf16_f32 v228, v132, v133
    v_cvt_pk_bf16_f32 v229, v134, v135
    v_cvt_pk_bf16_f32 v230, v148, v149
    v_cvt_pk_bf16_f32 v231, v150, v151
    buffer_store_dwordx4 v[228:231], v9, s[40:43], s21 offen
    v_lshlrev_b32 v40, 16, v196
    v_and_b32 v41, s32, v196
    v_lshlrev_b32 v42, 16, v197
    v_and_b32 v43, s32, v197
    v_pk_add_f32 v[136:137], v[136:137], v[40:41]
    v_pk_add_f32 v[138:139], v[138:139], v[42:43]
    v_lshlrev_b32 v40, 16, v204
    v_and_b32 v41, s32, v204
    v_lshlrev_b32 v42, 16, v205
    v_and_b32 v43, s32, v205
    v_pk_add_f32 v[152:153], v[152:153], v[40:41]
    v_pk_add_f32 v[154:155], v[154:155], v[42:43]
    v_lshlrev_b32 v32, 16, v232
    v_and_b32 v33, s32, v232
    v_lshlrev_b32 v34, 16, v233
    v_and_b32 v35, s32, v233
    v_lshlrev_b32 v36, 16, v234
    v_and_b32 v37, s32, v234
    v_lshlrev_b32 v38, 16, v235
    v_and_b32 v39, s32, v235
    v_permlane16_swap_b32 v136, v152
    v_permlane16_swap_b32 v137, v153
    v_permlane16_swap_b32 v138, v154
    v_permlane16_swap_b32 v139, v155
    v_pk_add_f32 v[136:137], v[136:137], v[32:33]
    v_pk_add_f32 v[138:139], v[138:139], v[34:35]
    v_pk_add_f32 v[152:153], v[152:153], v[36:37]
    v_pk_add_f32 v[154:155], v[154:155], v[38:39]
    v_cvt_pk_bf16_f32 v232, v136, v137
    v_cvt_pk_bf16_f32 v233, v138, v139
    v_cvt_pk_bf16_f32 v234, v152, v153
    v_cvt_pk_bf16_f32 v235, v154, v155
    buffer_store_dwordx4 v[232:235], v10, s[40:43], s21 offen
    v_lshlrev_b32 v40, 16, v198
    v_and_b32 v41, s32, v198
    v_lshlrev_b32 v42, 16, v199
    v_and_b32 v43, s32, v199
    v_pk_add_f32 v[140:141], v[140:141], v[40:41]
    v_pk_add_f32 v[142:143], v[142:143], v[42:43]
    v_lshlrev_b32 v40, 16, v206
    v_and_b32 v41, s32, v206
    v_lshlrev_b32 v42, 16, v207
    v_and_b32 v43, s32, v207
    v_pk_add_f32 v[156:157], v[156:157], v[40:41]
    v_pk_add_f32 v[158:159], v[158:159], v[42:43]
    v_lshlrev_b32 v32, 16, v236
    v_and_b32 v33, s32, v236
    v_lshlrev_b32 v34, 16, v237
    v_and_b32 v35, s32, v237
    v_lshlrev_b32 v36, 16, v238
    v_and_b32 v37, s32, v238
    v_lshlrev_b32 v38, 16, v239
    v_and_b32 v39, s32, v239
    v_permlane16_swap_b32 v140, v156
    v_permlane16_swap_b32 v141, v157
    v_permlane16_swap_b32 v142, v158
    v_permlane16_swap_b32 v143, v159
    v_pk_add_f32 v[140:141], v[140:141], v[32:33]
    v_pk_add_f32 v[142:143], v[142:143], v[34:35]
    v_pk_add_f32 v[156:157], v[156:157], v[36:37]
    v_pk_add_f32 v[158:159], v[158:159], v[38:39]
    v_cvt_pk_bf16_f32 v236, v140, v141
    v_cvt_pk_bf16_f32 v237, v142, v143
    v_cvt_pk_bf16_f32 v238, v156, v157
    v_cvt_pk_bf16_f32 v239, v158, v159
    buffer_store_dwordx4 v[236:239], v11, s[40:43], s21 offen
    s_branch KM_FIN
P3_L:
    s_lshl_b32 s35, s31, 11
    v_add_u32 v4, s35, v19
    s_lshl_b32 s32, s31, 14
    s_lshl_b32 s33, s53, 8
    s_add_u32 s32, s32, s33
    v_add_u32 v5, s32, v3
    v_xor_b32 v6, 128, v5
    v_add_u32 v6, 7168, v6
    v_lshrrev_b32 v22, 3, v1
    v_lshlrev_b32 v22, 11, v22
    v_lshlrev_b32 v23, 1, v16
    v_and_b32 v25, 7, v1
    v_xor_b32 v23, v23, v25
    v_lshl_add_u32 v22, v23, 4, v22
    s_lshl_b32 s33, s54, 7
    s_add_u32 s32, s32, s33
    v_add_u32 v7, s32, v22
    s_lshl_b32 s34, s31, 10
    s_sub_u32 s34, 8192, s34
    s_lshl_b32 s55, s2, 7
    s_add_u32 s55, s55, 32768
    s_xor_b32 s56, s55, 128
    s_barrier
    s_add_u32 m0, s57, s35
    s_add_u32 s57, s57, 16384
    buffer_load_dwordx4 v4, s[36:39], s21 offen sc1 lds
    buffer_load_dwordx4 v4, s[36:39], s21 offen offset:1024 sc1 lds
    s_add_u32 m0, m0, 8192
    s_cmp_lt_u32 s57, 163840
    buffer_load_dwordx4 v5, s[16:19], s22 offen sc1 lds
    buffer_load_dwordx4 v6, s[16:19], s22 offen offset:1024 sc1 lds
    s_cselect_b32 s57, s57, 0
    s_add_u32 s21, s21, 8192
    s_add_u32 s22, s22, 65536
    s_add_u32 m0, s57, s35
    s_add_u32 s57, s57, 16384
    buffer_load_dwordx4 v4, s[36:39], s21 offen sc1 lds
    buffer_load_dwordx4 v4, s[36:39], s21 offen offset:1024 sc1 lds
    s_add_u32 m0, m0, 8192
    s_cmp_lt_u32 s57, 163840
    buffer_load_dwordx4 v5, s[16:19], s22 offen sc1 lds
    buffer_load_dwordx4 v6, s[16:19], s22 offen offset:1024 sc1 lds
    s_cselect_b32 s57, s57, 0
    s_add_u32 s21, s21, 8192
    s_add_u32 s22, s22, 65536
    s_waitcnt vmcnt(10)
    s_barrier
    s_add_u32 m0, s57, s35
    s_add_u32 s57, s57, 16384
    buffer_load_dwordx4 v4, s[36:39], s21 offen sc1 lds
    buffer_load_dwordx4 v4, s[36:39], s21 offen offset:1024 sc1 lds
    s_add_u32 m0, m0, 8192
    s_cmp_lt_u32 s57, 163840
    buffer_load_dwordx4 v5, s[16:19], s22 offen sc1 lds
    buffer_load_dwordx4 v6, s[16:19], s22 offen offset:1024 sc1 lds
    s_cselect_b32 s57, s57, 0
    s_add_u32 s21, s21, 8192
    s_add_u32 s22, s22, 65536
    s_add_u32 m0, s57, s35
    s_add_u32 s57, s57, 16384
    buffer_load_dwordx4 v4, s[36:39], s21 offen sc1 lds
    buffer_load_dwordx4 v4, s[36:39], s21 offen offset:1024 sc1 lds
    s_add_u32 m0, m0, 8192
    s_cmp_lt_u32 s57, 163840
    buffer_load_dwordx4 v5, s[16:19], s22 offen sc1 lds
    buffer_load_dwordx4 v6, s[16:19], s22 offen offset:1024 sc1 lds
    s_cselect_b32 s57, s57, 0
    s_add_u32 s21, s21, 8192
    s_add_u32 s22, s22, 65536
    s_waitcnt vmcnt(18)
    s_barrier
    s_add_u32 m0, s57, s35
    s_add_u32 s57, s57, 16384
    buffer_load_dwordx4 v4, s[36:39], s21 offen sc1 lds
    buffer_load_dwordx4 v4, s[36:39], s21 offen offset:1024 sc1 lds
    s_add_u32 m0, m0, 8192
    s_cmp_lt_u32 s57, 163840
    buffer_load_dwordx4 v5, s[16:19], s22 offen sc1 lds
    buffer_load_dwordx4 v6, s[16:19], s22 offen offset:1024 sc1 lds
    s_cselect_b32 s57, s57, 0
    s_add_u32 s21, s21, 8192
    s_add_u32 s22, s22, 65536
    s_add_u32 m0, s57, s35
    s_add_u32 s57, s57, 16384
    buffer_load_dwordx4 v4, s[36:39], s21 offen sc1 lds
    buffer_load_dwordx4 v4, s[36:39], s21 offen offset:1024 sc1 lds
    s_add_u32 m0, m0, 8192
    s_cmp_lt_u32 s57, 163840
    buffer_load_dwordx4 v5, s[16:19], s22 offen sc1 lds
    buffer_load_dwordx4 v6, s[16:19], s22 offen offset:1024 sc1 lds
    s_cselect_b32 s57, s57, 0
    s_add_u32 s21, s21, 8192
    s_add_u32 s22, s22, 65536
    s_waitcnt vmcnt(20)
    s_barrier
    s_cmp_lg_u32 s3, 4
    s_cbranch_scc1 W4_10
    v_mov_b32 v22, s20
    v_mov_b32 v24, s8
    v_mov_b32 v25, s9
    s_mov_b64 exec, 1
    global_store_dwordx2 v22, v[24:25], s[58:59] sc1
    s_mov_b64 exec, -1
W4_10:
    s_add_u32 m0, s57, s35
    s_add_u32 s57, s57, 16384
    buffer_load_dwordx4 v4, s[36:39], s21 offen sc1 lds
    buffer_load_dwordx4 v4, s[36:39], s21 offen offset:1024 sc1 lds
    s_add_u32 m0, m0, 8192
    s_cmp_lt_u32 s57, 163840
    buffer_load_dwordx4 v5, s[16:19], s22 offen sc1 lds
    buffer_load_dwordx4 v6, s[16:19], s22 offen offset:1024 sc1 lds
    s_cselect_b32 s57, s57, 0
    s_add_u32 s21, s21, 8192
    s_add_u32 s22, s22, 65536
    s_add_u32 m0, s57, s35
    s_add_u32 s57, s57, 16384
    buffer_load_dwordx4 v4, s[36:39], s21 offen sc1 lds
    buffer_load_dwordx4 v4, s[36:39], s21 offen offset:1024 sc1 lds
    s_add_u32 m0, m0, 8192
    s_cmp_lt_u32 s57, 163840
    buffer_load_dwordx4 v5, s[16:19], s22 offen sc1 lds
    buffer_load_dwordx4 v6, s[16:19], s22 offen offset:1024 sc1 lds
    s_cselect_b32 s57, s57, 0
    s_add_u32 s21, s21, 8192
    s_add_u32 s22, s22, 65536
    s_waitcnt vmcnt(20)
    s_mov_b32 s25, 16
P3_LA:
    s_barrier
    s_add_u32 m0, s57, s35
    s_add_u32 s57, s57, 16384
    buffer_load_dwordx4 v4, s[36:39], s21 offen sc1 lds
    buffer_load_dwordx4 v4, s[36:39], s21 offen offset:1024 sc1 lds
    s_add_u32 m0, m0, 8192
    s_cmp_lt_u32 s57, 163840
    buffer_load_dwordx4 v5, s[16:19], s22 offen sc1 lds
    buffer_load_dwordx4 v6, s[16:19], s22 offen offset:1024 sc1 lds
    s_cselect_b32 s57, s57, 0
    s_add_u32 s21, s21, 8192
    s_add_u32 s22, s22, 65536
    s_add_u32 m0, s57, s35
    s_add_u32 s57, s57, 16384
    buffer_load_dwordx4 v4, s[36:39], s21 offen sc1 lds
    buffer_load_dwordx4 v4, s[36:39], s21 offen offset:1024 sc1 lds
    s_add_u32 m0, m0, 8192
    s_cmp_lt_u32 s57, 163840
    buffer_load_dwordx4 v5, s[16:19], s22 offen sc1 lds
    buffer_load_dwordx4 v6, s[16:19], s22 offen offset:1024 sc1 lds
    s_cselect_b32 s57, s57, 0
    s_add_u32 s21, s21, 8192
    s_add_u32 s22, s22, 65536
    s_waitcnt vmcnt(20)
    s_sub_u32 s25, s25, 1
    s_cmp_lg_u32 s25, 0
    s_cbranch_scc1 P3_LA
    s_cmp_lg_u32 s54, 0
    s_cbranch_scc1 P3_L1
    s_barrier
    s_cmp_lg_u32 s3, 4
    s_cbranch_scc1 W4_11
    s_lshr_b32 s32, s52, 1
    s_lshl_b32 s32, s32, 8
    s_add_u32 s32, s32, 16384
    v_and_b32 v27, 31, v1
    v_lshlrev_b32 v27, 3, v27
    v_add_u32 v27, s32, v27
    global_load_dwordx2 v[28:29], v27, s[58:59] sc1
W4_11:
    s_add_u32 m0, s35, 131072
    s_nop 0
    buffer_load_dwordx4 v4, s[36:39], s21 offen sc1 lds
    buffer_load_dwordx4 v4, s[36:39], s21 offen offset:1024 sc1 lds
    s_add_u32 m0, m0, 8192
    s_cmp_lt_u32 s57, 163840
    buffer_load_dwordx4 v5, s[16:19], s22 offen sc1 lds
    buffer_load_dwordx4 v6, s[16:19], s22 offen offset:1024 sc1 lds
    s_add_u32 s21, s21, 8192
    s_add_u32 s22, s22, 65536
    s_add_u32 m0, s35, 147456
    s_nop 0
    buffer_load_dwordx4 v4, s[36:39], s21 offen sc1 lds
    buffer_load_dwordx4 v4, s[36:39], s21 offen offset:1024 sc1 lds
    s_add_u32 m0, m0, 8192
    s_cmp_lt_u32 s57, 163840
    buffer_load_dwordx4 v5, s[16:19], s22 offen sc1 lds
    buffer_load_dwordx4 v6, s[16:19], s22 offen offset:1024 sc1 lds
    s_add_u32 s21, s21, 8192
    s_add_u32 s22, s22, 65536
    s_waitcnt vmcnt(20)
    s_barrier
    s_add_u32 m0, s35, 0
    s_nop 0
    buffer_load_dwordx4 v4, s[36:39], s21 offen sc1 lds
    buffer_load_dwordx4 v4, s[36:39], s21 offen offset:1024 sc1 lds
    s_add_u32 m0, m0, 8192
    s_cmp_lt_u32 s57, 163840
    buffer_load_dwordx4 v5, s[16:19], s22 offen sc1 lds
    buffer_load_dwordx4 v6, s[16:19], s22 offen offset:1024 sc1 lds
    s_add_u32 s21, s21, 8192
    s_add_u32 s22, s22, 65536
    s_add_u32 m0, s35, 16384
    s_nop 0
    buffer_load_dwordx4 v4, s[36:39], s21 offen sc1 lds
    buffer_load_dwordx4 v4, s[36:39], s21 offen offset:1024 sc1 lds
    s_add_u32 m0, m0, 8192
    s_cmp_lt_u32 s57, 163840
    buffer_load_dwordx4 v5, s[16:19], s22 offen sc1 lds
    buffer_load_dwordx4 v6, s[16:19], s22 offen offset:1024 sc1 lds
    s_add_u32 s21, s21, 8192
    s_add_u32 s22, s22, 65536
    s_waitcnt vmcnt(20)
    s_barrier
    s_add_u32 m0, s35, 32768
    s_nop 0
    buffer_load_dwordx4 v4, s[36:39], s21 offen sc1 lds
    buffer_load_dwordx4 v4, s[36:39], s21 offen offset:1024 sc1 lds
    s_add_u32 m0, m0, 8192
    s_cmp_lt_u32 s57, 163840
    buffer_load_dwordx4 v5, s[16:19], s22 offen sc1 lds
    buffer_load_dwordx4 v6, s[16:19], s22 offen offset:1024 sc1 lds
    s_add_u32 s21, s21, 8192
    s_add_u32 s22, s22, 65536
    s_add_u32 m0, s35, 49152
    s_nop 0
    buffer_load_dwordx4 v4, s[36:39], s21 offen sc1 lds
    buffer_load_dwordx4 v4, s[36:39], s21 offen offset:1024 sc1 lds
    s_add_u32 m0, m0, 8192
    s_cmp_lt_u32 s57, 163840
    buffer_load_dwordx4 v5, s[16:19], s22 offen sc1 lds
    buffer_load_dwordx4 v6, s[16:19], s22 offen offset:1024 sc1 lds
    s_add_u32 s21, s21, 8192
    s_add_u32 s22, s22, 65536
    s_waitcnt vmcnt(20)
    s_cmp_lg_u32 s3, 4
    s_cbranch_scc1 W4_12
    s_waitcnt vmcnt(24)
    s_mov_b32 s33, 2097152
PL13:
    v_cmp_eq_u64 vcc, s[8:9], v[28:29]
    s_cmp_eq_u64 vcc, -1
    s_cbranch_scc1 PD13
    s_sub_u32 s33, s33, 1
    s_cbranch_scc1 PD13
    s_sleep 1
    global_load_dwordx2 v[28:29], v27, s[58:59] sc1
    s_waitcnt vmcnt(0)
    s_branch PL13
PD13:
W4_12:
    s_barrier
    s_add_u32 m0, s35, 65536
    s_nop 0
    buffer_load_dwordx4 v4, s[36:39], s21 offen sc1 lds
    buffer_load_dwordx4 v4, s[36:39], s21 offen offset:1024 sc1 lds
    s_add_u32 m0, m0, 8192
    s_cmp_lt_u32 s57, 163840
    buffer_load_dwordx4 v5, s[16:19], s22 offen sc1 lds
    buffer_load_dwordx4 v6, s[16:19], s22 offen offset:1024 sc1 lds
    s_add_u32 s21, s21, 8192
    s_add_u32 s22, s22, 65536
    s_add_u32 m0, s35, 81920
    s_nop 0
    buffer_load_dwordx4 v4, s[36:39], s21 offen sc1 lds
    buffer_load_dwordx4 v4, s[36:39], s21 offen offset:1024 sc1 lds
    s_add_u32 m0, m0, 8192
    s_cmp_lt_u32 s57, 163840
    buffer_load_dwordx4 v5, s[16:19], s22 offen sc1 lds
    buffer_load_dwordx4 v6, s[16:19], s22 offen offset:1024 sc1 lds
    s_add_u32 s21, s21, 8192
    s_add_u32 s22, s22, 65536
    s_waitcnt vmcnt(20)
    s_barrier
    s_mov_b32 s22, 12
    s_mul_i32 s21, s52, 144
    s_add_u32 s21, s21, 112
    s_add_u32 s21, s21, s22
    s_lshl_b32 s21, s21, 13
    s_lshl_b32 s22, s22, 16
    s_add_u32 m0, s35, 98304
    s_nop 0
    buffer_load_dwordx4 v4, s[36:39], s21 offen sc1 lds
    buffer_load_dwordx4 v4, s[36:39], s21 offen offset:1024 sc1 lds
    s_add_u32 m0, m0, s34
    s_nop 0
    buffer_load_dwordx4 v7, s[92:95], s22 offen sc1 lds
    s_add_u32 s21, s21, 8192
    s_add_u32 s22, s22, 65536
    s_add_u32 m0, s35, 110592
    s_nop 0
    buffer_load_dwordx4 v4, s[36:39], s21 offen sc1 lds
    buffer_load_dwordx4 v4, s[36:39], s21 offen offset:1024 sc1 lds
    s_add_u32 m0, m0, s34
    s_nop 0
    buffer_load_dwordx4 v7, s[92:95], s22 offen sc1 lds
    s_add_u32 s21, s21, 8192
    s_add_u32 s22, s22, 65536
    s_waitcnt vmcnt(18)
    s_barrier
    s_add_u32 m0, s35, 131072
    s_nop 0
    buffer_load_dwordx4 v4, s[36:39], s21 offen sc1 lds
    buffer_load_dwordx4 v4, s[36:39], s21 offen offset:1024 sc1 lds
    s_add_u32 m0, m0, s34
    s_nop 0
    buffer_load_dwordx4 v7, s[92:95], s22 offen sc1 lds
    s_add_u32 s21, s21, 8192
    s_add_u32 s22, s22, 65536
    s_add_u32 m0, s35, 143360
    s_nop 0
    buffer_load_dwordx4 v4, s[36:39], s21 offen sc1 lds
    buffer_load_dwordx4 v4, s[36:39], s21 offen offset:1024 sc1 lds
    s_add_u32 m0, m0, s34
    s_nop 0
    buffer_load_dwordx4 v7, s[92:95], s22 offen sc1 lds
    s_add_u32 s21, s21, 8192
    s_add_u32 s22, s22, 65536
    s_waitcnt vmcnt(16)
    s_barrier
    s_add_u32 m0, s35, 0
    s_nop 0
    buffer_load_dwordx4 v4, s[36:39], s21 offen sc1 lds
    buffer_load_dwordx4 v4, s[36:39], s21 offen offset:1024 sc1 lds
    s_add_u32 m0, m0, s34
    s_nop 0
    buffer_load_dwordx4 v7, s[92:95], s22 offen sc1 lds
    s_add_u32 s21, s21, 8192
    s_add_u32 s22, s22, 65536
    s_add_u32 m0, s35, 12288
    s_nop 0
    buffer_load_dwordx4 v4, s[36:39], s21 offen sc1 lds
    buffer_load_dwordx4 v4, s[36:39], s21 offen offset:1024 sc1 lds
    s_add_u32 m0, m0, s34
    s_nop 0
    buffer_load_dwordx4 v7, s[92:95], s22 offen sc1 lds
    s_add_u32 s21, s21, 8192
    s_add_u32 s22, s22, 65536
    s_waitcnt vmcnt(15)
    s_barrier
    s_add_u32 m0, s35, 24576
    s_nop 0
    buffer_load_dwordx4 v4, s[36:39], s21 offen sc1 lds
    buffer_load_dwordx4 v4, s[36:39], s21 offen offset:1024 sc1 lds
    s_add_u32 m0, m0, s34
    s_nop 0
    buffer_load_dwordx4 v7, s[92:95], s22 offen sc1 lds
    s_add_u32 s21, s21, 8192
    s_add_u32 s22, s22, 65536
    s_add_u32 m0, s35, 36864
    s_nop 0
    buffer_load_dwordx4 v4, s[36:39], s21 offen sc1 lds
    buffer_load_dwordx4 v4, s[36:39], s21 offen offset:1024 sc1 lds
    s_add_u32 m0, m0, s34
    s_nop 0
    buffer_load_dwordx4 v7, s[92:95], s22 offen sc1 lds
    s_add_u32 s21, s21, 8192
    s_add_u32 s22, s22, 65536
    s_add_u32 m0, s35, 49152
    s_nop 0
    buffer_load_dwordx4 v4, s[36:39], s21 offen sc1 lds
    buffer_load_dwordx4 v4, s[36:39], s21 offen offset:1024 sc1 lds
    s_add_u32 m0, m0, s34
    s_nop 0
    buffer_load_dwordx4 v7, s[92:95], s22 offen sc1 lds
    s_add_u32 s21, s21, 8192
    s_add_u32 s22, s22, 65536
    s_waitcnt vmcnt(18)
    s_barrier
    s_add_u32 m0, s35, 65536
    s_nop 0
    buffer_load_dwordx4 v4, s[36:39], s21 offen sc1 lds
    buffer_load_dwordx4 v4, s[36:39], s21 offen offset:1024 sc1 lds
    s_add_u32 m0, m0, s34
    s_nop 0
    buffer_load_dwordx4 v7, s[92:95], s22 offen sc1 lds
    s_add_u32 s21, s21, 8192
    s_add_u32 s22, s22, 65536
    s_add_u32 m0, s35, 77824
    s_nop 0
    buffer_load_dwordx4 v4, s[36:39], s21 offen sc1 lds
    buffer_load_dwordx4 v4, s[36:39], s21 offen offset:1024 sc1 lds
    s_add_u32 m0, m0, s34
    s_nop 0
    buffer_load_dwordx4 v7, s[92:95], s22 offen sc1 lds
    s_add_u32 s21, s21, 8192
    s_add_u32 s22, s22, 65536
    s_waitcnt vmcnt(18)
    s_barrier
    s_add_u32 m0, s35, 90112
    s_nop 0
    buffer_load_dwordx4 v4, s[36:39], s21 offen sc1 lds
    buffer_load_dwordx4 v4, s[36:39], s21 offen offset:1024 sc1 lds
    s_add_u32 m0, m0, s34
    s_nop 0
    buffer_load_dwordx4 v7, s[92:95], s22 offen sc1 lds
    s_add_u32 s21, s21, 8192
    s_add_u32 s22, s22, 65536
    s_add_u32 m0, s35, 102400
    s_nop 0
    buffer_load_dwordx4 v4, s[36:39], s21 offen sc1 lds
    buffer_load_dwordx4 v4, s[36:39], s21 offen offset:1024 sc1 lds
    s_add_u32 m0, m0, s34
    s_nop 0
    buffer_load_dwordx4 v7, s[92:95], s22 offen sc1 lds
    s_add_u32 s21, s21, 8192
    s_add_u32 s22, s22, 65536
    s_add_u32 m0, s35, 114688
    s_nop 0
    buffer_load_dwordx4 v4, s[36:39], s21 offen sc1 lds
    buffer_load_dwordx4 v4, s[36:39], s21 offen offset:1024 sc1 lds
    s_add_u32 m0, m0, s34
    s_nop 0
    buffer_load_dwordx4 v7, s[92:95], s22 offen sc1 lds
    s_add_u32 s21, s21, 8192
    s_add_u32 s22, s22, 65536
    s_waitcnt vmcnt(21)
    s_barrier
    s_add_u32 m0, s35, 131072
    s_nop 0
    buffer_load_dwordx4 v4, s[36:39], s21 offen sc1 lds
    buffer_load_dwordx4 v4, s[36:39], s21 offen offset:1024 sc1 lds
    s_add_u32 m0, m0, s34
    s_nop 0
    buffer_load_dwordx4 v7, s[92:95], s22 offen sc1 lds
    s_add_u32 s21, s21, 8192
    s_add_u32 s22, s22, 65536
    s_add_u32 m0, s35, 143360
    s_nop 0
    buffer_load_dwordx4 v4, s[36:39], s21 offen sc1 lds
    buffer_load_dwordx4 v4, s[36:39], s21 offen offset:1024 sc1 lds
    s_add_u32 m0, m0, s34
    s_nop 0
    buffer_load_dwordx4 v7, s[92:95], s22 offen sc1 lds
    s_add_u32 s21, s21, 8192
    s_add_u32 s22, s22, 65536
    s_waitcnt vmcnt(21)
    s_barrier
    s_add_u32 m0, s35, 0
    s_nop 0
    buffer_load_dwordx4 v4, s[36:39], s21 offen sc1 lds
    buffer_load_dwordx4 v4, s[36:39], s21 offen offset:1024 sc1 lds
    s_add_u32 m0, m0, s34
    s_nop 0
    buffer_load_dwordx4 v7, s[92:95], s22 offen sc1 lds
    s_add_u32 s21, s21, 8192
    s_add_u32 s22, s22, 65536
    s_add_u32 m0, s35, 12288
    s_nop 0
    buffer_load_dwordx4 v4, s[36:39], s21 offen sc1 lds
    buffer_load_dwordx4 v4, s[36:39], s21 offen offset:1024 sc1 lds
    s_add_u32 m0, m0, s34
    s_nop 0
    buffer_load_dwordx4 v7, s[92:95], s22 offen sc1 lds
    s_add_u32 s21, s21, 8192
    s_add_u32 s22, s22, 65536
    s_waitcnt vmcnt(21)
    s_barrier
    s_cmp_lg_u32 s3, 4
    s_cbranch_scc1 W4_14
    v_mov_b32 v22, s56
    v_mov_b32 v24, s8
    v_mov_b32 v25, s9
    s_mov_b64 exec, 1
    global_store_dwordx2 v22, v[24:25], s[58:59] sc1
    s_mov_b64 exec, -1
    s_cmp_lg_u32 s2, 0
    s_cbranch_scc1 P3_NN0
    s_movk_i32 s32, 24576
    v_mov_b32 v22, s32
    v_mov_b32 v24, s8
    v_mov_b32 v25, s9
    s_mov_b64 exec, 1
    global_store_dwordx2 v22, v[24:25], s[58:59] sc1
    s_mov_b64 exec, -1
P3_NN0:
W4_14:
    s_add_u32 m0, s35, 24576
    s_nop 0
    buffer_load_dwordx4 v4, s[36:39], s21 offen sc1 lds
    buffer_load_dwordx4 v4, s[36:39], s21 offen offset:1024 sc1 lds
    s_add_u32 m0, m0, s34
    s_nop 0
    buffer_load_dwordx4 v7, s[92:95], s22 offen sc1 lds
    s_add_u32 s21, s21, 8192
    s_add_u32 s22, s22, 65536
    s_add_u32 m0, s35, 36864
    s_nop 0
    buffer_load_dwordx4 v4, s[36:39], s21 offen sc1 lds
    buffer_load_dwordx4 v4, s[36:39], s21 offen offset:1024 sc1 lds
    s_add_u32 m0, m0, s34
    s_nop 0
    buffer_load_dwordx4 v7, s[92:95], s22 offen sc1 lds
    s_add_u32 s21, s21, 8192
    s_add_u32 s22, s22, 65536
    s_waitcnt vmcnt(21)
    s_barrier
    s_cmp_lg_u32 s3, 4
    s_cbranch_scc1 W4_15
    v_and_b32 v27, 0, v1
    v_lshlrev_b32 v27, 3, v27
    v_add_u32 v27, s55, v27
    global_load_dwordx2 v[28:29], v27, s[58:59] sc1
W4_15:
    s_waitcnt vmcnt(15)
    s_barrier
    s_waitcnt vmcnt(9)
    s_cmp_lg_u32 s3, 4
    s_cbranch_scc1 W4_16
    s_waitcnt vmcnt(0)
    s_mov_b32 s33, 2097152
PL17:
    v_cmp_eq_u64 vcc, s[8:9], v[28:29]
    s_cmp_eq_u64 vcc, -1
    s_cbranch_scc1 PD17
    s_sub_u32 s33, s33, 1
    s_cbranch_scc1 PD17
    s_sleep 1
    global_load_dwordx2 v[28:29], v27, s[58:59] sc1
    s_waitcnt vmcnt(0)
    s_branch PL17
PD17:
W4_16:
    s_barrier
    s_waitcnt vmcnt(3)
    s_barrier
    s_waitcnt vmcnt(0)
    s_barrier
    s_waitcnt vmcnt(0)
    s_branch P3_LE
P3_L1:
    s_barrier
    s_cmp_lg_u32 s3, 4
    s_cbranch_scc1 W4_18
    s_lshr_b32 s32, s52, 1
    s_lshl_b32 s32, s32, 8
    s_add_u32 s32, s32, 16384
    v_and_b32 v27, 31, v1
    v_lshlrev_b32 v27, 3, v27
    v_add_u32 v27, s32, v27
    global_load_dwordx2 v[28:29], v27, s[58:59] sc1
W4_18:
    s_add_u32 m0, s35, 131072
    s_nop 0
    buffer_load_dwordx4 v4, s[36:39], s21 offen sc1 lds
    buffer_load_dwordx4 v4, s[36:39], s21 offen offset:1024 sc1 lds
    s_add_u32 m0, m0, 8192
    s_cmp_lt_u32 s57, 163840
    buffer_load_dwordx4 v5, s[16:19], s22 offen sc1 lds
    buffer_load_dwordx4 v6, s[16:19], s22 offen offset:1024 sc1 lds
    s_add_u32 s21, s21, 8192
    s_add_u32 s22, s22, 65536
    s_add_u32 m0, s35, 147456
    s_nop 0
    buffer_load_dwordx4 v4, s[36:39], s21 offen sc1 lds
    buffer_load_dwordx4 v4, s[36:39], s21 offen offset:1024 sc1 lds
    s_add_u32 m0, m0, 8192
    s_cmp_lt_u32 s57, 163840
    buffer_load_dwordx4 v5, s[16:19], s22 offen sc1 lds
    buffer_load_dwordx4 v6, s[16:19], s22 offen offset:1024 sc1 lds
    s_add_u32 s21, s21, 8192
    s_add_u32 s22, s22, 65536
    s_waitcnt vmcnt(20)
    s_barrier
    s_add_u32 m0, s35, 0
    s_nop 0
    buffer_load_dwordx4 v4, s[36:39], s21 offen sc1 lds
    buffer_load_dwordx4 v4, s[36:39], s21 offen offset:1024 sc1 lds
    s_add_u32 m0, m0, 8192
    s_cmp_lt_u32 s57, 163840
    buffer_load_dwordx4 v5, s[16:19], s22 offen sc1 lds
    buffer_load_dwordx4 v6, s[16:19], s22 offen offset:1024 sc1 lds
    s_add_u32 s21, s21, 8192
    s_add_u32 s22, s22, 65536
    s_add_u32 m0, s35, 16384
    s_nop 0
    buffer_load_dwordx4 v4, s[36:39], s21 offen sc1 lds
    buffer_load_dwordx4 v4, s[36:39], s21 offen offset:1024 sc1 lds
    s_add_u32 m0, m0, 8192
    s_cmp_lt_u32 s57, 163840
    buffer_load_dwordx4 v5, s[16:19], s22 offen sc1 lds
    buffer_load_dwordx4 v6, s[16:19], s22 offen offset:1024 sc1 lds
    s_add_u32 s21, s21, 8192
    s_add_u32 s22, s22, 65536
    s_waitcnt vmcnt(20)
    s_barrier
    s_add_u32 m0, s35, 32768
    s_nop 0
    buffer_load_dwordx4 v4, s[36:39], s21 offen sc1 lds
    buffer_load_dwordx4 v4, s[36:39], s21 offen offset:1024 sc1 lds
    s_add_u32 m0, m0, 8192
    s_cmp_lt_u32 s57, 163840
    buffer_load_dwordx4 v5, s[16:19], s22 offen sc1 lds
    buffer_load_dwordx4 v6, s[16:19], s22 offen offset:1024 sc1 lds
    s_add_u32 s21, s21, 8192
    s_add_u32 s22, s22, 65536
    s_add_u32 m0, s35, 49152
    s_nop 0
    buffer_load_dwordx4 v4, s[36:39], s21 offen sc1 lds
    buffer_load_dwordx4 v4, s[36:39], s21 offen offset:1024 sc1 lds
    s_add_u32 m0, m0, 8192
    s_cmp_lt_u32 s57, 163840
    buffer_load_dwordx4 v5, s[16:19], s22 offen sc1 lds
    buffer_load_dwordx4 v6, s[16:19], s22 offen offset:1024 sc1 lds
    s_add_u32 s21, s21, 8192
    s_add_u32 s22, s22, 65536
    s_waitcnt vmcnt(20)
    s_cmp_lg_u32 s3, 4
    s_cbranch_scc1 W4_19
    s_waitcnt vmcnt(24)
    s_mov_b32 s33, 2097152
PL20:
    v_cmp_eq_u64 vcc, s[8:9], v[28:29]
    s_cmp_eq_u64 vcc, -1
    s_cbranch_scc1 PD20
    s_sub_u32 s33, s33, 1
    s_cbranch_scc1 PD20
    s_sleep 1
    global_load_dwordx2 v[28:29], v27, s[58:59] sc1
    s_waitcnt vmcnt(0)
    s_branch PL20
PD20:
W4_19:
    s_barrier
    s_add_u32 m0, s35, 65536
    s_nop 0
    buffer_load_dwordx4 v4, s[36:39], s21 offen sc1 lds
    buffer_load_dwordx4 v4, s[36:39], s21 offen offset:1024 sc1 lds
    s_add_u32 m0, m0, 8192
    s_cmp_lt_u32 s57, 163840
    buffer_load_dwordx4 v5, s[16:19], s22 offen sc1 lds
    buffer_load_dwordx4 v6, s[16:19], s22 offen offset:1024 sc1 lds
    s_add_u32 s21, s21, 8192
    s_add_u32 s22, s22, 65536
    s_add_u32 m0, s35, 81920
    s_nop 0
    buffer_load_dwordx4 v4, s[36:39], s21 offen sc1 lds
    buffer_load_dwordx4 v4, s[36:39], s21 offen offset:1024 sc1 lds
    s_add_u32 m0, m0, 8192
    s_cmp_lt_u32 s57, 163840
    buffer_load_dwordx4 v5, s[16:19], s22 offen sc1 lds
    buffer_load_dwordx4 v6, s[16:19], s22 offen offset:1024 sc1 lds
    s_add_u32 s21, s21, 8192
    s_add_u32 s22, s22, 65536
    s_waitcnt vmcnt(20)
    s_barrier
    s_mov_b32 s22, 0
    s_mul_i32 s21, s52, 144
    s_add_u32 s21, s21, 112
    s_add_u32 s21, s21, s22
    s_lshl_b32 s21, s21, 13
    s_lshl_b32 s22, s22, 16
    s_add_u32 m0, s35, 98304
    s_nop 0
    buffer_load_dwordx4 v4, s[36:39], s21 offen sc1 lds
    buffer_load_dwordx4 v4, s[36:39], s21 offen offset:1024 sc1 lds
    s_add_u32 m0, m0, 8192
    s_cmp_lt_u32 s57, 163840
    buffer_load_dwordx4 v5, s[92:95], s22 offen sc1 lds
    buffer_load_dwordx4 v6, s[92:95], s22 offen offset:1024 sc1 lds
    s_add_u32 s21, s21, 8192
    s_add_u32 s22, s22, 65536
    s_add_u32 m0, s35, 114688
    s_nop 0
    buffer_load_dwordx4 v4, s[36:39], s21 offen sc1 lds
    buffer_load_dwordx4 v4, s[36:39], s21 offen offset:1024 sc1 lds
    s_add_u32 m0, m0, 8192
    s_cmp_lt_u32 s57, 163840
    buffer_load_dwordx4 v5, s[92:95], s22 offen sc1 lds
    buffer_load_dwordx4 v6, s[92:95], s22 offen offset:1024 sc1 lds
    s_add_u32 s21, s21, 8192
    s_add_u32 s22, s22, 65536
    s_waitcnt vmcnt(20)
    s_barrier
    s_add_u32 m0, s35, 131072
    s_nop 0
    buffer_load_dwordx4 v4, s[36:39], s21 offen sc1 lds
    buffer_load_dwordx4 v4, s[36:39], s21 offen offset:1024 sc1 lds
    s_add_u32 m0, m0, 8192
    s_cmp_lt_u32 s57, 163840
    buffer_load_dwordx4 v5, s[92:95], s22 offen sc1 lds
    buffer_load_dwordx4 v6, s[92:95], s22 offen offset:1024 sc1 lds
    s_add_u32 s21, s21, 8192
    s_add_u32 s22, s22, 65536
    s_add_u32 m0, s35, 147456
    s_nop 0
    buffer_load_dwordx4 v4, s[36:39], s21 offen sc1 lds
    buffer_load_dwordx4 v4, s[36:39], s21 offen offset:1024 sc1 lds
    s_add_u32 m0, m0, 8192
    s_cmp_lt_u32 s57, 163840
    buffer_load_dwordx4 v5, s[92:95], s22 offen sc1 lds
    buffer_load_dwordx4 v6, s[92:95], s22 offen offset:1024 sc1 lds
    s_add_u32 s21, s21, 8192
    s_add_u32 s22, s22, 65536
    s_waitcnt vmcnt(20)
    s_barrier
    s_add_u32 m0, s35, 0
    s_nop 0
    buffer_load_dwordx4 v4, s[36:39], s21 offen sc1 lds
    buffer_load_dwordx4 v4, s[36:39], s21 offen offset:1024 sc1 lds
    s_add_u32 m0, m0, 8192
    s_cmp_lt_u32 s57, 163840
    buffer_load_dwordx4 v5, s[92:95], s22 offen sc1 lds
    buffer_load_dwordx4 v6, s[92:95], s22 offen offset:1024 sc1 lds
    s_add_u32 s21, s21, 8192
    s_add_u32 s22, s22, 65536
    s_add_u32 m0, s35, 16384
    s_nop 0
    buffer_load_dwordx4 v4, s[36:39], s21 offen sc1 lds
    buffer_load_dwordx4 v4, s[36:39], s21 offen offset:1024 sc1 lds
    s_add_u32 m0, m0, 8192
    s_cmp_lt_u32 s57, 163840
    buffer_load_dwordx4 v5, s[92:95], s22 offen sc1 lds
    buffer_load_dwordx4 v6, s[92:95], s22 offen offset:1024 sc1 lds
    s_add_u32 s21, s21, 8192
    s_add_u32 s22, s22, 65536
    s_waitcnt vmcnt(20)
    s_barrier
    s_add_u32 m0, s35, 32768
    s_nop 0
    buffer_load_dwordx4 v4, s[36:39], s21 offen sc1 lds
    buffer_load_dwordx4 v4, s[36:39], s21 offen offset:1024 sc1 lds
    s_add_u32 m0, m0, 8192
    s_cmp_lt_u32 s57, 163840
    buffer_load_dwordx4 v5, s[92:95], s22 offen sc1 lds
    buffer_load_dwordx4 v6, s[92:95], s22 offen offset:1024 sc1 lds
    s_add_u32 s21, s21, 8192
    s_add_u32 s22, s22, 65536
    s_add_u32 m0, s35, 49152
    s_nop 0
    buffer_load_dwordx4 v4, s[36:39], s21 offen sc1 lds
    buffer_load_dwordx4 v4, s[36:39], s21 offen offset:1024 sc1 lds
    s_add_u32 m0, m0, 8192
    s_cmp_lt_u32 s57, 163840
    buffer_load_dwordx4 v5, s[92:95], s22 offen sc1 lds
    buffer_load_dwordx4 v6, s[92:95], s22 offen offset:1024 sc1 lds
    s_add_u32 s21, s21, 8192
    s_add_u32 s22, s22, 65536
    s_waitcnt vmcnt(20)
    s_barrier
    s_add_u32 m0, s35, 65536
    s_nop 0
    buffer_load_dwordx4 v4, s[36:39], s21 offen sc1 lds
    buffer_load_dwordx4 v4, s[36:39], s21 offen offset:1024 sc1 lds
    s_add_u32 m0, m0, 8192
    s_cmp_lt_u32 s57, 163840
    buffer_load_dwordx4 v5, s[92:95], s22 offen sc1 lds
    buffer_load_dwordx4 v6, s[92:95], s22 offen offset:1024 sc1 lds
    s_add_u32 s21, s21, 8192
    s_add_u32 s22, s22, 65536
    s_add_u32 m0, s35, 81920
    s_nop 0
    buffer_load_dwordx4 v4, s[36:39], s21 offen sc1 lds
    buffer_load_dwordx4 v4, s[36:39], s21 offen offset:1024 sc1 lds
    s_add_u32 m0, m0, 8192
    s_cmp_lt_u32 s57, 163840
    buffer_load_dwordx4 v5, s[92:95], s22 offen sc1 lds
    buffer_load_dwordx4 v6, s[92:95], s22 offen offset:1024 sc1 lds
    s_add_u32 s21, s21, 8192
    s_add_u32 s22, s22, 65536
    s_waitcnt vmcnt(20)
    s_barrier
    s_add_u32 m0, s35, 98304
    s_nop 0
    buffer_load_dwordx4 v4, s[36:39], s21 offen sc1 lds
    buffer_load_dwordx4 v4, s[36:39], s21 offen offset:1024 sc1 lds
    s_add_u32 m0, m0, 8192
    s_cmp_lt_u32 s57, 163840
    buffer_load_dwordx4 v5, s[92:95], s22 offen sc1 lds
    buffer_load_dwordx4 v6, s[92:95], s22 offen offset:1024 sc1 lds
    s_add_u32 s21, s21, 8192
    s_add_u32 s22, s22, 65536
    s_add_u32 m0, s35, 114688
    s_nop 0
    buffer_load_dwordx4 v4, s[36:39], s21 offen sc1 lds
    buffer_load_dwordx4 v4, s[36:39], s21 offen offset:1024 sc1 lds
    s_add_u32 m0, m0, 8192
    s_cmp_lt_u32 s57, 163840
    buffer_load_dwordx4 v5, s[92:95], s22 offen sc1 lds
    buffer_load_dwordx4 v6, s[92:95], s22 offen offset:1024 sc1 lds
    s_add_u32 s21, s21, 8192
    s_add_u32 s22, s22, 65536
    s_waitcnt vmcnt(20)
    s_barrier
    s_mov_b32 s22, 12
    s_mul_i32 s21, s52, 144
    s_add_u32 s21, s21, 112
    s_add_u32 s21, s21, s22
    s_lshl_b32 s21, s21, 13
    s_lshl_b32 s22, s22, 16
    s_add_u32 m0, s35, 131072
    s_nop 0
    buffer_load_dwordx4 v4, s[36:39], s21 offen sc1 lds
    buffer_load_dwordx4 v4, s[36:39], s21 offen offset:1024 sc1 lds
    s_add_u32 m0, m0, s34
    s_nop 0
    buffer_load_dwordx4 v7, s[92:95], s22 offen sc1 lds
    s_add_u32 s21, s21, 8192
    s_add_u32 s22, s22, 65536
    s_add_u32 m0, s35, 143360
    s_nop 0
    buffer_load_dwordx4 v4, s[36:39], s21 offen sc1 lds
    buffer_load_dwordx4 v4, s[36:39], s21 offen offset:1024 sc1 lds
    s_add_u32 m0, m0, s34
    s_nop 0
    buffer_load_dwordx4 v7, s[92:95], s22 offen sc1 lds
    s_add_u32 s21, s21, 8192
    s_add_u32 s22, s22, 65536
    s_waitcnt vmcnt(18)
    s_barrier
    s_add_u32 m0, s35, 0
    s_nop 0
    buffer_load_dwordx4 v4, s[36:39], s21 offen sc1 lds
    buffer_load_dwordx4 v4, s[36:39], s21 offen offset:1024 sc1 lds
    s_add_u32 m0, m0, s34
    s_nop 0
    buffer_load_dwordx4 v7, s[92:95], s22 offen sc1 lds
    s_add_u32 s21, s21, 8192
    s_add_u32 s22, s22, 65536
    s_add_u32 m0, s35, 12288
    s_nop 0
    buffer_load_dwordx4 v4, s[36:39], s21 offen sc1 lds
    buffer_load_dwordx4 v4, s[36:39], s21 offen offset:1024 sc1 lds
    s_add_u32 m0, m0, s34
    s_nop 0
    buffer_load_dwordx4 v7, s[92:95], s22 offen sc1 lds
    s_add_u32 s21, s21, 8192
    s_add_u32 s22, s22, 65536
    s_waitcnt vmcnt(16)
    s_barrier
    s_add_u32 m0, s35, 24576
    s_nop 0
    buffer_load_dwordx4 v4, s[36:39], s21 offen sc1 lds
    buffer_load_dwordx4 v4, s[36:39], s21 offen offset:1024 sc1 lds
    s_add_u32 m0, m0, s34
    s_nop 0
    buffer_load_dwordx4 v7, s[92:95], s22 offen sc1 lds
    s_add_u32 s21, s21, 8192
    s_add_u32 s22, s22, 65536
    s_add_u32 m0, s35, 36864
    s_nop 0
    buffer_load_dwordx4 v4, s[36:39], s21 offen sc1 lds
    buffer_load_dwordx4 v4, s[36:39], s21 offen offset:1024 sc1 lds
    s_add_u32 m0, m0, s34
    s_nop 0
    buffer_load_dwordx4 v7, s[92:95], s22 offen sc1 lds
    s_add_u32 s21, s21, 8192
    s_add_u32 s22, s22, 65536
    s_add_u32 m0, s35, 49152
    s_nop 0
    buffer_load_dwordx4 v4, s[36:39], s21 offen sc1 lds
    buffer_load_dwordx4 v4, s[36:39], s21 offen offset:1024 sc1 lds
    s_add_u32 m0, m0, s34
    s_nop 0
    buffer_load_dwordx4 v7, s[92:95], s22 offen sc1 lds
    s_add_u32 s21, s21, 8192
    s_add_u32 s22, s22, 65536
    s_waitcnt vmcnt(18)
    s_barrier
    s_add_u32 m0, s35, 65536
    s_nop 0
    buffer_load_dwordx4 v4, s[36:39], s21 offen sc1 lds
    buffer_load_dwordx4 v4, s[36:39], s21 offen offset:1024 sc1 lds
    s_add_u32 m0, m0, s34
    s_nop 0
    buffer_load_dwordx4 v7, s[92:95], s22 offen sc1 lds
    s_add_u32 s21, s21, 8192
    s_add_u32 s22, s22, 65536
    s_add_u32 m0, s35, 77824
    s_nop 0
    buffer_load_dwordx4 v4, s[36:39], s21 offen sc1 lds
    buffer_load_dwordx4 v4, s[36:39], s21 offen offset:1024 sc1 lds
    s_add_u32 m0, m0, s34
    s_nop 0
    buffer_load_dwordx4 v7, s[92:95], s22 offen sc1 lds
    s_add_u32 s21, s21, 8192
    s_add_u32 s22, s22, 65536
    s_waitcnt vmcnt(18)
    s_barrier
    s_add_u32 m0, s35, 90112
    s_nop 0
    buffer_load_dwordx4 v4, s[36:39], s21 offen sc1 lds
    buffer_load_dwordx4 v4, s[36:39], s21 offen offset:1024 sc1 lds
    s_add_u32 m0, m0, s34
    s_nop 0
    buffer_load_dwordx4 v7, s[92:95], s22 offen sc1 lds
    s_add_u32 s21, s21, 8192
    s_add_u32 s22, s22, 65536
    s_add_u32 m0, s35, 102400
    s_nop 0
    buffer_load_dwordx4 v4, s[36:39], s21 offen sc1 lds
    buffer_load_dwordx4 v4, s[36:39], s21 offen offset:1024 sc1 lds
    s_add_u32 m0, m0, s34
    s_nop 0
    buffer_load_dwordx4 v7, s[92:95], s22 offen sc1 lds
    s_add_u32 s21, s21, 8192
    s_add_u32 s22, s22, 65536
    s_add_u32 m0, s35, 114688
    s_nop 0
    buffer_load_dwordx4 v4, s[36:39], s21 offen sc1 lds
    buffer_load_dwordx4 v4, s[36:39], s21 offen offset:1024 sc1 lds
    s_add_u32 m0, m0, s34
    s_nop 0
    buffer_load_dwordx4 v7, s[92:95], s22 offen sc1 lds
    s_add_u32 s21, s21, 8192
    s_add_u32 s22, s22, 65536
    s_waitcnt vmcnt(21)
    s_barrier
    s_add_u32 m0, s35, 131072
    s_nop 0
    buffer_load_dwordx4 v4, s[36:39], s21 offen sc1 lds
    buffer_load_dwordx4 v4, s[36:39], s21 offen offset:1024 sc1 lds
    s_add_u32 m0, m0, s34
    s_nop 0
    buffer_load_dwordx4 v7, s[92:95], s22 offen sc1 lds
    s_add_u32 s21, s21, 8192
    s_add_u32 s22, s22, 65536
    s_add_u32 m0, s35, 143360
    s_nop 0
    buffer_load_dwordx4 v4, s[36:39], s21 offen sc1 lds
    buffer_load_dwordx4 v4, s[36:39], s21 offen offset:1024 sc1 lds
    s_add_u32 m0, m0, s34
    s_nop 0
    buffer_load_dwordx4 v7, s[92:95], s22 offen sc1 lds
    s_add_u32 s21, s21, 8192
    s_add_u32 s22, s22, 65536
    s_waitcnt vmcnt(21)
    s_barrier
    s_add_u32 m0, s35, 0
    s_nop 0
    buffer_load_dwordx4 v4, s[36:39], s21 offen sc1 lds
    buffer_load_dwordx4 v4, s[36:39], s21 offen offset:1024 sc1 lds
    s_add_u32 m0, m0, s34
    s_nop 0
    buffer_load_dwordx4 v7, s[92:95], s22 offen sc1 lds
    s_add_u32 s21, s21, 8192
    s_add_u32 s22, s22, 65536
    s_add_u32 m0, s35, 12288
    s_nop 0
    buffer_load_dwordx4 v4, s[36:39], s21 offen sc1 lds
    buffer_load_dwordx4 v4, s[36:39], s21 offen offset:1024 sc1 lds
    s_add_u32 m0, m0, s34
    s_nop 0
    buffer_load_dwordx4 v7, s[92:95], s22 offen sc1 lds
    s_add_u32 s21, s21, 8192
    s_add_u32 s22, s22, 65536
    s_waitcnt vmcnt(21)
    s_barrier
    s_add_u32 m0, s35, 24576
    s_nop 0
    buffer_load_dwordx4 v4, s[36:39], s21 offen sc1 lds
    buffer_load_dwordx4 v4, s[36:39], s21 offen offset:1024 sc1 lds
    s_add_u32 m0, m0, s34
    s_nop 0
    buffer_load_dwordx4 v7, s[92:95], s22 offen sc1 lds
    s_add_u32 s21, s21, 8192
    s_add_u32 s22, s22, 65536
    s_add_u32 m0, s35, 36864
    s_nop 0
    buffer_load_dwordx4 v4, s[36:39], s21 offen sc1 lds
    buffer_load_dwordx4 v4, s[36:39], s21 offen offset:1024 sc1 lds
    s_add_u32 m0, m0, s34
    s_nop 0
    buffer_load_dwordx4 v7, s[92:95], s22 offen sc1 lds
    s_add_u32 s21, s21, 8192
    s_add_u32 s22, s22, 65536
    s_waitcnt vmcnt(21)
    s_barrier
    s_cmp_lg_u32 s3, 4
    s_cbranch_scc1 W4_21
    v_mov_b32 v22, s56
    v_mov_b32 v24, s8
    v_mov_b32 v25, s9
    s_mov_b64 exec, 1
    global_store_dwordx2 v22, v[24:25], s[58:59] sc1
    s_mov_b64 exec, -1
    s_cmp_lg_u32 s2, 0
    s_cbranch_scc1 P3_NN1
    s_movk_i32 s32, 24576
    v_mov_b32 v22, s32
    v_mov_b32 v24, s8
    v_mov_b32 v25, s9
    s_mov_b64 exec, 1
    global_store_dwordx2 v22, v[24:25], s[58:59] sc1
    s_mov_b64 exec, -1
P3_NN1:
W4_21:
    s_add_u32 m0, s35, 49152
    s_nop 0
    buffer_load_dwordx4 v4, s[36:39], s21 offen sc1 lds
    buffer_load_dwordx4 v4, s[36:39], s21 offen offset:1024 sc1 lds
    s_add_u32 m0, m0, s34
    s_nop 0
    buffer_load_dwordx4 v7, s[92:95], s22 offen sc1 lds
    s_add_u32 s21, s21, 8192
    s_add_u32 s22, s22, 65536
    s_add_u32 m0, s35, 65536
    s_nop 0
    buffer_load_dwordx4 v4, s[36:39], s21 offen sc1 lds
    buffer_load_dwordx4 v4, s[36:39], s21 offen offset:1024 sc1 lds
    s_add_u32 m0, m0, s34
    s_nop 0
    buffer_load_dwordx4 v7, s[92:95], s22 offen sc1 lds
    s_add_u32 s21, s21, 8192
    s_add_u32 s22, s22, 65536
    s_waitcnt vmcnt(21)
    s_barrier
    s_cmp_lg_u32 s3, 4
    s_cbranch_scc1 W4_22
    v_and_b32 v27, 0, v1
    v_lshlrev_b32 v27, 3, v27
    v_add_u32 v27, s55, v27
    global_load_dwordx2 v[28:29], v27, s[58:59] sc1
W4_22:
    s_waitcnt vmcnt(15)
    s_barrier
    s_waitcnt vmcnt(9)
    s_cmp_lg_u32 s3, 4
    s_cbranch_scc1 W4_23
    s_waitcnt vmcnt(0)
    s_mov_b32 s33, 2097152
PL24:
    v_cmp_eq_u64 vcc, s[8:9], v[28:29]
    s_cmp_eq_u64 vcc, -1
    s_cbranch_scc1 PD24
    s_sub_u32 s33, s33, 1
    s_cbranch_scc1 PD24
    s_sleep 1
    global_load_dwordx2 v[28:29], v27, s[58:59] sc1
    s_waitcnt vmcnt(0)
    s_branch PL24
PD24:
W4_23:
    s_barrier
    s_waitcnt vmcnt(3)
    s_barrier
    s_waitcnt vmcnt(0)
    s_barrier
    s_waitcnt vmcnt(0)
P3_LE:
    s_branch KM_FIN
P2_SLOW:
    s_mov_b32 s32, 8192
    v_mov_b32 v27, 0xff800000
    v_mov_b32 v92, 0
    v_mov_b32 v128, 0
    v_mov_b32 v129, 0
    v_mov_b32 v130, 0
    v_mov_b32 v131, 0
    v_mov_b32 v132, 0
    v_mov_b32 v133, 0
    v_mov_b32 v134, 0
    v_mov_b32 v135, 0
    v_mov_b32 v136, 0
    v_mov_b32 v137, 0
    v_mov_b32 v138, 0
    v_mov_b32 v139, 0
    v_mov_b32 v140, 0
    v_mov_b32 v141, 0
    v_mov_b32 v142, 0
    v_mov_b32 v143, 0
P2_SL:
    s_add_u32 s33, s32, 0x20000
    buffer_load_dwordx4 v[40:43], v19, s[40:43], s32 offen sc1
    buffer_load_dwordx4 v[44:47], v19, s[40:43], s32 offen offset:1024 sc1
    buffer_load_dwordx4 v[56:59], v19, s[40:43], s33 offen sc1
    buffer_load_dwordx4 v[60:63], v19, s[40:43], s33 offen offset:1024 sc1
    s_waitcnt vmcnt(0)
    v_mfma_f32_32x32x16_bf16 v[96:111], v[40:43], v[32:35], 0
    v_mfma_f32_32x32x16_bf16 v[96:111], v[44:47], v[36:39], v[96:111]
    s_nop 15
    v_max3_f32 v26, v27, v96, v97
    v_max3_f32 v26, v26, v98, v99
    v_max3_f32 v26, v26, v100, v101
    v_max3_f32 v26, v26, v102, v103
    v_max3_f32 v26, v26, v104, v105
    v_max3_f32 v26, v26, v106, v107
    v_max3_f32 v26, v26, v108, v109
    v_max3_f32 v26, v26, v110, v111
    v_mov_b32 v28, v26
    s_nop 1
    v_permlane32_swap_b32 v26, v28
    s_nop 0
    v_max_f32 v26, v26, v28
    v_sub_f32 v28, v27, v26
    v_exp_f32 v28, v28
    v_mov_b32 v27, v26
    v_sub_f32 v96, v96, v26
    v_sub_f32 v97, v97, v26
    v_sub_f32 v98, v98, v26
    v_sub_f32 v99, v99, v26
    v_sub_f32 v100, v100, v26
    v_sub_f32 v101, v101, v26
    v_sub_f32 v102, v102, v26
    v_sub_f32 v103, v103, v26
    v_sub_f32 v104, v104, v26
    v_sub_f32 v105, v105, v26
    v_sub_f32 v106, v106, v26
    v_sub_f32 v107, v107, v26
    v_sub_f32 v108, v108, v26
    v_sub_f32 v109, v109, v26
    v_sub_f32 v110, v110, v26
    v_sub_f32 v111, v111, v26
    v_exp_f32 v96, v96
    v_exp_f32 v97, v97
    v_exp_f32 v98, v98
    v_exp_f32 v99, v99
    v_exp_f32 v100, v100
    v_exp_f32 v101, v101
    v_exp_f32 v102, v102
    v_exp_f32 v103, v103
    v_exp_f32 v104, v104
    v_exp_f32 v105, v105
    v_exp_f32 v106, v106
    v_exp_f32 v107, v107
    v_exp_f32 v108, v108
    v_exp_f32 v109, v109
    v_exp_f32 v110, v110
    v_exp_f32 v111, v111
    v_mul_f32 v128, v128, v28
    v_mul_f32 v129, v129, v28
    v_mul_f32 v130, v130, v28
    v_mul_f32 v131, v131, v28
    v_mul_f32 v132, v132, v28
    v_mul_f32 v133, v133, v28
    v_mul_f32 v134, v134, v28
    v_mul_f32 v135, v135, v28
    v_mul_f32 v136, v136, v28
    v_mul_f32 v137, v137, v28
    v_mul_f32 v138, v138, v28
    v_mul_f32 v139, v139, v28
    v_mul_f32 v140, v140, v28
    v_mul_f32 v141, v141, v28
    v_mul_f32 v142, v142, v28
    v_mul_f32 v143, v143, v28
    v_mul_f32 v92, v92, v28
    v_cvt_pk_bf16_f32 v72, v96, v97
    v_cvt_pk_bf16_f32 v73, v98, v99
    v_cvt_pk_bf16_f32 v74, v100, v101
    v_cvt_pk_bf16_f32 v75, v102, v103
    v_cvt_pk_bf16_f32 v76, v104, v105
    v_cvt_pk_bf16_f32 v77, v106, v107
    v_cvt_pk_bf16_f32 v78, v108, v109
    v_cvt_pk_bf16_f32 v79, v110, v111
    s_nop 1
    v_mfma_f32_32x32x16_bf16 v[128:143], v[56:59], v[72:75], v[128:143]
    v_mfma_f32_16x16x32_bf16 v[92:95], v[88:91], v[72:75], v[92:95]
    v_mfma_f32_32x32x16_bf16 v[128:143], v[60:63], v[76:79], v[128:143]
    v_mfma_f32_16x16x32_bf16 v[92:95], v[88:91], v[76:79], v[92:95]
    s_nop 15
    s_add_u32 s32, s32, 2048
    s_cmp_lt_u32 s32, 139264
    s_cbranch_scc1 P2_SL
    s_branch P2_FIN
KM_REDO:
    s_waitcnt vmcnt(0) lgkmcnt(0)
    s_barrier
    s_mov_b32 s2, s100
    v_mbcnt_lo_u32_b32 v0, -1, 0
    v_mbcnt_hi_u32_b32 v0, -1, v0
    v_lshl_add_u32 v0, s3, 6, v0
    s_branch KM_AGAIN
KM_FIN:
KM_END:
    s_endpgm
.section .rodata,"a"
.p2align 6
.amdhsa_kernel parallel_sum__grouped_kv_mqa__glu_gated_reglu__prompt_kernel
  .amdhsa_next_free_vgpr 256
  .amdhsa_next_free_sgpr 102
  .amdhsa_accum_offset 256
  .amdhsa_group_segment_fixed_size 0
  .amdhsa_kernarg_size 96
  .amdhsa_user_sgpr_count 2
  .amdhsa_user_sgpr_kernarg_segment_ptr 1
  .amdhsa_system_sgpr_workgroup_id_x 1
.end_amdhsa_kernel
```
